```python
import torch

def _softmax(x, axis=-1):
    return torch.softmax(x, dim=axis)
def _gelu(x):
    return torch.nn.functional.gelu(x, approximate="tanh")
def _silu(x):
    return torch.nn.functional.silu(x)
def _sigmoid(x):
    return torch.sigmoid(x)
def _layernorm(x, axis=-1, eps=1e-5):
    m = x.mean(dim=axis, keepdim=True)
    v = x.var(dim=axis, keepdim=True, unbiased=False)
    return (x - m) / torch.sqrt(v + eps)
def _scatter_add(tgt, idx, src, axis=0):
    return tgt.clone().index_add_(axis, idx, src)
def _segment_sum(src, seg, n):
    out = torch.zeros((n,) + src.shape[1:], dtype=src.dtype)
    return out.index_add_(0, seg, src)
def _pad(x, pw):
    flat = tuple(v for pair in reversed(pw) for v in pair)
    return torch.nn.functional.pad(x, flat)

kernel_name = 'interleave_layers__linear_kernel_hedgehog__mixer_s_mlp__prompt'

def setup_inputs():

    _w = (lambda a: (lambda t: t.to(torch.bfloat16) if t.is_floating_point() else t)(torch.as_tensor(a)))
    def _A_setup():
        B, S, D, H = 1, 2048, 640, 32
        Dh = D // H
        return {
            "x": _w((lambda *s: torch.randn(*s, dtype=torch.bfloat16) * 0.05)(B, S, D)),
            "wqkv": _w((lambda *s: torch.randn(*s, dtype=torch.bfloat16) * 0.4)(D, 3 * D)),
            "w_phi": _w((lambda *s: torch.randn(*s, dtype=torch.bfloat16) * 0.4)(H, Dh, Dh) * (Dh ** -0.5)),
            "wo": _w((lambda *s: torch.randn(*s, dtype=torch.bfloat16) * 0.05)(D, D)),
        }
    _A_in = _A_setup()

    def _B_setup():
        B, S, D, F = 1, 2048, 640, 1536
        return {
            "x":  _w((lambda *s: torch.randn(*s, dtype=torch.bfloat16) * 0.05)(B, S, D)),
            "w1": _w((lambda *s: torch.randn(*s, dtype=torch.bfloat16) * 3.2)(D, D) * (D ** -0.5)),
            "w2": _w((lambda *s: torch.randn(*s, dtype=torch.bfloat16) * 3.2)(D, D) * (D ** -0.5)),
            "w3": _w((lambda *s: torch.randn(*s, dtype=torch.bfloat16) * 3.2)(D, F) * (D ** -0.5)),
            "w4": _w((lambda *s: torch.randn(*s, dtype=torch.bfloat16) * 3.2)(F, D) * (F ** -0.5)),
        }
    _B_in = _B_setup()

    return {
        "A_x": _A_in["x"],
        "A_wqkv": _A_in["wqkv"],
        "A_w_phi": _A_in["w_phi"],
        "A_wo": _A_in["wo"],
        "B_x": _B_in["x"],
        "B_w1": _B_in["w1"],
        "B_w2": _B_in["w2"],
        "B_w3": _B_in["w3"],
        "B_w4": _B_in["w4"],
    }

def reference(A_x, A_wqkv, A_w_phi, A_wo, B_x, B_w1, B_w2, B_w3, B_w4):
    def _A_ref(x, wqkv, w_phi, wo):
        B, S, D = x.shape
        H = 32; Dh = D // H
        qkv = (lambda x, *d: x.permute(*d))((x @ wqkv).reshape(B, S, 3, H, Dh), 2, 0, 3, 1, 4)
        q, k, v = qkv[0], qkv[1], qkv[2]
        pq = torch.einsum("bhsd,hdf->bhsf", q, w_phi)
        pk = torch.einsum("bhsd,hdf->bhsf", k, w_phi)
        phi_q = torch.concatenate([_softmax(pq, axis=-1), _softmax(-pq, axis=-1)], axis=-1)
        phi_k = torch.concatenate([_softmax(pk, axis=-1), _softmax(-pk, axis=-1)], axis=-1)
        kv = torch.einsum("bhsf,bhsd->bhfd", phi_k, v)
        z  = torch.einsum("bhsf->bhf", phi_k)
        num = torch.einsum("bhqf,bhfd->bhqd", phi_q, kv)
        den = torch.einsum("bhqf,bhf->bhq", phi_q, z)[..., None] + 1e-6
        o = num / den
        return (lambda x, *d: x.permute(*d))(o, 0, 2, 1, 3).reshape(B, S, D) @ wo

    def _B_ref(x, w1, w2, w3, w4):
        B, S, D = x.shape
        h = _gelu(_layernorm(x, axis=-1) @ w1)
        c = D // 4
        g0 = _pad(h[:, :, 0*c:1*c], ((0, 0), (1, 0), (0, 0)))[:, :S, :]
        g1 = _pad(h[:, :, 1*c:2*c], ((0, 0), (0, 1), (0, 0)))[:, 1:, :]
        g2 = _pad(h[:, :, 2*c:3*c], ((0, 0), (2, 0), (0, 0)))[:, :S, :]
        g3 = _pad(h[:, :, 3*c:   ], ((0, 0), (0, 2), (0, 0)))[:, 2:, :]
        hs = torch.concatenate([g0, g1, g2, g3], axis=-1) @ w2
        x1 = x + hs
        h2 = _gelu(_layernorm(x1, axis=-1) @ w3) @ w4
        return x1 + h2

    x = A_x
    x = x + _A_ref(_layernorm(x, axis=-1), A_wqkv, A_w_phi, A_wo)
    x = x + _B_ref(_layernorm(x, axis=-1), B_w1, B_w2, B_w3, B_w4)
    x = x + _A_ref(_layernorm(x, axis=-1), A_wqkv, A_w_phi, A_wo)
    x = x + _B_ref(_layernorm(x, axis=-1), B_w1, B_w2, B_w3, B_w4)
    return x
```

```asm
; @launch grid=(256,1,1) block=(256,1,1) lds=163840
.amdgcn_target "amdgcn-amd-amdhsa--gfx950"
.text
.globl interleave_layers__linear_kernel_hedgehog__mixer_s_mlp__prompt_kernel
.p2align 8
.type interleave_layers__linear_kernel_hedgehog__mixer_s_mlp__prompt_kernel,@function
interleave_layers__linear_kernel_hedgehog__mixer_s_mlp__prompt_kernel:
L_main_begin:
  s_getpc_b64 s[96:97]
  s_cmp_ge_u32 s2, 256
  s_cbranch_scc1 L_main_exit
  s_load_dwordx2 s[4:5], s[0:1], 88
  s_load_dwordx16 s[44:59], s[0:1], 0
  s_load_dwordx4 s[60:63], s[0:1], 64
  v_lshlrev_b32 v25, 7, v0
  s_and_b32 s97, s97, 0xffff
  s_mov_b32 s98, L_main_end-L_main_begin-256
  s_mov_b32 s99, 0x00020000
  s_bfe_u32 s81, s2, 0x20003
  s_lshl_b32 s81, s81, 15
  s_and_b32 s81, s81, 98304
  buffer_load_dword a254, v25, s[96:99], s81 offen
  v_mov_b32 v33, v0
  v_lshrrev_b32 v32, 6, v0
  s_nop 0
  v_readfirstlane_b32 s14, v32
  v_and_b32 v0, 63, v0
  v_mov_b32 v34, 0x80000000
  s_lshr_b32 s84, s2, 3
  s_and_b32 s13, s84, 7
  s_lshr_b32 s84, s84, 3
  s_and_b32 s12, s2, 7
  s_lshl_b32 s12, s12, 2
  s_add_u32 s12, s12, s84
  v_lshlrev_b32 v1, 4, v0
  v_lshlrev_b32 v25, 7, v0
  s_lshl_b32 s15, s13, 2
  s_add_u32 s15, s15, s14
  s_lshl_b32 s84, s12, 2
  s_add_u32 s84, s84, s14
  s_mul_i32 s84, s84, 20480
  s_mul_i32 s85, s13, 160
  s_add_u32 s84, s84, s85
  v_and_b32 v35, 15, v0
  v_lshrrev_b32 v36, 4, v0
  v_mul_u32_u24 v35, 1280, v35
  v_mad_u32_u24 v35, v36, 40, v35
  v_add_u32 v255, s84, v35
  s_waitcnt lgkmcnt(0)
  s_and_b32 s5, s5, 0xffff
  s_mov_b32 s6, 268435456
  s_mov_b32 s7, 0x00020000
  s_mov_b32 s68, 9027584
  v_mov_b32 v248, 0
  buffer_load_dword v248, v248, s[4:7], s68 offen sc1
  s_and_b32 s17, s2, 7
  s_bfe_u32 s18, s2, 0x30003
  s_lshr_b32 s22, s2, 6
  s_cmp_ge_u32 s2, 192
  s_cbranch_scc1 L_ld_done
  s_mov_b32 s8, s46
  s_and_b32 s9, s47, 0xffff
  s_mov_b32 s10, 2457600
  s_mov_b32 s11, 0x00020000
  s_mov_b32 s16, 3840
  s_mul_i32 s19, s22, 1280
  s_add_u32 s19, s19, 1280
  s_cmp_eq_u32 s22, 2
  s_cselect_b32 s19, 0, s19
  s_mul_i32 s24, s17, 80
  s_mul_i32 s24, s24, s16
  s_mul_i32 s25, s18, 160
  s_add_u32 s24, s24, s25
  s_add_u32 s24, s24, s19
  s_lshl_b32 s25, s14, 10
  v_add_u32 v35, 0, v33
  v_mul_u32_u24 v36, 1639, v35
  v_lshrrev_b32 v36, 14, v36
  v_mul_u32_u24 v37, 10, v36
  v_sub_u32 v37, v35, v37
  v_mul_lo_u32 v36, v36, s16
  v_lshl_add_u32 v40, v37, 4, v36
  s_add_u32 m0, s25, 0
  s_nop 0
  buffer_load_dwordx4 v40, s[8:11], s24 offen lds
  v_add_u32 v35, 256, v33
  v_mul_u32_u24 v36, 1639, v35
  v_lshrrev_b32 v36, 14, v36
  v_mul_u32_u24 v37, 10, v36
  v_sub_u32 v37, v35, v37
  v_mul_lo_u32 v36, v36, s16
  v_lshl_add_u32 v41, v37, 4, v36
  s_add_u32 m0, s25, 4096
  s_nop 0
  buffer_load_dwordx4 v41, s[8:11], s24 offen lds
  v_add_u32 v35, 512, v33
  v_mul_u32_u24 v36, 1639, v35
  v_lshrrev_b32 v36, 14, v36
  v_mul_u32_u24 v37, 10, v36
  v_sub_u32 v37, v35, v37
  v_mul_lo_u32 v36, v36, s16
  v_lshl_add_u32 v42, v37, 4, v36
  s_add_u32 m0, s25, 8192
  s_nop 0
  buffer_load_dwordx4 v42, s[8:11], s24 offen lds
  v_add_u32 v35, 768, v33
  v_mul_u32_u24 v36, 1639, v35
  v_lshrrev_b32 v36, 14, v36
  v_mul_u32_u24 v37, 10, v36
  v_sub_u32 v37, v35, v37
  v_mul_lo_u32 v36, v36, s16
  v_lshl_add_u32 v43, v37, 4, v36
  v_cmp_gt_u32 vcc, 800, v35
  s_nop 1
  v_cndmask_b32 v43, v34, v43, vcc
  s_add_u32 m0, s25, 12288
  s_nop 0
  buffer_load_dwordx4 v43, s[8:11], s24 offen lds
L_ld_done:
  global_load_dwordx4 v[228:231], v255, s[44:45]
  global_load_dwordx4 v[232:235], v255, s[44:45] offset:16
  global_load_dwordx2 v[236:237], v255, s[44:45] offset:32
  s_mov_b64 s[60:61], s[48:49]
  s_mul_i32 s84, s15, 276480
  v_add_u32 v3, s84, v1
  s_mul_i32 s86, s12, 425984
  s_add_u32 s86, s86, 13631488
  s_lshr_b32 s84, s13, 1
  s_mul_i32 s84, s84, 5120
  s_and_b32 s85, s13, 1
  s_mul_i32 s75, s85, 2560
  s_add_u32 s75, s75, s84
  s_mul_i32 s85, s85, 3072
  s_add_u32 s84, s84, s85
  s_add_u32 s84, s84, s86
  s_add_u32 s50, s84, 80896
  s_add_u32 s51, s84, 183296
  s_mul_i32 s85, s14, 20480
  s_add_u32 s84, s84, s85
  s_sub_u32 s48, s84, 1024
  s_add_u32 s49, s84, 101376
  s_lshr_b32 s85, s14, 1
  s_mul_i32 s85, s85, 102400
  s_add_u32 s75, s75, s85
  s_and_b32 s85, s14, 1
  s_mul_i32 s85, s85, 1280
  s_add_u32 s75, s75, s85
  s_add_u32 s75, s75, s86
  s_add_u32 s75, s75, 81920
  s_lshl_b32 s84, s14, 3
  s_add_u32 s84, s84, s13
  s_mul_i32 s52, s84, 6144
  s_add_u32 s52, s52, s86
  s_add_u32 s52, s52, 204800
  s_add_u32 s53, s52, 4096
  s_lshl_b32 s84, s14, 7
  s_add_u32 s84, s84, s86
  s_lshl_b32 s85, s13, 9
  s_add_u32 s85, s85, s84
  s_add_u32 s54, s84, 401408
  s_add_u32 s57, s85, 401408
  s_add_u32 s55, s84, 405504
  s_add_u32 s58, s85, 405504
  s_add_u32 s56, s84, 409600
  s_add_u32 s59, s85, 409600
  s_mov_b32 s69, 1000000
  s_mov_b32 s71, 0
  s_mov_b32 s67, 0x07060302
  s_mov_b32 s3, 0x80000000
  s_getreg_b32 s74, hwreg(HW_REG_XCC_ID)
  s_and_b32 s74, s74, 15
  s_mov_b32 s76, 8978432
  s_lshl_b32 s77, s12, 3
  s_add_u32 s77, s77, s13
  s_lshl_b32 s77, s77, 6
  s_add_u32 s77, s77, 8978432
  v_and_b32 v116, 15, v0
  v_lshrrev_b32 v117, 4, v0
  v_mov_b32 v118, 0x80000000
  v_lshlrev_b32 v120, 3, v116
  v_lshl_add_u32 v15, v117, 10, v120
  v_lshl_add_u32 v120, v117, 2, v120
  v_cmp_gt_u32 vcc, 2, v117
  s_nop 1
  v_cndmask_b32 v26, v118, v120, vcc
  v_mov_b32 v20, 0
  v_mov_b32 v22, -1
  v_mov_b32 v21, 0
  s_movk_i32 s84, 3072
  s_bitcmp1_b32 s13, 0
  s_cselect_b32 s84, 512, s84
  v_add_u32 v119, s84, v1
  v_cmp_gt_u32 vcc, 32, v0
  s_nop 1
  v_cndmask_b32 v254, v118, v119, vcc
  v_and_b32 v119, 3, v0
  v_cmp_eq_u32 vcc, 0, v119
  s_nop 1
  v_cndmask_b32 v14, 0, 1, vcc
  s_mul_i32 s84, s15, 65536
  s_add_u32 s84, s84, 9437184
  s_lshl_b32 s85, s12, 11
  s_add_u32 s62, s84, s85
  s_lshl_b32 s85, s12, 6
  s_add_u32 s65, s84, s85
  s_add_u32 s66, s65, 32768
  s_lshl_b32 s64, s15, 12
  s_add_u32 s64, s64, 9043968
  s_lshl_b32 s85, s12, 7
  s_add_u32 s63, s64, s85
  s_mov_b32 s8, s60
  s_and_b32 s9, s61, 0xffff
  s_mov_b32 s10, 25600
  s_mov_b32 s11, 0x00020000
  s_mul_i32 s84, s15, 800
  v_add_u32 v35, 0, v0
  v_mul_u32_u24 v36, 171, v35
  v_lshrrev_b32 v36, 11, v36
  v_mul_u32_u24 v37, 12, v36
  v_sub_u32 v37, v35, v37
  v_cmp_gt_u32 vcc, 10, v37
  v_mul_u32_u24 v37, 80, v37
  v_lshl_add_u32 v37, v36, 1, v37
  v_cndmask_b32 v156, v34, v37, vcc
  buffer_load_ushort v148, v156, s[8:11], s84 offen
  buffer_load_ushort v149, v156, s[8:11], s84 offen offset:40
  v_add_u32 v35, 64, v0
  v_mul_u32_u24 v36, 171, v35
  v_lshrrev_b32 v36, 11, v36
  v_mul_u32_u24 v37, 12, v36
  v_sub_u32 v37, v35, v37
  v_cmp_gt_u32 vcc, 10, v37
  v_mul_u32_u24 v37, 80, v37
  v_lshl_add_u32 v37, v36, 1, v37
  v_cndmask_b32 v157, v34, v37, vcc
  buffer_load_ushort v150, v157, s[8:11], s84 offen
  buffer_load_ushort v151, v157, s[8:11], s84 offen offset:40
  v_add_u32 v35, 128, v0
  v_mul_u32_u24 v36, 171, v35
  v_lshrrev_b32 v36, 11, v36
  v_mul_u32_u24 v37, 12, v36
  v_sub_u32 v37, v35, v37
  v_cmp_gt_u32 vcc, 10, v37
  v_mul_u32_u24 v37, 80, v37
  v_lshl_add_u32 v37, v36, 1, v37
  v_cndmask_b32 v158, v34, v37, vcc
  buffer_load_ushort v152, v158, s[8:11], s84 offen
  buffer_load_ushort v153, v158, s[8:11], s84 offen offset:40
  v_add_u32 v35, 192, v0
  v_mul_u32_u24 v36, 171, v35
  v_lshrrev_b32 v36, 11, v36
  v_mul_u32_u24 v37, 12, v36
  v_sub_u32 v37, v35, v37
  v_cmp_gt_u32 vcc, 10, v37
  v_mul_u32_u24 v37, 80, v37
  v_lshl_add_u32 v37, v36, 1, v37
  v_cndmask_b32 v159, v34, v37, vcc
  buffer_load_ushort v154, v159, s[8:11], s84 offen
  buffer_load_ushort v155, v159, s[8:11], s84 offen offset:40
  s_and_b32 s17, s2, 7
  s_bfe_u32 s18, s2, 0x30003
  s_lshr_b32 s22, s2, 6
  s_lshl_b32 s23, s22, 3
  s_add_u32 s23, s23, 32
  s_cmp_eq_u32 s22, 0
  s_cselect_b32 s23, 24, s23
  s_load_dwordx2 s[40:41], s[0:1], s23
  s_load_dwordx2 s[42:43], s[0:1], 64
  s_mov_b32 s19, 0
  s_waitcnt lgkmcnt(0)
  s_cmp_ge_u32 s2, 192
  s_cbranch_scc1 L_ld2_w3
  s_mov_b32 s8, s40
  s_and_b32 s9, s41, 0xffff
  s_mov_b32 s10, 819200
  s_mov_b32 s11, 0x00020000
  s_mov_b32 s16, 1280
  s_mul_i32 s24, s17, 80
  s_mul_i32 s24, s24, s16
  s_mul_i32 s25, s18, 160
  s_add_u32 s24, s24, s25
  s_add_u32 s24, s24, s19
  s_lshl_b32 s25, s14, 10
  v_add_u32 v35, 0, v33
  v_mul_u32_u24 v36, 1639, v35
  v_lshrrev_b32 v36, 14, v36
  v_mul_u32_u24 v37, 10, v36
  v_sub_u32 v37, v35, v37
  v_mul_lo_u32 v36, v36, s16
  v_lshl_add_u32 v40, v37, 4, v36
  s_add_u32 m0, s25, 16384
  s_nop 0
  buffer_load_dwordx4 v40, s[8:11], s24 offen lds
  v_add_u32 v35, 256, v33
  v_mul_u32_u24 v36, 1639, v35
  v_lshrrev_b32 v36, 14, v36
  v_mul_u32_u24 v37, 10, v36
  v_sub_u32 v37, v35, v37
  v_mul_lo_u32 v36, v36, s16
  v_lshl_add_u32 v41, v37, 4, v36
  s_add_u32 m0, s25, 20480
  s_nop 0
  buffer_load_dwordx4 v41, s[8:11], s24 offen lds
  v_add_u32 v35, 512, v33
  v_mul_u32_u24 v36, 1639, v35
  v_lshrrev_b32 v36, 14, v36
  v_mul_u32_u24 v37, 10, v36
  v_sub_u32 v37, v35, v37
  v_mul_lo_u32 v36, v36, s16
  v_lshl_add_u32 v42, v37, 4, v36
  s_add_u32 m0, s25, 24576
  s_nop 0
  buffer_load_dwordx4 v42, s[8:11], s24 offen lds
  v_add_u32 v35, 768, v33
  v_mul_u32_u24 v36, 1639, v35
  v_lshrrev_b32 v36, 14, v36
  v_mul_u32_u24 v37, 10, v36
  v_sub_u32 v37, v35, v37
  v_mul_lo_u32 v36, v36, s16
  v_lshl_add_u32 v43, v37, 4, v36
  v_cmp_gt_u32 vcc, 800, v35
  s_nop 1
  v_cndmask_b32 v43, v34, v43, vcc
  s_add_u32 m0, s25, 28672
  s_nop 0
  buffer_load_dwordx4 v43, s[8:11], s24 offen lds
  s_mov_b32 s8, s42
  s_and_b32 s9, s43, 0xffff
  s_mov_b32 s10, 1966080
  s_mov_b32 s11, 0x00020000
  s_mul_i32 s24, s17, 192
  s_lshl_b32 s25, s22, 4
  s_add_u32 s24, s24, s25
  s_mul_i32 s24, s24, s16
  s_mul_i32 s25, s18, 160
  s_add_u32 s24, s24, s25
  s_add_u32 s24, s24, s19
  s_lshl_b32 s25, s14, 10
  v_add_u32 v35, 0, v33
  v_mul_u32_u24 v36, 1639, v35
  v_lshrrev_b32 v36, 14, v36
  v_mul_u32_u24 v37, 10, v36
  v_sub_u32 v37, v35, v37
  v_lshrrev_b32 v38, 4, v36
  v_lshl_add_u32 v36, v38, 5, v36
  v_mul_lo_u32 v36, v36, s16
  v_lshl_add_u32 v40, v37, 4, v36
  s_add_u32 m0, s25, 32768
  s_nop 0
  buffer_load_dwordx4 v40, s[8:11], s24 offen lds
  v_add_u32 v35, 256, v33
  v_mul_u32_u24 v36, 1639, v35
  v_lshrrev_b32 v36, 14, v36
  v_mul_u32_u24 v37, 10, v36
  v_sub_u32 v37, v35, v37
  v_lshrrev_b32 v38, 4, v36
  v_lshl_add_u32 v36, v38, 5, v36
  v_mul_lo_u32 v36, v36, s16
  v_lshl_add_u32 v41, v37, 4, v36
  s_add_u32 m0, s25, 36864
  s_nop 0
  buffer_load_dwordx4 v41, s[8:11], s24 offen lds
  v_add_u32 v35, 512, v33
  v_mul_u32_u24 v36, 1639, v35
  v_lshrrev_b32 v36, 14, v36
  v_mul_u32_u24 v37, 10, v36
  v_sub_u32 v37, v35, v37
  v_lshrrev_b32 v38, 4, v36
  v_lshl_add_u32 v36, v38, 5, v36
  v_mul_lo_u32 v36, v36, s16
  v_lshl_add_u32 v42, v37, 4, v36
  v_cmp_gt_u32 vcc, 640, v35
  s_nop 1
  v_cndmask_b32 v42, v34, v42, vcc
  s_add_u32 m0, s25, 40960
  s_nop 0
  buffer_load_dwordx4 v42, s[8:11], s24 offen lds
  s_branch L_ld2_done
L_ld2_w3:
  s_mov_b32 s8, s40
  s_and_b32 s9, s41, 0xffff
  s_mov_b32 s10, 1966080
  s_mov_b32 s11, 0x00020000
  s_mov_b32 s16, 3072
  s_mul_i32 s24, s17, 80
  s_mul_i32 s24, s24, s16
  s_mul_i32 s25, s18, 384
  s_add_u32 s24, s24, s25
  s_add_u32 s24, s24, s19
  s_lshl_b32 s25, s14, 10
  v_add_u32 v35, 0, v33
  v_mul_u32_u24 v36, 683, v35
  v_lshrrev_b32 v36, 14, v36
  v_mul_u32_u24 v37, 24, v36
  v_sub_u32 v37, v35, v37
  v_mul_lo_u32 v36, v36, s16
  v_lshl_add_u32 v40, v37, 4, v36
  s_add_u32 m0, s25, 16384
  s_nop 0
  buffer_load_dwordx4 v40, s[8:11], s24 offen lds
  v_add_u32 v35, 256, v33
  v_mul_u32_u24 v36, 683, v35
  v_lshrrev_b32 v36, 14, v36
  v_mul_u32_u24 v37, 24, v36
  v_sub_u32 v37, v35, v37
  v_mul_lo_u32 v36, v36, s16
  v_lshl_add_u32 v41, v37, 4, v36
  s_add_u32 m0, s25, 20480
  s_nop 0
  buffer_load_dwordx4 v41, s[8:11], s24 offen lds
  v_add_u32 v35, 512, v33
  v_mul_u32_u24 v36, 683, v35
  v_lshrrev_b32 v36, 14, v36
  v_mul_u32_u24 v37, 24, v36
  v_sub_u32 v37, v35, v37
  v_mul_lo_u32 v36, v36, s16
  v_lshl_add_u32 v42, v37, 4, v36
  s_add_u32 m0, s25, 24576
  s_nop 0
  buffer_load_dwordx4 v42, s[8:11], s24 offen lds
  v_add_u32 v35, 768, v33
  v_mul_u32_u24 v36, 683, v35
  v_lshrrev_b32 v36, 14, v36
  v_mul_u32_u24 v37, 24, v36
  v_sub_u32 v37, v35, v37
  v_mul_lo_u32 v36, v36, s16
  v_lshl_add_u32 v43, v37, 4, v36
  s_add_u32 m0, s25, 28672
  s_nop 0
  buffer_load_dwordx4 v43, s[8:11], s24 offen lds
  v_add_u32 v35, 1024, v33
  v_mul_u32_u24 v36, 683, v35
  v_lshrrev_b32 v36, 14, v36
  v_mul_u32_u24 v37, 24, v36
  v_sub_u32 v37, v35, v37
  v_mul_lo_u32 v36, v36, s16
  v_lshl_add_u32 v44, v37, 4, v36
  s_add_u32 m0, s25, 32768
  s_nop 0
  buffer_load_dwordx4 v44, s[8:11], s24 offen lds
  v_add_u32 v35, 1280, v33
  v_mul_u32_u24 v36, 683, v35
  v_lshrrev_b32 v36, 14, v36
  v_mul_u32_u24 v37, 24, v36
  v_sub_u32 v37, v35, v37
  v_mul_lo_u32 v36, v36, s16
  v_lshl_add_u32 v45, v37, 4, v36
  s_add_u32 m0, s25, 36864
  s_nop 0
  buffer_load_dwordx4 v45, s[8:11], s24 offen lds
  v_add_u32 v35, 1536, v33
  v_mul_u32_u24 v36, 683, v35
  v_lshrrev_b32 v36, 14, v36
  v_mul_u32_u24 v37, 24, v36
  v_sub_u32 v37, v35, v37
  v_mul_lo_u32 v36, v36, s16
  v_lshl_add_u32 v46, v37, 4, v36
  s_add_u32 m0, s25, 40960
  s_nop 0
  buffer_load_dwordx4 v46, s[8:11], s24 offen lds
  v_add_u32 v35, 1792, v33
  v_mul_u32_u24 v36, 683, v35
  v_lshrrev_b32 v36, 14, v36
  v_mul_u32_u24 v37, 24, v36
  v_sub_u32 v37, v35, v37
  v_mul_lo_u32 v36, v36, s16
  v_lshl_add_u32 v47, v37, 4, v36
  v_cmp_gt_u32 vcc, 1920, v35
  s_nop 1
  v_cndmask_b32 v47, v34, v47, vcc
  s_add_u32 m0, s25, 45056
  s_nop 0
  buffer_load_dwordx4 v47, s[8:11], s24 offen lds
L_ld2_done:
  s_waitcnt vmcnt(7)
  v_readfirstlane_b32 s68, v248
  s_nop 0
  s_mul_i32 s68, s68, 0x9e3779b1
  s_add_u32 s68, s68, 0x7f4a7c15
  s_barrier
  s_mov_b32 s23, 0
  s_mov_b32 s21, 0
  s_cmp_ge_u32 s2, 192
  s_cbranch_scc1 L_st_done
  s_mul_i32 s20, s22, 25
  s_lshr_b32 s21, s2, 3
  s_mul_i32 s21, s21, 384
  s_mov_b32 s23, 24
  v_lshrrev_b32 v35, 4, v0
  v_bfe_u32 v36, v0, 2, 2
  v_and_b32 v37, 3, v0
  v_mul_u32_u24 v37, 40, v37
  v_mad_u32_u24 v38, v35, 20, v36
  v_mul_u32_u24 v38, 160, v38
  v_add_u32 v38, v38, v37
  v_and_b32 v39, 1, v35
  v_mad_u32_u24 v39, v39, 20, v36
  v_mul_u32_u24 v39, 160, v39
  v_add_u32 v39, v39, v37
  v_cmp_gt_u32 vcc, 32, v0
  s_nop 1
  v_cndmask_b32 v52, v34, v1, vcc
  v_mov_b32 v53, 0x3f803f80
  v_cndmask_b32 v60, 0, v53, vcc
  v_mov_b32 v56, v53
  v_mov_b32 v57, v53
  v_mov_b32 v58, v53
  v_mov_b32 v59, v53
  v_mov_b32 v61, v60
  v_mov_b32 v62, v60
  v_mov_b32 v63, v60
  v_mul_u32_u24 v54, 80, v35
  s_and_b32 s26, s17, 1
  s_lshr_b32 s27, s17, 1
  s_add_u32 s28, s14, 0
  s_mov_b32 s34, s28
  s_lshl_b32 s29, s34, 3
  s_mov_b32 s32, s18
  s_mul_i32 s33, s34, 5
  v_add_u32 v50, s29, v38
  v_add_u32 v51, s29, v39
  ds_read_b64_tr_b16 v[64:65], v50 offset:0
  ds_read_b64_tr_b16 v[66:67], v50 offset:640
  ds_read_b64_tr_b16 v[68:69], v50 offset:1280
  ds_read_b64_tr_b16 v[70:71], v50 offset:1920
  ds_read_b64_tr_b16 v[72:73], v51 offset:2560
  ds_read_b64_tr_b16 v[74:75], v51 offset:8960
  s_lshl_b32 s36, s32, 2
  s_add_u32 s36, s36, s27
  s_mul_i32 s36, s36, 270
  s_add_u32 s36, s36, s20
  s_add_u32 s36, s36, s33
  s_lshl_b32 s36, s36, 10
  s_mul_i32 s37, s26, 3072
  s_add_u32 s37, s37, s36
  s_lshl_b32 s38, s26, 9
  s_add_u32 s38, s38, s36
  s_waitcnt lgkmcnt(4)
  buffer_store_dwordx4 v[64:67], v1, s[4:7], s37 offen sc1
  s_waitcnt lgkmcnt(2)
  buffer_store_dwordx4 v[68:71], v1, s[4:7], s37 offen offset:1024 sc1
  s_waitcnt lgkmcnt(0)
  buffer_store_dwordx4 v[72:75], v52, s[4:7], s38 offen offset:2048 sc1
  v_mfma_f32_16x16x32_bf16 v[76:79], v[64:67], v[56:59], 0
  v_mfma_f32_16x16x32_bf16 v[76:79], v[68:71], v[56:59], v[76:79]
  v_mfma_f32_16x16x32_bf16 v[76:79], v[72:75], v[60:63], v[76:79]
  s_lshl_b32 s39, s29, 1
  v_add_u32 v48, s39, v54
  s_nop 5
  ds_write_b128 v48, v[76:79] offset:49152
  s_add_u32 s28, s14, 4
  s_cmp_ge_u32 s28, 5
  s_cbranch_scc1 L_tile_end_a
  s_mov_b32 s34, s28
  s_lshl_b32 s29, s34, 3
  s_mov_b32 s32, s18
  s_mul_i32 s33, s34, 5
  v_add_u32 v50, s29, v38
  v_add_u32 v51, s29, v39
  ds_read_b64_tr_b16 v[80:81], v50 offset:0
  ds_read_b64_tr_b16 v[82:83], v50 offset:640
  ds_read_b64_tr_b16 v[84:85], v50 offset:1280
  ds_read_b64_tr_b16 v[86:87], v50 offset:1920
  ds_read_b64_tr_b16 v[88:89], v51 offset:2560
  ds_read_b64_tr_b16 v[90:91], v51 offset:8960
  s_lshl_b32 s36, s32, 2
  s_add_u32 s36, s36, s27
  s_mul_i32 s36, s36, 270
  s_add_u32 s36, s36, s20
  s_add_u32 s36, s36, s33
  s_lshl_b32 s36, s36, 10
  s_mul_i32 s37, s26, 3072
  s_add_u32 s37, s37, s36
  s_lshl_b32 s38, s26, 9
  s_add_u32 s38, s38, s36
  s_waitcnt lgkmcnt(4)
  buffer_store_dwordx4 v[80:83], v1, s[4:7], s37 offen sc1
  s_waitcnt lgkmcnt(2)
  buffer_store_dwordx4 v[84:87], v1, s[4:7], s37 offen offset:1024 sc1
  s_waitcnt lgkmcnt(0)
  buffer_store_dwordx4 v[88:91], v52, s[4:7], s38 offen offset:2048 sc1
  v_mfma_f32_16x16x32_bf16 v[92:95], v[80:83], v[56:59], 0
  v_mfma_f32_16x16x32_bf16 v[92:95], v[84:87], v[56:59], v[92:95]
  v_mfma_f32_16x16x32_bf16 v[92:95], v[88:91], v[60:63], v[92:95]
  s_lshl_b32 s39, s29, 1
  v_add_u32 v48, s39, v54
  s_nop 5
  ds_write_b128 v48, v[92:95] offset:49152
L_tile_end_a:
  s_nop 7
L_st_done:
  s_waitcnt lgkmcnt(0)
  s_barrier
  s_cmp_eq_u32 s14, 2
  s_cselect_b32 s23, s23, 0
  ds_read_b128 v[64:67], v1 offset:49152
  v_cmp_gt_u32 vcc, s23, v0
  s_mul_i32 s39, s17, 18432
  s_add_u32 s39, s39, s21
  s_add_u32 s39, s39, 9207808
  v_cndmask_b32 v48, v34, v1, vcc
  s_waitcnt lgkmcnt(0)
  buffer_store_dwordx4 v[64:67], v48, s[4:7], s39 offen sc1
  s_nop 1
  v_lshlrev_b32 v224, 16, v236
  v_and_b32 v225, 0xffff0000, v236
  v_permlane32_swap_b32 v236, v238
  v_lshlrev_b32 v226, 16, v237
  v_and_b32 v227, 0xffff0000, v237
  v_lshlrev_b32 v208, 16, v228
  v_and_b32 v209, 0xffff0000, v228
  v_lshlrev_b32 v216, 16, v232
  v_and_b32 v217, 0xffff0000, v232
  v_permlane32_swap_b32 v237, v239
  v_bitop3_b32 v236, v236, v14, v14 bitop3:0x30
  buffer_store_dwordx4 v[236:239], v254, s[4:7], s48 offen sc1
  v_bitop3_b32 v228, v228, v14, v14 bitop3:0x30
  v_bitop3_b32 v232, v232, v14, v14 bitop3:0x30
  s_xor_b32 s87, s14, 1
  s_mul_i32 s85, s87, 15360
  s_add_u32 s85, s85, 0
  v_add_u32 v4, s85, v1
  s_xor_b32 s88, s14, 3
  s_mul_i32 s85, s88, 15360
  s_add_u32 s85, s85, 5120
  v_add_u32 v5, s85, v1
  s_xor_b32 s89, s14, 2
  s_lshl_b32 s84, s14, 11
  s_mul_i32 s85, s89, 15360
  v_add_u32 v2, s84, v25
  s_add_u32 s85, s85, 10240
  s_bitcmp1_b32 s14, 0
  s_cselect_b32 s83, 1, -1
  v_add_u32 v6, s85, v1
  buffer_store_dwordx4 v[228:231], v1, s[4:7], s48 offen offset:1024 sc1
  s_lshr_b32 s84, s14, 1
  s_lshl_b32 s85, s12, 6
  s_lshl_b32 s83, s83, s84
  v_and_b32 v120, 15, v0
  s_add_u32 s83, s83, s85
  s_lshl_b32 s84, s87, 4
  s_add_u32 s84, s84, s83
  v_mov_b32 v122, 0x80000000
  v_cmp_gt_u32 vcc, 16, v0
  v_add_u32 v123, s84, v120
  v_lshrrev_b32 v125, 6, v123
  v_cndmask_b32 v2, v122, v2, vcc
  v_bfe_u32 v124, v123, 4, 2
  v_cmp_eq_u32 vcc, s12, v125
  v_lshrrev_b32 v121, 4, v0
  s_mov_b32 s85, 425984
  buffer_store_dwordx4 v[232:235], v1, s[4:7], s48 offen offset:2048 sc1
  v_cndmask_b32 v124, 4, v124, vcc
  v_cmp_gt_u32 vcc, 2048, v123
  v_and_b32 v123, 15, v123
  v_mul_u32_u24 v124, 20480, v124
  v_lshl_add_u32 v123, v121, 4, v123
  v_mul_lo_u32 v125, v125, s85
  v_lshl_add_u32 v123, v123, 4, v124
  v_add_u32 v123, v123, v125
  s_lshl_b32 s84, s88, 4
  v_cndmask_b32 v16, v122, v123, vcc
  s_add_u32 s84, s84, s83
  v_add_u32 v123, s84, v120
  v_lshrrev_b32 v125, 6, v123
  v_bfe_u32 v124, v123, 4, 2
  v_cmp_eq_u32 vcc, s12, v125
  v_lshlrev_b32 v210, 16, v229
  v_and_b32 v211, 0xffff0000, v229
  v_lshlrev_b32 v212, 16, v230
  v_and_b32 v213, 0xffff0000, v230
  v_cndmask_b32 v124, 4, v124, vcc
  v_pk_add_f32 v[116:117], v[208:209], v[210:211]
  v_pk_mul_f32 v[118:119], v[208:209], v[208:209]
  v_pk_fma_f32 v[118:119], v[210:211], v[210:211], v[118:119]
  v_pk_add_f32 v[116:117], v[116:117], v[212:213]
  v_pk_fma_f32 v[118:119], v[212:213], v[212:213], v[118:119]
  v_cmp_gt_u32 vcc, 2048, v123
  v_and_b32 v123, 15, v123
  v_mul_u32_u24 v124, 20480, v124
  v_lshl_add_u32 v123, v121, 4, v123
  v_mul_lo_u32 v125, v125, s85
  v_lshl_add_u32 v123, v123, 4, v124
  v_add_u32 v123, v123, v125
  v_lshlrev_b32 v214, 16, v231
  v_and_b32 v215, 0xffff0000, v231
  v_lshlrev_b32 v218, 16, v233
  v_and_b32 v219, 0xffff0000, v233
  s_lshl_b32 s84, s89, 4
  v_cndmask_b32 v17, v122, v123, vcc
  v_pk_add_f32 v[116:117], v[116:117], v[214:215]
  v_pk_fma_f32 v[118:119], v[214:215], v[214:215], v[118:119]
  v_pk_add_f32 v[116:117], v[116:117], v[216:217]
  v_pk_fma_f32 v[118:119], v[216:217], v[216:217], v[118:119]
  v_pk_add_f32 v[116:117], v[116:117], v[218:219]
  s_add_u32 s84, s84, s83
  v_add_u32 v123, s84, v120
  v_lshrrev_b32 v125, 6, v123
  v_bfe_u32 v124, v123, 4, 2
  v_cmp_eq_u32 vcc, s12, v125
  v_lshlrev_b32 v220, 16, v234
  v_and_b32 v221, 0xffff0000, v234
  v_cndmask_b32 v124, 4, v124, vcc
  v_cmp_gt_u32 vcc, 2048, v123
  v_lshlrev_b32 v222, 16, v235
  v_and_b32 v223, 0xffff0000, v235
  v_and_b32 v123, 15, v123
  v_pk_fma_f32 v[118:119], v[218:219], v[218:219], v[118:119]
  v_pk_add_f32 v[116:117], v[116:117], v[220:221]
  v_pk_fma_f32 v[118:119], v[220:221], v[220:221], v[118:119]
  v_pk_add_f32 v[116:117], v[116:117], v[222:223]
  v_pk_fma_f32 v[118:119], v[222:223], v[222:223], v[118:119]
  v_mul_u32_u24 v124, 20480, v124
  v_lshl_add_u32 v123, v121, 4, v123
  v_mul_lo_u32 v125, v125, s85
  v_lshl_add_u32 v123, v123, 4, v124
  v_add_u32 v123, v123, v125
  s_xor_b32 s90, s14, 0
  v_cndmask_b32 v18, v122, v123, vcc
  s_lshl_b32 s84, s90, 4
  s_add_u32 s84, s84, s83
  v_add_u32 v123, s84, v120
  v_lshrrev_b32 v125, 6, v123
  v_pk_add_f32 v[116:117], v[116:117], v[224:225]
  v_pk_fma_f32 v[118:119], v[224:225], v[224:225], v[118:119]
  v_pk_add_f32 v[116:117], v[116:117], v[226:227]
  v_pk_fma_f32 v[118:119], v[226:227], v[226:227], v[118:119]
  v_bfe_u32 v124, v123, 4, 2
  v_cmp_eq_u32 vcc, s12, v125
  v_add_f32 v116, v116, v117
  v_add_f32 v118, v118, v119
  v_cndmask_b32 v124, 4, v124, vcc
  v_cmp_gt_u32 vcc, 2048, v123
  v_and_b32 v123, 15, v123
  v_mul_u32_u24 v124, 20480, v124
  v_lshl_add_u32 v123, v121, 4, v123
  v_mul_lo_u32 v125, v125, s85
  v_lshl_add_u32 v123, v123, 4, v124
  v_permlane16_swap_b32 v116, v118
  v_add_u32 v123, v123, v125
  s_bitcmp1_b32 s13, 1
  s_cselect_b32 s84, 0, 62
  s_lshl_b32 s85, s14, 4
  v_cndmask_b32 v19, v122, v123, vcc
  s_sub_u32 s84, s85, s84
  v_add_f32 v116, v116, v118
  v_add_u32 v123, s84, v120
  v_mov_b32 v117, v116
  v_cmp_gt_u32 vcc, 2, v123
  v_lshrrev_b32 v124, 2, v120
  v_permlane32_swap_b32 v116, v117
  v_cndmask_b32 v24, v122, v1, vcc
  v_cndmask_b32 v23, v122, v254, vcc
  s_cmp_eq_u64 vcc, 0
  s_cselect_b32 s73, 1, 0
  v_cmp_eq_u32 vcc, v124, v121
  v_lshrrev_b32 v125, 5, v0
  v_and_b32 v123, 3, v0
  v_add_f32 v116, v116, v117
  v_mul_u32_u24 v124, 960, v121
  v_lshlrev_b32 v126, 4, v125
  v_and_b32 v116, -2, v116
  buffer_store_dword v116, v26, s[4:7], s57 offen sc1
  v_mad_u32_u24 v124, v123, 48, v124
  v_add_u32 v126, 112656, v126
  v_add_u32 v124, 98304, v124
  v_cndmask_b32 v8, v126, v124, vcc
  v_mul_u32_u24 v124, 80, v123
  v_mul_u32_u24 v126, 2080, v121
  v_add_u32 v124, v124, v126
  v_lshlrev_b32 v126, 6, v125
  v_add_u32 v124, 104192, v124
  v_add_u32 v126, 112688, v126
  s_mul_i32 s84, s14, 15360
  v_cndmask_b32 v9, v126, v124, vcc
  v_add_u32 v7, s84, v1
  v_lshl_add_u32 v124, v121, 6, v120
  s_lshl_b32 s84, s14, 4
  v_add_u32 v124, s84, v124
  v_mul_u32_u24 v124, 144, v124
  v_add_u32 v10, 61440, v124
  v_lshrrev_b32 v124, 2, v120
  v_lshl_add_u32 v124, v121, 3, v124
  s_lshl_b32 s84, s14, 6
  v_add_u32 v124, s84, v124
  s_lshl_b32 s84, s14, 9
  v_lshl_add_u32 v125, v0, 3, s84
  s_lshl_b32 s85, s14, 30
  s_lshl_b32 s84, s2, 6
  s_or_b32 s84, s84, s85
  v_mov_b32 v240, s68
  v_mov_b32 v242, s84
  v_mul_u32_u24 v124, 144, v124
  v_lshl_add_u32 v124, v123, 3, v124
  v_add_u32 v11, 61440, v124
  v_mul_u32_u24 v124, 80, v121
  v_mov_b32 v244, 0
  v_mov_b32 v245, 0
  v_add_u32 v125, 112640, v125
  v_add_u32 v12, 102144, v124
  ds_write_b64 v125, v[244:245]
  v_mul_u32_u24 v124, 192, v121
  s_mul_i32 s84, s14, 960
  v_add_u32 v13, 103424, v124
  s_add_u32 s84, s84, 98304
  v_mov_b32 v125, 103424
  v_lshl_add_u32 v124, v0, 2, s84
  s_lshl_b32 s84, s14, 1
  s_mul_i32 s100, s14, 5120
  s_add_u32 s100, s100, s86
  v_and_b32 v244, 31, v0
  v_mov_b32 v120, s68
  v_mov_b32 v121, s74
  s_mov_b32 s78, 0x3fb8aa3b
  v_lshlrev_b32 v127, 15, v14
  s_mul_i32 s83, s14, 2080
  s_add_u32 s83, s83, 104192
  s_mul_i32 s91, s14, 12288
  s_mul_i32 s72, s14, 9216
  s_mov_b32 s79, 0xc0135761
  s_mov_b32 s80, 0xbdd2d3e8
  s_add_u32 s91, s91, 114688
  s_add_u32 s72, s72, 61440
  s_mul_i32 s46, s14, 12288
  s_mul_i32 s45, s90, 49152
  s_add_u32 s45, s45, s46
  s_add_u32 s45, s45, s86
  s_add_u32 s45, s45, 204800
  s_add_u32 s46, s45, 4096
  s_add_u32 s47, s45, 8192
  s_add_u32 s101, s100, 102400
  s_waitcnt vmcnt(0)
  s_barrier
  buffer_store_dword v240, v242, s[4:7], s76 offen sc1
  s_waitcnt lgkmcnt(0)
  s_and_b32 s17, s2, 7
  s_bfe_u32 s18, s2, 0x30003
  s_lshr_b32 s22, s2, 6
  s_cmp_ge_u32 s2, 192
  s_cbranch_scc1 L_st2_w3
  s_mul_i32 s20, s22, 25
  s_add_u32 s20, s20, 75
  s_mul_i32 s21, s18, 384
  s_add_u32 s21, s21, 9216
  s_cmp_eq_u32 s22, 1
  s_cselect_b32 s23, 24, 0
  v_lshrrev_b32 v35, 4, v0
  v_bfe_u32 v36, v0, 2, 2
  v_and_b32 v37, 3, v0
  v_mul_u32_u24 v37, 40, v37
  v_mad_u32_u24 v38, v35, 20, v36
  v_mul_u32_u24 v38, 160, v38
  v_add_u32 v38, v38, v37
  v_and_b32 v39, 1, v35
  v_mad_u32_u24 v39, v39, 20, v36
  v_mul_u32_u24 v39, 160, v39
  v_add_u32 v39, v39, v37
  v_cmp_gt_u32 vcc, 32, v0
  s_nop 1
  v_cndmask_b32 v52, v34, v1, vcc
  v_mov_b32 v53, 0x3f803f80
  v_cndmask_b32 v60, 0, v53, vcc
  v_mov_b32 v56, v53
  v_mov_b32 v57, v53
  v_mov_b32 v58, v53
  v_mov_b32 v59, v53
  v_mov_b32 v61, v60
  v_mov_b32 v62, v60
  v_mov_b32 v63, v60
  v_mul_u32_u24 v54, 80, v35
  s_and_b32 s26, s17, 1
  s_lshr_b32 s27, s17, 1
  s_add_u32 s28, s14, 0
  s_mov_b32 s34, s28
  s_lshl_b32 s29, s34, 3
  s_mov_b32 s32, s18
  s_mul_i32 s33, s34, 5
  v_add_u32 v50, s29, v38
  v_add_u32 v51, s29, v39
  ds_read_b64_tr_b16 v[64:65], v50 offset:16384
  ds_read_b64_tr_b16 v[66:67], v50 offset:17024
  ds_read_b64_tr_b16 v[68:69], v50 offset:17664
  ds_read_b64_tr_b16 v[70:71], v50 offset:18304
  ds_read_b64_tr_b16 v[72:73], v51 offset:18944
  ds_read_b64_tr_b16 v[74:75], v51 offset:25344
  s_lshl_b32 s36, s32, 2
  s_add_u32 s36, s36, s27
  s_mul_i32 s36, s36, 270
  s_add_u32 s36, s36, s20
  s_add_u32 s36, s36, s33
  s_lshl_b32 s36, s36, 10
  s_mul_i32 s37, s26, 3072
  s_add_u32 s37, s37, s36
  s_lshl_b32 s38, s26, 9
  s_add_u32 s38, s38, s36
  s_waitcnt lgkmcnt(4)
  buffer_store_dwordx4 v[64:67], v1, s[4:7], s37 offen sc1
  s_waitcnt lgkmcnt(2)
  buffer_store_dwordx4 v[68:71], v1, s[4:7], s37 offen offset:1024 sc1
  s_waitcnt lgkmcnt(0)
  buffer_store_dwordx4 v[72:75], v52, s[4:7], s38 offen offset:2048 sc1
  v_mfma_f32_16x16x32_bf16 v[76:79], v[64:67], v[56:59], 0
  v_mfma_f32_16x16x32_bf16 v[76:79], v[68:71], v[56:59], v[76:79]
  v_mfma_f32_16x16x32_bf16 v[76:79], v[72:75], v[60:63], v[76:79]
  s_lshl_b32 s39, s29, 1
  v_add_u32 v48, s39, v54
  s_nop 5
  ds_write_b128 v48, v[76:79] offset:49152
  s_add_u32 s28, s14, 4
  s_cmp_ge_u32 s28, 5
  s_cbranch_scc1 L_tile_end_b
  s_mov_b32 s34, s28
  s_lshl_b32 s29, s34, 3
  s_mov_b32 s32, s18
  s_mul_i32 s33, s34, 5
  v_add_u32 v50, s29, v38
  v_add_u32 v51, s29, v39
  ds_read_b64_tr_b16 v[80:81], v50 offset:16384
  ds_read_b64_tr_b16 v[82:83], v50 offset:17024
  ds_read_b64_tr_b16 v[84:85], v50 offset:17664
  ds_read_b64_tr_b16 v[86:87], v50 offset:18304
  ds_read_b64_tr_b16 v[88:89], v51 offset:18944
  ds_read_b64_tr_b16 v[90:91], v51 offset:25344
  s_lshl_b32 s36, s32, 2
  s_add_u32 s36, s36, s27
  s_mul_i32 s36, s36, 270
  s_add_u32 s36, s36, s20
  s_add_u32 s36, s36, s33
  s_lshl_b32 s36, s36, 10
  s_mul_i32 s37, s26, 3072
  s_add_u32 s37, s37, s36
  s_lshl_b32 s38, s26, 9
  s_add_u32 s38, s38, s36
  s_waitcnt lgkmcnt(4)
  buffer_store_dwordx4 v[80:83], v1, s[4:7], s37 offen sc1
  s_waitcnt lgkmcnt(2)
  buffer_store_dwordx4 v[84:87], v1, s[4:7], s37 offen offset:1024 sc1
  s_waitcnt lgkmcnt(0)
  buffer_store_dwordx4 v[88:91], v52, s[4:7], s38 offen offset:2048 sc1
  v_mfma_f32_16x16x32_bf16 v[92:95], v[80:83], v[56:59], 0
  v_mfma_f32_16x16x32_bf16 v[92:95], v[84:87], v[56:59], v[92:95]
  v_mfma_f32_16x16x32_bf16 v[92:95], v[88:91], v[60:63], v[92:95]
  s_lshl_b32 s39, s29, 1
  v_add_u32 v48, s39, v54
  s_nop 5
  ds_write_b128 v48, v[92:95] offset:49152
L_tile_end_b:
  s_nop 7
  s_mov_b32 s20, 210
  v_lshrrev_b32 v35, 4, v0
  v_bfe_u32 v36, v0, 2, 2
  v_and_b32 v37, 3, v0
  v_mul_u32_u24 v37, 40, v37
  v_mad_u32_u24 v38, v35, 16, v36
  v_mul_u32_u24 v38, 160, v38
  v_add_u32 v38, v38, v37
  s_and_b32 s26, s17, 1
  s_lshr_b32 s27, s17, 1
  s_sub_u32 s28, 3, s14
  s_lshl_b32 s29, s28, 3
  s_mov_b32 s32, s18
  s_lshl_b32 s33, s28, 2
  s_mul_i32 s36, s22, 20
  s_add_u32 s33, s33, s36
  s_lshl_b32 s36, s26, 1
  s_add_u32 s33, s33, s36
  v_add_u32 v50, s29, v38
  ds_read_b64_tr_b16 v[64:65], v50 offset:32768
  ds_read_b64_tr_b16 v[66:67], v50 offset:33408
  ds_read_b64_tr_b16 v[68:69], v50 offset:34048
  ds_read_b64_tr_b16 v[70:71], v50 offset:34688
  s_lshl_b32 s36, s32, 2
  s_add_u32 s36, s36, s27
  s_mul_i32 s36, s36, 270
  s_add_u32 s36, s36, s20
  s_add_u32 s36, s36, s33
  s_lshl_b32 s36, s36, 10
  s_waitcnt lgkmcnt(2)
  buffer_store_dwordx4 v[64:67], v1, s[4:7], s36 offen offset:0 sc1
  s_waitcnt lgkmcnt(0)
  buffer_store_dwordx4 v[68:71], v1, s[4:7], s36 offen offset:1024 sc1
  s_sub_u32 s28, 7, s14
  s_cmp_ge_u32 s28, 5
  s_cbranch_scc1 L_tile_end_c
  s_lshl_b32 s29, s28, 3
  s_mov_b32 s32, s18
  s_lshl_b32 s33, s28, 2
  s_mul_i32 s36, s22, 20
  s_add_u32 s33, s33, s36
  s_lshl_b32 s36, s26, 1
  s_add_u32 s33, s33, s36
  v_add_u32 v50, s29, v38
  ds_read_b64_tr_b16 v[80:81], v50 offset:32768
  ds_read_b64_tr_b16 v[82:83], v50 offset:33408
  ds_read_b64_tr_b16 v[84:85], v50 offset:34048
  ds_read_b64_tr_b16 v[86:87], v50 offset:34688
  s_lshl_b32 s36, s32, 2
  s_add_u32 s36, s36, s27
  s_mul_i32 s36, s36, 270
  s_add_u32 s36, s36, s20
  s_add_u32 s36, s36, s33
  s_lshl_b32 s36, s36, 10
  s_waitcnt lgkmcnt(2)
  buffer_store_dwordx4 v[80:83], v1, s[4:7], s36 offen offset:0 sc1
  s_waitcnt lgkmcnt(0)
  buffer_store_dwordx4 v[84:87], v1, s[4:7], s36 offen offset:1024 sc1
L_tile_end_c:
  s_nop 7
  s_branch L_st2_done
L_st2_w3:
  s_mov_b32 s20, 150
  s_mul_i32 s21, s18, 768
  s_add_u32 s21, s21, 12288
  s_mov_b32 s23, 48
  v_lshrrev_b32 v35, 4, v0
  v_bfe_u32 v36, v0, 2, 2
  v_and_b32 v37, 3, v0
  v_mul_u32_u24 v37, 96, v37
  v_mad_u32_u24 v38, v35, 20, v36
  v_mul_u32_u24 v38, 384, v38
  v_add_u32 v38, v38, v37
  v_and_b32 v39, 1, v35
  v_mad_u32_u24 v39, v39, 20, v36
  v_mul_u32_u24 v39, 384, v39
  v_add_u32 v39, v39, v37
  v_cmp_gt_u32 vcc, 32, v0
  s_nop 1
  v_cndmask_b32 v52, v34, v1, vcc
  v_mov_b32 v53, 0x3f803f80
  v_cndmask_b32 v60, 0, v53, vcc
  v_mov_b32 v56, v53
  v_mov_b32 v57, v53
  v_mov_b32 v58, v53
  v_mov_b32 v59, v53
  v_mov_b32 v61, v60
  v_mov_b32 v62, v60
  v_mov_b32 v63, v60
  v_mul_u32_u24 v54, 192, v35
  s_and_b32 s26, s17, 1
  s_lshr_b32 s27, s17, 1
  s_add_u32 s28, s14, 0
  s_mov_b32 s34, s28
  s_lshl_b32 s29, s34, 3
  s_mov_b32 s32, s18
  s_mul_i32 s33, s34, 5
  v_add_u32 v50, s29, v38
  v_add_u32 v51, s29, v39
  ds_read_b64_tr_b16 v[64:65], v50 offset:16384
  ds_read_b64_tr_b16 v[66:67], v50 offset:17920
  ds_read_b64_tr_b16 v[68:69], v50 offset:19456
  ds_read_b64_tr_b16 v[70:71], v50 offset:20992
  ds_read_b64_tr_b16 v[72:73], v51 offset:22528
  ds_read_b64_tr_b16 v[74:75], v51 offset:37888
  s_lshl_b32 s36, s32, 2
  s_add_u32 s36, s36, s27
  s_mul_i32 s36, s36, 270
  s_add_u32 s36, s36, s20
  s_add_u32 s36, s36, s33
  s_lshl_b32 s36, s36, 10
  s_mul_i32 s37, s26, 3072
  s_add_u32 s37, s37, s36
  s_lshl_b32 s38, s26, 9
  s_add_u32 s38, s38, s36
  s_waitcnt lgkmcnt(4)
  buffer_store_dwordx4 v[64:67], v1, s[4:7], s37 offen sc1
  s_waitcnt lgkmcnt(2)
  buffer_store_dwordx4 v[68:71], v1, s[4:7], s37 offen offset:1024 sc1
  s_waitcnt lgkmcnt(0)
  buffer_store_dwordx4 v[72:75], v52, s[4:7], s38 offen offset:2048 sc1
  v_mfma_f32_16x16x32_bf16 v[76:79], v[64:67], v[56:59], 0
  v_mfma_f32_16x16x32_bf16 v[76:79], v[68:71], v[56:59], v[76:79]
  v_mfma_f32_16x16x32_bf16 v[76:79], v[72:75], v[60:63], v[76:79]
  s_lshl_b32 s39, s29, 1
  v_add_u32 v48, s39, v54
  s_nop 5
  ds_write_b128 v48, v[76:79] offset:49152
  s_add_u32 s28, s14, 4
  s_mov_b32 s34, s28
  s_lshl_b32 s29, s34, 3
  s_mov_b32 s32, s18
  s_mul_i32 s33, s34, 5
  v_add_u32 v50, s29, v38
  v_add_u32 v51, s29, v39
  ds_read_b64_tr_b16 v[80:81], v50 offset:16384
  ds_read_b64_tr_b16 v[82:83], v50 offset:17920
  ds_read_b64_tr_b16 v[84:85], v50 offset:19456
  ds_read_b64_tr_b16 v[86:87], v50 offset:20992
  ds_read_b64_tr_b16 v[88:89], v51 offset:22528
  ds_read_b64_tr_b16 v[90:91], v51 offset:37888
  s_lshl_b32 s36, s32, 2
  s_add_u32 s36, s36, s27
  s_mul_i32 s36, s36, 270
  s_add_u32 s36, s36, s20
  s_add_u32 s36, s36, s33
  s_lshl_b32 s36, s36, 10
  s_mul_i32 s37, s26, 3072
  s_add_u32 s37, s37, s36
  s_lshl_b32 s38, s26, 9
  s_add_u32 s38, s38, s36
  s_waitcnt lgkmcnt(4)
  buffer_store_dwordx4 v[80:83], v1, s[4:7], s37 offen sc1
  s_waitcnt lgkmcnt(2)
  buffer_store_dwordx4 v[84:87], v1, s[4:7], s37 offen offset:1024 sc1
  s_waitcnt lgkmcnt(0)
  buffer_store_dwordx4 v[88:91], v52, s[4:7], s38 offen offset:2048 sc1
  v_mfma_f32_16x16x32_bf16 v[92:95], v[80:83], v[56:59], 0
  v_mfma_f32_16x16x32_bf16 v[92:95], v[84:87], v[56:59], v[92:95]
  v_mfma_f32_16x16x32_bf16 v[92:95], v[88:91], v[60:63], v[92:95]
  s_lshl_b32 s39, s29, 1
  v_add_u32 v48, s39, v54
  s_nop 5
  ds_write_b128 v48, v[92:95] offset:49152
  s_add_u32 s28, s14, 8
  s_mov_b32 s34, s28
  s_lshl_b32 s29, s34, 3
  s_mov_b32 s32, s18
  s_mul_i32 s33, s34, 5
  v_add_u32 v50, s29, v38
  v_add_u32 v51, s29, v39
  ds_read_b64_tr_b16 v[96:97], v50 offset:16384
  ds_read_b64_tr_b16 v[98:99], v50 offset:17920
  ds_read_b64_tr_b16 v[100:101], v50 offset:19456
  ds_read_b64_tr_b16 v[102:103], v50 offset:20992
  ds_read_b64_tr_b16 v[104:105], v51 offset:22528
  ds_read_b64_tr_b16 v[106:107], v51 offset:37888
  s_lshl_b32 s36, s32, 2
  s_add_u32 s36, s36, s27
  s_mul_i32 s36, s36, 270
  s_add_u32 s36, s36, s20
  s_add_u32 s36, s36, s33
  s_lshl_b32 s36, s36, 10
  s_mul_i32 s37, s26, 3072
  s_add_u32 s37, s37, s36
  s_lshl_b32 s38, s26, 9
  s_add_u32 s38, s38, s36
  s_waitcnt lgkmcnt(4)
  buffer_store_dwordx4 v[96:99], v1, s[4:7], s37 offen sc1
  s_waitcnt lgkmcnt(2)
  buffer_store_dwordx4 v[100:103], v1, s[4:7], s37 offen offset:1024 sc1
  s_waitcnt lgkmcnt(0)
  buffer_store_dwordx4 v[104:107], v52, s[4:7], s38 offen offset:2048 sc1
  v_mfma_f32_16x16x32_bf16 v[108:111], v[96:99], v[56:59], 0
  v_mfma_f32_16x16x32_bf16 v[108:111], v[100:103], v[56:59], v[108:111]
  v_mfma_f32_16x16x32_bf16 v[108:111], v[104:107], v[60:63], v[108:111]
  s_lshl_b32 s39, s29, 1
  v_add_u32 v48, s39, v54
  s_nop 5
  ds_write_b128 v48, v[108:111] offset:49152
L_tile_end_d:
  s_nop 7
L_st2_done:
  s_waitcnt lgkmcnt(0)
  s_barrier
  s_cmp_eq_u32 s14, 2
  s_cselect_b32 s23, s23, 0
  ds_read_b128 v[64:67], v1 offset:49152
  v_cmp_gt_u32 vcc, s23, v0
  s_mul_i32 s39, s17, 18432
  s_add_u32 s39, s39, s21
  s_add_u32 s39, s39, 9207808
  v_cndmask_b32 v48, v34, v1, vcc
  s_waitcnt lgkmcnt(0)
  buffer_store_dwordx4 v[64:67], v48, s[4:7], s39 offen sc1
  s_nop 1
  buffer_store_dwordx4 v[22:25], v1, s[4:7], s62 offen offset:0 sc1
  v_cmp_gt_u32 vcc, 48, v0
  v_lshl_or_b32 v154, v155, 16, v154
  v_lshl_or_b32 v148, v149, 16, v148
  v_cndmask_b32 v125, v125, v124, vcc
  ds_write_b32 v125, v154 offset:768
  v_lshl_or_b32 v150, v151, 16, v150
  v_lshl_or_b32 v152, v153, 16, v152
  v_and_b32 v125, 1, v0
  v_add_u32 v125, s84, v125
  ds_write_b32 v124, v148 offset:0
  s_lshl_b32 s84, s13, 3
  buffer_store_dwordx4 v[22:25], v1, s[4:7], s62 offen offset:1024 sc1
  ds_write_b32 v124, v150 offset:256
  s_mul_i32 s16, s87, 20480
  s_add_u32 s16, s16, s100
  s_add_u32 s24, s16, 4096
  s_mul_i32 s17, s88, 20480
  s_add_u32 s17, s17, s100
  s_add_u32 s25, s17, 4096
  s_mul_i32 s18, s89, 20480
  s_add_u32 s18, s18, s100
  ds_write_b32 v124, v152 offset:512
  v_lshrrev_b32 v124, 1, v0
  v_lshl_add_u32 v123, v124, 6, s84
  s_and_b32 s84, s2, 0xc7
  v_cmp_gt_u32 vcc, 3, v124
  v_add_u32 v123, v123, v125
  buffer_store_dword v22, v26, s[4:7], s63 offen sc1
  v_lshl_add_u32 v126, v125, 3, s84
  v_cndmask_b32 v123, v126, v123, vcc
  v_lshlrev_b32 v123, 6, v123
  s_lshl_b32 s84, s14, 5
  v_add_u32 v244, s84, v244
  v_mul_u32_u24 v245, 103, v244
  v_lshrrev_b32 v245, 11, v245
  v_mul_u32_u24 v245, 172, v245
  s_mul_i32 s84, s13, 24
  v_add3_u32 v245, v245, v244, s84
  s_mul_i32 s84, s13, 48
  s_add_u32 s84, s84, 688
  v_lshlrev_b32 v247, 4, v244
  v_add_u32 v246, s84, v244
  v_add_u32 v247, 102144, v247
  buffer_store_dwordx4 v[20:23], v1, s[4:7], s49 offen offset:1024 sc1
  s_lshl_b32 s84, s14, 30
  s_or_b32 s84, s84, 16384
  v_mov_b32 v122, s84
  s_add_u32 s26, s18, 4096
  s_mul_i32 s19, s90, 20480
  s_add_u32 s19, s19, s100
  s_add_u32 s27, s19, 4096
  v_lshrrev_b32 v124, 2, v0
  v_and_b32 v125, 48, v1
  v_lshl_add_u32 v124, v124, 11, v125
  s_add_u32 s20, s16, 102400
  s_add_u32 s28, s16, 106496
  s_lshl_b32 s84, s14, 5
  s_add_u32 s21, s17, 102400
  s_add_u32 s29, s17, 106496
  s_add_u32 s22, s18, 102400
  s_add_u32 s30, s18, 106496
  s_add_u32 s23, s19, 102400
  s_add_u32 s31, s19, 106496
  s_mul_i32 s34, s14, 5120
  s_add_u32 s34, s34, 13733888
  buffer_store_dwordx4 v[20:23], v1, s[4:7], s49 offen offset:2048 sc1
  s_add_u32 s35, s34, 4096
  s_mul_i32 s36, s87, 49152
  s_mul_i32 s37, s14, 12288
  s_add_u32 s36, s36, s37
  s_add_u32 s36, s36, s86
  s_add_u32 s36, s36, 204800
  s_add_u32 s37, s36, 4096
  s_mul_i32 s39, s88, 49152
  s_mul_i32 s40, s14, 12288
  s_add_u32 s39, s39, s40
  s_add_u32 s39, s39, s86
  s_add_u32 s39, s39, 204800
  s_add_u32 s40, s39, 4096
  s_mul_i32 s42, s89, 49152
  s_mul_i32 s43, s14, 12288
  s_add_u32 s42, s42, s43
  s_add_u32 s42, s42, s86
  s_add_u32 s42, s42, 204800
  s_add_u32 s43, s42, 4096
  s_add_u32 s38, s36, 8192
  s_add_u32 s41, s39, 8192
  s_add_u32 s44, s42, 8192
  s_mul_i32 s32, s14, 5120
  s_add_u32 s32, s32, 13631488
  s_add_u32 s33, s32, 4096
  buffer_store_dwordx4 v[20:23], v254, s[4:7], s49 offen sc1
  s_load_dwordx2 s[8:9], s[0:1], 72
  s_mov_b32 s10, 2621440
  s_mov_b32 s11, 0x00020000
  buffer_store_dword v20, v26, s[4:7], s58 offen sc1
  s_waitcnt lgkmcnt(0)
  s_and_b32 s9, s9, 0xffff
  buffer_store_dword v22, v26, s[4:7], s59 offen sc1
  buffer_store_dwordx4 v[22:25], v1, s[4:7], s75 offen offset:0 sc1
  buffer_store_dwordx4 v[22:25], v1, s[4:7], s75 offen offset:256 sc1
L_start_1:
  buffer_load_dword v27, v123, s[4:7], s76 offen sc1
  s_waitcnt vmcnt(0)
  s_sub_u32 s69, s69, 1
  s_cbranch_scc1 L_start_1_to
  v_cmp_ne_u32 vcc, s68, v27
  s_nop 0
  s_cbranch_vccnz L_start_1
L_start_1_d:
  s_barrier
  s_mov_b32 s70, 0
  buffer_load_dwordx4 a[0:3], v3, s[4:7], s70 offen offset:0
  v_cmp_gt_u32 vcc, 80, v244
  s_nop 1
  v_cndmask_b32 v244, v246, v245, vcc
  v_lshrrev_b32 v245, 5, v0
  v_mul_u32_u24 v245, 18432, v245
  v_lshl_add_u32 v244, v244, 4, v245
  v_cmp_gt_u32 vcc, 32, v0
  buffer_load_dwordx4 a[4:7], v3, s[4:7], s70 offen offset:1024
  buffer_load_dwordx4 a[8:11], v3, s[4:7], s70 offen offset:2048
  buffer_load_dwordx4 a[12:15], v3, s[4:7], s70 offen offset:3072
  s_mov_b32 s70, 4096
  buffer_load_dwordx4 a[16:19], v3, s[4:7], s70 offen offset:0
  buffer_load_dwordx4 a[20:23], v3, s[4:7], s70 offen offset:1024
  buffer_load_dwordx4 a[24:27], v3, s[4:7], s70 offen offset:2048
  buffer_load_dwordx4 a[28:31], v3, s[4:7], s70 offen offset:3072
  s_mov_b32 s70, 8192
  buffer_load_dwordx4 a[32:35], v3, s[4:7], s70 offen offset:0
  buffer_load_dwordx4 a[36:39], v3, s[4:7], s70 offen offset:1024
  buffer_load_dwordx4 a[40:43], v3, s[4:7], s70 offen offset:2048
  buffer_load_dwordx4 a[44:47], v3, s[4:7], s70 offen offset:3072
  buffer_load_dwordx4 v[32:35], v1, s[4:7], s16 offen offset:0 sc1
  s_mov_b32 s70, 12288
  buffer_load_dwordx4 a[48:51], v3, s[4:7], s70 offen offset:0
  buffer_load_dwordx4 a[52:55], v3, s[4:7], s70 offen offset:1024
  buffer_load_dwordx4 a[56:59], v3, s[4:7], s70 offen offset:2048
  buffer_load_dwordx4 a[60:63], v3, s[4:7], s70 offen offset:3072
  s_mov_b32 s70, 16384
  buffer_load_dwordx4 a[64:67], v3, s[4:7], s70 offen offset:0
  buffer_load_dwordx4 a[68:71], v3, s[4:7], s70 offen offset:1024
  buffer_load_dwordx4 a[72:75], v3, s[4:7], s70 offen offset:2048
  buffer_load_dwordx4 a[76:79], v3, s[4:7], s70 offen offset:3072
  s_mov_b32 s70, 20480
  buffer_load_dwordx4 a[80:83], v3, s[4:7], s70 offen offset:0
  buffer_load_dwordx4 v[44:47], v1, s[4:7], s16 offen offset:3072 sc1
  buffer_load_dwordx4 a[84:87], v3, s[4:7], s70 offen offset:1024
  buffer_load_dwordx4 a[88:91], v3, s[4:7], s70 offen offset:2048
  buffer_load_dwordx4 a[92:95], v3, s[4:7], s70 offen offset:3072
  s_waitcnt vmcnt(13)
  v_mfma_f32_16x16x32_bf16 v[128:131], a[0:3], v[32:35], 0
  v_mfma_f32_16x16x32_bf16 v[132:135], a[20:23], v[32:35], 0
  buffer_load_dwordx4 v[36:39], v1, s[4:7], s16 offen offset:1024 sc1
  v_mfma_f32_16x16x32_bf16 v[136:139], a[40:43], v[32:35], 0
  buffer_load_dwordx4 v[48:51], v1, s[4:7], s24 offen offset:0 sc1
  s_mov_b32 s70, 24576
  buffer_load_dwordx4 a[96:99], v3, s[4:7], s70 offen offset:0
  buffer_load_dwordx4 v[40:43], v1, s[4:7], s16 offen offset:2048 sc1
  s_waitcnt vmcnt(13)
  v_mfma_f32_16x16x32_bf16 v[140:143], a[60:63], v[32:35], 0
  buffer_load_dwordx4 v[52:55], v1, s[4:7], s17 offen offset:0 sc1
  buffer_load_dwordx4 v[64:67], v1, s[4:7], s17 offen offset:3072 sc1
  buffer_load_dwordx4 v[56:59], v1, s[4:7], s17 offen offset:1024 sc1
  buffer_load_dwordx4 v[68:71], v1, s[4:7], s25 offen offset:0 sc1
  buffer_load_dwordx4 v[60:63], v1, s[4:7], s17 offen offset:2048 sc1
  s_waitcnt vmcnt(13)
  v_mfma_f32_16x16x32_bf16 v[144:147], a[80:83], v[32:35], 0
  s_mov_b32 s85, 9207808
  buffer_load_dwordx4 v[228:231], v244, s[4:7], s85 offen sc1
  s_waitcnt vmcnt(13)
  v_mfma_f32_16x16x32_bf16 v[128:131], a[12:15], v[44:47], v[128:131]
  v_mfma_f32_16x16x32_bf16 v[132:135], a[32:35], v[44:47], v[132:135]
  s_mov_b32 s85, 9244672
  buffer_load_dwordx4 v[232:235], v244, s[4:7], s85 offen sc1
  v_mfma_f32_16x16x32_bf16 v[136:139], a[52:55], v[44:47], v[136:139]
  v_mfma_f32_16x16x32_bf16 v[140:143], a[72:75], v[44:47], v[140:143]
  s_mov_b32 s85, 9281536
  buffer_load_dwordx4 v[236:239], v244, s[4:7], s85 offen sc1
  s_mov_b32 s85, 9318400
  buffer_load_dwordx4 v[240:243], v244, s[4:7], s85 offen sc1
  s_waitcnt vmcnt(13)
  v_mfma_f32_16x16x32_bf16 v[144:147], a[92:95], v[44:47], v[144:147]
  buffer_load_dwordx4 v[72:75], v1, s[4:7], s18 offen offset:0 sc1
  s_waitcnt vmcnt(13)
  v_mfma_f32_16x16x32_bf16 v[128:131], a[4:7], v[36:39], v[128:131]
  v_mfma_f32_16x16x32_bf16 v[132:135], a[24:27], v[36:39], v[132:135]
  v_mfma_f32_16x16x32_bf16 v[136:139], a[44:47], v[36:39], v[136:139]
  buffer_load_dwordx4 v[84:87], v1, s[4:7], s18 offen offset:3072 sc1
  v_mfma_f32_16x16x32_bf16 v[140:143], a[64:67], v[36:39], v[140:143]
  v_mfma_f32_16x16x32_bf16 v[144:147], a[84:87], v[36:39], v[144:147]
  s_waitcnt vmcnt(13)
  v_mfma_f32_16x16x32_bf16 v[128:131], a[16:19], v[48:51], v[128:131]
  v_mfma_f32_16x16x32_bf16 v[132:135], a[36:39], v[48:51], v[132:135]
  v_mfma_f32_16x16x32_bf16 v[136:139], a[56:59], v[48:51], v[136:139]
  buffer_load_dwordx4 v[76:79], v1, s[4:7], s18 offen offset:1024 sc1
  v_mfma_f32_16x16x32_bf16 v[140:143], a[76:79], v[48:51], v[140:143]
  s_waitcnt vmcnt(13)
  v_mfma_f32_16x16x32_bf16 v[144:147], a[96:99], v[48:51], v[144:147]
  buffer_load_dwordx4 v[88:91], v1, s[4:7], s26 offen offset:0 sc1
  s_waitcnt vmcnt(13)
  v_mfma_f32_16x16x32_bf16 v[128:131], a[8:11], v[40:43], v[128:131]
  v_mfma_f32_16x16x32_bf16 v[132:135], a[28:31], v[40:43], v[132:135]
  v_mfma_f32_16x16x32_bf16 v[136:139], a[48:51], v[40:43], v[136:139]
  v_mfma_f32_16x16x32_bf16 v[140:143], a[68:71], v[40:43], v[140:143]
  buffer_load_dwordx4 v[80:83], v1, s[4:7], s18 offen offset:2048 sc1
  v_mfma_f32_16x16x32_bf16 v[144:147], a[88:91], v[40:43], v[144:147]
  s_waitcnt vmcnt(13)
  v_mfma_f32_16x16x32_bf16 v[148:151], a[0:3], v[52:55], 0
  v_mfma_f32_16x16x32_bf16 v[152:155], a[20:23], v[52:55], 0
  v_mfma_f32_16x16x32_bf16 v[156:159], a[40:43], v[52:55], 0
  v_mfma_f32_16x16x32_bf16 v[160:163], a[60:63], v[52:55], 0
  buffer_load_dwordx2 v[112:113], v15, s[4:7], s54 offen offset:0 sc1
  v_mfma_f32_16x16x32_bf16 v[164:167], a[80:83], v[52:55], 0
  s_waitcnt vmcnt(13)
  v_mfma_f32_16x16x32_bf16 v[148:151], a[12:15], v[64:67], v[148:151]
  v_mfma_f32_16x16x32_bf16 v[152:155], a[32:35], v[64:67], v[152:155]
  v_mfma_f32_16x16x32_bf16 v[156:159], a[52:55], v[64:67], v[156:159]
  v_mfma_f32_16x16x32_bf16 v[160:163], a[72:75], v[64:67], v[160:163]
  buffer_load_dwordx2 v[114:115], v15, s[4:7], s54 offen offset:512 sc1
  v_mfma_f32_16x16x32_bf16 v[164:167], a[92:95], v[64:67], v[164:167]
  s_waitcnt vmcnt(13)
  v_mfma_f32_16x16x32_bf16 v[148:151], a[4:7], v[56:59], v[148:151]
  s_waitcnt vmcnt(12)
  v_mfma_f32_16x16x32_bf16 v[148:151], a[16:19], v[68:71], v[148:151]
  buffer_load_dwordx4 v[92:95], v1, s[4:7], s19 offen offset:0 sc1
  s_waitcnt vmcnt(12)
  v_mfma_f32_16x16x32_bf16 v[148:151], a[8:11], v[60:63], v[148:151]
  buffer_load_dwordx4 v[104:107], v1, s[4:7], s19 offen offset:3072 sc1
  v_mfma_f32_16x16x32_bf16 v[152:155], a[24:27], v[56:59], v[152:155]
  v_mfma_f32_16x16x32_bf16 v[152:155], a[36:39], v[68:71], v[152:155]
  v_mfma_f32_16x16x32_bf16 v[152:155], a[28:31], v[60:63], v[152:155]
  v_mfma_f32_16x16x32_bf16 v[156:159], a[44:47], v[56:59], v[156:159]
  v_mfma_f32_16x16x32_bf16 v[156:159], a[56:59], v[68:71], v[156:159]
  buffer_load_dwordx4 v[96:99], v1, s[4:7], s19 offen offset:1024 sc1
  v_mfma_f32_16x16x32_bf16 v[156:159], a[48:51], v[60:63], v[156:159]
  v_mfma_f32_16x16x32_bf16 v[160:163], a[64:67], v[56:59], v[160:163]
  v_mfma_f32_16x16x32_bf16 v[160:163], a[76:79], v[68:71], v[160:163]
  s_waitcnt vmcnt(12)
  v_add_f32 v228, v228, v232
  v_add_f32 v229, v229, v233
  v_add_f32 v230, v230, v234
  v_add_f32 v231, v231, v235
  v_mfma_f32_16x16x32_bf16 v[160:163], a[68:71], v[60:63], v[160:163]
  buffer_load_dwordx4 v[108:111], v1, s[4:7], s27 offen offset:0 sc1
  v_mfma_f32_16x16x32_bf16 v[164:167], a[84:87], v[56:59], v[164:167]
  v_mfma_f32_16x16x32_bf16 v[164:167], a[96:99], v[68:71], v[164:167]
  v_mfma_f32_16x16x32_bf16 v[164:167], a[88:91], v[60:63], v[164:167]
  s_waitcnt vmcnt(12)
  v_add_f32 v228, v228, v236
  v_add_f32 v229, v229, v237
  v_add_f32 v230, v230, v238
  v_add_f32 v231, v231, v239
  buffer_load_dwordx4 v[100:103], v1, s[4:7], s19 offen offset:2048 sc1
  s_waitcnt vmcnt(12)
  v_add_f32 v228, v228, v240
  v_add_f32 v229, v229, v241
  v_add_f32 v230, v230, v242
  v_add_f32 v231, v231, v243
  v_mov_b32 v232, v228
  v_mov_b32 v233, v229
  s_mov_b32 s81, 16384
  buffer_load_dword a254, v2, s[96:99], s81 offen
  v_mov_b32 v234, v230
  v_mov_b32 v235, v231
  v_permlane32_swap_b32 v228, v232
  v_permlane32_swap_b32 v229, v233
  v_permlane32_swap_b32 v230, v234
  v_permlane32_swap_b32 v231, v235
  v_add_f32 v228, v228, v232
  v_add_f32 v229, v229, v233
  v_add_f32 v230, v230, v234
  v_add_f32 v231, v231, v235
  ds_write_b128 v247, v[228:231]
  buffer_load_dwordx4 a[100:103], v3, s[4:7], s70 offen offset:1024
  s_waitcnt vmcnt(13)
  v_mfma_f32_16x16x32_bf16 v[168:171], a[0:3], v[72:75], 0
  s_waitcnt vmcnt(12)
  v_mfma_f32_16x16x32_bf16 v[168:171], a[12:15], v[84:87], v[168:171]
  buffer_load_dwordx4 a[104:107], v3, s[4:7], s70 offen offset:2048
  s_waitcnt vmcnt(12)
  v_mfma_f32_16x16x32_bf16 v[168:171], a[4:7], v[76:79], v[168:171]
  buffer_load_dwordx4 a[108:111], v3, s[4:7], s70 offen offset:3072
  s_waitcnt lgkmcnt(0)
  s_barrier
  ds_write_b128 v4, v[128:131] offset:0
  s_waitcnt vmcnt(12)
  v_mfma_f32_16x16x32_bf16 v[168:171], a[16:19], v[88:91], v[168:171]
  s_mov_b32 s70, 28672
  buffer_load_dwordx4 a[112:115], v3, s[4:7], s70 offen offset:0
  ds_read_b128 v[188:191], v12 offset:0
  ds_write_b128 v4, v[132:135] offset:1024
  s_waitcnt vmcnt(12)
  v_mfma_f32_16x16x32_bf16 v[168:171], a[8:11], v[80:83], v[168:171]
  ds_read_b128 v[192:195], v12 offset:16
  v_mfma_f32_16x16x32_bf16 v[172:175], a[20:23], v[72:75], 0
  buffer_load_dwordx4 a[116:119], v3, s[4:7], s70 offen offset:1024
  ds_write_b128 v4, v[136:139] offset:2048
  v_mfma_f32_16x16x32_bf16 v[172:175], a[32:35], v[84:87], v[172:175]
  ds_read_b128 v[196:199], v12 offset:32
  v_mfma_f32_16x16x32_bf16 v[172:175], a[24:27], v[76:79], v[172:175]
  ds_read_b128 v[200:203], v12 offset:48
  ds_write_b128 v4, v[140:143] offset:3072
  buffer_load_dwordx4 a[120:123], v3, s[4:7], s70 offen offset:2048
  v_mfma_f32_16x16x32_bf16 v[172:175], a[36:39], v[88:91], v[172:175]
  ds_read_b128 v[204:207], v12 offset:64
  v_mfma_f32_16x16x32_bf16 v[172:175], a[28:31], v[80:83], v[172:175]
  s_waitcnt vmcnt(12)
  v_add_f32 v112, v112, v114
  ds_write_b128 v4, v[144:147] offset:4096
  v_mfma_f32_16x16x32_bf16 v[176:179], a[40:43], v[72:75], 0
  v_mov_b32 v114, v112
  v_add_f32 v113, v113, v115
  v_mfma_f32_16x16x32_bf16 v[176:179], a[52:55], v[84:87], v[176:179]
  buffer_load_dwordx4 a[124:127], v3, s[4:7], s70 offen offset:3072
  ds_write_b128 v5, v[148:151] offset:0
  v_mfma_f32_16x16x32_bf16 v[176:179], a[44:47], v[76:79], v[176:179]
  v_permlane16_swap_b32 v112, v114
  v_mfma_f32_16x16x32_bf16 v[176:179], a[56:59], v[88:91], v[176:179]
  v_add_f32 v112, v112, v114
  v_mov_b32 v114, v112
  ds_write_b128 v5, v[152:155] offset:1024
  s_mov_b32 s70, 32768
  buffer_load_dwordx4 a[128:131], v3, s[4:7], s70 offen offset:0
  v_mfma_f32_16x16x32_bf16 v[176:179], a[48:51], v[80:83], v[176:179]
  v_permlane32_swap_b32 v112, v114
  v_mfma_f32_16x16x32_bf16 v[180:183], a[60:63], v[72:75], 0
  ds_write_b128 v5, v[156:159] offset:2048
  v_mfma_f32_16x16x32_bf16 v[180:183], a[72:75], v[84:87], v[180:183]
  v_add_f32 v112, v112, v114
  v_mul_f32 v28, 0xbacccccd, v112
  v_mfma_f32_16x16x32_bf16 v[180:183], a[64:67], v[76:79], v[180:183]
  buffer_load_dwordx4 a[132:135], v3, s[4:7], s70 offen offset:1024
  ds_write_b128 v5, v[160:163] offset:3072
  v_mfma_f32_16x16x32_bf16 v[180:183], a[76:79], v[88:91], v[180:183]
  s_waitcnt lgkmcnt(12)
  v_mul_f32 v188, v28, v188
  v_mul_f32 v189, v28, v189
  v_mfma_f32_16x16x32_bf16 v[180:183], a[68:71], v[80:83], v[180:183]
  v_mul_f32 v190, v28, v190
  v_mul_f32 v191, v28, v191
  ds_write_b128 v5, v[164:167] offset:4096
  buffer_load_dwordx4 a[136:139], v3, s[4:7], s70 offen offset:2048
  v_mfma_f32_16x16x32_bf16 v[184:187], a[80:83], v[72:75], 0
  v_mov_b32 v115, v113
  v_mfma_f32_16x16x32_bf16 v[184:187], a[92:95], v[84:87], v[184:187]
  ds_write_b128 v6, v[168:171] offset:0
  v_mfma_f32_16x16x32_bf16 v[184:187], a[84:87], v[76:79], v[184:187]
  v_permlane16_swap_b32 v113, v115
  v_mfma_f32_16x16x32_bf16 v[184:187], a[96:99], v[88:91], v[184:187]
  buffer_load_dwordx4 a[140:143], v3, s[4:7], s70 offen offset:3072
  v_mfma_f32_16x16x32_bf16 v[184:187], a[88:91], v[80:83], v[184:187]
  ds_write_b128 v6, v[172:175] offset:1024
  s_waitcnt vmcnt(16)
  v_mfma_f32_16x16x32_bf16 v[188:191], a[0:3], v[92:95], v[188:191]
  v_add_f32 v113, v113, v115
  v_mov_b32 v115, v113
  s_waitcnt vmcnt(15)
  v_mfma_f32_16x16x32_bf16 v[188:191], a[12:15], v[104:107], v[188:191]
  s_mov_b32 s70, 36864
  buffer_load_dwordx4 a[144:147], v3, s[4:7], s70 offen offset:0
  s_waitcnt lgkmcnt(2)
  s_barrier
  buffer_store_dwordx2 v[120:121], v122, s[4:7], s77 offen sc1
  v_bfe_u32 v122, v0, 3, 2
  v_lshrrev_b32 v123, 1, v122
  v_and_b32 v122, 1, v122
  v_sub_u32 v122, v123, v122
  v_add_u32 v122, s12, v122
  v_max_i32 v122, 0, v122
  v_and_b32 v123, 7, v0
  v_min_i32 v122, 31, v122
  v_lshl_add_u32 v122, v122, 3, v123
  v_and_b32 v123, 31, v0
  v_lshlrev_b32 v123, 3, v123
  v_add_u32 v123, s13, v123
  v_cndmask_b32 v122, v123, v122, vcc
  v_lshlrev_b32 v122, 6, v122
  v_add_u32 v122, 16384, v122
  ds_read_b128 v[132:135], v7 offset:1024
  buffer_load_dwordx4 a[148:151], v3, s[4:7], s70 offen offset:1024
  s_waitcnt vmcnt(17)
  v_mfma_f32_16x16x32_bf16 v[188:191], a[4:7], v[96:99], v[188:191]
  ds_read_b128 v[152:155], v7 offset:6144
  ds_write_b128 v6, v[176:179] offset:2048
  ds_read_b128 v[136:139], v7 offset:2048
  s_waitcnt vmcnt(16)
  v_mfma_f32_16x16x32_bf16 v[188:191], a[16:19], v[108:111], v[188:191]
  v_permlane32_swap_b32 v113, v115
  ds_read_b128 v[156:159], v7 offset:7168
  s_waitcnt vmcnt(15)
  v_mfma_f32_16x16x32_bf16 v[188:191], a[8:11], v[100:103], v[188:191]
  buffer_load_dwordx4 a[152:155], v3, s[4:7], s70 offen offset:2048
  ds_write_b128 v6, v[180:183] offset:3072
  ds_read_b128 v[140:143], v7 offset:3072
  v_add_f32 v113, v113, v115
  v_mul_f32 v113, 0x3acccccd, v113
  v_fma_f32 v29, -v28, v28, v113
  ds_read_b128 v[160:163], v7 offset:8192
  v_max_f32 v29, 0, v29
  v_add_f32 v31, 0x3727c5ac, v29
  v_rsq_f32 v30, v31
  ds_write_b128 v6, v[184:187] offset:4096
  buffer_load_dwordx4 a[156:159], v3, s[4:7], s70 offen offset:3072
  ds_read_b128 v[144:147], v7 offset:4096
  v_mul_f32 v252, s78, v30
  s_waitcnt lgkmcnt(8)
  v_add_f32 v132, v132, v152
  v_add_f32 v133, v133, v153
  ds_read_b128 v[164:167], v7 offset:9216
  v_add_f32 v134, v134, v154
  v_add_f32 v135, v135, v155
  v_fmac_f32 v132, v28, v192
  ds_read_b128 v[128:131], v7 offset:0
  v_fmac_f32 v133, v28, v193
  v_fmac_f32 v134, v28, v194
  v_fmac_f32 v135, v28, v195
  ds_read_b128 v[148:151], v7 offset:5120
  s_waitcnt lgkmcnt(8)
  v_add_f32 v136, v136, v156
  v_mfma_f32_16x16x32_bf16 v[192:195], a[20:23], v[92:95], v[132:135]
  s_mov_b32 s70, 40960
  buffer_load_dwordx4 a[160:163], v3, s[4:7], s70 offen offset:0
  v_mfma_f32_16x16x32_bf16 v[192:195], a[32:35], v[104:107], v[192:195]
  v_add_f32 v137, v137, v157
  v_add_f32 v138, v138, v158
  v_mfma_f32_16x16x32_bf16 v[192:195], a[24:27], v[96:99], v[192:195]
  v_add_f32 v139, v139, v159
  v_fmac_f32 v136, v28, v196
  v_mfma_f32_16x16x32_bf16 v[192:195], a[36:39], v[108:111], v[192:195]
  v_fmac_f32 v137, v28, v197
  v_fmac_f32 v138, v28, v198
  v_mfma_f32_16x16x32_bf16 v[192:195], a[28:31], v[100:103], v[192:195]
  v_fmac_f32 v139, v28, v199
  buffer_load_dwordx4 a[164:167], v3, s[4:7], s70 offen offset:1024
  s_waitcnt lgkmcnt(5)
  v_add_f32 v140, v140, v160
  v_mfma_f32_16x16x32_bf16 v[196:199], a[40:43], v[92:95], v[136:139]
  v_add_f32 v141, v141, v161
  v_add_f32 v142, v142, v162
  v_mfma_f32_16x16x32_bf16 v[196:199], a[52:55], v[104:107], v[196:199]
  v_add_f32 v143, v143, v163
  v_fmac_f32 v140, v28, v200
  v_mfma_f32_16x16x32_bf16 v[196:199], a[44:47], v[96:99], v[196:199]
  v_fmac_f32 v141, v28, v201
  v_fmac_f32 v142, v28, v202
  v_mfma_f32_16x16x32_bf16 v[196:199], a[56:59], v[108:111], v[196:199]
  v_fmac_f32 v143, v28, v203
  buffer_load_dwordx4 a[168:171], v3, s[4:7], s70 offen offset:2048
  s_waitcnt lgkmcnt(0)
  s_barrier
  v_mfma_f32_16x16x32_bf16 v[196:199], a[48:51], v[100:103], v[196:199]
  ds_read_b128 v[168:171], v7 offset:10240
  v_add_f32 v128, v128, v148
  v_mfma_f32_16x16x32_bf16 v[200:203], a[60:63], v[92:95], v[140:143]
  ds_read_b128 v[172:175], v7 offset:11264
  v_add_f32 v129, v129, v149
  buffer_load_dwordx4 a[172:175], v3, s[4:7], s70 offen offset:3072
  v_mfma_f32_16x16x32_bf16 v[200:203], a[72:75], v[104:107], v[200:203]
  ds_read_b128 v[176:179], v7 offset:12288
  v_add_f32 v130, v130, v150
  v_mfma_f32_16x16x32_bf16 v[200:203], a[64:67], v[96:99], v[200:203]
  ds_read_b128 v[180:183], v7 offset:13312
  v_add_f32 v131, v131, v151
  v_mfma_f32_16x16x32_bf16 v[200:203], a[76:79], v[108:111], v[200:203]
  ds_read_b128 v[184:187], v7 offset:14336
  v_add_f32 v144, v144, v164
  v_mfma_f32_16x16x32_bf16 v[200:203], a[68:71], v[100:103], v[200:203]
  ds_read_b128 v[148:151], v8 offset:0
  v_add_f32 v145, v145, v165
  s_mov_b32 s70, 45056
  buffer_load_dwordx4 a[176:179], v3, s[4:7], s70 offen offset:0
  v_add_f32 v146, v146, v166
  v_add_f32 v147, v147, v167
  v_fmac_f32 v144, v28, v204
  v_fmac_f32 v145, v28, v205
  v_fmac_f32 v146, v28, v206
  v_fmac_f32 v147, v28, v207
  ds_read_b128 v[152:155], v8 offset:192
  v_add_f32 v188, v188, v128
  v_mfma_f32_16x16x32_bf16 v[204:207], a[80:83], v[92:95], v[144:147]
  ds_read_b128 v[156:159], v8 offset:384
  v_add_f32 v189, v189, v129
  v_mfma_f32_16x16x32_bf16 v[204:207], a[92:95], v[104:107], v[204:207]
  ds_read_b128 v[160:163], v8 offset:576
  buffer_load_dwordx4 a[180:183], v3, s[4:7], s70 offen offset:1024
  v_mfma_f32_16x16x32_bf16 v[204:207], a[84:87], v[96:99], v[204:207]
  ds_read_b128 v[164:167], v8 offset:768
  v_add_f32 v190, v190, v130
  v_mfma_f32_16x16x32_bf16 v[204:207], a[96:99], v[108:111], v[204:207]
  v_add_f32 v191, v191, v131
  s_waitcnt lgkmcnt(9)
  v_add_f32 v188, v188, v168
  v_add_f32 v189, v189, v169
  v_add_f32 v190, v190, v170
  v_add_f32 v191, v191, v171
  ds_read_b128 v[168:171], v8 offset:16
  v_mfma_f32_16x16x32_bf16 v[204:207], a[88:91], v[100:103], v[204:207]
  v_cvt_pk_bf16_f32 v128, v188, v189
  v_cvt_pk_bf16_f32 v129, v190, v191
  buffer_load_dwordx4 a[184:187], v3, s[4:7], s70 offen offset:2048
  s_waitcnt lgkmcnt(9)
  v_pk_add_f32 v[192:193], v[192:193], v[172:173]
  v_pk_add_f32 v[194:195], v[194:195], v[174:175]
  ds_read_b128 v[172:175], v8 offset:208
  s_waitcnt lgkmcnt(9)
  v_pk_add_f32 v[196:197], v[196:197], v[176:177]
  v_pk_add_f32 v[198:199], v[198:199], v[178:179]
  s_waitcnt lgkmcnt(8)
  v_pk_add_f32 v[200:201], v[200:201], v[180:181]
  v_pk_add_f32 v[202:203], v[202:203], v[182:183]
  ds_read_b128 v[176:179], v8 offset:400
  s_waitcnt lgkmcnt(8)
  v_pk_add_f32 v[204:205], v[204:205], v[184:185]
  v_pk_add_f32 v[206:207], v[206:207], v[186:187]
  v_cvt_pk_bf16_f32 v130, v192, v193
  ds_read_b128 v[180:183], v8 offset:592
  v_cvt_pk_bf16_f32 v131, v194, v195
  buffer_load_dwordx4 a[188:191], v3, s[4:7], s70 offen offset:3072
  v_mov_b32 v138, 0
  ds_read_b128 v[184:187], v8 offset:784
  s_waitcnt lgkmcnt(9)
  v_mfma_f32_16x16x32_bf16 v[228:231], v[148:151], v[128:131], 0
  v_cvt_pk_bf16_f32 v132, v196, v197
  ds_read_b128 v[148:151], v8 offset:32
  s_waitcnt lgkmcnt(9)
  v_mfma_f32_16x16x32_bf16 v[232:235], v[152:155], v[128:131], 0
  v_cvt_pk_bf16_f32 v133, v198, v199
  ds_read_b128 v[152:155], v8 offset:224
  s_waitcnt lgkmcnt(9)
  v_mfma_f32_16x16x32_bf16 v[236:239], v[156:159], v[128:131], 0
  v_cvt_pk_bf16_f32 v134, v200, v201
  ds_read_b128 v[156:159], v8 offset:416
  s_waitcnt lgkmcnt(9)
  v_mfma_f32_16x16x32_bf16 v[240:243], v[160:163], v[128:131], 0
  s_mov_b32 s70, 49152
  buffer_load_dwordx4 a[192:195], v3, s[4:7], s70 offen offset:0
  ds_read_b128 v[160:163], v8 offset:608
  s_waitcnt lgkmcnt(9)
  v_mfma_f32_16x16x32_bf16 v[244:247], v[164:167], v[128:131], 0
  v_cvt_pk_bf16_f32 v135, v202, v203
  ds_read_b128 v[164:167], v8 offset:800
  v_mov_b32 v139, 0
  s_waitcnt lgkmcnt(9)
  v_mfma_f32_16x16x32_bf16 v[228:231], v[168:171], v[132:135], v[228:231]
  v_cvt_pk_bf16_f32 v136, v204, v205
  s_waitcnt lgkmcnt(8)
  v_mfma_f32_16x16x32_bf16 v[232:235], v[172:175], v[132:135], v[232:235]
  v_cvt_pk_bf16_f32 v137, v206, v207
  s_waitcnt lgkmcnt(7)
  v_mfma_f32_16x16x32_bf16 v[236:239], v[176:179], v[132:135], v[236:239]
  buffer_load_dwordx4 a[196:199], v3, s[4:7], s70 offen offset:1024
  s_waitcnt lgkmcnt(6)
  v_mfma_f32_16x16x32_bf16 v[240:243], v[180:183], v[132:135], v[240:243]
  s_waitcnt lgkmcnt(5)
  v_mfma_f32_16x16x32_bf16 v[244:247], v[184:187], v[132:135], v[244:247]
  s_waitcnt lgkmcnt(4)
  v_mfma_f32_16x16x32_bf16 v[228:231], v[148:151], v[136:139], v[228:231]
  s_waitcnt lgkmcnt(3)
  v_mfma_f32_16x16x32_bf16 v[232:235], v[152:155], v[136:139], v[232:235]
  s_waitcnt lgkmcnt(2)
  v_mfma_f32_16x16x32_bf16 v[236:239], v[156:159], v[136:139], v[236:239]
  buffer_load_dwordx4 a[200:203], v3, s[4:7], s70 offen offset:2048
  s_waitcnt lgkmcnt(1)
  v_mfma_f32_16x16x32_bf16 v[240:243], v[160:163], v[136:139], v[240:243]
  s_waitcnt lgkmcnt(0)
  v_mfma_f32_16x16x32_bf16 v[244:247], v[164:167], v[136:139], v[244:247]
  s_waitcnt vmcnt(26)
  v_mfma_f32_16x16x32_bf16 v[128:131], a[100:103], v[32:35], 0
  s_waitcnt vmcnt(25)
  v_mfma_f32_16x16x32_bf16 v[128:131], a[104:107], v[36:39], v[128:131]
  buffer_load_dwordx4 a[204:207], v3, s[4:7], s70 offen offset:3072
  s_waitcnt vmcnt(25)
  v_mfma_f32_16x16x32_bf16 v[128:131], a[108:111], v[40:43], v[128:131]
  v_max3_f32 v248, v228, v229, v230
  s_waitcnt vmcnt(24)
  v_mfma_f32_16x16x32_bf16 v[128:131], a[112:115], v[44:47], v[128:131]
  v_max3_f32 v248, v248, v231, v232
  s_waitcnt vmcnt(23)
  v_mfma_f32_16x16x32_bf16 v[128:131], a[116:119], v[48:51], v[128:131]
  v_max3_f32 v248, v248, v233, v234
  s_waitcnt vmcnt(22)
  v_mfma_f32_16x16x32_bf16 v[132:135], a[120:123], v[32:35], 0
  v_max3_f32 v248, v248, v235, v236
  s_waitcnt vmcnt(21)
  v_mfma_f32_16x16x32_bf16 v[132:135], a[124:127], v[36:39], v[132:135]
  s_mov_b32 s70, 53248
  buffer_load_dwordx4 a[208:211], v3, s[4:7], s70 offen offset:0
  s_waitcnt vmcnt(21)
  v_mfma_f32_16x16x32_bf16 v[132:135], a[128:131], v[40:43], v[132:135]
  v_max3_f32 v248, v248, v237, v238
  s_waitcnt vmcnt(20)
  v_mfma_f32_16x16x32_bf16 v[132:135], a[132:135], v[44:47], v[132:135]
  v_max3_f32 v248, v248, v239, v240
  s_waitcnt vmcnt(19)
  v_mfma_f32_16x16x32_bf16 v[132:135], a[136:139], v[48:51], v[132:135]
  v_max3_f32 v248, v248, v241, v242
  s_waitcnt vmcnt(18)
  v_mfma_f32_16x16x32_bf16 v[136:139], a[140:143], v[32:35], 0
  v_max3_f32 v248, v248, v243, v244
  buffer_load_dwordx2 v[120:121], v122, s[4:7], s76 offen sc1
  s_waitcnt vmcnt(18)
  v_mfma_f32_16x16x32_bf16 v[136:139], a[144:147], v[36:39], v[136:139]
  v_max3_f32 v248, v248, v245, v246
  s_waitcnt vmcnt(16)
  v_mfma_f32_16x16x32_bf16 v[136:139], a[148:151], v[40:43], v[136:139]
  v_max_f32 v248, v248, v247
  v_mul_f32 v248, v252, v248
  v_pk_fma_f32 v[188:189], v[228:229], v[252:253], v[248:249] op_sel_hi:[1,0,0] neg_lo:[0,0,1] neg_hi:[0,0,1]
  v_pk_fma_f32 v[190:191], v[230:231], v[252:253], v[248:249] op_sel_hi:[1,0,0] neg_lo:[0,0,1] neg_hi:[0,0,1]
  v_pk_fma_f32 v[192:193], v[232:233], v[252:253], v[248:249] op_sel_hi:[1,0,0] neg_lo:[0,0,1] neg_hi:[0,0,1]
  v_pk_fma_f32 v[194:195], v[234:235], v[252:253], v[248:249] op_sel_hi:[1,0,0] neg_lo:[0,0,1] neg_hi:[0,0,1]
  v_pk_fma_f32 v[196:197], v[236:237], v[252:253], v[248:249] op_sel_hi:[1,0,0] neg_lo:[0,0,1] neg_hi:[0,0,1]
  v_pk_fma_f32 v[198:199], v[238:239], v[252:253], v[248:249] op_sel_hi:[1,0,0] neg_lo:[0,0,1] neg_hi:[0,0,1]
  v_pk_fma_f32 v[200:201], v[240:241], v[252:253], v[248:249] op_sel_hi:[1,0,0] neg_lo:[0,0,1] neg_hi:[0,0,1]
  v_pk_fma_f32 v[202:203], v[242:243], v[252:253], v[248:249] op_sel_hi:[1,0,0] neg_lo:[0,0,1] neg_hi:[0,0,1]
  v_pk_fma_f32 v[204:205], v[244:245], v[252:253], v[248:249] op_sel_hi:[1,0,0] neg_lo:[0,0,1] neg_hi:[0,0,1]
  v_pk_fma_f32 v[206:207], v[246:247], v[252:253], v[248:249] op_sel_hi:[1,0,0] neg_lo:[0,0,1] neg_hi:[0,0,1]
  buffer_load_dwordx4 a[212:215], v3, s[4:7], s70 offen offset:1024
  s_waitcnt vmcnt(16)
  v_mfma_f32_16x16x32_bf16 v[136:139], a[152:155], v[44:47], v[136:139]
  v_exp_f32 v188, v188
  s_waitcnt vmcnt(15)
  v_mfma_f32_16x16x32_bf16 v[136:139], a[156:159], v[48:51], v[136:139]
  v_exp_f32 v189, v189
  s_waitcnt vmcnt(14)
  v_mfma_f32_16x16x32_bf16 v[140:143], a[160:163], v[32:35], 0
  v_exp_f32 v190, v190
  s_waitcnt vmcnt(13)
  v_mfma_f32_16x16x32_bf16 v[140:143], a[164:167], v[36:39], v[140:143]
  v_exp_f32 v191, v191
  s_waitcnt vmcnt(12)
  v_mfma_f32_16x16x32_bf16 v[140:143], a[168:171], v[40:43], v[140:143]
  buffer_load_dwordx4 a[216:219], v3, s[4:7], s70 offen offset:2048
  v_min3_f32 v250, v228, v229, v230
  s_waitcnt vmcnt(12)
  v_mfma_f32_16x16x32_bf16 v[140:143], a[172:175], v[44:47], v[140:143]
  v_exp_f32 v192, v192
  v_exp_f32 v193, v193
  v_exp_f32 v194, v194
  v_exp_f32 v195, v195
  v_exp_f32 v196, v196
  v_exp_f32 v197, v197
  v_exp_f32 v198, v198
  buffer_load_dwordx4 a[220:223], v3, s[4:7], s70 offen offset:3072
  s_waitcnt vmcnt(12)
  v_mfma_f32_16x16x32_bf16 v[140:143], a[176:179], v[48:51], v[140:143]
  v_exp_f32 v199, v199
  v_exp_f32 v200, v200
  v_exp_f32 v201, v201
  v_exp_f32 v202, v202
  v_exp_f32 v203, v203
  v_exp_f32 v204, v204
  v_exp_f32 v205, v205
  s_mov_b32 s70, 57344
  buffer_load_dwordx4 a[224:227], v3, s[4:7], s70 offen offset:0
  s_waitcnt vmcnt(12)
  v_mfma_f32_16x16x32_bf16 v[144:147], a[180:183], v[32:35], 0
  v_exp_f32 v206, v206
  v_exp_f32 v207, v207
  v_pk_add_f32 v[248:249], v[188:189], v[190:191]
  v_pk_add_f32 v[248:249], v[248:249], v[192:193]
  v_pk_add_f32 v[248:249], v[248:249], v[194:195]
  v_pk_add_f32 v[248:249], v[248:249], v[196:197]
  v_pk_add_f32 v[248:249], v[248:249], v[198:199]
  v_pk_add_f32 v[248:249], v[248:249], v[200:201]
  v_pk_add_f32 v[248:249], v[248:249], v[202:203]
  v_pk_add_f32 v[248:249], v[248:249], v[204:205]
  v_pk_add_f32 v[248:249], v[248:249], v[206:207]
  buffer_load_dwordx4 a[228:231], v3, s[4:7], s70 offen offset:1024
  s_waitcnt vmcnt(12)
  v_mfma_f32_16x16x32_bf16 v[144:147], a[184:187], v[36:39], v[144:147]
  ds_write_b128 v4, v[128:131] offset:0
  v_add_f32 v248, v248, v249
  v_rcp_f32 v248, v248
  s_nop 0
  v_pk_mul_f32 v[188:189], v[188:189], v[248:249] op_sel_hi:[1,0]
  v_pk_mul_f32 v[190:191], v[190:191], v[248:249] op_sel_hi:[1,0]
  v_pk_mul_f32 v[192:193], v[192:193], v[248:249] op_sel_hi:[1,0]
  v_pk_mul_f32 v[194:195], v[194:195], v[248:249] op_sel_hi:[1,0]
  v_pk_mul_f32 v[196:197], v[196:197], v[248:249] op_sel_hi:[1,0]
  v_pk_mul_f32 v[198:199], v[198:199], v[248:249] op_sel_hi:[1,0]
  v_pk_mul_f32 v[200:201], v[200:201], v[248:249] op_sel_hi:[1,0]
  v_pk_mul_f32 v[202:203], v[202:203], v[248:249] op_sel_hi:[1,0]
  v_pk_mul_f32 v[204:205], v[204:205], v[248:249] op_sel_hi:[1,0]
  v_pk_mul_f32 v[206:207], v[206:207], v[248:249] op_sel_hi:[1,0]
  buffer_load_dwordx4 a[232:235], v3, s[4:7], s70 offen offset:2048
  s_waitcnt vmcnt(12)
  v_mfma_f32_16x16x32_bf16 v[144:147], a[188:191], v[40:43], v[144:147]
  ds_write_b128 v4, v[132:135] offset:1024
  v_min3_f32 v250, v250, v231, v232
  s_waitcnt vmcnt(11)
  v_mfma_f32_16x16x32_bf16 v[144:147], a[192:195], v[44:47], v[144:147]
  v_min3_f32 v250, v250, v233, v234
  v_min3_f32 v250, v250, v235, v236
  v_min3_f32 v250, v250, v237, v238
  v_min3_f32 v250, v250, v239, v240
  ds_write_b128 v4, v[136:139] offset:2048
  buffer_load_dwordx4 a[236:239], v3, s[4:7], s70 offen offset:3072
  v_min3_f32 v250, v250, v241, v242
  v_min3_f32 v250, v250, v243, v244
  v_cvt_pk_bf16_f32 v188, v188, v189
  s_waitcnt vmcnt(11)
  v_mfma_f32_16x16x32_bf16 v[144:147], a[196:199], v[48:51], v[144:147]
  v_min3_f32 v250, v250, v245, v246
  v_mfma_f32_16x16x32_bf16 v[148:151], a[100:103], v[52:55], 0
  ds_write_b128 v4, v[140:143] offset:3072
  v_mfma_f32_16x16x32_bf16 v[148:151], a[104:107], v[56:59], v[148:151]
  s_mov_b32 s70, 61440
  buffer_load_dwordx4 a[240:243], v3, s[4:7], s70 offen offset:0
  v_mfma_f32_16x16x32_bf16 v[148:151], a[108:111], v[60:63], v[148:151]
  v_cvt_pk_bf16_f32 v189, v190, v191
  v_mfma_f32_16x16x32_bf16 v[148:151], a[112:115], v[64:67], v[148:151]
  ds_write_b128 v4, v[144:147] offset:4096
  v_mfma_f32_16x16x32_bf16 v[148:151], a[116:119], v[68:71], v[148:151]
  v_min_f32 v250, v250, v247
  v_mul_f32 v250, v252, v250
  v_pk_fma_f32 v[228:229], v[228:229], v[252:253], v[250:251] op_sel_hi:[1,0,0] neg_lo:[1,0,0] neg_hi:[1,0,0]
  v_pk_fma_f32 v[230:231], v[230:231], v[252:253], v[250:251] op_sel_hi:[1,0,0] neg_lo:[1,0,0] neg_hi:[1,0,0]
  v_pk_fma_f32 v[232:233], v[232:233], v[252:253], v[250:251] op_sel_hi:[1,0,0] neg_lo:[1,0,0] neg_hi:[1,0,0]
  v_pk_fma_f32 v[234:235], v[234:235], v[252:253], v[250:251] op_sel_hi:[1,0,0] neg_lo:[1,0,0] neg_hi:[1,0,0]
  v_pk_fma_f32 v[236:237], v[236:237], v[252:253], v[250:251] op_sel_hi:[1,0,0] neg_lo:[1,0,0] neg_hi:[1,0,0]
  v_pk_fma_f32 v[238:239], v[238:239], v[252:253], v[250:251] op_sel_hi:[1,0,0] neg_lo:[1,0,0] neg_hi:[1,0,0]
  v_pk_fma_f32 v[240:241], v[240:241], v[252:253], v[250:251] op_sel_hi:[1,0,0] neg_lo:[1,0,0] neg_hi:[1,0,0]
  v_pk_fma_f32 v[242:243], v[242:243], v[252:253], v[250:251] op_sel_hi:[1,0,0] neg_lo:[1,0,0] neg_hi:[1,0,0]
  v_pk_fma_f32 v[244:245], v[244:245], v[252:253], v[250:251] op_sel_hi:[1,0,0] neg_lo:[1,0,0] neg_hi:[1,0,0]
  v_pk_fma_f32 v[246:247], v[246:247], v[252:253], v[250:251] op_sel_hi:[1,0,0] neg_lo:[1,0,0] neg_hi:[1,0,0]
  buffer_load_dwordx4 a[244:247], v3, s[4:7], s70 offen offset:1024
  v_mfma_f32_16x16x32_bf16 v[152:155], a[120:123], v[52:55], 0
  ds_write_b128 v5, v[148:151] offset:0
  v_mfma_f32_16x16x32_bf16 v[152:155], a[124:127], v[56:59], v[152:155]
  v_cvt_pk_bf16_f32 v190, v192, v193
  v_mfma_f32_16x16x32_bf16 v[152:155], a[128:131], v[60:63], v[152:155]
  v_cvt_pk_bf16_f32 v191, v194, v195
  v_mfma_f32_16x16x32_bf16 v[152:155], a[132:135], v[64:67], v[152:155]
  buffer_load_dwordx4 a[248:251], v3, s[4:7], s70 offen offset:2048
  v_mfma_f32_16x16x32_bf16 v[152:155], a[136:139], v[68:71], v[152:155]
  ds_write_b128 v10, v[188:191] offset:0
  v_mfma_f32_16x16x32_bf16 v[156:159], a[140:143], v[52:55], 0
  s_waitcnt vmcnt(10)
  v_cmp_ne_u32 vcc, s68, v120
  ds_read_b128 v[188:191], v12 offset:320
  s_cbranch_vccnz L_retry_2
L_ok_3:
  v_mfma_f32_16x16x32_bf16 v[156:159], a[144:147], v[56:59], v[156:159]
  buffer_load_dwordx4 a[0:3], v3, s[4:7], s70 offen offset:3072
  v_mfma_f32_16x16x32_bf16 v[156:159], a[148:151], v[60:63], v[156:159]
  ds_write_b128 v5, v[152:155] offset:1024
  v_mfma_f32_16x16x32_bf16 v[156:159], a[152:155], v[64:67], v[156:159]
  v_exp_f32 v228, v228
  v_mfma_f32_16x16x32_bf16 v[156:159], a[156:159], v[68:71], v[156:159]
  v_exp_f32 v229, v229
  v_mfma_f32_16x16x32_bf16 v[160:163], a[160:163], v[52:55], 0
  s_mov_b32 s70, 65536
  buffer_load_dwordx4 a[4:7], v3, s[4:7], s70 offen offset:0
  v_mfma_f32_16x16x32_bf16 v[160:163], a[164:167], v[56:59], v[160:163]
  v_exp_f32 v230, v230
  v_mfma_f32_16x16x32_bf16 v[160:163], a[168:171], v[60:63], v[160:163]
  v_exp_f32 v231, v231
  v_mfma_f32_16x16x32_bf16 v[160:163], a[172:175], v[64:67], v[160:163]
  ds_write_b128 v5, v[156:159] offset:2048
  v_mfma_f32_16x16x32_bf16 v[160:163], a[176:179], v[68:71], v[160:163]
  buffer_load_dwordx4 a[8:11], v3, s[4:7], s70 offen offset:1024
  v_mfma_f32_16x16x32_bf16 v[164:167], a[180:183], v[52:55], 0
  v_exp_f32 v232, v232
  v_mfma_f32_16x16x32_bf16 v[164:167], a[184:187], v[56:59], v[164:167]
  v_exp_f32 v233, v233
  v_mfma_f32_16x16x32_bf16 v[164:167], a[188:191], v[60:63], v[164:167]
  v_exp_f32 v234, v234
  v_mfma_f32_16x16x32_bf16 v[164:167], a[192:195], v[64:67], v[164:167]
  ds_write_b128 v5, v[160:163] offset:3072
  buffer_load_dwordx4 a[12:15], v3, s[4:7], s70 offen offset:2048
  v_mfma_f32_16x16x32_bf16 v[164:167], a[196:199], v[68:71], v[164:167]
  v_exp_f32 v235, v235
  v_mfma_f32_16x16x32_bf16 v[168:171], a[100:103], v[72:75], 0
  v_exp_f32 v236, v236
  v_mfma_f32_16x16x32_bf16 v[168:171], a[104:107], v[76:79], v[168:171]
  v_exp_f32 v237, v237
  v_mfma_f32_16x16x32_bf16 v[168:171], a[108:111], v[80:83], v[168:171]
  v_exp_f32 v238, v238
  v_mfma_f32_16x16x32_bf16 v[168:171], a[112:115], v[84:87], v[168:171]
  buffer_load_dwordx4 a[16:19], v3, s[4:7], s70 offen offset:3072
  v_mfma_f32_16x16x32_bf16 v[168:171], a[116:119], v[88:91], v[168:171]
  ds_write_b128 v5, v[164:167] offset:4096
  v_mfma_f32_16x16x32_bf16 v[172:175], a[120:123], v[72:75], 0
  v_exp_f32 v239, v239
  v_mfma_f32_16x16x32_bf16 v[172:175], a[124:127], v[76:79], v[172:175]
  v_exp_f32 v240, v240
  v_mfma_f32_16x16x32_bf16 v[172:175], a[128:131], v[80:83], v[172:175]
  s_mov_b32 s70, 69632
  buffer_load_dwordx4 a[20:23], v3, s[4:7], s70 offen offset:0
  v_mfma_f32_16x16x32_bf16 v[172:175], a[132:135], v[84:87], v[172:175]
  v_exp_f32 v241, v241
  v_mfma_f32_16x16x32_bf16 v[172:175], a[136:139], v[88:91], v[172:175]
  v_exp_f32 v242, v242
  v_mfma_f32_16x16x32_bf16 v[176:179], a[140:143], v[72:75], 0
  v_exp_f32 v243, v243
  v_mfma_f32_16x16x32_bf16 v[176:179], a[144:147], v[76:79], v[176:179]
  v_exp_f32 v244, v244
  v_mfma_f32_16x16x32_bf16 v[176:179], a[148:151], v[80:83], v[176:179]
  buffer_load_dwordx4 a[24:27], v3, s[4:7], s70 offen offset:1024
  v_mfma_f32_16x16x32_bf16 v[176:179], a[152:155], v[84:87], v[176:179]
  v_exp_f32 v245, v245
  v_mfma_f32_16x16x32_bf16 v[176:179], a[156:159], v[88:91], v[176:179]
  v_exp_f32 v246, v246
  v_mfma_f32_16x16x32_bf16 v[180:183], a[160:163], v[72:75], 0
  v_exp_f32 v247, v247
  v_pk_add_f32 v[250:251], v[228:229], v[230:231]
  v_pk_add_f32 v[250:251], v[250:251], v[232:233]
  v_pk_add_f32 v[250:251], v[250:251], v[234:235]
  v_pk_add_f32 v[250:251], v[250:251], v[236:237]
  v_pk_add_f32 v[250:251], v[250:251], v[238:239]
  v_pk_add_f32 v[250:251], v[250:251], v[240:241]
  v_pk_add_f32 v[250:251], v[250:251], v[242:243]
  v_pk_add_f32 v[250:251], v[250:251], v[244:245]
  v_pk_add_f32 v[250:251], v[250:251], v[246:247]
  buffer_load_dwordx4 a[28:31], v3, s[4:7], s70 offen offset:2048
  v_mfma_f32_16x16x32_bf16 v[180:183], a[164:167], v[76:79], v[180:183]
  s_waitcnt lgkmcnt(0)
  s_barrier
  v_mfma_f32_16x16x32_bf16 v[180:183], a[168:171], v[80:83], v[180:183]
  v_cvt_pk_bf16_f32 v192, v196, v197
  v_mfma_f32_16x16x32_bf16 v[180:183], a[172:175], v[84:87], v[180:183]
  buffer_load_dwordx4 a[32:35], v3, s[4:7], s70 offen offset:3072
  v_mfma_f32_16x16x32_bf16 v[180:183], a[176:179], v[88:91], v[180:183]
  v_cvt_pk_bf16_f32 v193, v198, v199
  v_mfma_f32_16x16x32_bf16 v[184:187], a[180:183], v[72:75], 0
  v_cvt_pk_bf16_f32 v194, v200, v201
  v_mfma_f32_16x16x32_bf16 v[184:187], a[184:187], v[76:79], v[184:187]
  v_cvt_pk_bf16_f32 v195, v202, v203
  ds_write_b128 v10, v[192:195] offset:16
  v_mfma_f32_16x16x32_bf16 v[184:187], a[188:191], v[80:83], v[184:187]
  s_mov_b32 s70, 73728
  buffer_load_dwordx4 a[36:39], v3, s[4:7], s70 offen offset:0
  ds_read_b128 v[132:135], v7 offset:1024
  v_add_f32 v250, v250, v251
  v_rcp_f32 v250, v250
  ds_read_b128 v[152:155], v7 offset:6144
  v_pk_mul_f32 v[228:229], v[228:229], v[250:251] op_sel_hi:[1,0]
  v_pk_mul_f32 v[230:231], v[230:231], v[250:251] op_sel_hi:[1,0]
  v_pk_mul_f32 v[232:233], v[232:233], v[250:251] op_sel_hi:[1,0]
  v_pk_mul_f32 v[234:235], v[234:235], v[250:251] op_sel_hi:[1,0]
  v_pk_mul_f32 v[236:237], v[236:237], v[250:251] op_sel_hi:[1,0]
  v_pk_mul_f32 v[238:239], v[238:239], v[250:251] op_sel_hi:[1,0]
  v_pk_mul_f32 v[240:241], v[240:241], v[250:251] op_sel_hi:[1,0]
  v_pk_mul_f32 v[242:243], v[242:243], v[250:251] op_sel_hi:[1,0]
  v_pk_mul_f32 v[244:245], v[244:245], v[250:251] op_sel_hi:[1,0]
  v_pk_mul_f32 v[246:247], v[246:247], v[250:251] op_sel_hi:[1,0]
  buffer_load_dwordx4 a[40:43], v3, s[4:7], s70 offen offset:1024
  ds_read_b128 v[192:195], v12 offset:336
  v_mfma_f32_16x16x32_bf16 v[184:187], a[192:195], v[84:87], v[184:187]
  v_cvt_pk_bf16_f32 v196, v204, v205
  v_mfma_f32_16x16x32_bf16 v[184:187], a[196:199], v[88:91], v[184:187]
  v_cvt_pk_bf16_f32 v197, v206, v207
  v_cvt_pk_bf16_f32 v198, v228, v229
  v_cvt_pk_bf16_f32 v199, v230, v231
  ds_write_b128 v10, v[196:199] offset:32
  buffer_load_dwordx4 a[44:47], v3, s[4:7], s70 offen offset:2048
  v_mul_f32 v188, v28, v188
  v_mul_f32 v189, v28, v189
  v_mul_f32 v190, v28, v190
  v_mul_f32 v191, v28, v191
  ds_read_b128 v[136:139], v7 offset:2048
  v_cmp_ne_u32 vcc, s74, v121
  v_mfma_f32_16x16x32_bf16 v[188:191], a[100:103], v[92:95], v[188:191]
  ds_write_b128 v6, v[168:171] offset:0
  ds_read_b128 v[156:159], v7 offset:7168
  v_mfma_f32_16x16x32_bf16 v[188:191], a[104:107], v[96:99], v[188:191]
  buffer_load_dwordx4 a[48:51], v3, s[4:7], s70 offen offset:3072
  ds_read_b128 v[196:199], v12 offset:352
  v_mfma_f32_16x16x32_bf16 v[188:191], a[108:111], v[100:103], v[188:191]
  v_cvt_pk_bf16_f32 v200, v232, v233
  ds_write_b128 v6, v[172:175] offset:1024
  ds_read_b128 v[140:143], v7 offset:3072
  v_mfma_f32_16x16x32_bf16 v[188:191], a[112:115], v[104:107], v[188:191]
  v_cvt_pk_bf16_f32 v201, v234, v235
  ds_read_b128 v[160:163], v7 offset:8192
  v_mfma_f32_16x16x32_bf16 v[188:191], a[116:119], v[108:111], v[188:191]
  s_mov_b32 s70, 77824
  buffer_load_dwordx4 a[52:55], v3, s[4:7], s70 offen offset:0
  ds_write_b128 v6, v[176:179] offset:2048
  ds_read_b128 v[144:147], v7 offset:4096
  v_cvt_pk_bf16_f32 v202, v236, v237
  v_cvt_pk_bf16_f32 v203, v238, v239
  s_waitcnt lgkmcnt(11)
  v_add_f32 v132, v132, v152
  ds_read_b128 v[164:167], v7 offset:9216
  v_add_f32 v133, v133, v153
  v_add_f32 v134, v134, v154
  v_add_f32 v135, v135, v155
  ds_write_b128 v6, v[180:183] offset:3072
  buffer_load_dwordx4 a[56:59], v3, s[4:7], s70 offen offset:1024
  ds_read_b128 v[128:131], v7 offset:0
  s_waitcnt lgkmcnt(13)
  v_fmac_f32 v132, v28, v192
  v_fmac_f32 v133, v28, v193
  v_fmac_f32 v134, v28, v194
  ds_read_b128 v[148:151], v7 offset:5120
  v_fmac_f32 v135, v28, v195
  v_cvt_pk_bf16_f32 v204, v240, v241
  ds_write_b128 v6, v[184:187] offset:4096
  v_mfma_f32_16x16x32_bf16 v[192:195], a[120:123], v[92:95], v[132:135]
  v_cvt_pk_bf16_f32 v205, v242, v243
  v_mfma_f32_16x16x32_bf16 v[192:195], a[124:127], v[96:99], v[192:195]
  buffer_load_dwordx4 a[60:63], v3, s[4:7], s70 offen offset:2048
  ds_write_b128 v10, v[200:203] offset:48
  v_mfma_f32_16x16x32_bf16 v[192:195], a[128:131], v[100:103], v[192:195]
  v_cvt_pk_bf16_f32 v206, v244, v245
  ds_read_b128 v[200:203], v12 offset:368
  v_mfma_f32_16x16x32_bf16 v[192:195], a[132:135], v[104:107], v[192:195]
  v_cvt_pk_bf16_f32 v207, v246, v247
  ds_write_b128 v10, v[204:207] offset:64
  buffer_load_dwordx4 a[64:67], v3, s[4:7], s70 offen offset:3072
  v_mfma_f32_16x16x32_bf16 v[192:195], a[136:139], v[108:111], v[192:195]
  s_waitcnt lgkmcnt(14)
  v_add_f32 v136, v136, v156
  v_add_f32 v137, v137, v157
  v_add_f32 v138, v138, v158
  v_add_f32 v139, v139, v159
  s_waitcnt lgkmcnt(13)
  v_fmac_f32 v136, v28, v196
  v_fmac_f32 v137, v28, v197
  v_fmac_f32 v138, v28, v198
  v_fmac_f32 v139, v28, v199
  s_waitcnt lgkmcnt(3)
  s_barrier
  s_mov_b32 s70, 81920
  buffer_load_dwordx4 a[68:71], v3, s[4:7], s70 offen offset:0
  v_mfma_f32_16x16x32_bf16 v[196:199], a[140:143], v[92:95], v[136:139]
  ds_read_b128 v[204:207], v12 offset:384
  v_add_f32 v140, v140, v160
  v_mfma_f32_16x16x32_bf16 v[196:199], a[144:147], v[96:99], v[196:199]
  ds_read_b128 v[172:175], v7 offset:11264
  v_add_f32 v141, v141, v161
  v_mfma_f32_16x16x32_bf16 v[196:199], a[148:151], v[100:103], v[196:199]
  ds_read_b128 v[168:171], v7 offset:10240
  v_add_f32 v142, v142, v162
  v_mfma_f32_16x16x32_bf16 v[196:199], a[152:155], v[104:107], v[196:199]
  v_add_f32 v143, v143, v163
  buffer_load_dwordx4 a[72:75], v3, s[4:7], s70 offen offset:1024
  v_mfma_f32_16x16x32_bf16 v[196:199], a[156:159], v[108:111], v[196:199]
  s_waitcnt lgkmcnt(4)
  v_fmac_f32 v140, v28, v200
  v_fmac_f32 v141, v28, v201
  v_fmac_f32 v142, v28, v202
  v_fmac_f32 v143, v28, v203
  ds_read_b128 v[176:179], v7 offset:12288
  v_add_f32 v144, v144, v164
  v_mfma_f32_16x16x32_bf16 v[200:203], a[160:163], v[92:95], v[140:143]
  ds_read_b128 v[180:183], v7 offset:13312
  v_add_f32 v145, v145, v165
  v_mfma_f32_16x16x32_bf16 v[200:203], a[164:167], v[96:99], v[200:203]
  ds_read_b128 v[184:187], v7 offset:14336
  v_add_f32 v146, v146, v166
  v_mfma_f32_16x16x32_bf16 v[200:203], a[168:171], v[100:103], v[200:203]
  buffer_load_dwordx4 a[76:79], v3, s[4:7], s70 offen offset:2048
  v_mfma_f32_16x16x32_bf16 v[200:203], a[172:175], v[104:107], v[200:203]
  v_add_f32 v147, v147, v167
  v_add_f32 v128, v128, v148
  v_mfma_f32_16x16x32_bf16 v[200:203], a[176:179], v[108:111], v[200:203]
  s_waitcnt lgkmcnt(5)
  v_fmac_f32 v144, v28, v204
  v_fmac_f32 v145, v28, v205
  v_fmac_f32 v146, v28, v206
  v_fmac_f32 v147, v28, v207
  v_add_f32 v129, v129, v149
  v_add_f32 v130, v130, v150
  v_mfma_f32_16x16x32_bf16 v[204:207], a[180:183], v[92:95], v[144:147]
  v_add_f32 v131, v131, v151
  buffer_load_dwordx4 a[80:83], v3, s[4:7], s70 offen offset:3072
  v_mfma_f32_16x16x32_bf16 v[204:207], a[184:187], v[96:99], v[204:207]
  v_add_f32 v188, v188, v128
  v_add_f32 v189, v189, v129
  s_waitcnt lgkmcnt(4)
  v_pk_add_f32 v[192:193], v[192:193], v[172:173]
  v_pk_add_f32 v[194:195], v[194:195], v[174:175]
  v_add_f32 v190, v190, v130
  v_add_f32 v191, v191, v131
  s_waitcnt lgkmcnt(3)
  v_add_f32 v188, v188, v168
  v_add_f32 v189, v189, v169
  v_add_f32 v190, v190, v170
  v_add_f32 v191, v191, v171
  v_pk_mul_f32 v[192:193], v[192:193], v[30:31] op_sel_hi:[1,0]
  s_mov_b32 s70, 86016
  buffer_load_dwordx4 a[84:87], v3, s[4:7], s70 offen offset:0
  v_pk_mul_f32 v[194:195], v[194:195], v[30:31] op_sel_hi:[1,0]
  v_pk_mul_f32 v[188:189], v[188:189], v[30:31] op_sel_hi:[1,0]
  v_pk_mul_f32 v[190:191], v[190:191], v[30:31] op_sel_hi:[1,0]
  v_mov_b32 v246, 0x3f80
  v_mfma_f32_16x16x32_bf16 v[204:207], a[188:191], v[100:103], v[204:207]
  v_cvt_pk_bf16_f32 v238, v192, v193
  v_cvt_pk_bf16_f32 v239, v194, v195
  v_cvt_pk_bf16_f32 v236, v188, v189
  v_cvt_pk_bf16_f32 v237, v190, v191
  ds_write_b128 v10, v[236:239] offset:80
  v_mfma_f32_16x16x32_bf16 v[204:207], a[192:195], v[104:107], v[204:207]
  buffer_load_dwordx4 a[88:91], v3, s[4:7], s70 offen offset:1024
  v_mfma_f32_16x16x32_bf16 v[204:207], a[196:199], v[108:111], v[204:207]
  v_mov_b32 v247, 0
  v_and_b32 v120, 7, v0
  s_waitcnt lgkmcnt(3)
  v_pk_add_f32 v[196:197], v[196:197], v[176:177]
  v_pk_add_f32 v[198:199], v[198:199], v[178:179]
  s_waitcnt lgkmcnt(2)
  v_pk_add_f32 v[200:201], v[200:201], v[180:181]
  v_pk_add_f32 v[202:203], v[202:203], v[182:183]
  v_pk_mul_f32 v[196:197], v[196:197], v[30:31] op_sel_hi:[1,0]
  v_pk_mul_f32 v[198:199], v[198:199], v[30:31] op_sel_hi:[1,0]
  v_pk_mul_f32 v[200:201], v[200:201], v[30:31] op_sel_hi:[1,0]
  v_pk_mul_f32 v[202:203], v[202:203], v[30:31] op_sel_hi:[1,0]
  buffer_load_dwordx4 a[92:95], v3, s[4:7], s70 offen offset:2048
  v_cvt_pk_bf16_f32 v240, v196, v197
  v_cvt_pk_bf16_f32 v241, v198, v199
  v_cvt_pk_bf16_f32 v242, v200, v201
  v_cvt_pk_bf16_f32 v243, v202, v203
  ds_write_b128 v10, v[240:243] offset:96
  s_waitcnt lgkmcnt(2)
  v_pk_add_f32 v[204:205], v[204:205], v[184:185]
  v_pk_add_f32 v[206:207], v[206:207], v[186:187]
  v_pk_mul_f32 v[204:205], v[204:205], v[30:31] op_sel_hi:[1,0]
  v_pk_mul_f32 v[206:207], v[206:207], v[30:31] op_sel_hi:[1,0]
  v_cvt_pk_bf16_f32 v244, v204, v205
  buffer_load_dwordx4 a[96:99], v3, s[4:7], s70 offen offset:3072
  v_cvt_pk_bf16_f32 v245, v206, v207
  ds_write_b128 v10, v[244:247] offset:112
  v_lshrrev_b32 v121, 4, v0
  v_lshlrev_b32 v120, 4, v120
  v_lshl_add_u32 v117, v121, 7, v120
  s_and_b32 s85, vcc_lo, 0xff
  s_cselect_b32 s71, 0, 1
  v_and_b32 v120, 8, v0
  v_mov_b32 v122, 0x80000000
  v_cmp_ne_u32 vcc, 0, v120
  v_and_b32 v120, 12, v0
  v_lshl_add_u32 v125, v121, 2, v125
  v_cndmask_b32 v117, v122, v117, vcc
  s_mov_b32 s70, 90112
  buffer_load_dwordx4 a[100:103], v3, s[4:7], s70 offen offset:0
  v_cmp_gt_u32 vcc, 32, v0
  ds_read_b128 v[192:195], v12 offset:656
  v_mov_b32 v121, 0x3727c5ac
  v_cndmask_b32 v118, v122, v1, vcc
  v_cmp_eq_u32 vcc, 0, v120
  ds_read_b128 v[196:199], v12 offset:672
  s_nop 0
  v_cndmask_b32 v125, v122, v125, vcc
  ds_read_b128 v[200:203], v12 offset:688
  ds_read_b128 v[204:207], v12 offset:704
  buffer_load_dwordx4 a[104:107], v3, s[4:7], s70 offen offset:1024
  s_waitcnt lgkmcnt(4)
  s_barrier
  buffer_load_dwordx4 a[108:111], v3, s[4:7], s70 offen offset:2048
  ds_read_b64_tr_b16 v[128:129], v11 offset:0
  ds_read_b64_tr_b16 v[130:131], v11 offset:576
  ds_read_b64_tr_b16 v[140:141], v11 offset:80
  ds_read_b64_tr_b16 v[142:143], v11 offset:656
  buffer_load_dwordx4 a[112:115], v3, s[4:7], s70 offen offset:3072
  ds_read_b64_tr_b16 v[144:145], v11 offset:96
  ds_read_b64_tr_b16 v[146:147], v11 offset:672
  ds_read_b64_tr_b16 v[132:133], v11 offset:32
  ds_read_b64_tr_b16 v[134:135], v11 offset:608
  s_mov_b32 s70, 94208
  buffer_load_dwordx4 a[116:119], v3, s[4:7], s70 offen offset:0
  ds_read_b64_tr_b16 v[136:137], v11 offset:64
  ds_read_b64_tr_b16 v[138:139], v11 offset:640
  ds_read_b64_tr_b16 v[148:149], v11 offset:4608
  ds_read_b64_tr_b16 v[150:151], v11 offset:5184
  ds_read_b64_tr_b16 v[160:161], v11 offset:4688
  s_waitcnt lgkmcnt(9)
  v_mfma_f32_16x16x32_bf16 v[168:171], v[128:131], v[140:143], 0
  buffer_load_dwordx4 a[120:123], v3, s[4:7], s70 offen offset:1024
  ds_read_b64_tr_b16 v[162:163], v11 offset:5264
  ds_read_b64_tr_b16 v[164:165], v11 offset:4704
  s_waitcnt lgkmcnt(9)
  v_mfma_f32_16x16x32_bf16 v[172:175], v[128:131], v[144:147], 0
  ds_read_b64_tr_b16 v[166:167], v11 offset:5280
  ds_read_b64_tr_b16 v[152:153], v11 offset:4640
  s_waitcnt lgkmcnt(9)
  v_mfma_f32_16x16x32_bf16 v[176:179], v[132:135], v[140:143], 0
  buffer_load_dwordx4 a[124:127], v3, s[4:7], s70 offen offset:2048
  ds_read_b64_tr_b16 v[154:155], v11 offset:5216
  v_mfma_f32_16x16x32_bf16 v[180:183], v[132:135], v[144:147], 0
  ds_read_b64_tr_b16 v[156:157], v11 offset:4672
  s_waitcnt lgkmcnt(9)
  v_mfma_f32_16x16x32_bf16 v[184:187], v[136:139], v[140:143], 0
  ds_read_b64_tr_b16 v[158:159], v11 offset:5248
  v_mfma_f32_16x16x32_bf16 v[188:191], v[136:139], v[144:147], 0
  buffer_load_dwordx4 a[128:131], v3, s[4:7], s70 offen offset:3072
  s_waitcnt lgkmcnt(6)
  v_mfma_f32_16x16x32_bf16 v[168:171], v[148:151], v[160:163], v[168:171]
  s_waitcnt lgkmcnt(4)
  v_mfma_f32_16x16x32_bf16 v[172:175], v[148:151], v[164:167], v[172:175]
  s_mov_b32 s70, 98304
  buffer_load_dwordx4 a[132:135], v3, s[4:7], s70 offen offset:0
  s_waitcnt lgkmcnt(2)
  v_mfma_f32_16x16x32_bf16 v[176:179], v[152:155], v[160:163], v[176:179]
  v_mfma_f32_16x16x32_bf16 v[180:183], v[152:155], v[164:167], v[180:183]
  s_waitcnt lgkmcnt(0)
  v_mfma_f32_16x16x32_bf16 v[184:187], v[156:159], v[160:163], v[184:187]
  v_mfma_f32_16x16x32_bf16 v[188:191], v[156:159], v[164:167], v[188:191]
  buffer_load_dwordx4 a[136:139], v3, s[4:7], s70 offen offset:1024
  v_cvt_pk_bf16_f32 v228, v168, v169
  v_cvt_pk_bf16_f32 v232, v172, v173
  v_cvt_pk_bf16_f32 v229, v170, v171
  v_cvt_pk_bf16_f32 v233, v174, v175
  v_cvt_pk_bf16_f32 v230, v176, v177
  v_cvt_pk_bf16_f32 v231, v178, v179
  v_cvt_pk_bf16_f32 v236, v184, v185
  v_cvt_pk_bf16_f32 v234, v180, v181
  v_cvt_pk_bf16_f32 v235, v182, v183
  v_cvt_pk_bf16_f32 v237, v186, v187
  v_cvt_pk_bf16_f32 v238, v188, v189
  v_cvt_pk_bf16_f32 v239, v190, v191
  v_bitop3_b32 v228, v228, v14, v14 bitop3:0x30
  v_bitop3_b32 v232, v232, v14, v14 bitop3:0x30
  v_bitop3_b32 v236, v236, v14, v14 bitop3:0x30
  buffer_store_dwordx4 v[228:231], v1, s[4:7], s62 offen offset:0 sc1
  v_mfma_f32_16x16x32_bf16 v[128:131], a[200:203], v[32:35], 0
  ds_read_b128 v[188:191], v12 offset:640
  buffer_store_dwordx4 v[232:235], v117, s[4:7], s62 offen offset:1024 sc1
  v_mfma_f32_16x16x32_bf16 v[128:131], a[204:207], v[36:39], v[128:131]
  buffer_store_dwordx4 v[236:239], v118, s[4:7], s62 offen offset:1536 sc1
  v_mfma_f32_16x16x32_bf16 v[128:131], a[208:211], v[40:43], v[128:131]
  s_waitcnt vmcnt(47)
  v_mfma_f32_16x16x32_bf16 v[128:131], a[212:215], v[44:47], v[128:131]
  s_waitcnt vmcnt(46)
  v_mfma_f32_16x16x32_bf16 v[128:131], a[216:219], v[48:51], v[128:131]
  s_waitcnt vmcnt(45)
  v_mfma_f32_16x16x32_bf16 v[132:135], a[220:223], v[32:35], 0
  buffer_load_dwordx4 a[140:143], v3, s[4:7], s70 offen offset:2048
  s_waitcnt vmcnt(45)
  v_mfma_f32_16x16x32_bf16 v[132:135], a[224:227], v[36:39], v[132:135]
  s_waitcnt vmcnt(44)
  v_mfma_f32_16x16x32_bf16 v[132:135], a[228:231], v[40:43], v[132:135]
  s_waitcnt vmcnt(43)
  v_mfma_f32_16x16x32_bf16 v[132:135], a[232:235], v[44:47], v[132:135]
  s_waitcnt lgkmcnt(0)
  v_mul_f32 v188, v28, v188
  v_mul_f32 v189, v28, v189
  s_waitcnt vmcnt(42)
  v_mfma_f32_16x16x32_bf16 v[132:135], a[236:239], v[48:51], v[132:135]
  ds_write_b128 v4, v[128:131] offset:0
  buffer_store_dwordx4 v[22:25], v1, s[4:7], s52 offen offset:0 sc1
  s_waitcnt vmcnt(42)
  v_mfma_f32_16x16x32_bf16 v[136:139], a[240:243], v[32:35], 0
  v_mul_f32 v190, v28, v190
  v_mul_f32 v191, v28, v191
  s_waitcnt vmcnt(41)
  v_mfma_f32_16x16x32_bf16 v[136:139], a[244:247], v[36:39], v[136:139]
  s_waitcnt vmcnt(40)
  v_mfma_f32_16x16x32_bf16 v[136:139], a[248:251], v[40:43], v[136:139]
  s_waitcnt vmcnt(39)
  v_mfma_f32_16x16x32_bf16 v[136:139], a[0:3], v[44:47], v[136:139]
  buffer_load_dwordx4 a[144:147], v3, s[4:7], s70 offen offset:3072
  s_waitcnt vmcnt(39)
  v_mfma_f32_16x16x32_bf16 v[136:139], a[4:7], v[48:51], v[136:139]
  ds_write_b128 v4, v[132:135] offset:1024
  s_waitcnt vmcnt(38)
  v_mfma_f32_16x16x32_bf16 v[140:143], a[8:11], v[32:35], 0
  s_waitcnt vmcnt(37)
  v_mfma_f32_16x16x32_bf16 v[140:143], a[12:15], v[36:39], v[140:143]
  s_waitcnt vmcnt(36)
  v_mfma_f32_16x16x32_bf16 v[140:143], a[16:19], v[40:43], v[140:143]
  buffer_store_dwordx4 v[22:25], v1, s[4:7], s52 offen offset:1024 sc1
  s_waitcnt vmcnt(36)
  v_mfma_f32_16x16x32_bf16 v[140:143], a[20:23], v[44:47], v[140:143]
  s_waitcnt vmcnt(35)
  v_mfma_f32_16x16x32_bf16 v[140:143], a[24:27], v[48:51], v[140:143]
  s_waitcnt vmcnt(34)
  v_mfma_f32_16x16x32_bf16 v[144:147], a[28:31], v[32:35], 0
  ds_write_b128 v4, v[136:139] offset:2048
  s_waitcnt vmcnt(33)
  v_mfma_f32_16x16x32_bf16 v[144:147], a[32:35], v[36:39], v[144:147]
  buffer_store_dwordx4 v[22:25], v1, s[4:7], s52 offen offset:2048 sc1
  s_waitcnt vmcnt(33)
  v_mfma_f32_16x16x32_bf16 v[144:147], a[36:39], v[40:43], v[144:147]
  v_lshrrev_b32 v40, 2, v0
  v_and_b32 v41, 15, v0
  s_waitcnt vmcnt(32)
  v_mfma_f32_16x16x32_bf16 v[144:147], a[40:43], v[44:47], v[144:147]
  v_and_b32 v45, 48, v1
  v_lshl_add_u32 v40, v40, 7, v45
  s_waitcnt vmcnt(31)
  v_mfma_f32_16x16x32_bf16 v[144:147], a[44:47], v[48:51], v[144:147]
  ds_write_b128 v4, v[140:143] offset:3072
  v_mfma_f32_16x16x32_bf16 v[148:151], a[200:203], v[52:55], 0
  buffer_store_dwordx4 v[22:25], v1, s[4:7], s52 offen offset:3072 sc1
  v_mfma_f32_16x16x32_bf16 v[148:151], a[204:207], v[56:59], v[148:151]
  ds_read_b128 v[48:51], v8 offset:16
  v_mul_u32_u24 v41, 80, v41
  v_mfma_f32_16x16x32_bf16 v[148:151], a[208:211], v[60:63], v[148:151]
  v_lshrrev_b32 v45, 4, v0
  v_lshl_add_u32 v41, v45, 3, v41
  v_mfma_f32_16x16x32_bf16 v[148:151], a[212:215], v[64:67], v[148:151]
  ds_write_b128 v4, v[144:147] offset:4096
  v_mfma_f32_16x16x32_bf16 v[148:151], a[216:219], v[68:71], v[148:151]
  buffer_store_dwordx4 v[22:25], v1, s[4:7], s53 offen offset:0 sc1
  v_mfma_f32_16x16x32_bf16 v[152:155], a[220:223], v[52:55], 0
  v_and_b32 v45, 7, v0
  v_and_b32 v46, 24, v0
  v_mfma_f32_16x16x32_bf16 v[152:155], a[224:227], v[56:59], v[152:155]
  v_mul_u32_u24 v45, 80, v45
  v_add_u32 v41, s83, v41
  v_mfma_f32_16x16x32_bf16 v[152:155], a[228:231], v[60:63], v[152:155]
  ds_write_b128 v5, v[148:151] offset:0
  buffer_load_dwordx4 v[240:243], v124, s[4:7], s65 offen sc1
  v_mfma_f32_16x16x32_bf16 v[152:155], a[232:235], v[64:67], v[152:155]
  v_add3_u32 v45, v45, v46, s83
  v_mfma_f32_16x16x32_bf16 v[152:155], a[236:239], v[68:71], v[152:155]
  v_add_u32 v45, 1280, v45
  v_add_u32 v46, 48, v41
  v_mfma_f32_16x16x32_bf16 v[156:159], a[240:243], v[52:55], 0
  v_mfma_f32_16x16x32_bf16 v[156:159], a[244:247], v[56:59], v[156:159]
  buffer_load_dwordx4 v[244:247], v124, s[4:7], s66 offen sc1
  v_mfma_f32_16x16x32_bf16 v[156:159], a[248:251], v[60:63], v[156:159]
  v_mfma_f32_16x16x32_bf16 v[156:159], a[0:3], v[64:67], v[156:159]
  v_mfma_f32_16x16x32_bf16 v[156:159], a[4:7], v[68:71], v[156:159]
  ds_write_b128 v5, v[152:155] offset:1024
  v_mfma_f32_16x16x32_bf16 v[160:163], a[8:11], v[52:55], 0
  buffer_store_dwordx4 v[22:25], v1, s[4:7], s53 offen offset:1024 sc1
  v_mfma_f32_16x16x32_bf16 v[160:163], a[12:15], v[56:59], v[160:163]
  v_mfma_f32_16x16x32_bf16 v[160:163], a[16:19], v[60:63], v[160:163]
  v_mfma_f32_16x16x32_bf16 v[160:163], a[20:23], v[64:67], v[160:163]
  v_mfma_f32_16x16x32_bf16 v[160:163], a[24:27], v[68:71], v[160:163]
  s_mov_b32 s70, 102400
  buffer_load_dwordx4 a[148:151], v3, s[4:7], s70 offen offset:0
  v_mfma_f32_16x16x32_bf16 v[164:167], a[28:31], v[52:55], 0
  ds_write_b128 v5, v[156:159] offset:2048
  v_mfma_f32_16x16x32_bf16 v[164:167], a[32:35], v[56:59], v[164:167]
  ds_read_b128 v[52:55], v8 offset:208
  v_mfma_f32_16x16x32_bf16 v[164:167], a[36:39], v[60:63], v[164:167]
  ds_read_b128 v[56:59], v8 offset:400
  v_mfma_f32_16x16x32_bf16 v[164:167], a[40:43], v[64:67], v[164:167]
  buffer_load_dwordx4 a[152:155], v3, s[4:7], s70 offen offset:1024
  v_mfma_f32_16x16x32_bf16 v[164:167], a[44:47], v[68:71], v[164:167]
  ds_write_b128 v5, v[160:163] offset:3072
  v_mfma_f32_16x16x32_bf16 v[168:171], a[200:203], v[72:75], 0
  ds_read_b128 v[60:63], v8 offset:592
  v_mfma_f32_16x16x32_bf16 v[168:171], a[204:207], v[76:79], v[168:171]
  ds_read_b128 v[64:67], v8 offset:784
  v_mfma_f32_16x16x32_bf16 v[168:171], a[208:211], v[80:83], v[168:171]
  buffer_load_dwordx4 a[156:159], v3, s[4:7], s70 offen offset:2048
  v_mfma_f32_16x16x32_bf16 v[168:171], a[212:215], v[84:87], v[168:171]
  ds_write_b128 v5, v[164:167] offset:4096
  v_mfma_f32_16x16x32_bf16 v[168:171], a[216:219], v[88:91], v[168:171]
  ds_read_b128 v[68:71], v8 offset:32
  v_mfma_f32_16x16x32_bf16 v[172:175], a[220:223], v[72:75], 0
  v_mfma_f32_16x16x32_bf16 v[172:175], a[224:227], v[76:79], v[172:175]
  buffer_load_dwordx4 a[160:163], v3, s[4:7], s70 offen offset:3072
  v_mfma_f32_16x16x32_bf16 v[172:175], a[228:231], v[80:83], v[172:175]
  v_mfma_f32_16x16x32_bf16 v[172:175], a[232:235], v[84:87], v[172:175]
  v_mfma_f32_16x16x32_bf16 v[172:175], a[236:239], v[88:91], v[172:175]
  v_mfma_f32_16x16x32_bf16 v[176:179], a[240:243], v[72:75], 0
  ds_write_b128 v6, v[168:171] offset:0
  s_mov_b32 s70, 106496
  buffer_load_dwordx4 a[164:167], v3, s[4:7], s70 offen offset:0
  v_mfma_f32_16x16x32_bf16 v[176:179], a[244:247], v[76:79], v[176:179]
  v_mfma_f32_16x16x32_bf16 v[176:179], a[248:251], v[80:83], v[176:179]
  s_waitcnt lgkmcnt(2)
  s_barrier
  v_mfma_f32_16x16x32_bf16 v[176:179], a[0:3], v[84:87], v[176:179]
  buffer_load_dwordx4 a[168:171], v3, s[4:7], s70 offen offset:1024
  v_mfma_f32_16x16x32_bf16 v[176:179], a[4:7], v[88:91], v[176:179]
  ds_read_b128 v[132:135], v7 offset:1024
  v_mfma_f32_16x16x32_bf16 v[180:183], a[8:11], v[72:75], 0
  ds_read_b128 v[152:155], v7 offset:6144
  v_mfma_f32_16x16x32_bf16 v[180:183], a[12:15], v[76:79], v[180:183]
  ds_read_b128 v[136:139], v7 offset:2048
  v_mfma_f32_16x16x32_bf16 v[180:183], a[16:19], v[80:83], v[180:183]
  ds_read_b128 v[156:159], v7 offset:7168
  buffer_load_dwordx4 a[172:175], v3, s[4:7], s70 offen offset:2048
  v_mfma_f32_16x16x32_bf16 v[180:183], a[20:23], v[84:87], v[180:183]
  ds_write_b128 v6, v[172:175] offset:1024
  v_mfma_f32_16x16x32_bf16 v[180:183], a[24:27], v[88:91], v[180:183]
  ds_read_b128 v[140:143], v7 offset:3072
  v_mfma_f32_16x16x32_bf16 v[184:187], a[28:31], v[72:75], 0
  ds_read_b128 v[160:163], v7 offset:8192
  v_mfma_f32_16x16x32_bf16 v[184:187], a[32:35], v[76:79], v[184:187]
  buffer_load_dwordx4 a[176:179], v3, s[4:7], s70 offen offset:3072
  v_mfma_f32_16x16x32_bf16 v[184:187], a[36:39], v[80:83], v[184:187]
  ds_write_b128 v6, v[176:179] offset:2048
  v_mfma_f32_16x16x32_bf16 v[184:187], a[40:43], v[84:87], v[184:187]
  ds_read_b128 v[144:147], v7 offset:4096
  s_waitcnt lgkmcnt(7)
  v_add_f32 v132, v132, v152
  v_mfma_f32_16x16x32_bf16 v[184:187], a[44:47], v[88:91], v[184:187]
  ds_read_b128 v[164:167], v7 offset:9216
  v_add_f32 v133, v133, v153
  v_mfma_f32_16x16x32_bf16 v[188:191], a[200:203], v[92:95], v[188:191]
  s_mov_b32 s70, 110592
  buffer_load_dwordx4 a[180:183], v3, s[4:7], s70 offen offset:0
  v_mfma_f32_16x16x32_bf16 v[188:191], a[204:207], v[96:99], v[188:191]
  ds_write_b128 v6, v[180:183] offset:3072
  v_mfma_f32_16x16x32_bf16 v[188:191], a[208:211], v[100:103], v[188:191]
  ds_read_b128 v[128:131], v7 offset:0
  v_add_f32 v134, v134, v154
  v_mfma_f32_16x16x32_bf16 v[188:191], a[212:215], v[104:107], v[188:191]
  ds_read_b128 v[148:151], v7 offset:5120
  v_add_f32 v135, v135, v155
  ds_write_b128 v6, v[184:187] offset:4096
  buffer_load_dwordx4 a[184:187], v3, s[4:7], s70 offen offset:1024
  v_mfma_f32_16x16x32_bf16 v[188:191], a[216:219], v[108:111], v[188:191]
  v_fmac_f32 v132, v28, v192
  v_fmac_f32 v133, v28, v193
  v_fmac_f32 v134, v28, v194
  v_fmac_f32 v135, v28, v195
  s_waitcnt lgkmcnt(10)
  v_add_f32 v136, v136, v156
  v_add_f32 v137, v137, v157
  v_mfma_f32_16x16x32_bf16 v[192:195], a[220:223], v[92:95], v[132:135]
  v_add_f32 v138, v138, v158
  v_add_f32 v139, v139, v159
  v_mfma_f32_16x16x32_bf16 v[192:195], a[224:227], v[96:99], v[192:195]
  s_waitcnt vmcnt(11)
  v_bitop3_b32 v27, v240, v244, v14 bitop3:0xa8
  v_cmp_ne_u32 vcc, 0, v27
  v_mfma_f32_16x16x32_bf16 v[192:195], a[228:231], v[100:103], v[192:195]
  buffer_load_dwordx4 a[188:191], v3, s[4:7], s70 offen offset:2048
  s_cbranch_vccz L_ok_5
L_retry_4:
  s_sub_u32 s69, s69, 1
  s_cbranch_scc1 L_retry_4_to
  buffer_load_dwordx4 v[240:243], v124, s[4:7], s65 offen sc1
  buffer_load_dwordx4 v[244:247], v124, s[4:7], s66 offen sc1
  s_waitcnt vmcnt(0)
  v_bitop3_b32 v27, v240, v244, v14 bitop3:0xa8
  v_cmp_ne_u32 vcc, 0, v27
  s_nop 1
  s_cbranch_vccnz L_retry_4
L_ok_5:
  v_lshlrev_b32 v228, 16, v240
  v_lshlrev_b32 v236, 16, v244
  v_and_b32 v229, 0xffff0000, v240
  v_and_b32 v237, 0xffff0000, v244
  v_lshlrev_b32 v230, 16, v241
  v_and_b32 v231, 0xffff0000, v241
  v_lshlrev_b32 v238, 16, v245
  v_and_b32 v239, 0xffff0000, v245
  v_add_u32 v228, v228, v127
  v_add_u32 v236, v236, v127
  v_add_f32 v229, v229, v237
  v_add_f32 v230, v230, v238
  v_add_f32 v231, v231, v239
  v_add_f32 v228, v228, v236
  v_lshlrev_b32 v232, 16, v242
  v_and_b32 v233, 0xffff0000, v242
  v_lshlrev_b32 v234, 16, v243
  buffer_load_dwordx4 a[192:195], v3, s[4:7], s70 offen offset:3072
  v_and_b32 v235, 0xffff0000, v243
  v_and_b32 v237, 0xffff0000, v246
  v_lshlrev_b32 v238, 16, v247
  v_and_b32 v239, 0xffff0000, v247
  v_lshlrev_b32 v236, 16, v246
  v_add_f32 v233, v233, v237
  v_add_f32 v234, v234, v238
  v_add_f32 v235, v235, v239
  v_add_f32 v232, v232, v236
  v_permlane32_swap_b32 v229, v233
  v_permlane32_swap_b32 v230, v234
  v_permlane32_swap_b32 v231, v235
  v_permlane32_swap_b32 v228, v232
  v_add_f32 v229, v229, v233
  v_add_f32 v230, v230, v234
  s_mov_b32 s70, 114688
  buffer_load_dwordx4 a[196:199], v3, s[4:7], s70 offen offset:0
  v_add_f32 v231, v231, v235
  v_add_f32 v228, v228, v232
  v_cmp_eq_u32 vcc, 0, v0
  v_permlane16_swap_b32 v229, v231
  v_permlane16_swap_b32 v228, v230
  v_add_f32 v229, v229, v231
  v_add_f32 v228, v228, v230
  v_cndmask_b32 v127, 0, 1, vcc
  v_add_f32_dpp v231, v229, v229 row_ror:4 row_mask:0xf bank_mask:0xf
  v_add_f32_dpp v230, v228, v228 row_ror:4 row_mask:0xf bank_mask:0xf
  v_mfma_f32_16x16x32_bf16 v[192:195], a[232:235], v[104:107], v[192:195]
  v_add_f32_dpp v229, v231, v231 row_ror:8 row_mask:0xf bank_mask:0xf
  buffer_load_dwordx4 a[200:203], v3, s[4:7], s70 offen offset:1024
  v_add_f32_dpp v228, v230, v230 row_ror:8 row_mask:0xf bank_mask:0xf
  v_cvt_pk_bf16_f32 v126, v228, v229
  v_bitop3_b32 v126, v126, v127, v127 bitop3:0x30
  v_mfma_f32_16x16x32_bf16 v[192:195], a[236:239], v[108:111], v[192:195]
  buffer_store_dword v126, v125, s[4:7], s63 offen sc1
  v_fmac_f32 v136, v28, v196
  v_fmac_f32 v137, v28, v197
  v_fmac_f32 v138, v28, v198
  v_fmac_f32 v139, v28, v199
  s_waitcnt lgkmcnt(0)
  s_barrier
  v_add_f32 v140, v140, v160
  v_mfma_f32_16x16x32_bf16 v[196:199], a[240:243], v[92:95], v[136:139]
  buffer_load_dwordx4 a[204:207], v3, s[4:7], s70 offen offset:2048
  v_mfma_f32_16x16x32_bf16 v[196:199], a[244:247], v[96:99], v[196:199]
  v_add_f32 v141, v141, v161
  v_add_f32 v142, v142, v162
  v_mfma_f32_16x16x32_bf16 v[196:199], a[248:251], v[100:103], v[196:199]
  v_add_f32 v143, v143, v163
  v_fmac_f32 v140, v28, v200
  v_mfma_f32_16x16x32_bf16 v[196:199], a[0:3], v[104:107], v[196:199]
  v_fmac_f32 v141, v28, v201
  v_fmac_f32 v142, v28, v202
  v_mfma_f32_16x16x32_bf16 v[196:199], a[4:7], v[108:111], v[196:199]
  v_fmac_f32 v143, v28, v203
  s_mov_b32 s81, 24576
  buffer_load_dword a254, v2, s[96:99], s81 offen
  v_mfma_f32_16x16x32_bf16 v[200:203], a[8:11], v[92:95], v[140:143]
  ds_read_b128 v[172:175], v7 offset:11264
  v_add_f32 v128, v128, v148
  v_add_f32 v129, v129, v149
  v_add_f32 v130, v130, v150
  ds_read_b128 v[168:171], v7 offset:10240
  v_add_f32 v131, v131, v151
  v_mfma_f32_16x16x32_bf16 v[200:203], a[12:15], v[96:99], v[200:203]
  ds_read_b128 v[148:151], v8 offset:0
  v_add_f32 v144, v144, v164
  v_mfma_f32_16x16x32_bf16 v[200:203], a[16:19], v[100:103], v[200:203]
  ds_read_b128 v[152:155], v8 offset:192
  v_add_f32 v145, v145, v165
  v_mfma_f32_16x16x32_bf16 v[200:203], a[20:23], v[104:107], v[200:203]
  buffer_load_dwordx4 a[208:211], v3, s[4:7], s70 offen offset:3072
  ds_read_b128 v[176:179], v7 offset:12288
  v_mfma_f32_16x16x32_bf16 v[200:203], a[24:27], v[108:111], v[200:203]
  v_add_f32 v146, v146, v166
  ds_read_b128 v[156:159], v8 offset:384
  v_add_f32 v147, v147, v167
  v_fmac_f32 v144, v28, v204
  v_fmac_f32 v145, v28, v205
  ds_read_b128 v[180:183], v7 offset:13312
  v_fmac_f32 v146, v28, v206
  v_fmac_f32 v147, v28, v207
  v_add_f32 v188, v188, v128
  ds_read_b128 v[160:163], v8 offset:576
  v_mfma_f32_16x16x32_bf16 v[204:207], a[28:31], v[92:95], v[144:147]
  v_add_f32 v189, v189, v129
  s_mov_b32 s70, 118784
  buffer_load_dwordx4 a[212:215], v3, s[4:7], s70 offen offset:0
  ds_read_b128 v[184:187], v7 offset:14336
  v_mfma_f32_16x16x32_bf16 v[204:207], a[32:35], v[96:99], v[204:207]
  v_add_f32 v190, v190, v130
  ds_read_b128 v[164:167], v8 offset:768
  v_mfma_f32_16x16x32_bf16 v[204:207], a[36:39], v[100:103], v[204:207]
  v_add_f32 v191, v191, v131
  s_waitcnt lgkmcnt(8)
  v_add_f32 v188, v188, v168
  v_mfma_f32_16x16x32_bf16 v[204:207], a[40:43], v[104:107], v[204:207]
  v_add_f32 v189, v189, v169
  v_add_f32 v190, v190, v170
  v_mfma_f32_16x16x32_bf16 v[204:207], a[44:47], v[108:111], v[204:207]
  buffer_load_dwordx4 a[216:219], v3, s[4:7], s70 offen offset:1024
  v_add_f32 v191, v191, v171
  v_pk_add_f32 v[192:193], v[192:193], v[172:173]
  v_pk_add_f32 v[194:195], v[194:195], v[174:175]
  v_cvt_pk_bf16_f32 v128, v188, v189
  v_cvt_pk_bf16_f32 v129, v190, v191
  v_cvt_pk_bf16_f32 v130, v192, v193
  v_cvt_pk_bf16_f32 v131, v194, v195
  v_cmp_gt_u32 vcc, 32, v0
  ds_read_b128 v[72:75], v8 offset:224
  s_waitcnt lgkmcnt(8)
  v_mfma_f32_16x16x32_bf16 v[168:171], v[148:151], v[128:131], 0
  v_cndmask_b32 v42, v46, v45, vcc
  v_add_u32 v45, 32, v45
  s_waitcnt lgkmcnt(7)
  v_mfma_f32_16x16x32_bf16 v[172:175], v[152:155], v[128:131], 0
  buffer_load_dwordx4 a[220:223], v3, s[4:7], s70 offen offset:2048
  v_add_u32 v46, 640, v46
  s_waitcnt lgkmcnt(6)
  v_pk_add_f32 v[196:197], v[196:197], v[176:177]
  v_pk_add_f32 v[198:199], v[198:199], v[178:179]
  v_cndmask_b32 v43, v46, v45, vcc
  s_waitcnt lgkmcnt(5)
  v_mfma_f32_16x16x32_bf16 v[176:179], v[156:159], v[128:131], 0
  ds_read_b128 v[76:79], v8 offset:416
  v_cvt_pk_bf16_f32 v132, v196, v197
  s_waitcnt lgkmcnt(5)
  v_pk_add_f32 v[200:201], v[200:201], v[180:181]
  v_pk_add_f32 v[202:203], v[202:203], v[182:183]
  ds_read_b128 v[80:83], v8 offset:608
  s_waitcnt lgkmcnt(5)
  v_mfma_f32_16x16x32_bf16 v[180:183], v[160:163], v[128:131], 0
  buffer_load_dwordx4 a[224:227], v3, s[4:7], s70 offen offset:3072
  v_cvt_pk_bf16_f32 v133, v198, v199
  s_waitcnt lgkmcnt(4)
  v_pk_add_f32 v[204:205], v[204:205], v[184:185]
  v_pk_add_f32 v[206:207], v[206:207], v[186:187]
  ds_read_b128 v[84:87], v8 offset:800
  s_waitcnt lgkmcnt(4)
  v_mfma_f32_16x16x32_bf16 v[184:187], v[164:167], v[128:131], 0
  v_cvt_pk_bf16_f32 v134, v200, v201
  v_cvt_pk_bf16_f32 v135, v202, v203
  v_cvt_pk_bf16_f32 v136, v204, v205
  v_mov_b32 v138, 0
  v_mfma_f32_16x16x32_bf16 v[168:171], v[48:51], v[132:135], v[168:171]
  v_cvt_pk_bf16_f32 v137, v206, v207
  v_mfma_f32_16x16x32_bf16 v[172:175], v[52:55], v[132:135], v[172:175]
  s_mov_b32 s70, 122880
  buffer_load_dwordx4 a[228:231], v3, s[4:7], s70 offen offset:0
  v_mfma_f32_16x16x32_bf16 v[176:179], v[56:59], v[132:135], v[176:179]
  v_mov_b32 v139, 0
  v_mfma_f32_16x16x32_bf16 v[180:183], v[60:63], v[132:135], v[180:183]
  v_mfma_f32_16x16x32_bf16 v[184:187], v[64:67], v[132:135], v[184:187]
  v_mfma_f32_16x16x32_bf16 v[168:171], v[68:71], v[136:139], v[168:171]
  s_waitcnt lgkmcnt(3)
  v_mfma_f32_16x16x32_bf16 v[172:175], v[72:75], v[136:139], v[172:175]
  buffer_load_dwordx4 a[232:235], v3, s[4:7], s70 offen offset:1024
  s_waitcnt lgkmcnt(2)
  v_mfma_f32_16x16x32_bf16 v[176:179], v[76:79], v[136:139], v[176:179]
  s_waitcnt lgkmcnt(1)
  v_mfma_f32_16x16x32_bf16 v[180:183], v[80:83], v[136:139], v[180:183]
  s_waitcnt lgkmcnt(0)
  v_mfma_f32_16x16x32_bf16 v[184:187], v[84:87], v[136:139], v[184:187]
  v_max3_f32 v248, v168, v169, v170
  buffer_load_dwordx4 a[236:239], v3, s[4:7], s70 offen offset:2048
  v_min3_f32 v250, v168, v169, v170
  v_max3_f32 v248, v248, v171, v172
  v_max3_f32 v248, v248, v173, v174
  v_min3_f32 v250, v250, v171, v172
  v_max3_f32 v248, v248, v175, v176
  v_max3_f32 v248, v248, v177, v178
  v_max3_f32 v248, v248, v179, v180
  v_max3_f32 v248, v248, v181, v182
  v_max3_f32 v248, v248, v183, v184
  v_max3_f32 v248, v248, v185, v186
  v_min3_f32 v250, v250, v173, v174
  buffer_load_dwordx4 a[240:243], v3, s[4:7], s70 offen offset:3072
  v_max_f32 v248, v248, v187
  v_min3_f32 v250, v250, v175, v176
  v_mul_f32 v248, v252, v248
  v_pk_fma_f32 v[188:189], v[168:169], v[252:253], v[248:249] op_sel_hi:[1,0,0] neg_lo:[0,0,1] neg_hi:[0,0,1]
  v_pk_fma_f32 v[190:191], v[170:171], v[252:253], v[248:249] op_sel_hi:[1,0,0] neg_lo:[0,0,1] neg_hi:[0,0,1]
  v_min3_f32 v250, v250, v177, v178
  v_pk_fma_f32 v[192:193], v[172:173], v[252:253], v[248:249] op_sel_hi:[1,0,0] neg_lo:[0,0,1] neg_hi:[0,0,1]
  v_exp_f32 v188, v188
  v_exp_f32 v189, v189
  v_exp_f32 v190, v190
  v_exp_f32 v191, v191
  s_mov_b32 s70, 126976
  buffer_load_dwordx4 a[244:247], v3, s[4:7], s70 offen offset:0
  v_min3_f32 v250, v250, v179, v180
  v_pk_fma_f32 v[194:195], v[174:175], v[252:253], v[248:249] op_sel_hi:[1,0,0] neg_lo:[0,0,1] neg_hi:[0,0,1]
  v_pk_fma_f32 v[196:197], v[176:177], v[252:253], v[248:249] op_sel_hi:[1,0,0] neg_lo:[0,0,1] neg_hi:[0,0,1]
  v_pk_fma_f32 v[198:199], v[178:179], v[252:253], v[248:249] op_sel_hi:[1,0,0] neg_lo:[0,0,1] neg_hi:[0,0,1]
  v_pk_fma_f32 v[200:201], v[180:181], v[252:253], v[248:249] op_sel_hi:[1,0,0] neg_lo:[0,0,1] neg_hi:[0,0,1]
  v_pk_fma_f32 v[202:203], v[182:183], v[252:253], v[248:249] op_sel_hi:[1,0,0] neg_lo:[0,0,1] neg_hi:[0,0,1]
  v_pk_fma_f32 v[204:205], v[184:185], v[252:253], v[248:249] op_sel_hi:[1,0,0] neg_lo:[0,0,1] neg_hi:[0,0,1]
  v_pk_fma_f32 v[206:207], v[186:187], v[252:253], v[248:249] op_sel_hi:[1,0,0] neg_lo:[0,0,1] neg_hi:[0,0,1]
  v_exp_f32 v192, v192
  v_exp_f32 v193, v193
  v_min3_f32 v250, v250, v181, v182
  buffer_load_dwordx4 a[248:251], v3, s[4:7], s70 offen offset:1024
  v_pk_add_f32 v[248:249], v[188:189], v[190:191]
  v_exp_f32 v194, v194
  v_exp_f32 v195, v195
  v_min3_f32 v250, v250, v183, v184
  v_pk_add_f32 v[248:249], v[248:249], v[192:193]
  v_exp_f32 v196, v196
  v_exp_f32 v197, v197
  v_min3_f32 v250, v250, v185, v186
  v_pk_add_f32 v[248:249], v[248:249], v[194:195]
  v_exp_f32 v198, v198
  buffer_load_dwordx4 a[0:3], v3, s[4:7], s70 offen offset:2048
  v_exp_f32 v199, v199
  v_min_f32 v250, v250, v187
  v_pk_add_f32 v[248:249], v[248:249], v[196:197]
  v_exp_f32 v200, v200
  v_exp_f32 v201, v201
  v_mul_f32 v250, v252, v250
  v_pk_add_f32 v[248:249], v[248:249], v[198:199]
  v_pk_fma_f32 v[168:169], v[168:169], v[252:253], v[250:251] op_sel_hi:[1,0,0] neg_lo:[1,0,0] neg_hi:[1,0,0]
  v_pk_fma_f32 v[170:171], v[170:171], v[252:253], v[250:251] op_sel_hi:[1,0,0] neg_lo:[1,0,0] neg_hi:[1,0,0]
  v_exp_f32 v202, v202
  v_exp_f32 v203, v203
  buffer_load_dwordx4 a[4:7], v3, s[4:7], s70 offen offset:3072
  v_pk_add_f32 v[248:249], v[248:249], v[200:201]
  v_pk_fma_f32 v[172:173], v[172:173], v[252:253], v[250:251] op_sel_hi:[1,0,0] neg_lo:[1,0,0] neg_hi:[1,0,0]
  v_exp_f32 v168, v168
  v_exp_f32 v169, v169
  v_exp_f32 v170, v170
  v_exp_f32 v171, v171
  v_exp_f32 v204, v204
  v_exp_f32 v205, v205
  v_pk_fma_f32 v[174:175], v[174:175], v[252:253], v[250:251] op_sel_hi:[1,0,0] neg_lo:[1,0,0] neg_hi:[1,0,0]
  s_mov_b32 s70, 131072
  buffer_load_dwordx4 a[8:11], v3, s[4:7], s70 offen offset:0
  v_pk_fma_f32 v[176:177], v[176:177], v[252:253], v[250:251] op_sel_hi:[1,0,0] neg_lo:[1,0,0] neg_hi:[1,0,0]
  v_pk_fma_f32 v[178:179], v[178:179], v[252:253], v[250:251] op_sel_hi:[1,0,0] neg_lo:[1,0,0] neg_hi:[1,0,0]
  v_pk_fma_f32 v[180:181], v[180:181], v[252:253], v[250:251] op_sel_hi:[1,0,0] neg_lo:[1,0,0] neg_hi:[1,0,0]
  v_pk_fma_f32 v[182:183], v[182:183], v[252:253], v[250:251] op_sel_hi:[1,0,0] neg_lo:[1,0,0] neg_hi:[1,0,0]
  v_pk_fma_f32 v[184:185], v[184:185], v[252:253], v[250:251] op_sel_hi:[1,0,0] neg_lo:[1,0,0] neg_hi:[1,0,0]
  v_pk_fma_f32 v[186:187], v[186:187], v[252:253], v[250:251] op_sel_hi:[1,0,0] neg_lo:[1,0,0] neg_hi:[1,0,0]
  v_pk_add_f32 v[248:249], v[248:249], v[202:203]
  v_exp_f32 v172, v172
  v_exp_f32 v173, v173
  v_exp_f32 v206, v206
  v_exp_f32 v207, v207
  buffer_load_dwordx4 v[32:35], v40, s[4:7], s64 offen offset:0 sc1
  v_pk_add_f32 v[250:251], v[168:169], v[170:171]
  v_pk_add_f32 v[248:249], v[248:249], v[204:205]
  v_exp_f32 v174, v174
  v_exp_f32 v175, v175
  v_pk_add_f32 v[250:251], v[250:251], v[172:173]
  v_pk_add_f32 v[248:249], v[248:249], v[206:207]
  v_exp_f32 v176, v176
  v_exp_f32 v177, v177
  v_pk_add_f32 v[250:251], v[250:251], v[174:175]
  v_add_f32 v248, v248, v249
  v_exp_f32 v178, v178
  buffer_load_dwordx4 v[36:39], v40, s[4:7], s64 offen offset:2048 sc1
  v_exp_f32 v179, v179
  v_pk_add_f32 v[250:251], v[250:251], v[176:177]
  v_rcp_f32 v248, v248
  v_exp_f32 v180, v180
  v_exp_f32 v181, v181
  v_pk_add_f32 v[250:251], v[250:251], v[178:179]
  v_exp_f32 v182, v182
  v_exp_f32 v183, v183
  v_pk_mul_f32 v[188:189], v[188:189], v[248:249] op_sel_hi:[1,0]
  v_pk_mul_f32 v[190:191], v[190:191], v[248:249] op_sel_hi:[1,0]
  buffer_load_dwordx4 a[12:15], v3, s[4:7], s70 offen offset:1024
  v_pk_mul_f32 v[192:193], v[192:193], v[248:249] op_sel_hi:[1,0]
  v_pk_mul_f32 v[194:195], v[194:195], v[248:249] op_sel_hi:[1,0]
  v_pk_add_f32 v[250:251], v[250:251], v[180:181]
  v_exp_f32 v184, v184
  v_exp_f32 v185, v185
  v_cvt_pk_bf16_f32 v228, v188, v189
  v_cvt_pk_bf16_f32 v229, v190, v191
  v_cvt_pk_bf16_f32 v230, v192, v193
  v_cvt_pk_bf16_f32 v231, v194, v195
  v_pk_add_f32 v[250:251], v[250:251], v[182:183]
  v_exp_f32 v186, v186
  buffer_load_dwordx4 a[16:19], v3, s[4:7], s70 offen offset:2048
  v_exp_f32 v187, v187
  v_pk_add_f32 v[250:251], v[250:251], v[184:185]
  v_pk_mul_f32 v[196:197], v[196:197], v[248:249] op_sel_hi:[1,0]
  v_pk_mul_f32 v[198:199], v[198:199], v[248:249] op_sel_hi:[1,0]
  v_pk_mul_f32 v[200:201], v[200:201], v[248:249] op_sel_hi:[1,0]
  v_pk_mul_f32 v[202:203], v[202:203], v[248:249] op_sel_hi:[1,0]
  v_pk_add_f32 v[250:251], v[250:251], v[186:187]
  v_cvt_pk_bf16_f32 v232, v196, v197
  v_cvt_pk_bf16_f32 v233, v198, v199
  v_cvt_pk_bf16_f32 v234, v200, v201
  v_cvt_pk_bf16_f32 v235, v202, v203
  v_add_f32 v250, v250, v251
  buffer_load_dwordx4 a[20:23], v3, s[4:7], s70 offen offset:3072
  v_rcp_f32 v250, v250
  v_pk_mul_f32 v[204:205], v[204:205], v[248:249] op_sel_hi:[1,0]
  v_pk_mul_f32 v[206:207], v[206:207], v[248:249] op_sel_hi:[1,0]
  v_pk_mul_f32 v[168:169], v[168:169], v[250:251] op_sel_hi:[1,0]
  v_pk_mul_f32 v[170:171], v[170:171], v[250:251] op_sel_hi:[1,0]
  v_cvt_pk_bf16_f32 v236, v204, v205
  v_cvt_pk_bf16_f32 v237, v206, v207
  v_cvt_pk_bf16_f32 v238, v168, v169
  v_cvt_pk_bf16_f32 v239, v170, v171
  v_pk_mul_f32 v[172:173], v[172:173], v[250:251] op_sel_hi:[1,0]
  v_pk_mul_f32 v[174:175], v[174:175], v[250:251] op_sel_hi:[1,0]
  v_pk_mul_f32 v[176:177], v[176:177], v[250:251] op_sel_hi:[1,0]
  s_mov_b32 s70, 135168
  buffer_load_dwordx4 a[24:27], v3, s[4:7], s70 offen offset:0
  v_pk_mul_f32 v[178:179], v[178:179], v[250:251] op_sel_hi:[1,0]
  v_cvt_pk_bf16_f32 v240, v172, v173
  v_cvt_pk_bf16_f32 v241, v174, v175
  v_cvt_pk_bf16_f32 v242, v176, v177
  v_cvt_pk_bf16_f32 v243, v178, v179
  v_pk_mul_f32 v[180:181], v[180:181], v[250:251] op_sel_hi:[1,0]
  v_pk_mul_f32 v[182:183], v[182:183], v[250:251] op_sel_hi:[1,0]
  v_pk_mul_f32 v[184:185], v[184:185], v[250:251] op_sel_hi:[1,0]
  v_pk_mul_f32 v[186:187], v[186:187], v[250:251] op_sel_hi:[1,0]
  v_cvt_pk_bf16_f32 v244, v180, v181
  v_cvt_pk_bf16_f32 v245, v182, v183
  v_cvt_pk_bf16_f32 v246, v184, v185
  buffer_load_dwordx4 a[28:31], v3, s[4:7], s70 offen offset:1024
  v_cvt_pk_bf16_f32 v247, v186, v187
  v_add_u32 v249, s91, v1
  v_add_u32 v251, s72, v1
  buffer_load_dwordx4 a[32:35], v3, s[4:7], s70 offen offset:2048
  buffer_load_dwordx4 a[36:39], v3, s[4:7], s70 offen offset:3072
  s_mov_b32 s70, 139264
  buffer_load_dwordx4 a[40:43], v3, s[4:7], s70 offen offset:0
  buffer_load_dwordx4 a[44:47], v3, s[4:7], s70 offen offset:1024
  s_add_u32 m0, s91, 0
  s_mov_b32 s2, 199680
  buffer_load_dwordx4 v3, s[4:7], s2 offen lds
  s_add_u32 m0, s91, 1024
  s_mov_b32 s2, 200704
  buffer_load_dwordx4 v3, s[4:7], s2 offen lds
  s_add_u32 m0, s91, 2048
  s_mov_b32 s2, 201728
  buffer_load_dwordx4 v3, s[4:7], s2 offen lds
  s_add_u32 m0, s91, 3072
  s_mov_b32 s2, 202752
  buffer_load_dwordx4 v3, s[4:7], s2 offen lds
  s_waitcnt vmcnt(13)
  v_bitop3_b32 v27, v32, v36, v14 bitop3:0xa8
  v_cmp_ne_u32 vcc, 0, v27
  s_nop 0
  s_cbranch_vccz L_ok_7
L_retry_6:
  s_sub_u32 s69, s69, 1
  s_cbranch_scc1 L_retry_6_to
  buffer_load_dwordx4 v[32:35], v40, s[4:7], s64 offen offset:0 sc1
  buffer_load_dwordx4 v[36:39], v40, s[4:7], s64 offen offset:2048 sc1
  s_waitcnt vmcnt(0)
  v_bitop3_b32 v27, v32, v36, v14 bitop3:0xa8
  v_cmp_ne_u32 vcc, 0, v27
  s_nop 1
  s_cbranch_vccnz L_retry_6
L_ok_7:
  ds_write_b64 v41, v[32:33]
  ds_write_b64 v41, v[34:35] offset:32
  s_add_u32 m0, s91, 4096
  s_mov_b32 s2, 203776
  buffer_load_dwordx4 v3, s[4:7], s2 offen lds
  ds_write_b64 v42, v[36:37]
  ds_write_b64 v43, v[38:39]
  s_add_u32 m0, s91, 5120
  s_mov_b32 s2, 204800
  buffer_load_dwordx4 v3, s[4:7], s2 offen lds
  s_add_u32 m0, s91, 6144
  s_mov_b32 s2, 205824
  buffer_load_dwordx4 v3, s[4:7], s2 offen lds
  s_waitcnt lgkmcnt(0)
  s_barrier
  s_add_u32 m0, s91, 7168
  s_mov_b32 s2, 206848
  buffer_load_dwordx4 v3, s[4:7], s2 offen lds
  ds_read_b128 v[48:51], v9 offset:1600
  ds_read_b128 v[52:55], v9 offset:1616
  ds_read_b128 v[56:59], v9 offset:1632
  ds_read_b128 v[60:63], v9 offset:1648
  s_add_u32 m0, s91, 8192
  s_mov_b32 s2, 207872
  buffer_load_dwordx4 v3, s[4:7], s2 offen lds
  ds_read_b128 v[64:67], v9 offset:1664
  ds_read_b128 v[68:71], v9 offset:0
  ds_read_b128 v[72:75], v9 offset:16
  ds_read_b128 v[76:79], v9 offset:32
  s_add_u32 m0, s91, 9216
  s_mov_b32 s2, 208896
  buffer_load_dwordx4 v3, s[4:7], s2 offen lds
  ds_read_b128 v[80:83], v9 offset:48
  s_waitcnt lgkmcnt(8)
  v_mfma_f32_16x16x32_bf16 v[188:191], v[48:51], v[228:231], 0
  ds_read_b128 v[84:87], v9 offset:64
  s_waitcnt lgkmcnt(8)
  v_mfma_f32_16x16x32_bf16 v[188:191], v[52:55], v[232:235], v[188:191]
  ds_read_b128 v[88:91], v9 offset:320
  s_waitcnt lgkmcnt(8)
  v_mfma_f32_16x16x32_bf16 v[188:191], v[56:59], v[236:239], v[188:191]
  ds_read_b128 v[92:95], v9 offset:336
  s_waitcnt lgkmcnt(8)
  v_mfma_f32_16x16x32_bf16 v[188:191], v[60:63], v[240:243], v[188:191]
  s_add_u32 m0, s91, 10240
  s_mov_b32 s2, 209920
  buffer_load_dwordx4 v3, s[4:7], s2 offen lds
  ds_read_b128 v[96:99], v9 offset:352
  s_waitcnt lgkmcnt(8)
  v_mfma_f32_16x16x32_bf16 v[188:191], v[64:67], v[244:247], v[188:191]
  ds_read_b128 v[100:103], v9 offset:368
  s_waitcnt lgkmcnt(8)
  v_mfma_f32_16x16x32_bf16 v[168:171], v[68:71], v[228:231], 0
  ds_read_b128 v[104:107], v9 offset:384
  s_waitcnt lgkmcnt(8)
  v_mfma_f32_16x16x32_bf16 v[168:171], v[72:75], v[232:235], v[168:171]
  ds_read_b128 v[108:111], v9 offset:640
  s_waitcnt lgkmcnt(8)
  v_mfma_f32_16x16x32_bf16 v[168:171], v[76:79], v[236:239], v[168:171]
  s_add_u32 m0, s91, 11264
  s_mov_b32 s2, 210944
  buffer_load_dwordx4 v3, s[4:7], s2 offen lds
  ds_read_b128 v[48:51], v9 offset:656
  s_waitcnt lgkmcnt(8)
  v_mfma_f32_16x16x32_bf16 v[168:171], v[80:83], v[240:243], v[168:171]
  v_add_f32 v248, 0x358637bd, v188
  ds_read_b128 v[52:55], v9 offset:672
  s_waitcnt lgkmcnt(8)
  v_mfma_f32_16x16x32_bf16 v[168:171], v[84:87], v[244:247], v[168:171]
  ds_read_b128 v[56:59], v9 offset:688
  s_waitcnt lgkmcnt(8)
  v_mfma_f32_16x16x32_bf16 v[172:175], v[88:91], v[228:231], 0
  ds_read_b128 v[60:63], v9 offset:704
  s_waitcnt lgkmcnt(8)
  v_mfma_f32_16x16x32_bf16 v[172:175], v[92:95], v[232:235], v[172:175]
  s_add_u32 m0, s72, 0
  s_mov_b32 s2, 211968
  buffer_load_dwordx4 v3, s[4:7], s2 offen lds
  ds_read_b128 v[64:67], v9 offset:960
  s_waitcnt lgkmcnt(8)
  v_mfma_f32_16x16x32_bf16 v[172:175], v[96:99], v[236:239], v[172:175]
  ds_read_b128 v[68:71], v9 offset:976
  s_waitcnt lgkmcnt(8)
  v_mfma_f32_16x16x32_bf16 v[172:175], v[100:103], v[240:243], v[172:175]
  ds_read_b128 v[72:75], v9 offset:992
  s_waitcnt lgkmcnt(8)
  v_mfma_f32_16x16x32_bf16 v[172:175], v[104:107], v[244:247], v[172:175]
  ds_read_b128 v[76:79], v9 offset:1008
  s_waitcnt lgkmcnt(8)
  v_mfma_f32_16x16x32_bf16 v[176:179], v[108:111], v[228:231], 0
  s_add_u32 m0, s72, 1024
  s_mov_b32 s2, 212992
  buffer_load_dwordx4 v3, s[4:7], s2 offen lds
  ds_read_b128 v[80:83], v9 offset:1024
  s_waitcnt lgkmcnt(8)
  v_mfma_f32_16x16x32_bf16 v[176:179], v[48:51], v[232:235], v[176:179]
  v_rcp_f32 v248, v248
  s_waitcnt lgkmcnt(7)
  v_mfma_f32_16x16x32_bf16 v[176:179], v[52:55], v[236:239], v[176:179]
  v_mul_f32 v168, v168, v248
  v_mul_f32 v169, v169, v248
  v_cvt_pk_bf16_f32 v148, v168, v169
  v_mul_f32 v170, v170, v248
  v_mul_f32 v171, v171, v248
  v_mul_f32 v172, v172, v248
  v_mul_f32 v173, v173, v248
  v_mul_f32 v174, v174, v248
  v_mul_f32 v175, v175, v248
  v_perm_b32 v148, v148, v168, s67
  v_cvt_pk_bf16_f32 v149, v170, v171
  s_add_u32 m0, s72, 2048
  s_mov_b32 s2, 214016
  buffer_load_dwordx4 v3, s[4:7], s2 offen lds
  v_cvt_pk_bf16_f32 v150, v172, v173
  v_cvt_pk_bf16_f32 v151, v174, v175
  v_or_b32 v148, 1, v148
  s_waitcnt lgkmcnt(6)
  v_mfma_f32_16x16x32_bf16 v[176:179], v[56:59], v[240:243], v[176:179]
  s_cmp_eq_u32 s71, 0
  s_cbranch_scc1 L_slow_8
  buffer_store_dwordx4 v[148:151], v1, s[4:7], s49 offen offset:1024
L_back_9:
  s_waitcnt lgkmcnt(5)
  v_mfma_f32_16x16x32_bf16 v[176:179], v[60:63], v[244:247], v[176:179]
  ds_read_b128 v[84:87], v9 offset:1280
  s_waitcnt lgkmcnt(5)
  v_mfma_f32_16x16x32_bf16 v[180:183], v[64:67], v[228:231], 0
  ds_read_b128 v[88:91], v9 offset:1296
  s_waitcnt lgkmcnt(5)
  v_mfma_f32_16x16x32_bf16 v[180:183], v[68:71], v[232:235], v[180:183]
  ds_read_b128 v[92:95], v9 offset:1312
  s_waitcnt lgkmcnt(5)
  v_mfma_f32_16x16x32_bf16 v[180:183], v[72:75], v[236:239], v[180:183]
  ds_read_b128 v[96:99], v9 offset:1328
  s_waitcnt lgkmcnt(5)
  v_mfma_f32_16x16x32_bf16 v[180:183], v[76:79], v[240:243], v[180:183]
  ds_read_b128 v[100:103], v9 offset:1344
  v_mul_f32 v176, v176, v248
  s_waitcnt lgkmcnt(5)
  v_mfma_f32_16x16x32_bf16 v[180:183], v[80:83], v[244:247], v[180:183]
  v_mul_f32 v177, v177, v248
  v_cvt_pk_bf16_f32 v152, v176, v177
  v_mul_f32 v178, v178, v248
  v_mul_f32 v179, v179, v248
  v_perm_b32 v152, v152, v176, s67
  v_cvt_pk_bf16_f32 v153, v178, v179
  v_or_b32 v152, 1, v152
  s_nop 0
  v_mul_f32 v180, v180, v248
  v_mul_f32 v181, v181, v248
  v_mul_f32 v182, v182, v248
  v_mul_f32 v183, v183, v248
  v_cvt_pk_bf16_f32 v154, v180, v181
  v_cvt_pk_bf16_f32 v155, v182, v183
  s_cmp_eq_u32 s71, 0
  s_cbranch_scc1 L_slow_10
  buffer_store_dwordx4 v[152:155], v1, s[4:7], s49 offen offset:2048
L_back_11:
  s_waitcnt lgkmcnt(4)
  v_mfma_f32_16x16x32_bf16 v[184:187], v[84:87], v[228:231], 0
  s_waitcnt lgkmcnt(3)
  v_mfma_f32_16x16x32_bf16 v[184:187], v[88:91], v[232:235], v[184:187]
  s_waitcnt lgkmcnt(2)
  v_mfma_f32_16x16x32_bf16 v[184:187], v[92:95], v[236:239], v[184:187]
  s_waitcnt lgkmcnt(1)
  v_mfma_f32_16x16x32_bf16 v[184:187], v[96:99], v[240:243], v[184:187]
  s_waitcnt lgkmcnt(0)
  v_mfma_f32_16x16x32_bf16 v[184:187], v[100:103], v[244:247], v[184:187]
  v_and_b32 v244, 31, v0
  v_add_u32 v244, s84, v244
  v_mul_u32_u24 v245, 103, v244
  v_lshrrev_b32 v245, 11, v245
  v_mul_u32_u24 v245, 172, v245
  s_mul_i32 s84, s13, 24
  v_add3_u32 v245, v245, v244, s84
  s_mul_i32 s84, s13, 48
  s_add_u32 s84, s84, 688
  v_lshlrev_b32 v247, 4, v244
  v_mul_f32 v184, v184, v248
  v_mul_f32 v185, v185, v248
  v_mul_f32 v186, v186, v248
  v_mul_f32 v187, v187, v248
  v_cvt_pk_bf16_f32 v156, v184, v185
  v_cvt_pk_bf16_f32 v157, v186, v187
  v_cmp_gt_u32 vcc, 80, v244
  v_permlane32_swap_b32 v156, v158
  v_permlane32_swap_b32 v157, v159
  v_or_b32 v156, 1, v156
  s_cmp_eq_u32 s71, 0
  s_cbranch_scc1 L_slow_12
  buffer_store_dwordx4 v[156:159], v254, s[4:7], s49 offen
L_back_13:
  v_add_u32 v246, s84, v244
  v_cndmask_b32 v244, v246, v245, vcc
  v_lshrrev_b32 v245, 5, v0
  v_mul_u32_u24 v245, 18432, v245
  v_lshl_add_u32 v244, v244, 4, v245
  v_add_u32 v247, 102144, v247
  buffer_load_dwordx4 v[32:35], v1, s[4:7], s20 offen offset:0 sc1
  buffer_load_dwordx4 v[44:47], v1, s[4:7], s20 offen offset:3072 sc1
  buffer_load_dwordx4 v[36:39], v1, s[4:7], s20 offen offset:1024 sc1
  buffer_load_dwordx4 v[48:51], v1, s[4:7], s28 offen offset:0 sc1
  buffer_load_dwordx4 v[40:43], v1, s[4:7], s20 offen offset:2048 sc1
  buffer_load_dwordx4 v[52:55], v1, s[4:7], s21 offen offset:0 sc1
  buffer_load_dwordx4 v[64:67], v1, s[4:7], s21 offen offset:3072 sc1
  buffer_load_dwordx4 v[56:59], v1, s[4:7], s21 offen offset:1024 sc1
  s_waitcnt vmcnt(6)
  v_bitop3_b32 v27, v32, v44, v14 bitop3:0x2a
  v_cmp_ne_u32 vcc, 0, v27
  s_nop 0
  s_cbranch_vccz L_ok_15
L_retry_14:
  s_sub_u32 s69, s69, 1
  s_cbranch_scc1 L_retry_14_to
  buffer_load_dwordx4 v[32:35], v1, s[4:7], s20 offen offset:0 sc1
  buffer_load_dwordx4 v[44:47], v1, s[4:7], s20 offen offset:3072 sc1
  s_waitcnt vmcnt(0)
  v_bitop3_b32 v27, v32, v44, v14 bitop3:0x2a
  v_cmp_ne_u32 vcc, 0, v27
  s_nop 1
  s_cbranch_vccnz L_retry_14
  v_bitop3_b32 v27, v36, v48, v40 bitop3:0x80
  v_bitop3_b32 v27, v27, v52, v64 bitop3:0x80
  v_bitop3_b32 v27, v27, v56, v14 bitop3:0x2a
  v_cmp_ne_u32 vcc, 0, v27
  s_nop 1
  s_cbranch_vccz L_ok_15
  buffer_load_dwordx4 v[36:39], v1, s[4:7], s20 offen offset:1024 sc1
  buffer_load_dwordx4 v[48:51], v1, s[4:7], s28 offen offset:0 sc1
  buffer_load_dwordx4 v[40:43], v1, s[4:7], s20 offen offset:2048 sc1
  buffer_load_dwordx4 v[52:55], v1, s[4:7], s21 offen offset:0 sc1
  buffer_load_dwordx4 v[64:67], v1, s[4:7], s21 offen offset:3072 sc1
  buffer_load_dwordx4 v[56:59], v1, s[4:7], s21 offen offset:1024 sc1
L_ok_15:
  v_mfma_f32_16x16x32_bf16 v[128:131], a[48:51], v[32:35], 0
  buffer_load_dwordx4 v[68:71], v1, s[4:7], s29 offen offset:0 sc1
  v_mfma_f32_16x16x32_bf16 v[132:135], a[68:71], v[32:35], 0
  v_mfma_f32_16x16x32_bf16 v[136:139], a[88:91], v[32:35], 0
  v_mfma_f32_16x16x32_bf16 v[140:143], a[108:111], v[32:35], 0
  v_mfma_f32_16x16x32_bf16 v[144:147], a[128:131], v[32:35], 0
  buffer_load_dwordx4 v[60:63], v1, s[4:7], s21 offen offset:2048 sc1
  v_mfma_f32_16x16x32_bf16 v[128:131], a[60:63], v[44:47], v[128:131]
  v_mfma_f32_16x16x32_bf16 v[132:135], a[80:83], v[44:47], v[132:135]
  v_mfma_f32_16x16x32_bf16 v[136:139], a[100:103], v[44:47], v[136:139]
  s_waitcnt vmcnt(6)
  v_bitop3_b32 v27, v36, v48, v14 bitop3:0x2a
  v_mfma_f32_16x16x32_bf16 v[140:143], a[120:123], v[44:47], v[140:143]
  v_cmp_ne_u32 vcc, 0, v27
  v_mfma_f32_16x16x32_bf16 v[144:147], a[140:143], v[44:47], v[144:147]
  buffer_load_dwordx4 v[72:75], v1, s[4:7], s22 offen offset:0 sc1
  s_cbranch_vccz L_ok_17
L_retry_16:
  s_sub_u32 s69, s69, 1
  s_cbranch_scc1 L_retry_16_to
  buffer_load_dwordx4 v[36:39], v1, s[4:7], s20 offen offset:1024 sc1
  buffer_load_dwordx4 v[48:51], v1, s[4:7], s28 offen offset:0 sc1
  s_waitcnt vmcnt(0)
  v_bitop3_b32 v27, v36, v48, v14 bitop3:0x2a
  v_cmp_ne_u32 vcc, 0, v27
  s_nop 1
  s_cbranch_vccnz L_retry_16
  v_bitop3_b32 v27, v40, v52, v64 bitop3:0x80
  v_bitop3_b32 v27, v27, v56, v68 bitop3:0x80
  v_bitop3_b32 v27, v27, v60, v72 bitop3:0x80
  v_bitop3_b32 v27, v27, v27, v14 bitop3:0x2a
  v_cmp_ne_u32 vcc, 0, v27
  s_nop 1
  s_cbranch_vccz L_ok_17
  buffer_load_dwordx4 v[40:43], v1, s[4:7], s20 offen offset:2048 sc1
  buffer_load_dwordx4 v[52:55], v1, s[4:7], s21 offen offset:0 sc1
  buffer_load_dwordx4 v[64:67], v1, s[4:7], s21 offen offset:3072 sc1
  buffer_load_dwordx4 v[56:59], v1, s[4:7], s21 offen offset:1024 sc1
  buffer_load_dwordx4 v[68:71], v1, s[4:7], s29 offen offset:0 sc1
  buffer_load_dwordx4 v[60:63], v1, s[4:7], s21 offen offset:2048 sc1
  buffer_load_dwordx4 v[72:75], v1, s[4:7], s22 offen offset:0 sc1
L_ok_17:
  v_mfma_f32_16x16x32_bf16 v[128:131], a[52:55], v[36:39], v[128:131]
  v_mfma_f32_16x16x32_bf16 v[132:135], a[72:75], v[36:39], v[132:135]
  s_waitcnt vmcnt(6)
  v_bitop3_b32 v27, v40, v40, v14 bitop3:0x2a
  v_mfma_f32_16x16x32_bf16 v[136:139], a[92:95], v[36:39], v[136:139]
  v_cmp_ne_u32 vcc, 0, v27
  v_mfma_f32_16x16x32_bf16 v[140:143], a[112:115], v[36:39], v[140:143]
  buffer_load_dwordx4 v[84:87], v1, s[4:7], s22 offen offset:3072 sc1
  v_mfma_f32_16x16x32_bf16 v[144:147], a[132:135], v[36:39], v[144:147]
  s_cbranch_vccz L_ok_19
L_retry_18:
  s_sub_u32 s69, s69, 1
  s_cbranch_scc1 L_retry_18_to
  buffer_load_dwordx4 v[40:43], v1, s[4:7], s20 offen offset:2048 sc1
  s_waitcnt vmcnt(0)
  v_bitop3_b32 v27, v40, v40, v14 bitop3:0x2a
  v_cmp_ne_u32 vcc, 0, v27
  s_nop 1
  s_cbranch_vccnz L_retry_18
  v_bitop3_b32 v27, v52, v64, v56 bitop3:0x80
  v_bitop3_b32 v27, v27, v68, v60 bitop3:0x80
  v_bitop3_b32 v27, v27, v72, v84 bitop3:0x80
  v_bitop3_b32 v27, v27, v27, v14 bitop3:0x2a
  v_cmp_ne_u32 vcc, 0, v27
  s_nop 1
  s_cbranch_vccz L_ok_19
  buffer_load_dwordx4 v[52:55], v1, s[4:7], s21 offen offset:0 sc1
  buffer_load_dwordx4 v[64:67], v1, s[4:7], s21 offen offset:3072 sc1
  buffer_load_dwordx4 v[56:59], v1, s[4:7], s21 offen offset:1024 sc1
  buffer_load_dwordx4 v[68:71], v1, s[4:7], s29 offen offset:0 sc1
  buffer_load_dwordx4 v[60:63], v1, s[4:7], s21 offen offset:2048 sc1
  buffer_load_dwordx4 v[72:75], v1, s[4:7], s22 offen offset:0 sc1
  buffer_load_dwordx4 v[84:87], v1, s[4:7], s22 offen offset:3072 sc1
L_ok_19:
  v_mfma_f32_16x16x32_bf16 v[128:131], a[64:67], v[48:51], v[128:131]
  v_mfma_f32_16x16x32_bf16 v[132:135], a[84:87], v[48:51], v[132:135]
  v_mfma_f32_16x16x32_bf16 v[136:139], a[104:107], v[48:51], v[136:139]
  s_mov_b32 s85, 9207808
  buffer_load_dwordx4 v[228:231], v244, s[4:7], s85 offen sc1
  v_mfma_f32_16x16x32_bf16 v[140:143], a[124:127], v[48:51], v[140:143]
  v_mfma_f32_16x16x32_bf16 v[144:147], a[144:147], v[48:51], v[144:147]
  s_waitcnt vmcnt(6)
  v_bitop3_b32 v27, v52, v64, v14 bitop3:0x2a
  v_mfma_f32_16x16x32_bf16 v[128:131], a[56:59], v[40:43], v[128:131]
  v_cmp_ne_u32 vcc, 0, v27
  v_mfma_f32_16x16x32_bf16 v[132:135], a[76:79], v[40:43], v[132:135]
  s_cbranch_vccz L_ok_21
L_retry_20:
  s_sub_u32 s69, s69, 1
  s_cbranch_scc1 L_retry_20_to
  buffer_load_dwordx4 v[52:55], v1, s[4:7], s21 offen offset:0 sc1
  buffer_load_dwordx4 v[64:67], v1, s[4:7], s21 offen offset:3072 sc1
  s_waitcnt vmcnt(0)
  v_bitop3_b32 v27, v52, v64, v14 bitop3:0x2a
  v_cmp_ne_u32 vcc, 0, v27
  s_nop 1
  s_cbranch_vccnz L_retry_20
  v_bitop3_b32 v27, v56, v68, v60 bitop3:0x80
  v_bitop3_b32 v27, v27, v72, v84 bitop3:0x80
  v_bitop3_b32 v27, v27, v27, v14 bitop3:0x2a
  v_cmp_ne_u32 vcc, 0, v27
  s_nop 1
  s_cbranch_vccz L_ok_21
  buffer_load_dwordx4 v[56:59], v1, s[4:7], s21 offen offset:1024 sc1
  buffer_load_dwordx4 v[68:71], v1, s[4:7], s29 offen offset:0 sc1
  buffer_load_dwordx4 v[60:63], v1, s[4:7], s21 offen offset:2048 sc1
  buffer_load_dwordx4 v[72:75], v1, s[4:7], s22 offen offset:0 sc1
  buffer_load_dwordx4 v[84:87], v1, s[4:7], s22 offen offset:3072 sc1
  buffer_load_dword a253, v26, s[4:7], s76 offen
L_ok_21:
  s_mov_b32 s85, 9244672
  buffer_load_dwordx4 v[232:235], v244, s[4:7], s85 offen sc1
  v_mfma_f32_16x16x32_bf16 v[136:139], a[96:99], v[40:43], v[136:139]
  v_mfma_f32_16x16x32_bf16 v[140:143], a[116:119], v[40:43], v[140:143]
  v_mfma_f32_16x16x32_bf16 v[144:147], a[136:139], v[40:43], v[144:147]
  ds_write_b128 v4, v[128:131] offset:0
  v_mfma_f32_16x16x32_bf16 v[148:151], a[48:51], v[52:55], 0
  buffer_load_dwordx4 v[76:79], v1, s[4:7], s22 offen offset:1024 sc1
  v_mfma_f32_16x16x32_bf16 v[152:155], a[68:71], v[52:55], 0
  v_mfma_f32_16x16x32_bf16 v[156:159], a[88:91], v[52:55], 0
  ds_write_b128 v4, v[132:135] offset:1024
  v_mfma_f32_16x16x32_bf16 v[160:163], a[108:111], v[52:55], 0
  v_mfma_f32_16x16x32_bf16 v[164:167], a[128:131], v[52:55], 0
  buffer_load_dwordx4 v[88:91], v1, s[4:7], s30 offen offset:0 sc1
  v_mfma_f32_16x16x32_bf16 v[148:151], a[60:63], v[64:67], v[148:151]
  ds_write_b128 v4, v[136:139] offset:2048
  v_mfma_f32_16x16x32_bf16 v[152:155], a[80:83], v[64:67], v[152:155]
  s_waitcnt vmcnt(6)
  v_bitop3_b32 v27, v56, v68, v60 bitop3:0x80
  v_mfma_f32_16x16x32_bf16 v[156:159], a[100:103], v[64:67], v[156:159]
  v_bitop3_b32 v27, v27, v27, v14 bitop3:0x2a
  v_mfma_f32_16x16x32_bf16 v[160:163], a[120:123], v[64:67], v[160:163]
  buffer_load_dwordx4 v[80:83], v1, s[4:7], s22 offen offset:2048 sc1
  v_mfma_f32_16x16x32_bf16 v[164:167], a[140:143], v[64:67], v[164:167]
  v_cmp_ne_u32 vcc, 0, v27
  ds_write_b128 v4, v[140:143] offset:3072
  s_cbranch_vccz L_ok_23
L_retry_22:
  s_sub_u32 s69, s69, 1
  s_cbranch_scc1 L_retry_22_to
  buffer_load_dwordx4 v[56:59], v1, s[4:7], s21 offen offset:1024 sc1
  buffer_load_dwordx4 v[68:71], v1, s[4:7], s29 offen offset:0 sc1
  buffer_load_dwordx4 v[60:63], v1, s[4:7], s21 offen offset:2048 sc1
  s_waitcnt vmcnt(0)
  v_bitop3_b32 v27, v56, v68, v60 bitop3:0x80
  v_bitop3_b32 v27, v27, v27, v14 bitop3:0x2a
  v_cmp_ne_u32 vcc, 0, v27
  s_nop 1
  s_cbranch_vccnz L_retry_22
  v_bitop3_b32 v27, v72, v84, v76 bitop3:0x80
  v_bitop3_b32 v27, v27, v88, v80 bitop3:0x80
  v_bitop3_b32 v27, v27, v27, v14 bitop3:0x2a
  v_cmp_ne_u32 vcc, 0, v27
  s_nop 1
  s_cbranch_vccz L_ok_23
  buffer_load_dwordx4 v[72:75], v1, s[4:7], s22 offen offset:0 sc1
  buffer_load_dwordx4 v[84:87], v1, s[4:7], s22 offen offset:3072 sc1
  buffer_load_dword a253, v26, s[4:7], s76 offen
  buffer_load_dword a253, v26, s[4:7], s76 offen
  buffer_load_dwordx4 v[76:79], v1, s[4:7], s22 offen offset:1024 sc1
  buffer_load_dwordx4 v[88:91], v1, s[4:7], s30 offen offset:0 sc1
  buffer_load_dwordx4 v[80:83], v1, s[4:7], s22 offen offset:2048 sc1
L_ok_23:
  v_mfma_f32_16x16x32_bf16 v[148:151], a[52:55], v[56:59], v[148:151]
  v_mfma_f32_16x16x32_bf16 v[148:151], a[64:67], v[68:71], v[148:151]
  s_mov_b32 s85, 9281536
  buffer_load_dwordx4 v[236:239], v244, s[4:7], s85 offen sc1
  v_mfma_f32_16x16x32_bf16 v[148:151], a[56:59], v[60:63], v[148:151]
  ds_write_b128 v4, v[144:147] offset:4096
  v_mfma_f32_16x16x32_bf16 v[152:155], a[72:75], v[56:59], v[152:155]
  v_mfma_f32_16x16x32_bf16 v[152:155], a[84:87], v[68:71], v[152:155]
  v_mfma_f32_16x16x32_bf16 v[152:155], a[76:79], v[60:63], v[152:155]
  s_mov_b32 s85, 9318400
  buffer_load_dwordx4 v[240:243], v244, s[4:7], s85 offen sc1
  v_mfma_f32_16x16x32_bf16 v[156:159], a[92:95], v[56:59], v[156:159]
  v_mfma_f32_16x16x32_bf16 v[156:159], a[104:107], v[68:71], v[156:159]
  ds_write_b128 v5, v[148:151] offset:0
  v_mfma_f32_16x16x32_bf16 v[156:159], a[96:99], v[60:63], v[156:159]
  v_mfma_f32_16x16x32_bf16 v[160:163], a[112:115], v[56:59], v[160:163]
  buffer_load_dwordx4 v[92:95], v1, s[4:7], s23 offen offset:0 sc1
  v_mfma_f32_16x16x32_bf16 v[160:163], a[124:127], v[68:71], v[160:163]
  ds_write_b128 v5, v[152:155] offset:1024
  v_mfma_f32_16x16x32_bf16 v[160:163], a[116:119], v[60:63], v[160:163]
  v_mfma_f32_16x16x32_bf16 v[164:167], a[132:135], v[56:59], v[164:167]
  v_mfma_f32_16x16x32_bf16 v[164:167], a[144:147], v[68:71], v[164:167]
  buffer_load_dwordx4 v[104:107], v1, s[4:7], s23 offen offset:3072 sc1
  v_mfma_f32_16x16x32_bf16 v[164:167], a[136:139], v[60:63], v[164:167]
  ds_write_b128 v5, v[156:159] offset:2048
  buffer_load_dwordx4 v[96:99], v1, s[4:7], s23 offen offset:1024 sc1
  s_nop 1
  ds_write_b128 v5, v[160:163] offset:3072
  buffer_load_dwordx4 v[108:111], v1, s[4:7], s31 offen offset:0 sc1
  s_nop 1
  ds_write_b128 v5, v[164:167] offset:4096
  buffer_load_dwordx4 v[100:103], v1, s[4:7], s23 offen offset:2048 sc1
  s_add_u32 m0, s72, 3072
  s_mov_b32 s2, 215040
  buffer_load_dwordx4 v3, s[4:7], s2 offen lds
  s_add_u32 m0, s72, 4096
  s_mov_b32 s2, 216064
  buffer_load_dwordx4 v3, s[4:7], s2 offen lds
  s_waitcnt vmcnt(12)
  v_add_f32 v228, v228, v232
  v_add_f32 v229, v229, v233
  v_add_f32 v230, v230, v234
  v_add_f32 v231, v231, v235
  s_add_u32 m0, s72, 5120
  s_mov_b32 s2, 217088
  buffer_load_dwordx4 v3, s[4:7], s2 offen lds
  s_waitcnt vmcnt(12)
  v_bitop3_b32 v27, v72, v84, v76 bitop3:0x80
  s_add_u32 m0, s72, 6144
  s_mov_b32 s2, 218112
  buffer_load_dwordx4 v3, s[4:7], s2 offen lds
  s_add_u32 m0, s72, 7168
  s_mov_b32 s2, 219136
  buffer_load_dwordx4 v3, s[4:7], s2 offen lds
  s_waitcnt vmcnt(12)
  v_bitop3_b32 v27, v27, v88, v80 bitop3:0x80
  v_bitop3_b32 v27, v27, v27, v14 bitop3:0x2a
  v_cmp_ne_u32 vcc, 0, v27
  s_nop 0
  s_cbranch_vccnz L_retry_24
L_ok_25:
  v_mfma_f32_16x16x32_bf16 v[168:171], a[48:51], v[72:75], 0
  v_mfma_f32_16x16x32_bf16 v[168:171], a[60:63], v[84:87], v[168:171]
  s_add_u32 m0, s72, 8192
  s_mov_b32 s2, 220160
  buffer_load_dwordx4 v3, s[4:7], s2 offen lds
  v_mfma_f32_16x16x32_bf16 v[168:171], a[52:55], v[76:79], v[168:171]
  v_mfma_f32_16x16x32_bf16 v[168:171], a[64:67], v[88:91], v[168:171]
  v_mfma_f32_16x16x32_bf16 v[168:171], a[56:59], v[80:83], v[168:171]
  s_waitcnt vmcnt(12)
  v_add_f32 v228, v228, v236
  v_add_f32 v229, v229, v237
  v_mfma_f32_16x16x32_bf16 v[172:175], a[68:71], v[72:75], 0
  v_add_f32 v230, v230, v238
  v_add_f32 v231, v231, v239
  v_mfma_f32_16x16x32_bf16 v[172:175], a[80:83], v[84:87], v[172:175]
  v_mfma_f32_16x16x32_bf16 v[172:175], a[72:75], v[76:79], v[172:175]
  v_mfma_f32_16x16x32_bf16 v[172:175], a[84:87], v[88:91], v[172:175]
  ds_write_b128 v6, v[168:171] offset:0
  v_mfma_f32_16x16x32_bf16 v[172:175], a[76:79], v[80:83], v[172:175]
  s_waitcnt vmcnt(11)
  v_add_f32 v228, v228, v240
  v_add_f32 v229, v229, v241
  v_mfma_f32_16x16x32_bf16 v[176:179], a[88:91], v[72:75], 0
  v_add_f32 v230, v230, v242
  v_add_f32 v231, v231, v243
  v_mfma_f32_16x16x32_bf16 v[176:179], a[100:103], v[84:87], v[176:179]
  v_mov_b32 v232, v228
  v_mov_b32 v233, v229
  v_mfma_f32_16x16x32_bf16 v[176:179], a[92:95], v[76:79], v[176:179]
  v_mov_b32 v234, v230
  v_mov_b32 v235, v231
  v_mfma_f32_16x16x32_bf16 v[176:179], a[104:107], v[88:91], v[176:179]
  v_permlane32_swap_b32 v228, v232
  v_mfma_f32_16x16x32_bf16 v[176:179], a[96:99], v[80:83], v[176:179]
  v_permlane32_swap_b32 v229, v233
  v_mfma_f32_16x16x32_bf16 v[180:183], a[108:111], v[72:75], 0
  v_permlane32_swap_b32 v230, v234
  v_permlane32_swap_b32 v231, v235
  v_mfma_f32_16x16x32_bf16 v[180:183], a[120:123], v[84:87], v[180:183]
  v_add_f32 v228, v228, v232
  v_add_f32 v229, v229, v233
  v_add_f32 v230, v230, v234
  v_add_f32 v231, v231, v235
  ds_write_b128 v247, v[228:231]
  v_mfma_f32_16x16x32_bf16 v[180:183], a[112:115], v[76:79], v[180:183]
  v_mfma_f32_16x16x32_bf16 v[180:183], a[124:127], v[88:91], v[180:183]
  v_mfma_f32_16x16x32_bf16 v[180:183], a[116:119], v[80:83], v[180:183]
  ds_write_b128 v6, v[172:175] offset:1024
  v_mfma_f32_16x16x32_bf16 v[184:187], a[128:131], v[72:75], 0
  s_waitcnt vmcnt(8)
  v_bitop3_b32 v27, v92, v104, v96 bitop3:0x80
  v_mfma_f32_16x16x32_bf16 v[184:187], a[140:143], v[84:87], v[184:187]
  v_mfma_f32_16x16x32_bf16 v[184:187], a[132:135], v[76:79], v[184:187]
  ds_write_b128 v6, v[176:179] offset:2048
  v_mfma_f32_16x16x32_bf16 v[184:187], a[144:147], v[88:91], v[184:187]
  v_mfma_f32_16x16x32_bf16 v[184:187], a[136:139], v[80:83], v[184:187]
  s_waitcnt lgkmcnt(2)
  s_barrier
  ds_write_b128 v6, v[180:183] offset:3072
  ds_read_b128 v[132:135], v7 offset:1024
  s_waitcnt vmcnt(6)
  v_bitop3_b32 v27, v27, v108, v100 bitop3:0x80
  v_bitop3_b32 v27, v27, v27, v14 bitop3:0x2a
  v_cmp_ne_u32 vcc, 0, v27
  ds_read_b128 v[152:155], v7 offset:6144
  s_cbranch_vccnz L_retry_26
L_ok_27:
  v_mfma_f32_16x16x32_bf16 v[188:191], a[48:51], v[92:95], v[208:211]
  buffer_load_dwordx4 a[48:51], v3, s[4:7], s70 offen offset:2048
  ds_write_b128 v6, v[184:187] offset:4096
  ds_read_b128 v[136:139], v7 offset:2048
  v_mfma_f32_16x16x32_bf16 v[188:191], a[60:63], v[104:107], v[188:191]
  ds_read_b128 v[156:159], v7 offset:7168
  v_mfma_f32_16x16x32_bf16 v[188:191], a[52:55], v[96:99], v[188:191]
  ds_read_b128 v[140:143], v7 offset:3072
  v_mfma_f32_16x16x32_bf16 v[188:191], a[64:67], v[108:111], v[188:191]
  buffer_load_dwordx4 a[52:55], v3, s[4:7], s70 offen offset:3072
  ds_read_b128 v[160:163], v7 offset:8192
  v_mfma_f32_16x16x32_bf16 v[188:191], a[56:59], v[100:103], v[188:191]
  ds_read_b128 v[144:147], v7 offset:4096
  ds_read_b128 v[164:167], v7 offset:9216
  ds_read_b128 v[128:131], v7 offset:0
  s_waitcnt lgkmcnt(8)
  v_add_f32 v132, v132, v152
  s_mov_b32 s70, 143360
  buffer_load_dwordx4 a[56:59], v3, s[4:7], s70 offen offset:0
  ds_read_b128 v[148:151], v7 offset:5120
  v_add_f32 v133, v133, v153
  v_add_f32 v134, v134, v154
  v_add_f32 v135, v135, v155
  v_add_f32 v132, v132, v212
  v_add_f32 v133, v133, v213
  v_add_f32 v134, v134, v214
  v_add_f32 v135, v135, v215
  s_nop 1
  v_mfma_f32_16x16x32_bf16 v[192:195], a[68:71], v[92:95], v[132:135]
  s_waitcnt lgkmcnt(6)
  v_add_f32 v136, v136, v156
  v_mfma_f32_16x16x32_bf16 v[192:195], a[80:83], v[104:107], v[192:195]
  buffer_load_dwordx4 a[60:63], v3, s[4:7], s70 offen offset:1024
  v_mfma_f32_16x16x32_bf16 v[192:195], a[72:75], v[96:99], v[192:195]
  v_add_f32 v137, v137, v157
  v_add_f32 v138, v138, v158
  v_mfma_f32_16x16x32_bf16 v[192:195], a[84:87], v[108:111], v[192:195]
  v_add_f32 v139, v139, v159
  v_add_f32 v136, v136, v216
  v_mfma_f32_16x16x32_bf16 v[192:195], a[76:79], v[100:103], v[192:195]
  v_add_f32 v137, v137, v217
  v_add_f32 v138, v138, v218
  v_add_f32 v139, v139, v219
  s_waitcnt lgkmcnt(4)
  v_add_f32 v140, v140, v160
  v_add_f32 v141, v141, v161
  v_mfma_f32_16x16x32_bf16 v[196:199], a[88:91], v[92:95], v[136:139]
  buffer_load_dwordx4 a[64:67], v3, s[4:7], s70 offen offset:2048
  v_mfma_f32_16x16x32_bf16 v[196:199], a[100:103], v[104:107], v[196:199]
  s_waitcnt lgkmcnt(0)
  s_barrier
  ds_read_b128 v[172:175], v7 offset:11264
  v_add_f32 v128, v128, v148
  v_add_f32 v129, v129, v149
  v_mfma_f32_16x16x32_bf16 v[196:199], a[92:95], v[96:99], v[196:199]
  ds_read_b128 v[168:171], v7 offset:10240
  buffer_load_dwordx4 a[68:71], v3, s[4:7], s70 offen offset:3072
  v_add_f32 v130, v130, v150
  v_add_f32 v131, v131, v151
  v_add_f32 v188, v188, v128
  v_add_f32 v189, v189, v129
  v_add_f32 v190, v190, v130
  v_add_f32 v191, v191, v131
  v_mfma_f32_16x16x32_bf16 v[196:199], a[104:107], v[108:111], v[196:199]
  ds_read_b128 v[176:179], v7 offset:12288
  v_add_f32 v142, v142, v162
  v_mfma_f32_16x16x32_bf16 v[196:199], a[96:99], v[100:103], v[196:199]
  ds_read_b128 v[180:183], v7 offset:13312
  v_add_f32 v143, v143, v163
  v_add_f32 v140, v140, v220
  v_add_f32 v141, v141, v221
  s_mov_b32 s70, 147456
  buffer_load_dwordx4 a[72:75], v3, s[4:7], s70 offen offset:0
  v_add_f32 v142, v142, v222
  v_add_f32 v143, v143, v223
  ds_read_b128 v[184:187], v7 offset:14336
  v_add_f32 v144, v144, v164
  v_mfma_f32_16x16x32_bf16 v[200:203], a[108:111], v[92:95], v[140:143]
  v_add_f32 v145, v145, v165
  v_add_f32 v146, v146, v166
  v_mfma_f32_16x16x32_bf16 v[200:203], a[120:123], v[104:107], v[200:203]
  v_add_f32 v147, v147, v167
  v_add_f32 v144, v144, v224
  s_waitcnt lgkmcnt(4)
  v_pk_add_f32 v[192:193], v[192:193], v[172:173]
  v_pk_add_f32 v[194:195], v[194:195], v[174:175]
  buffer_load_dwordx4 a[76:79], v3, s[4:7], s70 offen offset:1024
  s_waitcnt lgkmcnt(3)
  v_add_f32 v188, v188, v168
  v_add_f32 v189, v189, v169
  v_add_f32 v190, v190, v170
  v_add_f32 v191, v191, v171
  v_cvt_pk_bf16_f32 v148, v188, v189
  v_cvt_pk_bf16_f32 v150, v192, v193
  v_cvt_pk_bf16_f32 v151, v194, v195
  v_cvt_pk_bf16_f32 v149, v190, v191
  v_or_b32 v148, v14, v148
  s_cmp_eq_u32 s71, 0
  s_cbranch_scc1 L_slow_28
  buffer_store_dwordx4 v[148:151], v1, s[4:7], s48 offen offset:1024
L_back_29:
  v_pk_add_f32 v[116:117], v[188:189], v[190:191]
  v_pk_mul_f32 v[118:119], v[188:189], v[188:189]
  v_pk_fma_f32 v[118:119], v[190:191], v[190:191], v[118:119]
  v_pk_add_f32 v[116:117], v[116:117], v[192:193]
  v_pk_fma_f32 v[118:119], v[192:193], v[192:193], v[118:119]
  v_add_f32 v145, v145, v225
  v_mfma_f32_16x16x32_bf16 v[200:203], a[112:115], v[96:99], v[200:203]
  v_add_f32 v146, v146, v226
  v_add_f32 v147, v147, v227
  v_mfma_f32_16x16x32_bf16 v[200:203], a[124:127], v[108:111], v[200:203]
  v_mfma_f32_16x16x32_bf16 v[200:203], a[116:119], v[100:103], v[200:203]
  v_mfma_f32_16x16x32_bf16 v[204:207], a[128:131], v[92:95], v[144:147]
  v_mfma_f32_16x16x32_bf16 v[204:207], a[140:143], v[104:107], v[204:207]
  v_mfma_f32_16x16x32_bf16 v[204:207], a[132:135], v[96:99], v[204:207]
  v_mfma_f32_16x16x32_bf16 v[204:207], a[144:147], v[108:111], v[204:207]
  v_mfma_f32_16x16x32_bf16 v[204:207], a[136:139], v[100:103], v[204:207]
  s_waitcnt lgkmcnt(2)
  v_pk_add_f32 v[196:197], v[196:197], v[176:177]
  v_pk_add_f32 v[198:199], v[198:199], v[178:179]
  s_waitcnt lgkmcnt(1)
  v_pk_add_f32 v[200:201], v[200:201], v[180:181]
  v_pk_add_f32 v[202:203], v[202:203], v[182:183]
  v_cvt_pk_bf16_f32 v152, v196, v197
  v_cvt_pk_bf16_f32 v153, v198, v199
  v_cvt_pk_bf16_f32 v154, v200, v201
  v_cvt_pk_bf16_f32 v155, v202, v203
  v_or_b32 v152, v14, v152
  s_cmp_eq_u32 s71, 0
  s_cbranch_scc1 L_slow_30
  buffer_store_dwordx4 v[152:155], v1, s[4:7], s48 offen offset:2048
L_back_31:
  s_waitcnt lgkmcnt(0)
  v_pk_add_f32 v[204:205], v[204:205], v[184:185]
  v_pk_add_f32 v[206:207], v[206:207], v[186:187]
  v_cvt_pk_bf16_f32 v156, v204, v205
  v_cvt_pk_bf16_f32 v157, v206, v207
  v_pk_add_f32 v[116:117], v[116:117], v[194:195]
  v_pk_fma_f32 v[118:119], v[194:195], v[194:195], v[118:119]
  v_pk_add_f32 v[116:117], v[116:117], v[196:197]
  v_pk_fma_f32 v[118:119], v[196:197], v[196:197], v[118:119]
  v_pk_add_f32 v[116:117], v[116:117], v[198:199]
  v_permlane32_swap_b32 v156, v158
  v_permlane32_swap_b32 v157, v159
  v_or_b32 v156, v14, v156
  s_cmp_eq_u32 s71, 0
  s_cbranch_scc1 L_slow_32
  buffer_store_dwordx4 v[156:159], v254, s[4:7], s48 offen
L_back_33:
  v_pk_fma_f32 v[118:119], v[198:199], v[198:199], v[118:119]
  v_pk_add_f32 v[116:117], v[116:117], v[200:201]
  v_pk_fma_f32 v[118:119], v[200:201], v[200:201], v[118:119]
  v_pk_add_f32 v[116:117], v[116:117], v[202:203]
  v_pk_fma_f32 v[118:119], v[202:203], v[202:203], v[118:119]
  v_pk_add_f32 v[116:117], v[116:117], v[204:205]
  v_pk_fma_f32 v[118:119], v[204:205], v[204:205], v[118:119]
  v_pk_add_f32 v[116:117], v[116:117], v[206:207]
  v_pk_fma_f32 v[118:119], v[206:207], v[206:207], v[118:119]
  buffer_load_dwordx4 v[32:35], v1, s[4:7], s16 offen offset:0 sc1
  v_add_f32 v116, v116, v117
  v_add_f32 v118, v118, v119
  v_mov_b64 v[208:209], v[188:189]
  v_mov_b64 v[210:211], v[190:191]
  v_mov_b64 v[212:213], v[192:193]
  v_mov_b64 v[214:215], v[194:195]
  v_mov_b64 v[216:217], v[196:197]
  v_mov_b64 v[218:219], v[198:199]
  v_mov_b64 v[220:221], v[200:201]
  v_mov_b64 v[222:223], v[202:203]
  v_mov_b64 v[224:225], v[204:205]
  v_mov_b64 v[226:227], v[206:207]
  v_permlane16_swap_b32 v116, v118
  buffer_load_dwordx4 v[44:47], v1, s[4:7], s16 offen offset:3072 sc1
  v_add_f32 v116, v116, v118
  v_mov_b32 v117, v116
  ds_read_b128 v[188:191], v12 offset:960
  s_nop 0
  v_permlane32_swap_b32 v116, v117
  v_add_f32 v116, v116, v117
  v_or_b32 v116, 1, v116
  s_cmp_eq_u32 s71, 0
  s_cbranch_scc1 L_slow_34
  buffer_store_dword v116, v26, s[4:7], s58 offen
L_back_35:
  ds_read_b128 v[192:195], v12 offset:976
  ds_read_b128 v[196:199], v12 offset:992
  ds_read_b128 v[200:203], v12 offset:1008
  ds_read_b128 v[204:207], v12 offset:1024
  buffer_load_dwordx4 v[36:39], v1, s[4:7], s16 offen offset:1024 sc1
  buffer_load_dwordx4 v[48:51], v1, s[4:7], s24 offen offset:0 sc1
  buffer_load_dwordx4 v[40:43], v1, s[4:7], s16 offen offset:2048 sc1
  buffer_load_dwordx4 v[52:55], v1, s[4:7], s17 offen offset:0 sc1
  buffer_load_dwordx4 v[64:67], v1, s[4:7], s17 offen offset:3072 sc1
  buffer_load_dwordx4 v[56:59], v1, s[4:7], s17 offen offset:1024 sc1
  s_waitcnt vmcnt(7)
  v_bitop3_b32 v27, v32, v44, v14 bitop3:0x2a
  v_cmp_ne_u32 vcc, 0, v27
  s_nop 0
  s_cbranch_vccz L_ok_37
L_retry_36:
  s_sub_u32 s69, s69, 1
  s_cbranch_scc1 L_retry_36_to
  buffer_load_dwordx4 v[32:35], v1, s[4:7], s16 offen offset:0 sc1
  buffer_load_dwordx4 v[44:47], v1, s[4:7], s16 offen offset:3072 sc1
  s_waitcnt vmcnt(0)
  v_bitop3_b32 v27, v32, v44, v14 bitop3:0x2a
  v_cmp_ne_u32 vcc, 0, v27
  s_nop 1
  s_cbranch_vccnz L_retry_36
  v_bitop3_b32 v27, v36, v48, v40 bitop3:0x80
  v_bitop3_b32 v27, v27, v52, v64 bitop3:0x80
  v_bitop3_b32 v27, v27, v56, v14 bitop3:0x2a
  v_cmp_ne_u32 vcc, 0, v27
  s_nop 1
  s_cbranch_vccz L_ok_37
  buffer_load_dwordx4 v[36:39], v1, s[4:7], s16 offen offset:1024 sc1
  buffer_load_dwordx4 v[48:51], v1, s[4:7], s24 offen offset:0 sc1
  buffer_load_dwordx4 v[40:43], v1, s[4:7], s16 offen offset:2048 sc1
  buffer_load_dwordx4 v[52:55], v1, s[4:7], s17 offen offset:0 sc1
  buffer_load_dwordx4 v[64:67], v1, s[4:7], s17 offen offset:3072 sc1
  buffer_load_dwordx4 v[56:59], v1, s[4:7], s17 offen offset:1024 sc1
L_ok_37:
  v_mfma_f32_16x16x32_bf16 v[128:131], a[148:151], v[32:35], 0
  v_mfma_f32_16x16x32_bf16 v[132:135], a[168:171], v[32:35], 0
  buffer_load_dwordx4 v[68:71], v1, s[4:7], s25 offen offset:0 sc1
  v_mfma_f32_16x16x32_bf16 v[136:139], a[188:191], v[32:35], 0
  v_mfma_f32_16x16x32_bf16 v[140:143], a[208:211], v[32:35], 0
  v_mfma_f32_16x16x32_bf16 v[144:147], a[228:231], v[32:35], 0
  v_mfma_f32_16x16x32_bf16 v[128:131], a[160:163], v[44:47], v[128:131]
  v_mfma_f32_16x16x32_bf16 v[132:135], a[180:183], v[44:47], v[132:135]
  buffer_load_dwordx4 v[60:63], v1, s[4:7], s17 offen offset:2048 sc1
  v_mfma_f32_16x16x32_bf16 v[136:139], a[200:203], v[44:47], v[136:139]
  s_waitcnt vmcnt(6)
  v_bitop3_b32 v27, v36, v48, v14 bitop3:0x2a
  v_mfma_f32_16x16x32_bf16 v[140:143], a[220:223], v[44:47], v[140:143]
  v_cmp_ne_u32 vcc, 0, v27
  v_mfma_f32_16x16x32_bf16 v[144:147], a[240:243], v[44:47], v[144:147]
  s_cbranch_vccz L_ok_39
L_retry_38:
  s_sub_u32 s69, s69, 1
  s_cbranch_scc1 L_retry_38_to
  buffer_load_dwordx4 v[36:39], v1, s[4:7], s16 offen offset:1024 sc1
  buffer_load_dwordx4 v[48:51], v1, s[4:7], s24 offen offset:0 sc1
  s_waitcnt vmcnt(0)
  v_bitop3_b32 v27, v36, v48, v14 bitop3:0x2a
  v_cmp_ne_u32 vcc, 0, v27
  s_nop 1
  s_cbranch_vccnz L_retry_38
  v_bitop3_b32 v27, v40, v52, v64 bitop3:0x80
  v_bitop3_b32 v27, v27, v56, v68 bitop3:0x80
  v_bitop3_b32 v27, v27, v60, v14 bitop3:0x2a
  v_cmp_ne_u32 vcc, 0, v27
  s_nop 1
  s_cbranch_vccz L_ok_39
  buffer_load_dwordx4 v[40:43], v1, s[4:7], s16 offen offset:2048 sc1
  buffer_load_dwordx4 v[52:55], v1, s[4:7], s17 offen offset:0 sc1
  buffer_load_dwordx4 v[64:67], v1, s[4:7], s17 offen offset:3072 sc1
  buffer_load_dwordx4 v[56:59], v1, s[4:7], s17 offen offset:1024 sc1
  buffer_load_dwordx4 v[68:71], v1, s[4:7], s25 offen offset:0 sc1
  buffer_load_dwordx4 v[60:63], v1, s[4:7], s17 offen offset:2048 sc1
L_ok_39:
  v_mfma_f32_16x16x32_bf16 v[128:131], a[152:155], v[36:39], v[128:131]
  v_mfma_f32_16x16x32_bf16 v[132:135], a[172:175], v[36:39], v[132:135]
  buffer_load_dwordx4 v[72:75], v1, s[4:7], s18 offen offset:0 sc1
  v_mfma_f32_16x16x32_bf16 v[136:139], a[192:195], v[36:39], v[136:139]
  s_waitcnt vmcnt(6)
  v_bitop3_b32 v27, v40, v40, v14 bitop3:0x2a
  v_mfma_f32_16x16x32_bf16 v[140:143], a[212:215], v[36:39], v[140:143]
  v_cmp_ne_u32 vcc, 0, v27
  v_mfma_f32_16x16x32_bf16 v[144:147], a[232:235], v[36:39], v[144:147]
  s_cbranch_vccz L_ok_41
L_retry_40:
  s_sub_u32 s69, s69, 1
  s_cbranch_scc1 L_retry_40_to
  buffer_load_dwordx4 v[40:43], v1, s[4:7], s16 offen offset:2048 sc1
  s_waitcnt vmcnt(0)
  v_bitop3_b32 v27, v40, v40, v14 bitop3:0x2a
  v_cmp_ne_u32 vcc, 0, v27
  s_nop 1
  s_cbranch_vccnz L_retry_40
  v_bitop3_b32 v27, v52, v64, v56 bitop3:0x80
  v_bitop3_b32 v27, v27, v68, v60 bitop3:0x80
  v_bitop3_b32 v27, v27, v72, v14 bitop3:0x2a
  v_cmp_ne_u32 vcc, 0, v27
  s_nop 1
  s_cbranch_vccz L_ok_41
  buffer_load_dwordx4 v[52:55], v1, s[4:7], s17 offen offset:0 sc1
  buffer_load_dwordx4 v[64:67], v1, s[4:7], s17 offen offset:3072 sc1
  buffer_load_dwordx4 v[56:59], v1, s[4:7], s17 offen offset:1024 sc1
  buffer_load_dwordx4 v[68:71], v1, s[4:7], s25 offen offset:0 sc1
  buffer_load_dwordx4 v[60:63], v1, s[4:7], s17 offen offset:2048 sc1
  buffer_load_dwordx4 v[72:75], v1, s[4:7], s18 offen offset:0 sc1
L_ok_41:
  v_mfma_f32_16x16x32_bf16 v[128:131], a[164:167], v[48:51], v[128:131]
  buffer_load_dwordx4 v[84:87], v1, s[4:7], s18 offen offset:3072 sc1
  v_mfma_f32_16x16x32_bf16 v[132:135], a[184:187], v[48:51], v[132:135]
  v_mfma_f32_16x16x32_bf16 v[136:139], a[204:207], v[48:51], v[136:139]
  v_mfma_f32_16x16x32_bf16 v[140:143], a[224:227], v[48:51], v[140:143]
  v_mfma_f32_16x16x32_bf16 v[144:147], a[244:247], v[48:51], v[144:147]
  v_mfma_f32_16x16x32_bf16 v[128:131], a[156:159], v[40:43], v[128:131]
  buffer_load_dwordx4 v[76:79], v1, s[4:7], s18 offen offset:1024 sc1
  v_mfma_f32_16x16x32_bf16 v[132:135], a[176:179], v[40:43], v[132:135]
  s_waitcnt vmcnt(6)
  v_bitop3_b32 v27, v52, v64, v14 bitop3:0x2a
  v_mfma_f32_16x16x32_bf16 v[136:139], a[196:199], v[40:43], v[136:139]
  v_cmp_ne_u32 vcc, 0, v27
  v_mfma_f32_16x16x32_bf16 v[140:143], a[216:219], v[40:43], v[140:143]
  s_cbranch_vccz L_ok_43
L_retry_42:
  s_sub_u32 s69, s69, 1
  s_cbranch_scc1 L_retry_42_to
  buffer_load_dwordx4 v[52:55], v1, s[4:7], s17 offen offset:0 sc1
  buffer_load_dwordx4 v[64:67], v1, s[4:7], s17 offen offset:3072 sc1
  s_waitcnt vmcnt(0)
  v_bitop3_b32 v27, v52, v64, v14 bitop3:0x2a
  v_cmp_ne_u32 vcc, 0, v27
  s_nop 1
  s_cbranch_vccnz L_retry_42
  v_bitop3_b32 v27, v56, v68, v60 bitop3:0x80
  v_bitop3_b32 v27, v27, v72, v84 bitop3:0x80
  v_bitop3_b32 v27, v27, v76, v14 bitop3:0x2a
  v_cmp_ne_u32 vcc, 0, v27
  s_nop 1
  s_cbranch_vccz L_ok_43
  buffer_load_dwordx4 v[56:59], v1, s[4:7], s17 offen offset:1024 sc1
  buffer_load_dwordx4 v[68:71], v1, s[4:7], s25 offen offset:0 sc1
  buffer_load_dwordx4 v[60:63], v1, s[4:7], s17 offen offset:2048 sc1
  buffer_load_dwordx4 v[72:75], v1, s[4:7], s18 offen offset:0 sc1
  buffer_load_dwordx4 v[84:87], v1, s[4:7], s18 offen offset:3072 sc1
  buffer_load_dwordx4 v[76:79], v1, s[4:7], s18 offen offset:1024 sc1
L_ok_43:
  v_mfma_f32_16x16x32_bf16 v[144:147], a[236:239], v[40:43], v[144:147]
  ds_write_b128 v4, v[128:131] offset:0
  buffer_load_dwordx4 v[88:91], v1, s[4:7], s26 offen offset:0 sc1
  v_mfma_f32_16x16x32_bf16 v[148:151], a[148:151], v[52:55], 0
  v_mfma_f32_16x16x32_bf16 v[152:155], a[168:171], v[52:55], 0
  v_mfma_f32_16x16x32_bf16 v[156:159], a[188:191], v[52:55], 0
  ds_write_b128 v4, v[132:135] offset:1024
  v_mfma_f32_16x16x32_bf16 v[160:163], a[208:211], v[52:55], 0
  buffer_load_dwordx4 v[80:83], v1, s[4:7], s18 offen offset:2048 sc1
  v_mfma_f32_16x16x32_bf16 v[164:167], a[228:231], v[52:55], 0
  v_mfma_f32_16x16x32_bf16 v[148:151], a[160:163], v[64:67], v[148:151]
  ds_write_b128 v4, v[136:139] offset:2048
  v_mfma_f32_16x16x32_bf16 v[152:155], a[180:183], v[64:67], v[152:155]
  s_waitcnt vmcnt(5)
  v_bitop3_b32 v27, v56, v68, v60 bitop3:0x80
  v_mfma_f32_16x16x32_bf16 v[156:159], a[200:203], v[64:67], v[156:159]
  buffer_load_dwordx2 v[112:113], v15, s[4:7], s55 offen offset:0 sc1
  v_mfma_f32_16x16x32_bf16 v[160:163], a[220:223], v[64:67], v[160:163]
  v_bitop3_b32 v27, v27, v27, v14 bitop3:0x2a
  v_mfma_f32_16x16x32_bf16 v[164:167], a[240:243], v[64:67], v[164:167]
  v_cmp_ne_u32 vcc, 0, v27
  ds_write_b128 v4, v[140:143] offset:3072
  s_cbranch_vccz L_ok_45
L_retry_44:
  s_sub_u32 s69, s69, 1
  s_cbranch_scc1 L_retry_44_to
  buffer_load_dwordx4 v[56:59], v1, s[4:7], s17 offen offset:1024 sc1
  buffer_load_dwordx4 v[68:71], v1, s[4:7], s25 offen offset:0 sc1
  buffer_load_dwordx4 v[60:63], v1, s[4:7], s17 offen offset:2048 sc1
  s_waitcnt vmcnt(0)
  v_bitop3_b32 v27, v56, v68, v60 bitop3:0x80
  v_bitop3_b32 v27, v27, v27, v14 bitop3:0x2a
  v_cmp_ne_u32 vcc, 0, v27
  s_nop 1
  s_cbranch_vccnz L_retry_44
  v_bitop3_b32 v27, v72, v84, v76 bitop3:0x80
  v_bitop3_b32 v27, v27, v88, v80 bitop3:0x80
  v_bitop3_b32 v27, v27, v112, v14 bitop3:0x2a
  v_cmp_ne_u32 vcc, 0, v27
  s_nop 1
  s_cbranch_vccz L_ok_45
  buffer_load_dwordx4 v[72:75], v1, s[4:7], s18 offen offset:0 sc1
  buffer_load_dwordx4 v[84:87], v1, s[4:7], s18 offen offset:3072 sc1
  buffer_load_dwordx4 v[76:79], v1, s[4:7], s18 offen offset:1024 sc1
  buffer_load_dwordx4 v[88:91], v1, s[4:7], s26 offen offset:0 sc1
  buffer_load_dwordx4 v[80:83], v1, s[4:7], s18 offen offset:2048 sc1
  buffer_load_dwordx2 v[112:113], v15, s[4:7], s55 offen offset:0 sc1
L_ok_45:
  v_mfma_f32_16x16x32_bf16 v[148:151], a[152:155], v[56:59], v[148:151]
  buffer_load_dwordx2 v[114:115], v15, s[4:7], s55 offen offset:512 sc1
  v_mfma_f32_16x16x32_bf16 v[148:151], a[164:167], v[68:71], v[148:151]
  ds_write_b128 v4, v[144:147] offset:4096
  v_mfma_f32_16x16x32_bf16 v[148:151], a[156:159], v[60:63], v[148:151]
  v_mfma_f32_16x16x32_bf16 v[152:155], a[172:175], v[56:59], v[152:155]
  v_mfma_f32_16x16x32_bf16 v[152:155], a[184:187], v[68:71], v[152:155]
  buffer_load_dwordx4 v[92:95], v1, s[4:7], s19 offen offset:0 sc1
  v_mfma_f32_16x16x32_bf16 v[152:155], a[176:179], v[60:63], v[152:155]
  v_mfma_f32_16x16x32_bf16 v[156:159], a[192:195], v[56:59], v[156:159]
  s_waitcnt vmcnt(5)
  v_bitop3_b32 v27, v72, v84, v76 bitop3:0x80
  v_mfma_f32_16x16x32_bf16 v[156:159], a[204:207], v[68:71], v[156:159]
  v_mfma_f32_16x16x32_bf16 v[156:159], a[196:199], v[60:63], v[156:159]
  ds_write_b128 v5, v[148:151] offset:0
  buffer_load_dwordx4 v[104:107], v1, s[4:7], s19 offen offset:3072 sc1
  v_mfma_f32_16x16x32_bf16 v[160:163], a[212:215], v[56:59], v[160:163]
  v_mfma_f32_16x16x32_bf16 v[160:163], a[224:227], v[68:71], v[160:163]
  v_mfma_f32_16x16x32_bf16 v[160:163], a[216:219], v[60:63], v[160:163]
  ds_write_b128 v5, v[152:155] offset:1024
  v_mfma_f32_16x16x32_bf16 v[164:167], a[232:235], v[56:59], v[164:167]
  buffer_load_dwordx4 v[96:99], v1, s[4:7], s19 offen offset:1024 sc1
  v_mfma_f32_16x16x32_bf16 v[164:167], a[244:247], v[68:71], v[164:167]
  v_mfma_f32_16x16x32_bf16 v[164:167], a[236:239], v[60:63], v[164:167]
  ds_write_b128 v5, v[156:159] offset:2048
  s_waitcnt vmcnt(5)
  v_bitop3_b32 v27, v27, v88, v80 bitop3:0x80
  v_bitop3_b32 v27, v27, v27, v14 bitop3:0x2a
  v_cmp_ne_u32 vcc, 0, v27
  s_nop 0
  s_cbranch_vccnz L_retry_46
L_ok_47:
  v_mfma_f32_16x16x32_bf16 v[168:171], a[148:151], v[72:75], 0
  buffer_load_dwordx4 v[108:111], v1, s[4:7], s27 offen offset:0 sc1
  v_mfma_f32_16x16x32_bf16 v[168:171], a[160:163], v[84:87], v[168:171]
  ds_write_b128 v5, v[160:163] offset:3072
  v_mfma_f32_16x16x32_bf16 v[168:171], a[152:155], v[76:79], v[168:171]
  v_mfma_f32_16x16x32_bf16 v[168:171], a[164:167], v[88:91], v[168:171]
  v_mfma_f32_16x16x32_bf16 v[168:171], a[156:159], v[80:83], v[168:171]
  buffer_load_dwordx4 v[100:103], v1, s[4:7], s19 offen offset:2048 sc1
  v_mfma_f32_16x16x32_bf16 v[172:175], a[168:171], v[72:75], 0
  ds_write_b128 v5, v[164:167] offset:4096
  v_mfma_f32_16x16x32_bf16 v[172:175], a[180:183], v[84:87], v[172:175]
  v_mfma_f32_16x16x32_bf16 v[172:175], a[172:175], v[76:79], v[172:175]
  v_mfma_f32_16x16x32_bf16 v[172:175], a[184:187], v[88:91], v[172:175]
  s_mov_b32 s81, 32768
  buffer_load_dword a254, v2, s[96:99], s81 offen
  v_mfma_f32_16x16x32_bf16 v[172:175], a[176:179], v[80:83], v[172:175]
  v_mfma_f32_16x16x32_bf16 v[176:179], a[188:191], v[72:75], 0
  v_mfma_f32_16x16x32_bf16 v[176:179], a[200:203], v[84:87], v[176:179]
  v_mfma_f32_16x16x32_bf16 v[176:179], a[192:195], v[76:79], v[176:179]
  v_mfma_f32_16x16x32_bf16 v[176:179], a[204:207], v[88:91], v[176:179]
  buffer_load_dwordx4 a[80:83], v3, s[4:7], s70 offen offset:2048
  v_mfma_f32_16x16x32_bf16 v[176:179], a[196:199], v[80:83], v[176:179]
  v_mfma_f32_16x16x32_bf16 v[180:183], a[208:211], v[72:75], 0
  s_waitcnt lgkmcnt(0)
  s_barrier
  v_mfma_f32_16x16x32_bf16 v[180:183], a[220:223], v[84:87], v[180:183]
  buffer_load_dwordx4 a[84:87], v3, s[4:7], s70 offen offset:3072
  v_mfma_f32_16x16x32_bf16 v[180:183], a[212:215], v[76:79], v[180:183]
  ds_write_b128 v6, v[168:171] offset:0
  v_mfma_f32_16x16x32_bf16 v[180:183], a[224:227], v[88:91], v[180:183]
  ds_read_b128 v[132:135], v7 offset:1024
  v_mfma_f32_16x16x32_bf16 v[180:183], a[216:219], v[80:83], v[180:183]
  ds_read_b128 v[152:155], v7 offset:6144
  v_mfma_f32_16x16x32_bf16 v[184:187], a[228:231], v[72:75], 0
  s_mov_b32 s70, 151552
  buffer_load_dwordx4 a[88:91], v3, s[4:7], s70 offen offset:0
  v_mfma_f32_16x16x32_bf16 v[184:187], a[240:243], v[84:87], v[184:187]
  ds_write_b128 v6, v[172:175] offset:1024
  v_mfma_f32_16x16x32_bf16 v[184:187], a[232:235], v[76:79], v[184:187]
  ds_read_b128 v[136:139], v7 offset:2048
  v_mfma_f32_16x16x32_bf16 v[184:187], a[244:247], v[88:91], v[184:187]
  ds_read_b128 v[156:159], v7 offset:7168
  v_mfma_f32_16x16x32_bf16 v[184:187], a[236:239], v[80:83], v[184:187]
  buffer_load_dwordx4 a[92:95], v3, s[4:7], s70 offen offset:1024
  ds_write_b128 v6, v[176:179] offset:2048
  ds_read_b128 v[140:143], v7 offset:3072
  ds_read_b128 v[160:163], v7 offset:8192
  ds_write_b128 v6, v[180:183] offset:3072
  buffer_load_dwordx4 a[96:99], v3, s[4:7], s70 offen offset:2048
  ds_read_b128 v[144:147], v7 offset:4096
  s_waitcnt lgkmcnt(8)
  v_add_f32 v132, v132, v152
  v_add_f32 v133, v133, v153
  v_add_f32 v134, v134, v154
  ds_read_b128 v[164:167], v7 offset:9216
  v_add_f32 v135, v135, v155
  ds_write_b128 v6, v[184:187] offset:4096
  ds_read_b128 v[128:131], v7 offset:0
  s_waitcnt vmcnt(11)
  v_bitop3_b32 v27, v112, v114, v14 bitop3:0x2a
  v_cmp_ne_u32 vcc, 0, v27
  s_waitcnt lgkmcnt(8)
  v_add_f32 v136, v136, v156
  buffer_load_dwordx4 a[100:103], v3, s[4:7], s70 offen offset:3072
  ds_read_b128 v[148:151], v7 offset:5120
  s_cbranch_vccz L_ok_49
L_retry_48:
  s_sub_u32 s69, s69, 1
  s_cbranch_scc1 L_retry_48_to
  buffer_load_dwordx2 v[112:113], v15, s[4:7], s55 offen offset:0 sc1
  buffer_load_dwordx2 v[114:115], v15, s[4:7], s55 offen offset:512 sc1
  s_waitcnt vmcnt(0)
  v_bitop3_b32 v27, v112, v114, v14 bitop3:0x2a
  v_cmp_ne_u32 vcc, 0, v27
  s_nop 1
  s_cbranch_vccnz L_retry_48
  v_bitop3_b32 v27, v92, v104, v96 bitop3:0x80
  v_bitop3_b32 v27, v27, v108, v100 bitop3:0x80
  v_bitop3_b32 v27, v27, v27, v14 bitop3:0x2a
  v_cmp_ne_u32 vcc, 0, v27
  s_nop 1
  s_cbranch_vccz L_ok_49
  buffer_load_dwordx4 v[92:95], v1, s[4:7], s19 offen offset:0 sc1
  buffer_load_dwordx4 v[104:107], v1, s[4:7], s19 offen offset:3072 sc1
  buffer_load_dwordx4 v[96:99], v1, s[4:7], s19 offen offset:1024 sc1
  buffer_load_dwordx4 v[108:111], v1, s[4:7], s27 offen offset:0 sc1
  buffer_load_dwordx4 v[100:103], v1, s[4:7], s19 offen offset:2048 sc1
  buffer_load_dword a253, v26, s[4:7], s76 offen
  buffer_load_dword a253, v26, s[4:7], s76 offen
  buffer_load_dword a253, v26, s[4:7], s76 offen
  buffer_load_dword a253, v26, s[4:7], s76 offen
  buffer_load_dword a253, v26, s[4:7], s76 offen
  buffer_load_dword a253, v26, s[4:7], s76 offen
  buffer_load_dword a253, v26, s[4:7], s76 offen
L_ok_49:
  v_add_f32 v112, v112, v114
  v_mov_b32 v114, v112
  v_add_f32 v113, v113, v115
  v_mov_b32 v115, v113
  v_permlane16_swap_b32 v112, v114
  v_add_f32 v112, v112, v114
  v_mov_b32 v114, v112
  v_permlane16_swap_b32 v113, v115
  v_add_f32 v113, v113, v115
  v_permlane32_swap_b32 v112, v114
  s_mov_b32 s70, 155648
  buffer_load_dwordx4 a[104:107], v3, s[4:7], s70 offen offset:0
  v_add_f32 v112, v112, v114
  v_mul_f32 v28, 0xbacccccd, v112
  v_mul_f32 v188, v28, v188
  v_mul_f32 v189, v28, v189
  v_mul_f32 v190, v28, v190
  v_mul_f32 v191, v28, v191
  v_fmac_f32 v132, v28, v192
  v_fmac_f32 v133, v28, v193
  v_fmac_f32 v134, v28, v194
  v_fmac_f32 v135, v28, v195
  v_mov_b32 v115, v113
  v_add_f32 v137, v137, v157
  v_add_f32 v138, v138, v158
  v_permlane32_swap_b32 v113, v115
  buffer_load_dwordx4 a[108:111], v3, s[4:7], s70 offen offset:1024
  v_add_f32 v113, v113, v115
  v_add_f32 v139, v139, v159
  v_mul_f32 v113, 0x3acccccd, v113
  v_fmac_f32 v136, v28, v196
  v_fmac_f32 v137, v28, v197
  v_fmac_f32 v138, v28, v198
  v_fmac_f32 v139, v28, v199
  v_fma_f32 v29, -v28, v28, v113
  v_max_f32 v29, 0, v29
  v_add_f32 v31, 0x3727c5ac, v29
  v_rsq_f32 v30, v31
  s_waitcnt vmcnt(11)
  v_bitop3_b32 v27, v92, v104, v96 bitop3:0x80
  v_mul_f32 v120, v30, v30
  v_fma_f32 v120, v120, v29, v121
  buffer_load_dwordx4 a[112:115], v3, s[4:7], s70 offen offset:2048
  v_rsq_f32 v120, v120
  s_waitcnt lgkmcnt(0)
  v_add_f32 v128, v128, v148
  v_mul_f32 v120, v120, v30
  v_add_f32 v129, v129, v149
  v_add_f32 v130, v130, v150
  v_add_f32 v131, v131, v151
  v_mul_f32 v250, v120, v120
  v_mul_f32 v250, v250, v120
  v_mul_f32 v248, s79, v120
  v_mul_f32 v250, s80, v250
  v_add_f32 v140, v140, v160
  v_add_f32 v141, v141, v161
  v_add_f32 v142, v142, v162
  v_add_f32 v143, v143, v163
  v_fmac_f32 v140, v28, v200
  buffer_load_dwordx4 a[116:119], v3, s[4:7], s70 offen offset:3072
  v_fmac_f32 v141, v28, v201
  v_fmac_f32 v142, v28, v202
  v_fmac_f32 v143, v28, v203
  v_rcp_f32 v252, v120
  v_add_f32 v144, v144, v164
  v_add_f32 v145, v145, v165
  v_add_f32 v146, v146, v166
  v_add_f32 v147, v147, v167
  v_fmac_f32 v144, v28, v204
  v_fmac_f32 v145, v28, v205
  s_waitcnt vmcnt(11)
  v_bitop3_b32 v27, v27, v108, v100 bitop3:0x80
  v_bitop3_b32 v27, v27, v27, v14 bitop3:0x2a
  v_cmp_ne_u32 vcc, 0, v27
  v_fmac_f32 v146, v28, v206
  s_mov_b32 s70, 159744
  buffer_load_dwordx4 a[120:123], v3, s[4:7], s70 offen offset:0
  s_cbranch_vccnz L_retry_50
L_ok_51:
  v_pk_add_f32 v[228:229], v[208:209], v[28:29] op_sel_hi:[1,0]
  v_pk_add_f32 v[230:231], v[210:211], v[28:29] op_sel_hi:[1,0]
  v_pk_add_f32 v[232:233], v[212:213], v[28:29] op_sel_hi:[1,0]
  v_pk_add_f32 v[234:235], v[214:215], v[28:29] op_sel_hi:[1,0]
  v_pk_add_f32 v[236:237], v[216:217], v[28:29] op_sel_hi:[1,0]
  v_pk_add_f32 v[238:239], v[218:219], v[28:29] op_sel_hi:[1,0]
  v_pk_add_f32 v[240:241], v[220:221], v[28:29] op_sel_hi:[1,0]
  v_pk_add_f32 v[242:243], v[222:223], v[28:29] op_sel_hi:[1,0]
  v_pk_add_f32 v[244:245], v[224:225], v[28:29] op_sel_hi:[1,0]
  v_pk_add_f32 v[246:247], v[226:227], v[28:29] op_sel_hi:[1,0]
  v_pk_mul_f32 v[228:229], v[228:229], v[30:31] op_sel_hi:[1,0]
  v_pk_mul_f32 v[230:231], v[230:231], v[30:31] op_sel_hi:[1,0]
  v_pk_mul_f32 v[232:233], v[232:233], v[30:31] op_sel_hi:[1,0]
  v_pk_mul_f32 v[234:235], v[234:235], v[30:31] op_sel_hi:[1,0]
  v_pk_mul_f32 v[236:237], v[236:237], v[30:31] op_sel_hi:[1,0]
  v_pk_mul_f32 v[238:239], v[238:239], v[30:31] op_sel_hi:[1,0]
  v_pk_mul_f32 v[240:241], v[240:241], v[30:31] op_sel_hi:[1,0]
  v_pk_mul_f32 v[242:243], v[242:243], v[30:31] op_sel_hi:[1,0]
  v_pk_mul_f32 v[244:245], v[244:245], v[30:31] op_sel_hi:[1,0]
  v_pk_mul_f32 v[246:247], v[246:247], v[30:31] op_sel_hi:[1,0]
  buffer_load_dwordx4 a[124:127], v3, s[4:7], s70 offen offset:1024
  v_mfma_f32_16x16x32_bf16 v[188:191], a[148:151], v[92:95], v[188:191]
  s_barrier
  v_mfma_f32_16x16x32_bf16 v[188:191], a[160:163], v[104:107], v[188:191]
  ds_read_b128 v[172:175], v7 offset:11264
  v_fmac_f32 v147, v28, v207
  v_mfma_f32_16x16x32_bf16 v[188:191], a[152:155], v[96:99], v[188:191]
  buffer_load_dwordx4 a[128:131], v3, s[4:7], s70 offen offset:2048
  v_mfma_f32_16x16x32_bf16 v[188:191], a[164:167], v[108:111], v[188:191]
  ds_read_b128 v[168:171], v7 offset:10240
  v_mfma_f32_16x16x32_bf16 v[188:191], a[156:159], v[100:103], v[188:191]
  ds_read_b128 v[176:179], v7 offset:12288
  v_mfma_f32_16x16x32_bf16 v[192:195], a[168:171], v[92:95], v[132:135]
  ds_read_b128 v[180:183], v7 offset:13312
  v_mfma_f32_16x16x32_bf16 v[192:195], a[180:183], v[104:107], v[192:195]
  ds_read_b128 v[184:187], v7 offset:14336
  buffer_load_dwordx4 a[132:135], v3, s[4:7], s70 offen offset:3072
  v_mfma_f32_16x16x32_bf16 v[192:195], a[172:175], v[96:99], v[192:195]
  s_nop 0
  v_add_f32 v188, v188, v128
  v_mfma_f32_16x16x32_bf16 v[192:195], a[184:187], v[108:111], v[192:195]
  v_add_f32 v189, v189, v129
  v_add_f32 v190, v190, v130
  v_mfma_f32_16x16x32_bf16 v[192:195], a[176:179], v[100:103], v[192:195]
  v_add_f32 v191, v191, v131
  v_mfma_f32_16x16x32_bf16 v[196:199], a[188:191], v[92:95], v[136:139]
  v_mfma_f32_16x16x32_bf16 v[196:199], a[200:203], v[104:107], v[196:199]
  s_mov_b32 s70, 163840
  buffer_load_dwordx4 a[136:139], v3, s[4:7], s70 offen offset:0
  v_mfma_f32_16x16x32_bf16 v[196:199], a[192:195], v[96:99], v[196:199]
  s_waitcnt lgkmcnt(3)
  v_add_f32 v188, v188, v168
  v_pk_add_f32 v[192:193], v[192:193], v[172:173]
  v_pk_add_f32 v[194:195], v[194:195], v[174:175]
  v_add_f32 v189, v189, v169
  v_add_f32 v190, v190, v170
  v_add_f32 v191, v191, v171
  v_pk_mul_f32 v[128:129], v[188:189], v[188:189]
  v_pk_fma_f32 v[128:129], v[128:129], v[250:251], v[248:249] op_sel_hi:[1,0,0]
  v_pk_mul_f32 v[128:129], v[128:129], v[188:189]
  v_pk_mul_f32 v[130:131], v[190:191], v[190:191]
  v_pk_fma_f32 v[130:131], v[130:131], v[250:251], v[248:249] op_sel_hi:[1,0,0]
  v_pk_mul_f32 v[130:131], v[130:131], v[190:191]
  v_pk_mul_f32 v[132:133], v[192:193], v[192:193]
  v_pk_fma_f32 v[132:133], v[132:133], v[250:251], v[248:249] op_sel_hi:[1,0,0]
  v_pk_mul_f32 v[132:133], v[132:133], v[192:193]
  v_pk_mul_f32 v[134:135], v[194:195], v[194:195]
  v_pk_fma_f32 v[134:135], v[134:135], v[250:251], v[248:249] op_sel_hi:[1,0,0]
  v_pk_mul_f32 v[134:135], v[134:135], v[194:195]
  buffer_load_dwordx4 a[140:143], v3, s[4:7], s70 offen offset:1024
  v_mfma_f32_16x16x32_bf16 v[196:199], a[204:207], v[108:111], v[196:199]
  v_exp_f32 v128, v128
  v_mfma_f32_16x16x32_bf16 v[196:199], a[196:199], v[100:103], v[196:199]
  v_exp_f32 v129, v129
  v_mfma_f32_16x16x32_bf16 v[200:203], a[208:211], v[92:95], v[140:143]
  v_exp_f32 v130, v130
  v_mfma_f32_16x16x32_bf16 v[200:203], a[220:223], v[104:107], v[200:203]
  v_exp_f32 v131, v131
  v_exp_f32 v132, v132
  v_exp_f32 v133, v133
  buffer_load_dwordx4 a[144:147], v3, s[4:7], s70 offen offset:2048
  v_exp_f32 v134, v134
  v_exp_f32 v135, v135
  v_pk_fma_f32 v[128:129], v[128:129], v[252:253], v[252:253] op_sel_hi:[1,0,0]
  v_pk_fma_f32 v[130:131], v[130:131], v[252:253], v[252:253] op_sel_hi:[1,0,0]
  v_pk_fma_f32 v[132:133], v[132:133], v[252:253], v[252:253] op_sel_hi:[1,0,0]
  v_pk_fma_f32 v[134:135], v[134:135], v[252:253], v[252:253] op_sel_hi:[1,0,0]
  v_mfma_f32_16x16x32_bf16 v[200:203], a[212:215], v[96:99], v[200:203]
  v_rcp_f32 v128, v128
  v_mfma_f32_16x16x32_bf16 v[200:203], a[224:227], v[108:111], v[200:203]
  buffer_load_dwordx4 a[148:151], v3, s[4:7], s70 offen offset:3072
  v_rcp_f32 v129, v129
  v_rcp_f32 v130, v130
  v_rcp_f32 v131, v131
  v_rcp_f32 v132, v132
  v_rcp_f32 v133, v133
  v_rcp_f32 v134, v134
  v_rcp_f32 v135, v135
  v_pk_mul_f32 v[188:189], v[188:189], v[128:129]
  v_pk_mul_f32 v[190:191], v[190:191], v[130:131]
  v_pk_mul_f32 v[192:193], v[192:193], v[132:133]
  v_pk_mul_f32 v[194:195], v[194:195], v[134:135]
  s_mov_b32 s70, 167936
  buffer_load_dwordx4 a[152:155], v3, s[4:7], s70 offen offset:0
  v_mfma_f32_16x16x32_bf16 v[200:203], a[216:219], v[100:103], v[200:203]
  v_cvt_pk_bf16_f32 v148, v188, v189
  v_add_u32 v188, 0x10000, v188
  v_perm_b32 v148, v148, v188, s67
  v_cvt_pk_bf16_f32 v149, v190, v191
  v_cvt_pk_bf16_f32 v150, v192, v193
  v_cvt_pk_bf16_f32 v151, v194, v195
  v_and_b32 v148, -2, v148
  s_cmp_eq_u32 s71, 0
  s_cbranch_scc1 L_slow_52
  buffer_store_dwordx4 v[148:151], v1, s[4:7], s49 offen offset:1024
L_back_53:
  s_cmp_eq_u32 s73, 1
  s_cbranch_scc1 L_nohalo_54
  buffer_store_dwordx4 v[148:151], v24, s[4:7], s51 offen offset:1024 sc1
  s_nop 1
L_nohalo_54:
  s_waitcnt lgkmcnt(2)
  v_pk_add_f32 v[196:197], v[196:197], v[176:177]
  v_pk_add_f32 v[198:199], v[198:199], v[178:179]
  s_waitcnt lgkmcnt(1)
  v_pk_add_f32 v[200:201], v[200:201], v[180:181]
  v_pk_add_f32 v[202:203], v[202:203], v[182:183]
  v_pk_mul_f32 v[136:137], v[196:197], v[196:197]
  v_pk_fma_f32 v[136:137], v[136:137], v[250:251], v[248:249] op_sel_hi:[1,0,0]
  v_pk_mul_f32 v[136:137], v[136:137], v[196:197]
  v_pk_mul_f32 v[138:139], v[198:199], v[198:199]
  v_pk_fma_f32 v[138:139], v[138:139], v[250:251], v[248:249] op_sel_hi:[1,0,0]
  v_pk_mul_f32 v[138:139], v[138:139], v[198:199]
  v_pk_mul_f32 v[140:141], v[200:201], v[200:201]
  v_pk_fma_f32 v[140:141], v[140:141], v[250:251], v[248:249] op_sel_hi:[1,0,0]
  v_pk_mul_f32 v[140:141], v[140:141], v[200:201]
  v_pk_mul_f32 v[142:143], v[202:203], v[202:203]
  v_pk_fma_f32 v[142:143], v[142:143], v[250:251], v[248:249] op_sel_hi:[1,0,0]
  v_pk_mul_f32 v[142:143], v[142:143], v[202:203]
  v_exp_f32 v136, v136
  v_exp_f32 v137, v137
  v_exp_f32 v138, v138
  v_exp_f32 v139, v139
  v_exp_f32 v140, v140
  v_exp_f32 v141, v141
  v_exp_f32 v142, v142
  v_exp_f32 v143, v143
  v_pk_fma_f32 v[136:137], v[136:137], v[252:253], v[252:253] op_sel_hi:[1,0,0]
  v_pk_fma_f32 v[138:139], v[138:139], v[252:253], v[252:253] op_sel_hi:[1,0,0]
  v_pk_fma_f32 v[140:141], v[140:141], v[252:253], v[252:253] op_sel_hi:[1,0,0]
  v_pk_fma_f32 v[142:143], v[142:143], v[252:253], v[252:253] op_sel_hi:[1,0,0]
  v_rcp_f32 v136, v136
  v_rcp_f32 v137, v137
  v_rcp_f32 v138, v138
  v_rcp_f32 v139, v139
  v_rcp_f32 v140, v140
  v_rcp_f32 v141, v141
  v_rcp_f32 v142, v142
  v_rcp_f32 v143, v143
  v_pk_mul_f32 v[196:197], v[196:197], v[136:137]
  v_pk_mul_f32 v[198:199], v[198:199], v[138:139]
  v_pk_mul_f32 v[200:201], v[200:201], v[140:141]
  v_pk_mul_f32 v[202:203], v[202:203], v[142:143]
  v_mfma_f32_16x16x32_bf16 v[204:207], a[228:231], v[92:95], v[144:147]
  v_cvt_pk_bf16_f32 v152, v196, v197
  v_mfma_f32_16x16x32_bf16 v[204:207], a[240:243], v[104:107], v[204:207]
  v_add_u32 v196, 0x10000, v196
  v_perm_b32 v152, v152, v196, s67
  v_mfma_f32_16x16x32_bf16 v[204:207], a[232:235], v[96:99], v[204:207]
  v_cvt_pk_bf16_f32 v153, v198, v199
  v_cvt_pk_bf16_f32 v154, v200, v201
  v_cvt_pk_bf16_f32 v155, v202, v203
  v_and_b32 v152, -2, v152
  s_cmp_eq_u32 s71, 0
  s_cbranch_scc1 L_slow_55
  buffer_store_dwordx4 v[152:155], v1, s[4:7], s49 offen offset:2048
L_back_56:
  s_cmp_eq_u32 s73, 1
  s_cbranch_scc1 L_nohalo_57
  buffer_store_dwordx4 v[152:155], v24, s[4:7], s51 offen offset:2048 sc1
  s_nop 1
L_nohalo_57:
  v_mfma_f32_16x16x32_bf16 v[204:207], a[244:247], v[108:111], v[204:207]
  v_mfma_f32_16x16x32_bf16 v[204:207], a[236:239], v[100:103], v[204:207]
  buffer_load_dwordx4 v[32:35], v16, s[4:7], s34 offen offset:0 sc1
  s_waitcnt lgkmcnt(0)
  s_nop 5
  v_pk_add_f32 v[204:205], v[204:205], v[184:185]
  v_pk_add_f32 v[206:207], v[206:207], v[186:187]
  v_pk_mul_f32 v[144:145], v[204:205], v[204:205]
  v_pk_fma_f32 v[144:145], v[144:145], v[250:251], v[248:249] op_sel_hi:[1,0,0]
  v_pk_mul_f32 v[144:145], v[144:145], v[204:205]
  v_pk_mul_f32 v[146:147], v[206:207], v[206:207]
  v_pk_fma_f32 v[146:147], v[146:147], v[250:251], v[248:249] op_sel_hi:[1,0,0]
  v_pk_mul_f32 v[146:147], v[146:147], v[206:207]
  buffer_load_dwordx4 v[44:47], v16, s[4:7], s34 offen offset:3072 sc1
  v_exp_f32 v144, v144
  v_exp_f32 v145, v145
  v_exp_f32 v146, v146
  v_exp_f32 v147, v147
  v_pk_fma_f32 v[144:145], v[144:145], v[252:253], v[252:253] op_sel_hi:[1,0,0]
  v_pk_fma_f32 v[146:147], v[146:147], v[252:253], v[252:253] op_sel_hi:[1,0,0]
  v_rcp_f32 v144, v144
  v_rcp_f32 v145, v145
  v_rcp_f32 v146, v146
  v_rcp_f32 v147, v147
  v_pk_mul_f32 v[204:205], v[204:205], v[144:145]
  v_pk_mul_f32 v[206:207], v[206:207], v[146:147]
  v_cvt_pk_bf16_f32 v156, v204, v205
  v_cvt_pk_bf16_f32 v157, v206, v207
  s_nop 0
  v_permlane32_swap_b32 v156, v158
  v_and_b32 v156, -2, v156
  v_permlane32_swap_b32 v157, v159
  s_cmp_eq_u32 s71, 0
  s_cbranch_scc1 L_slow_58
  buffer_store_dwordx4 v[156:159], v254, s[4:7], s49 offen
L_back_59:
  s_cmp_eq_u32 s73, 1
  s_cbranch_scc1 L_nohalo_60
  buffer_store_dwordx4 v[156:159], v23, s[4:7], s51 offen sc1
  s_nop 1
L_nohalo_60:
  buffer_load_dwordx4 v[36:39], v16, s[4:7], s34 offen offset:1024 sc1
  buffer_load_dwordx4 v[48:51], v16, s[4:7], s35 offen offset:0 sc1
  s_waitcnt vmcnt(3)
  v_bitop3_b32 v27, v32, v44, 1 bitop3:0xa8
  v_cmp_ne_u32 vcc, 0, v27
  s_nop 0
  s_cbranch_vccz L_ok_62
L_retry_61:
  s_sub_u32 s69, s69, 1
  s_cbranch_scc1 L_retry_61_to
  buffer_load_dwordx4 v[32:35], v16, s[4:7], s34 offen offset:0 sc1
  buffer_load_dwordx4 v[44:47], v16, s[4:7], s34 offen offset:3072 sc1
  s_waitcnt vmcnt(0)
  v_bitop3_b32 v27, v32, v44, 1 bitop3:0xa8
  v_cmp_ne_u32 vcc, 0, v27
  s_nop 1
  s_cbranch_vccnz L_retry_61
  v_bitop3_b32 v27, v36, v48, 1 bitop3:0xa8
  v_cmp_ne_u32 vcc, 0, v27
  s_nop 1
  s_cbranch_vccz L_ok_62
  buffer_load_dwordx4 v[36:39], v16, s[4:7], s34 offen offset:1024 sc1
  buffer_load_dwordx4 v[48:51], v16, s[4:7], s35 offen offset:0 sc1
L_ok_62:
  v_mfma_f32_16x16x32_bf16 v[128:131], a[248:251], v[32:35], 0
  v_mfma_f32_16x16x32_bf16 v[132:135], a[16:19], v[32:35], 0
  v_mfma_f32_16x16x32_bf16 v[136:139], a[36:39], v[32:35], 0
  buffer_load_dwordx4 v[40:43], v16, s[4:7], s34 offen offset:2048 sc1
  v_mfma_f32_16x16x32_bf16 v[140:143], a[56:59], v[32:35], 0
  v_mfma_f32_16x16x32_bf16 v[144:147], a[76:79], v[32:35], 0
  v_mfma_f32_16x16x32_bf16 v[128:131], a[8:11], v[44:47], v[128:131]
  v_mfma_f32_16x16x32_bf16 v[132:135], a[28:31], v[44:47], v[132:135]
  buffer_load_dwordx4 v[52:55], v17, s[4:7], s34 offen offset:0 sc1
  v_mfma_f32_16x16x32_bf16 v[136:139], a[48:51], v[44:47], v[136:139]
  v_mfma_f32_16x16x32_bf16 v[140:143], a[68:71], v[44:47], v[140:143]
  v_mfma_f32_16x16x32_bf16 v[144:147], a[88:91], v[44:47], v[144:147]
  buffer_load_dwordx4 v[64:67], v17, s[4:7], s34 offen offset:3072 sc1
  s_waitcnt vmcnt(3)
  v_bitop3_b32 v27, v36, v48, 1 bitop3:0xa8
  v_cmp_ne_u32 vcc, 0, v27
  s_nop 0
  s_cbranch_vccz L_ok_64
L_retry_63:
  s_sub_u32 s69, s69, 1
  s_cbranch_scc1 L_retry_63_to
  buffer_load_dwordx4 v[36:39], v16, s[4:7], s34 offen offset:1024 sc1
  buffer_load_dwordx4 v[48:51], v16, s[4:7], s35 offen offset:0 sc1
  s_waitcnt vmcnt(0)
  v_bitop3_b32 v27, v36, v48, 1 bitop3:0xa8
  v_cmp_ne_u32 vcc, 0, v27
  s_nop 1
  s_cbranch_vccnz L_retry_63
  v_bitop3_b32 v27, v40, v52, v64 bitop3:0xfe
  v_bitop3_b32 v27, v27, v27, 1 bitop3:0xa8
  v_cmp_ne_u32 vcc, 0, v27
  s_nop 1
  s_cbranch_vccz L_ok_64
  buffer_load_dwordx4 v[40:43], v16, s[4:7], s34 offen offset:2048 sc1
  buffer_load_dwordx4 v[52:55], v17, s[4:7], s34 offen offset:0 sc1
  buffer_load_dwordx4 v[64:67], v17, s[4:7], s34 offen offset:3072 sc1
L_ok_64:
  v_mfma_f32_16x16x32_bf16 v[128:131], a[0:3], v[36:39], v[128:131]
  buffer_load_dwordx4 v[56:59], v17, s[4:7], s34 offen offset:1024 sc1
  v_mfma_f32_16x16x32_bf16 v[132:135], a[20:23], v[36:39], v[132:135]
  v_mfma_f32_16x16x32_bf16 v[136:139], a[40:43], v[36:39], v[136:139]
  v_mfma_f32_16x16x32_bf16 v[140:143], a[60:63], v[36:39], v[140:143]
  v_mfma_f32_16x16x32_bf16 v[144:147], a[80:83], v[36:39], v[144:147]
  buffer_load_dwordx4 v[68:71], v17, s[4:7], s35 offen offset:0 sc1
  v_mfma_f32_16x16x32_bf16 v[128:131], a[12:15], v[48:51], v[128:131]
  v_mfma_f32_16x16x32_bf16 v[132:135], a[32:35], v[48:51], v[132:135]
  v_mfma_f32_16x16x32_bf16 v[136:139], a[52:55], v[48:51], v[136:139]
  v_mfma_f32_16x16x32_bf16 v[140:143], a[72:75], v[48:51], v[140:143]
  buffer_load_dwordx4 v[60:63], v17, s[4:7], s34 offen offset:2048 sc1
  v_mfma_f32_16x16x32_bf16 v[144:147], a[92:95], v[48:51], v[144:147]
  s_waitcnt vmcnt(5)
  v_bitop3_b32 v27, v40, v40, 1 bitop3:0xa8
  buffer_load_dwordx4 v[72:75], v18, s[4:7], s34 offen offset:0 sc1
  v_cmp_ne_u32 vcc, 0, v27
  s_nop 0
  s_cbranch_vccz L_ok_66
L_retry_65:
  s_sub_u32 s69, s69, 1
  s_cbranch_scc1 L_retry_65_to
  buffer_load_dwordx4 v[40:43], v16, s[4:7], s34 offen offset:2048 sc1
  s_waitcnt vmcnt(0)
  v_bitop3_b32 v27, v40, v40, 1 bitop3:0xa8
  v_cmp_ne_u32 vcc, 0, v27
  s_nop 1
  s_cbranch_vccnz L_retry_65
  v_bitop3_b32 v27, v52, v64, v56 bitop3:0xfe
  v_bitop3_b32 v27, v27, v68, v60 bitop3:0xfe
  v_bitop3_b32 v27, v27, v72, 1 bitop3:0xa8
  v_cmp_ne_u32 vcc, 0, v27
  s_nop 1
  s_cbranch_vccz L_ok_66
  buffer_load_dwordx4 v[52:55], v17, s[4:7], s34 offen offset:0 sc1
  buffer_load_dwordx4 v[64:67], v17, s[4:7], s34 offen offset:3072 sc1
  buffer_load_dwordx4 v[56:59], v17, s[4:7], s34 offen offset:1024 sc1
  buffer_load_dwordx4 v[68:71], v17, s[4:7], s35 offen offset:0 sc1
  buffer_load_dwordx4 v[60:63], v17, s[4:7], s34 offen offset:2048 sc1
  buffer_load_dwordx4 v[72:75], v18, s[4:7], s34 offen offset:0 sc1
L_ok_66:
  v_mfma_f32_16x16x32_bf16 v[128:131], a[4:7], v[40:43], v[128:131]
  v_mfma_f32_16x16x32_bf16 v[132:135], a[24:27], v[40:43], v[132:135]
  v_mfma_f32_16x16x32_bf16 v[136:139], a[44:47], v[40:43], v[136:139]
  buffer_load_dwordx4 v[84:87], v18, s[4:7], s34 offen offset:3072 sc1
  v_mfma_f32_16x16x32_bf16 v[140:143], a[64:67], v[40:43], v[140:143]
  v_mfma_f32_16x16x32_bf16 v[144:147], a[84:87], v[40:43], v[144:147]
  s_nop 2
  ds_write_b128 v4, v[128:131] offset:0
  s_waitcnt vmcnt(5)
  v_bitop3_b32 v27, v52, v64, 1 bitop3:0xa8
  buffer_load_dwordx4 v[76:79], v18, s[4:7], s34 offen offset:1024 sc1
  v_cmp_ne_u32 vcc, 0, v27
  s_nop 0
  s_cbranch_vccz L_ok_68
L_retry_67:
  s_sub_u32 s69, s69, 1
  s_cbranch_scc1 L_retry_67_to
  buffer_load_dwordx4 v[52:55], v17, s[4:7], s34 offen offset:0 sc1
  buffer_load_dwordx4 v[64:67], v17, s[4:7], s34 offen offset:3072 sc1
  s_waitcnt vmcnt(0)
  v_bitop3_b32 v27, v52, v64, 1 bitop3:0xa8
  v_cmp_ne_u32 vcc, 0, v27
  s_nop 1
  s_cbranch_vccnz L_retry_67
  v_bitop3_b32 v27, v56, v68, v60 bitop3:0xfe
  v_bitop3_b32 v27, v27, v72, v84 bitop3:0xfe
  v_bitop3_b32 v27, v27, v76, 1 bitop3:0xa8
  v_cmp_ne_u32 vcc, 0, v27
  s_nop 1
  s_cbranch_vccz L_ok_68
  buffer_load_dwordx4 v[56:59], v17, s[4:7], s34 offen offset:1024 sc1
  buffer_load_dwordx4 v[68:71], v17, s[4:7], s35 offen offset:0 sc1
  buffer_load_dwordx4 v[60:63], v17, s[4:7], s34 offen offset:2048 sc1
  buffer_load_dwordx4 v[72:75], v18, s[4:7], s34 offen offset:0 sc1
  buffer_load_dwordx4 v[84:87], v18, s[4:7], s34 offen offset:3072 sc1
  buffer_load_dwordx4 v[76:79], v18, s[4:7], s34 offen offset:1024 sc1
L_ok_68:
  v_mfma_f32_16x16x32_bf16 v[148:151], a[248:251], v[52:55], 0
  ds_write_b128 v4, v[132:135] offset:1024
  v_mfma_f32_16x16x32_bf16 v[152:155], a[16:19], v[52:55], 0
  v_mfma_f32_16x16x32_bf16 v[156:159], a[36:39], v[52:55], 0
  buffer_load_dwordx4 v[88:91], v18, s[4:7], s35 offen offset:0 sc1
  v_mfma_f32_16x16x32_bf16 v[160:163], a[56:59], v[52:55], 0
  ds_write_b128 v4, v[136:139] offset:2048
  v_mfma_f32_16x16x32_bf16 v[164:167], a[76:79], v[52:55], 0
  v_mfma_f32_16x16x32_bf16 v[148:151], a[8:11], v[64:67], v[148:151]
  v_mfma_f32_16x16x32_bf16 v[152:155], a[28:31], v[64:67], v[152:155]
  buffer_load_dwordx4 v[80:83], v18, s[4:7], s34 offen offset:2048 sc1
  v_mfma_f32_16x16x32_bf16 v[156:159], a[48:51], v[64:67], v[156:159]
  ds_write_b128 v4, v[140:143] offset:3072
  v_mfma_f32_16x16x32_bf16 v[160:163], a[68:71], v[64:67], v[160:163]
  v_mfma_f32_16x16x32_bf16 v[164:167], a[88:91], v[64:67], v[164:167]
  s_waitcnt vmcnt(5)
  v_bitop3_b32 v27, v56, v68, v60 bitop3:0xfe
  v_bitop3_b32 v27, v27, v27, 1 bitop3:0xa8
  buffer_load_dwordx4 v[92:95], v19, s[4:7], s34 offen offset:0 sc1
  v_cmp_ne_u32 vcc, 0, v27
  ds_write_b128 v4, v[144:147] offset:4096
  s_cbranch_vccz L_ok_70
L_retry_69:
  s_sub_u32 s69, s69, 1
  s_cbranch_scc1 L_retry_69_to
  buffer_load_dwordx4 v[56:59], v17, s[4:7], s34 offen offset:1024 sc1
  buffer_load_dwordx4 v[68:71], v17, s[4:7], s35 offen offset:0 sc1
  buffer_load_dwordx4 v[60:63], v17, s[4:7], s34 offen offset:2048 sc1
  s_waitcnt vmcnt(0)
  v_bitop3_b32 v27, v56, v68, v60 bitop3:0xfe
  v_bitop3_b32 v27, v27, v27, 1 bitop3:0xa8
  v_cmp_ne_u32 vcc, 0, v27
  s_nop 1
  s_cbranch_vccnz L_retry_69
  v_bitop3_b32 v27, v72, v84, v76 bitop3:0xfe
  v_bitop3_b32 v27, v27, v88, v80 bitop3:0xfe
  v_bitop3_b32 v27, v27, v92, 1 bitop3:0xa8
  v_cmp_ne_u32 vcc, 0, v27
  s_nop 1
  s_cbranch_vccz L_ok_70
  buffer_load_dwordx4 v[72:75], v18, s[4:7], s34 offen offset:0 sc1
  buffer_load_dwordx4 v[84:87], v18, s[4:7], s34 offen offset:3072 sc1
  buffer_load_dwordx4 v[76:79], v18, s[4:7], s34 offen offset:1024 sc1
  buffer_load_dwordx4 v[88:91], v18, s[4:7], s35 offen offset:0 sc1
  buffer_load_dwordx4 v[80:83], v18, s[4:7], s34 offen offset:2048 sc1
  buffer_load_dwordx4 v[92:95], v19, s[4:7], s34 offen offset:0 sc1
L_ok_70:
  v_mfma_f32_16x16x32_bf16 v[148:151], a[0:3], v[56:59], v[148:151]
  v_mfma_f32_16x16x32_bf16 v[148:151], a[12:15], v[68:71], v[148:151]
  v_mfma_f32_16x16x32_bf16 v[148:151], a[4:7], v[60:63], v[148:151]
  buffer_load_dwordx4 v[104:107], v19, s[4:7], s34 offen offset:3072 sc1
  v_mfma_f32_16x16x32_bf16 v[152:155], a[20:23], v[56:59], v[152:155]
  v_mfma_f32_16x16x32_bf16 v[152:155], a[32:35], v[68:71], v[152:155]
  v_mfma_f32_16x16x32_bf16 v[152:155], a[24:27], v[60:63], v[152:155]
  v_mfma_f32_16x16x32_bf16 v[156:159], a[40:43], v[56:59], v[156:159]
  v_mfma_f32_16x16x32_bf16 v[156:159], a[52:55], v[68:71], v[156:159]
  buffer_load_dwordx4 v[96:99], v19, s[4:7], s34 offen offset:1024 sc1
  v_mfma_f32_16x16x32_bf16 v[156:159], a[44:47], v[60:63], v[156:159]
  ds_write_b128 v5, v[148:151] offset:0
  v_mfma_f32_16x16x32_bf16 v[160:163], a[60:63], v[56:59], v[160:163]
  s_waitcnt vmcnt(5)
  v_bitop3_b32 v27, v72, v84, v76 bitop3:0xfe
  v_mfma_f32_16x16x32_bf16 v[160:163], a[72:75], v[68:71], v[160:163]
  v_mfma_f32_16x16x32_bf16 v[160:163], a[64:67], v[60:63], v[160:163]
  buffer_load_dwordx4 v[108:111], v19, s[4:7], s35 offen offset:0 sc1
  v_mfma_f32_16x16x32_bf16 v[164:167], a[80:83], v[56:59], v[164:167]
  ds_write_b128 v5, v[152:155] offset:1024
  v_mfma_f32_16x16x32_bf16 v[164:167], a[92:95], v[68:71], v[164:167]
  v_mfma_f32_16x16x32_bf16 v[164:167], a[84:87], v[60:63], v[164:167]
  ds_write_b128 v5, v[156:159] offset:2048
  buffer_load_dwordx4 v[100:103], v19, s[4:7], s34 offen offset:2048 sc1
  s_waitcnt vmcnt(5)
  v_bitop3_b32 v27, v27, v88, v80 bitop3:0xfe
  v_bitop3_b32 v27, v27, v27, 1 bitop3:0xa8
  v_cmp_ne_u32 vcc, 0, v27
  ds_write_b128 v5, v[160:163] offset:3072
  s_cbranch_vccz L_ok_72
L_retry_71:
  s_sub_u32 s69, s69, 1
  s_cbranch_scc1 L_retry_71_to
  buffer_load_dwordx4 v[72:75], v18, s[4:7], s34 offen offset:0 sc1
  buffer_load_dwordx4 v[84:87], v18, s[4:7], s34 offen offset:3072 sc1
  buffer_load_dwordx4 v[76:79], v18, s[4:7], s34 offen offset:1024 sc1
  buffer_load_dwordx4 v[88:91], v18, s[4:7], s35 offen offset:0 sc1
  buffer_load_dwordx4 v[80:83], v18, s[4:7], s34 offen offset:2048 sc1
  s_waitcnt vmcnt(0)
  v_bitop3_b32 v27, v72, v84, v76 bitop3:0xfe
  v_bitop3_b32 v27, v27, v88, v80 bitop3:0xfe
  v_bitop3_b32 v27, v27, v27, 1 bitop3:0xa8
  v_cmp_ne_u32 vcc, 0, v27
  s_nop 1
  s_cbranch_vccnz L_retry_71
  v_bitop3_b32 v27, v92, v104, v96 bitop3:0xfe
  v_bitop3_b32 v27, v27, v108, v100 bitop3:0xfe
  v_bitop3_b32 v27, v27, v27, 1 bitop3:0xa8
  v_cmp_ne_u32 vcc, 0, v27
  s_nop 1
  s_cbranch_vccz L_ok_72
  buffer_load_dwordx4 v[92:95], v19, s[4:7], s34 offen offset:0 sc1
  buffer_load_dwordx4 v[104:107], v19, s[4:7], s34 offen offset:3072 sc1
  buffer_load_dwordx4 v[96:99], v19, s[4:7], s34 offen offset:1024 sc1
  buffer_load_dwordx4 v[108:111], v19, s[4:7], s35 offen offset:0 sc1
  buffer_load_dwordx4 v[100:103], v19, s[4:7], s34 offen offset:2048 sc1
L_ok_72:
  v_mfma_f32_16x16x32_bf16 v[168:171], a[248:251], v[72:75], 0
  buffer_load_dwordx4 a[156:159], v3, s[4:7], s70 offen offset:1024
  v_mfma_f32_16x16x32_bf16 v[168:171], a[8:11], v[84:87], v[168:171]
  ds_write_b128 v5, v[164:167] offset:4096
  v_mfma_f32_16x16x32_bf16 v[168:171], a[0:3], v[76:79], v[168:171]
  v_mfma_f32_16x16x32_bf16 v[168:171], a[12:15], v[88:91], v[168:171]
  v_mfma_f32_16x16x32_bf16 v[168:171], a[4:7], v[80:83], v[168:171]
  buffer_load_dwordx4 a[160:163], v3, s[4:7], s70 offen offset:2048
  v_mfma_f32_16x16x32_bf16 v[172:175], a[16:19], v[72:75], 0
  v_mfma_f32_16x16x32_bf16 v[172:175], a[28:31], v[84:87], v[172:175]
  v_mfma_f32_16x16x32_bf16 v[172:175], a[20:23], v[76:79], v[172:175]
  v_mfma_f32_16x16x32_bf16 v[172:175], a[32:35], v[88:91], v[172:175]
  v_mfma_f32_16x16x32_bf16 v[172:175], a[24:27], v[80:83], v[172:175]
  buffer_load_dwordx4 a[164:167], v3, s[4:7], s70 offen offset:3072
  v_mfma_f32_16x16x32_bf16 v[176:179], a[36:39], v[72:75], 0
  v_mfma_f32_16x16x32_bf16 v[176:179], a[48:51], v[84:87], v[176:179]
  s_waitcnt lgkmcnt(0)
  s_barrier
  v_mfma_f32_16x16x32_bf16 v[176:179], a[40:43], v[76:79], v[176:179]
  s_mov_b32 s70, 172032
  buffer_load_dwordx4 a[168:171], v3, s[4:7], s70 offen offset:0
  v_mfma_f32_16x16x32_bf16 v[176:179], a[52:55], v[88:91], v[176:179]
  ds_read_b128 v[132:135], v7 offset:1024
  v_mfma_f32_16x16x32_bf16 v[176:179], a[44:47], v[80:83], v[176:179]
  ds_read_b128 v[152:155], v7 offset:6144
  v_mfma_f32_16x16x32_bf16 v[180:183], a[56:59], v[72:75], 0
  ds_write_b128 v6, v[168:171] offset:0
  v_mfma_f32_16x16x32_bf16 v[180:183], a[68:71], v[84:87], v[180:183]
  buffer_load_dwordx4 a[172:175], v3, s[4:7], s70 offen offset:1024
  v_mfma_f32_16x16x32_bf16 v[180:183], a[60:63], v[76:79], v[180:183]
  s_waitcnt vmcnt(7)
  v_bitop3_b32 v27, v92, v104, v96 bitop3:0xfe
  v_mfma_f32_16x16x32_bf16 v[180:183], a[72:75], v[88:91], v[180:183]
  ds_write_b128 v6, v[172:175] offset:1024
  v_mfma_f32_16x16x32_bf16 v[180:183], a[64:67], v[80:83], v[180:183]
  s_waitcnt vmcnt(5)
  v_bitop3_b32 v27, v27, v108, v100 bitop3:0xfe
  v_mfma_f32_16x16x32_bf16 v[184:187], a[76:79], v[72:75], 0
  buffer_load_dwordx4 a[176:179], v3, s[4:7], s70 offen offset:2048
  v_mfma_f32_16x16x32_bf16 v[184:187], a[88:91], v[84:87], v[184:187]
  ds_write_b128 v6, v[176:179] offset:2048
  v_mfma_f32_16x16x32_bf16 v[184:187], a[80:83], v[76:79], v[184:187]
  ds_read_b128 v[136:139], v7 offset:2048
  s_waitcnt lgkmcnt(4)
  v_add_f32 v132, v132, v152
  v_mfma_f32_16x16x32_bf16 v[184:187], a[92:95], v[88:91], v[184:187]
  ds_read_b128 v[156:159], v7 offset:7168
  v_add_f32 v133, v133, v153
  v_mfma_f32_16x16x32_bf16 v[184:187], a[84:87], v[80:83], v[184:187]
  buffer_load_dwordx4 a[180:183], v3, s[4:7], s70 offen offset:3072
  ds_write_b128 v6, v[180:183] offset:3072
  ds_read_b128 v[140:143], v7 offset:3072
  v_bitop3_b32 v27, v27, v27, 1 bitop3:0xa8
  v_cmp_ne_u32 vcc, 0, v27
  v_add_f32 v134, v134, v154
  ds_read_b128 v[160:163], v7 offset:8192
  s_cbranch_vccz L_ok_74
L_retry_73:
  s_sub_u32 s69, s69, 1
  s_cbranch_scc1 L_retry_73_to
  buffer_load_dwordx4 v[92:95], v19, s[4:7], s34 offen offset:0 sc1
  buffer_load_dwordx4 v[104:107], v19, s[4:7], s34 offen offset:3072 sc1
  buffer_load_dwordx4 v[96:99], v19, s[4:7], s34 offen offset:1024 sc1
  buffer_load_dwordx4 v[108:111], v19, s[4:7], s35 offen offset:0 sc1
  buffer_load_dwordx4 v[100:103], v19, s[4:7], s34 offen offset:2048 sc1
  s_waitcnt vmcnt(0)
  v_bitop3_b32 v27, v92, v104, v96 bitop3:0xfe
  v_bitop3_b32 v27, v27, v108, v100 bitop3:0xfe
  v_bitop3_b32 v27, v27, v27, 1 bitop3:0xa8
  v_cmp_ne_u32 vcc, 0, v27
  s_nop 1
  s_cbranch_vccnz L_retry_73
L_ok_74:
  v_mfma_f32_16x16x32_bf16 v[188:191], a[248:251], v[92:95], v[228:231]
  ds_write_b128 v6, v[184:187] offset:4096
  s_mov_b32 s70, 176128
  buffer_load_dwordx4 a[184:187], v3, s[4:7], s70 offen offset:0
  ds_read_b128 v[144:147], v7 offset:4096
  v_mfma_f32_16x16x32_bf16 v[188:191], a[8:11], v[104:107], v[188:191]
  v_add_f32 v135, v135, v155
  ds_read_b128 v[164:167], v7 offset:9216
  v_mfma_f32_16x16x32_bf16 v[188:191], a[0:3], v[96:99], v[188:191]
  v_add_f32 v132, v132, v232
  ds_read_b128 v[128:131], v7 offset:0
  v_mfma_f32_16x16x32_bf16 v[188:191], a[12:15], v[108:111], v[188:191]
  v_add_f32 v133, v133, v233
  ds_read_b128 v[148:151], v7 offset:5120
  v_mfma_f32_16x16x32_bf16 v[188:191], a[4:7], v[100:103], v[188:191]
  buffer_load_dwordx4 a[188:191], v3, s[4:7], s70 offen offset:1024
  v_add_f32 v134, v134, v234
  v_add_f32 v135, v135, v235
  s_waitcnt lgkmcnt(8)
  v_add_f32 v136, v136, v156
  v_add_f32 v137, v137, v157
  v_mfma_f32_16x16x32_bf16 v[192:195], a[16:19], v[92:95], v[132:135]
  v_add_f32 v138, v138, v158
  v_add_f32 v139, v139, v159
  v_mfma_f32_16x16x32_bf16 v[192:195], a[28:31], v[104:107], v[192:195]
  v_add_f32 v136, v136, v236
  v_add_f32 v137, v137, v237
  v_mfma_f32_16x16x32_bf16 v[192:195], a[20:23], v[96:99], v[192:195]
  v_add_f32 v138, v138, v238
  v_add_f32 v139, v139, v239
  v_mfma_f32_16x16x32_bf16 v[192:195], a[32:35], v[108:111], v[192:195]
  buffer_load_dwordx4 a[192:195], v3, s[4:7], s70 offen offset:2048
  v_mfma_f32_16x16x32_bf16 v[192:195], a[24:27], v[100:103], v[192:195]
  s_waitcnt lgkmcnt(5)
  v_add_f32 v140, v140, v160
  v_add_f32 v141, v141, v161
  v_mfma_f32_16x16x32_bf16 v[196:199], a[36:39], v[92:95], v[136:139]
  v_add_f32 v142, v142, v162
  v_add_f32 v143, v143, v163
  v_mfma_f32_16x16x32_bf16 v[196:199], a[48:51], v[104:107], v[196:199]
  v_add_f32 v140, v140, v240
  v_add_f32 v141, v141, v241
  v_mfma_f32_16x16x32_bf16 v[196:199], a[40:43], v[96:99], v[196:199]
  s_waitcnt lgkmcnt(0)
  s_barrier
  buffer_load_dwordx4 a[196:199], v3, s[4:7], s70 offen offset:3072
  ds_read_b128 v[172:175], v7 offset:11264
  v_mfma_f32_16x16x32_bf16 v[196:199], a[52:55], v[108:111], v[196:199]
  v_add_f32 v142, v142, v242
  ds_read_b128 v[168:171], v7 offset:10240
  v_mfma_f32_16x16x32_bf16 v[196:199], a[44:47], v[100:103], v[196:199]
  v_add_f32 v143, v143, v243
  ds_read_b128 v[176:179], v7 offset:12288
  v_add_f32 v128, v128, v148
  v_mfma_f32_16x16x32_bf16 v[200:203], a[56:59], v[92:95], v[140:143]
  ds_read_b128 v[180:183], v7 offset:13312
  v_add_f32 v129, v129, v149
  v_mfma_f32_16x16x32_bf16 v[200:203], a[68:71], v[104:107], v[200:203]
  s_mov_b32 s70, 180224
  buffer_load_dwordx4 a[200:203], v3, s[4:7], s70 offen offset:0
  v_mfma_f32_16x16x32_bf16 v[200:203], a[60:63], v[96:99], v[200:203]
  ds_read_b128 v[184:187], v7 offset:14336
  v_add_f32 v188, v188, v128
  v_mfma_f32_16x16x32_bf16 v[200:203], a[72:75], v[108:111], v[200:203]
  v_add_f32 v189, v189, v129
  v_add_f32 v130, v130, v150
  v_add_f32 v131, v131, v151
  v_add_f32 v190, v190, v130
  v_add_f32 v191, v191, v131
  v_mfma_f32_16x16x32_bf16 v[200:203], a[64:67], v[100:103], v[200:203]
  v_add_f32 v144, v144, v164
  v_add_f32 v145, v145, v165
  buffer_load_dwordx4 a[204:207], v3, s[4:7], s70 offen offset:1024
  v_add_f32 v146, v146, v166
  v_add_f32 v147, v147, v167
  s_waitcnt lgkmcnt(4)
  v_pk_add_f32 v[192:193], v[192:193], v[172:173]
  v_pk_add_f32 v[194:195], v[194:195], v[174:175]
  v_cvt_pk_bf16_f32 v150, v192, v193
  v_cvt_pk_bf16_f32 v151, v194, v195
  s_waitcnt lgkmcnt(3)
  v_add_f32 v188, v188, v168
  v_add_f32 v189, v189, v169
  v_cvt_pk_bf16_f32 v148, v188, v189
  v_add_f32 v190, v190, v170
  v_add_f32 v191, v191, v171
  v_bitop3_b32 v148, v148, v14, v14 bitop3:0x30
  buffer_load_dwordx4 a[208:211], v3, s[4:7], s70 offen offset:2048
  v_cvt_pk_bf16_f32 v149, v190, v191
  v_add_f32 v144, v144, v244
  v_add_f32 v145, v145, v245
  v_add_f32 v146, v146, v246
  v_add_f32 v147, v147, v247
  v_pk_add_f32 v[116:117], v[188:189], v[190:191]
  v_pk_mul_f32 v[118:119], v[188:189], v[188:189]
  v_pk_fma_f32 v[118:119], v[190:191], v[190:191], v[118:119]
  v_pk_add_f32 v[116:117], v[116:117], v[192:193]
  v_pk_fma_f32 v[118:119], v[192:193], v[192:193], v[118:119]
  s_cmp_eq_u32 s71, 0
  s_cbranch_scc1 L_slow_75
  buffer_store_dwordx4 v[148:151], v1, s[4:7], s48 offen offset:1024
L_back_76:
  v_mfma_f32_16x16x32_bf16 v[204:207], a[76:79], v[92:95], v[144:147]
  ds_read_b128 v[228:231], v13 offset:32
  v_mfma_f32_16x16x32_bf16 v[204:207], a[88:91], v[104:107], v[204:207]
  ds_read_b128 v[232:235], v13 offset:48
  v_mfma_f32_16x16x32_bf16 v[204:207], a[80:83], v[96:99], v[204:207]
  s_waitcnt lgkmcnt(2)
  s_barrier
  v_mfma_f32_16x16x32_bf16 v[204:207], a[92:95], v[108:111], v[204:207]
  ds_read_b128 v[236:239], v13 offset:64
  v_mfma_f32_16x16x32_bf16 v[204:207], a[84:87], v[100:103], v[204:207]
  ds_read_b128 v[240:243], v13 offset:80
  v_pk_add_f32 v[196:197], v[196:197], v[176:177]
  v_pk_add_f32 v[198:199], v[198:199], v[178:179]
  v_pk_add_f32 v[116:117], v[116:117], v[194:195]
  v_pk_fma_f32 v[118:119], v[194:195], v[194:195], v[118:119]
  v_pk_add_f32 v[116:117], v[116:117], v[196:197]
  v_pk_fma_f32 v[118:119], v[196:197], v[196:197], v[118:119]
  v_pk_add_f32 v[116:117], v[116:117], v[198:199]
  v_pk_add_f32 v[200:201], v[200:201], v[180:181]
  v_pk_add_f32 v[202:203], v[202:203], v[182:183]
  v_pk_fma_f32 v[118:119], v[198:199], v[198:199], v[118:119]
  v_pk_add_f32 v[116:117], v[116:117], v[200:201]
  v_pk_fma_f32 v[118:119], v[200:201], v[200:201], v[118:119]
  v_pk_add_f32 v[116:117], v[116:117], v[202:203]
  v_pk_fma_f32 v[118:119], v[202:203], v[202:203], v[118:119]
  v_cvt_pk_bf16_f32 v152, v196, v197
  v_pk_add_f32 v[204:205], v[204:205], v[184:185]
  v_pk_add_f32 v[206:207], v[206:207], v[186:187]
  v_cvt_pk_bf16_f32 v153, v198, v199
  v_cvt_pk_bf16_f32 v154, v200, v201
  v_cvt_pk_bf16_f32 v155, v202, v203
  v_bitop3_b32 v152, v152, v14, v14 bitop3:0x30
  s_cmp_eq_u32 s71, 0
  s_cbranch_scc1 L_slow_77
  buffer_store_dwordx4 v[152:155], v1, s[4:7], s48 offen offset:2048
L_back_78:
  v_pk_add_f32 v[116:117], v[116:117], v[204:205]
  v_pk_fma_f32 v[118:119], v[204:205], v[204:205], v[118:119]
  v_pk_add_f32 v[116:117], v[116:117], v[206:207]
  v_pk_fma_f32 v[118:119], v[206:207], v[206:207], v[118:119]
  v_add_f32 v116, v116, v117
  v_add_f32 v118, v118, v119
  v_cvt_pk_bf16_f32 v156, v204, v205
  v_cvt_pk_bf16_f32 v157, v206, v207
  v_permlane16_swap_b32 v116, v118
  v_add_f32 v116, v116, v118
  v_mov_b32 v117, v116
  v_permlane32_swap_b32 v156, v158
  v_permlane32_swap_b32 v157, v159
  v_permlane32_swap_b32 v116, v117
  v_add_f32 v116, v116, v117
  v_and_b32 v116, -2, v116
  s_cmp_eq_u32 s71, 0
  s_cbranch_scc1 L_slow_81
  buffer_store_dword v116, v26, s[4:7], s59 offen
L_back_82:
  v_bitop3_b32 v156, v156, v14, v14 bitop3:0x30
  s_cmp_eq_u32 s71, 0
  s_cbranch_scc1 L_slow_79
  buffer_store_dwordx4 v[156:159], v254, s[4:7], s48 offen
L_back_80:
  v_pk_add_f32 v[208:209], v[208:209], v[188:189]
  v_pk_add_f32 v[210:211], v[210:211], v[190:191]
  v_pk_add_f32 v[212:213], v[212:213], v[192:193]
  v_pk_add_f32 v[214:215], v[214:215], v[194:195]
  v_pk_add_f32 v[216:217], v[216:217], v[196:197]
  v_pk_add_f32 v[218:219], v[218:219], v[198:199]
  v_pk_add_f32 v[220:221], v[220:221], v[200:201]
  v_pk_add_f32 v[222:223], v[222:223], v[202:203]
  v_pk_add_f32 v[224:225], v[224:225], v[204:205]
  v_pk_add_f32 v[226:227], v[226:227], v[206:207]
  buffer_load_dwordx4 v[32:35], v1, s[4:7], s16 offen offset:0 sc1
  ds_read_b128 v[200:203], v13 offset:0
  ds_read_b128 v[204:207], v13 offset:16
  ds_read_b128 a[24:27], v249 offset:0
  ds_read_b128 a[28:31], v249 offset:1024
  buffer_load_dwordx4 v[44:47], v1, s[4:7], s16 offen offset:3072 sc1
  ds_read_b128 a[32:35], v249 offset:2048
  ds_read_b128 a[36:39], v249 offset:3072
  ds_read_b128 a[40:43], v249 offset:4096
  ds_read_b128 a[44:47], v249 offset:5120
  ds_read_b128 a[48:51], v249 offset:6144
  buffer_load_dwordx4 v[36:39], v1, s[4:7], s16 offen offset:1024 sc1
  ds_read_b128 a[52:55], v249 offset:7168
  ds_read_b128 a[56:59], v249 offset:8192
  ds_read_b128 a[60:63], v249 offset:9216
  ds_read_b128 a[64:67], v249 offset:10240
  buffer_load_dwordx4 v[48:51], v1, s[4:7], s24 offen offset:0 sc1
  ds_read_b128 a[68:71], v249 offset:11264
  ds_read_b128 a[72:75], v251 offset:0
  ds_read_b128 a[76:79], v251 offset:1024
  ds_read_b128 a[80:83], v251 offset:2048
  ds_read_b128 a[84:87], v251 offset:3072
  buffer_load_dwordx4 v[40:43], v1, s[4:7], s16 offen offset:2048 sc1
  ds_read_b128 a[88:91], v251 offset:4096
  ds_read_b128 a[92:95], v251 offset:5120
  buffer_load_dwordx4 v[52:55], v1, s[4:7], s17 offen offset:0 sc1
  buffer_load_dwordx4 v[64:67], v1, s[4:7], s17 offen offset:3072 sc1
  buffer_load_dwordx4 v[56:59], v1, s[4:7], s17 offen offset:1024 sc1
  s_waitcnt vmcnt(6)
  v_bitop3_b32 v27, v32, v44, v14 bitop3:0xa8
  v_cmp_ne_u32 vcc, 0, v27
  s_nop 0
  s_cbranch_vccz L_ok_84
L_retry_83:
  s_sub_u32 s69, s69, 1
  s_cbranch_scc1 L_retry_83_to
  buffer_load_dwordx4 v[32:35], v1, s[4:7], s16 offen offset:0 sc1
  buffer_load_dwordx4 v[44:47], v1, s[4:7], s16 offen offset:3072 sc1
  s_waitcnt vmcnt(0)
  v_bitop3_b32 v27, v32, v44, v14 bitop3:0xa8
  v_cmp_ne_u32 vcc, 0, v27
  s_nop 1
  s_cbranch_vccnz L_retry_83
  v_bitop3_b32 v27, v36, v48, v40 bitop3:0xfe
  v_bitop3_b32 v27, v27, v52, v64 bitop3:0xfe
  v_bitop3_b32 v27, v27, v56, v14 bitop3:0xa8
  v_cmp_ne_u32 vcc, 0, v27
  s_nop 1
  s_cbranch_vccz L_ok_84
  buffer_load_dwordx4 v[36:39], v1, s[4:7], s16 offen offset:1024 sc1
  buffer_load_dwordx4 v[48:51], v1, s[4:7], s24 offen offset:0 sc1
  buffer_load_dwordx4 v[40:43], v1, s[4:7], s16 offen offset:2048 sc1
  buffer_load_dwordx4 v[52:55], v1, s[4:7], s17 offen offset:0 sc1
  buffer_load_dwordx4 v[64:67], v1, s[4:7], s17 offen offset:3072 sc1
  buffer_load_dwordx4 v[56:59], v1, s[4:7], s17 offen offset:1024 sc1
L_ok_84:
  v_mfma_f32_16x16x32_bf16 v[128:131], a[96:99], v[32:35], 0
  v_mfma_f32_16x16x32_bf16 v[132:135], a[116:119], v[32:35], 0
  v_mfma_f32_16x16x32_bf16 v[152:155], a[136:139], v[32:35], 0
  buffer_load_dwordx4 v[68:71], v1, s[4:7], s25 offen offset:0 sc1
  v_mfma_f32_16x16x32_bf16 v[156:159], a[156:159], v[32:35], 0
  v_mfma_f32_16x16x32_bf16 v[128:131], a[108:111], v[44:47], v[128:131]
  v_mfma_f32_16x16x32_bf16 v[132:135], a[128:131], v[44:47], v[132:135]
  v_mfma_f32_16x16x32_bf16 v[152:155], a[148:151], v[44:47], v[152:155]
  buffer_load_dwordx4 v[60:63], v1, s[4:7], s17 offen offset:2048 sc1
  s_waitcnt vmcnt(6)
  v_bitop3_b32 v27, v36, v48, v14 bitop3:0xa8
  v_mfma_f32_16x16x32_bf16 v[156:159], a[168:171], v[44:47], v[156:159]
  v_cmp_ne_u32 vcc, 0, v27
  s_nop 0
  s_cbranch_vccz L_ok_86
L_retry_85:
  s_sub_u32 s69, s69, 1
  s_cbranch_scc1 L_retry_85_to
  buffer_load_dwordx4 v[36:39], v1, s[4:7], s16 offen offset:1024 sc1
  buffer_load_dwordx4 v[48:51], v1, s[4:7], s24 offen offset:0 sc1
  s_waitcnt vmcnt(0)
  v_bitop3_b32 v27, v36, v48, v14 bitop3:0xa8
  v_cmp_ne_u32 vcc, 0, v27
  s_nop 1
  s_cbranch_vccnz L_retry_85
  v_bitop3_b32 v27, v40, v52, v64 bitop3:0xfe
  v_bitop3_b32 v27, v27, v56, v68 bitop3:0xfe
  v_bitop3_b32 v27, v27, v60, v14 bitop3:0xa8
  v_cmp_ne_u32 vcc, 0, v27
  s_nop 1
  s_cbranch_vccz L_ok_86
  buffer_load_dwordx4 v[40:43], v1, s[4:7], s16 offen offset:2048 sc1
  buffer_load_dwordx4 v[52:55], v1, s[4:7], s17 offen offset:0 sc1
  buffer_load_dwordx4 v[64:67], v1, s[4:7], s17 offen offset:3072 sc1
  buffer_load_dwordx4 v[56:59], v1, s[4:7], s17 offen offset:1024 sc1
  buffer_load_dwordx4 v[68:71], v1, s[4:7], s25 offen offset:0 sc1
  buffer_load_dwordx4 v[60:63], v1, s[4:7], s17 offen offset:2048 sc1
L_ok_86:
  v_mfma_f32_16x16x32_bf16 v[128:131], a[100:103], v[36:39], v[128:131]
  v_mfma_f32_16x16x32_bf16 v[132:135], a[120:123], v[36:39], v[132:135]
  v_mfma_f32_16x16x32_bf16 v[152:155], a[140:143], v[36:39], v[152:155]
  buffer_load_dwordx4 v[72:75], v1, s[4:7], s18 offen offset:0 sc1
  v_mfma_f32_16x16x32_bf16 v[156:159], a[160:163], v[36:39], v[156:159]
  s_waitcnt vmcnt(6)
  v_bitop3_b32 v27, v40, v40, v14 bitop3:0xa8
  v_mfma_f32_16x16x32_bf16 v[128:131], a[112:115], v[48:51], v[128:131]
  v_cmp_ne_u32 vcc, 0, v27
  v_mfma_f32_16x16x32_bf16 v[132:135], a[132:135], v[48:51], v[132:135]
  s_cbranch_vccz L_ok_88
L_retry_87:
  s_sub_u32 s69, s69, 1
  s_cbranch_scc1 L_retry_87_to
  buffer_load_dwordx4 v[40:43], v1, s[4:7], s16 offen offset:2048 sc1
  s_waitcnt vmcnt(0)
  v_bitop3_b32 v27, v40, v40, v14 bitop3:0xa8
  v_cmp_ne_u32 vcc, 0, v27
  s_nop 1
  s_cbranch_vccnz L_retry_87
  v_bitop3_b32 v27, v52, v64, v56 bitop3:0xfe
  v_bitop3_b32 v27, v27, v68, v60 bitop3:0xfe
  v_bitop3_b32 v27, v27, v72, v14 bitop3:0xa8
  v_cmp_ne_u32 vcc, 0, v27
  s_nop 1
  s_cbranch_vccz L_ok_88
  buffer_load_dwordx4 v[52:55], v1, s[4:7], s17 offen offset:0 sc1
  buffer_load_dwordx4 v[64:67], v1, s[4:7], s17 offen offset:3072 sc1
  buffer_load_dwordx4 v[56:59], v1, s[4:7], s17 offen offset:1024 sc1
  buffer_load_dwordx4 v[68:71], v1, s[4:7], s25 offen offset:0 sc1
  buffer_load_dwordx4 v[60:63], v1, s[4:7], s17 offen offset:2048 sc1
  buffer_load_dwordx4 v[72:75], v1, s[4:7], s18 offen offset:0 sc1
L_ok_88:
  v_mfma_f32_16x16x32_bf16 v[152:155], a[152:155], v[48:51], v[152:155]
  buffer_load_dwordx4 v[84:87], v1, s[4:7], s18 offen offset:3072 sc1
  v_mfma_f32_16x16x32_bf16 v[156:159], a[172:175], v[48:51], v[156:159]
  v_mfma_f32_16x16x32_bf16 v[128:131], a[104:107], v[40:43], v[128:131]
  v_mfma_f32_16x16x32_bf16 v[132:135], a[124:127], v[40:43], v[132:135]
  v_mfma_f32_16x16x32_bf16 v[152:155], a[144:147], v[40:43], v[152:155]
  buffer_load_dwordx4 v[76:79], v1, s[4:7], s18 offen offset:1024 sc1
  s_waitcnt vmcnt(6)
  v_bitop3_b32 v27, v52, v64, v14 bitop3:0xa8
  v_mfma_f32_16x16x32_bf16 v[156:159], a[164:167], v[40:43], v[156:159]
  v_cmp_ne_u32 vcc, 0, v27
  s_nop 0
  s_cbranch_vccz L_ok_90
L_retry_89:
  s_sub_u32 s69, s69, 1
  s_cbranch_scc1 L_retry_89_to
  buffer_load_dwordx4 v[52:55], v1, s[4:7], s17 offen offset:0 sc1
  buffer_load_dwordx4 v[64:67], v1, s[4:7], s17 offen offset:3072 sc1
  s_waitcnt vmcnt(0)
  v_bitop3_b32 v27, v52, v64, v14 bitop3:0xa8
  v_cmp_ne_u32 vcc, 0, v27
  s_nop 1
  s_cbranch_vccnz L_retry_89
  v_bitop3_b32 v27, v56, v68, v60 bitop3:0xfe
  v_bitop3_b32 v27, v27, v72, v84 bitop3:0xfe
  v_bitop3_b32 v27, v27, v76, v14 bitop3:0xa8
  v_cmp_ne_u32 vcc, 0, v27
  s_nop 1
  s_cbranch_vccz L_ok_90
  buffer_load_dwordx4 v[56:59], v1, s[4:7], s17 offen offset:1024 sc1
  buffer_load_dwordx4 v[68:71], v1, s[4:7], s25 offen offset:0 sc1
  buffer_load_dwordx4 v[60:63], v1, s[4:7], s17 offen offset:2048 sc1
  buffer_load_dwordx4 v[72:75], v1, s[4:7], s18 offen offset:0 sc1
  buffer_load_dwordx4 v[84:87], v1, s[4:7], s18 offen offset:3072 sc1
  buffer_load_dwordx4 v[76:79], v1, s[4:7], s18 offen offset:1024 sc1
L_ok_90:
  v_mfma_f32_16x16x32_bf16 v[136:139], a[96:99], v[52:55], 0
  ds_write_b128 v4, v[128:131] offset:0
  v_mfma_f32_16x16x32_bf16 v[140:143], a[116:119], v[52:55], 0
  buffer_load_dwordx4 v[88:91], v1, s[4:7], s26 offen offset:0 sc1
  v_mfma_f32_16x16x32_bf16 v[160:163], a[136:139], v[52:55], 0
  v_mfma_f32_16x16x32_bf16 v[164:167], a[156:159], v[52:55], 0
  ds_write_b128 v4, v[132:135] offset:1024
  v_mfma_f32_16x16x32_bf16 v[136:139], a[108:111], v[64:67], v[136:139]
  v_mfma_f32_16x16x32_bf16 v[140:143], a[128:131], v[64:67], v[140:143]
  buffer_load_dwordx4 v[80:83], v1, s[4:7], s18 offen offset:2048 sc1
  v_mfma_f32_16x16x32_bf16 v[160:163], a[148:151], v[64:67], v[160:163]
  ds_write_b128 v4, v[152:155] offset:2048
  v_mfma_f32_16x16x32_bf16 v[164:167], a[168:171], v[64:67], v[164:167]
  s_waitcnt vmcnt(5)
  v_bitop3_b32 v27, v56, v68, v60 bitop3:0xfe
  v_bitop3_b32 v27, v27, v27, v14 bitop3:0xa8
  buffer_load_dwordx2 v[112:113], v15, s[4:7], s56 offen offset:0 sc1
  v_cmp_ne_u32 vcc, 0, v27
  ds_write_b128 v4, v[156:159] offset:3072
  s_cbranch_vccz L_ok_92
L_retry_91:
  s_sub_u32 s69, s69, 1
  s_cbranch_scc1 L_retry_91_to
  buffer_load_dwordx4 v[56:59], v1, s[4:7], s17 offen offset:1024 sc1
  buffer_load_dwordx4 v[68:71], v1, s[4:7], s25 offen offset:0 sc1
  buffer_load_dwordx4 v[60:63], v1, s[4:7], s17 offen offset:2048 sc1
  s_waitcnt vmcnt(0)
  v_bitop3_b32 v27, v56, v68, v60 bitop3:0xfe
  v_bitop3_b32 v27, v27, v27, v14 bitop3:0xa8
  v_cmp_ne_u32 vcc, 0, v27
  s_nop 1
  s_cbranch_vccnz L_retry_91
  v_bitop3_b32 v27, v72, v84, v76 bitop3:0xfe
  v_bitop3_b32 v27, v27, v88, v80 bitop3:0xfe
  v_bitop3_b32 v27, v27, v112, v14 bitop3:0xa8
  v_cmp_ne_u32 vcc, 0, v27
  s_nop 1
  s_cbranch_vccz L_ok_92
  buffer_load_dwordx4 v[72:75], v1, s[4:7], s18 offen offset:0 sc1
  buffer_load_dwordx4 v[84:87], v1, s[4:7], s18 offen offset:3072 sc1
  buffer_load_dwordx4 v[76:79], v1, s[4:7], s18 offen offset:1024 sc1
  buffer_load_dwordx4 v[88:91], v1, s[4:7], s26 offen offset:0 sc1
  buffer_load_dwordx4 v[80:83], v1, s[4:7], s18 offen offset:2048 sc1
  buffer_load_dwordx2 v[112:113], v15, s[4:7], s56 offen offset:0 sc1
L_ok_92:
  v_mfma_f32_16x16x32_bf16 v[136:139], a[100:103], v[56:59], v[136:139]
  v_mfma_f32_16x16x32_bf16 v[136:139], a[112:115], v[68:71], v[136:139]
  buffer_load_dwordx2 v[114:115], v15, s[4:7], s56 offen offset:512 sc1
  v_mfma_f32_16x16x32_bf16 v[136:139], a[104:107], v[60:63], v[136:139]
  v_mfma_f32_16x16x32_bf16 v[140:143], a[120:123], v[56:59], v[140:143]
  v_mfma_f32_16x16x32_bf16 v[140:143], a[132:135], v[68:71], v[140:143]
  v_mfma_f32_16x16x32_bf16 v[140:143], a[124:127], v[60:63], v[140:143]
  buffer_load_dwordx4 v[92:95], v1, s[4:7], s19 offen offset:0 sc1
  v_mfma_f32_16x16x32_bf16 v[160:163], a[140:143], v[56:59], v[160:163]
  v_mfma_f32_16x16x32_bf16 v[160:163], a[152:155], v[68:71], v[160:163]
  v_mfma_f32_16x16x32_bf16 v[160:163], a[144:147], v[60:63], v[160:163]
  v_mfma_f32_16x16x32_bf16 v[164:167], a[160:163], v[56:59], v[164:167]
  s_waitcnt vmcnt(5)
  v_bitop3_b32 v27, v72, v84, v76 bitop3:0xfe
  buffer_load_dwordx4 v[104:107], v1, s[4:7], s19 offen offset:3072 sc1
  v_mfma_f32_16x16x32_bf16 v[164:167], a[172:175], v[68:71], v[164:167]
  ds_write_b128 v5, v[136:139] offset:0
  v_mfma_f32_16x16x32_bf16 v[164:167], a[164:167], v[60:63], v[164:167]
  ds_write_b128 v5, v[140:143] offset:1024
  buffer_load_dwordx4 v[96:99], v1, s[4:7], s19 offen offset:1024 sc1
  ds_write_b128 v5, v[160:163] offset:2048
  s_waitcnt vmcnt(5)
  v_bitop3_b32 v27, v27, v88, v80 bitop3:0xfe
  v_bitop3_b32 v27, v27, v27, v14 bitop3:0xa8
  v_cmp_ne_u32 vcc, 0, v27
  buffer_load_dwordx4 v[108:111], v1, s[4:7], s27 offen offset:0 sc1
  s_cbranch_vccnz L_retry_93
L_ok_94:
  v_mfma_f32_16x16x32_bf16 v[144:147], a[96:99], v[72:75], 0
  ds_write_b128 v5, v[164:167] offset:3072
  v_mfma_f32_16x16x32_bf16 v[144:147], a[108:111], v[84:87], v[144:147]
  v_mfma_f32_16x16x32_bf16 v[144:147], a[100:103], v[76:79], v[144:147]
  buffer_load_dwordx4 v[100:103], v1, s[4:7], s19 offen offset:2048 sc1
  v_mfma_f32_16x16x32_bf16 v[144:147], a[112:115], v[88:91], v[144:147]
  v_mfma_f32_16x16x32_bf16 v[144:147], a[104:107], v[80:83], v[144:147]
  v_mfma_f32_16x16x32_bf16 v[148:151], a[116:119], v[72:75], 0
  v_mfma_f32_16x16x32_bf16 v[148:151], a[128:131], v[84:87], v[148:151]
  buffer_load_dwordx4 a[212:215], v3, s[4:7], s70 offen offset:3072
  v_mfma_f32_16x16x32_bf16 v[148:151], a[120:123], v[76:79], v[148:151]
  v_mfma_f32_16x16x32_bf16 v[148:151], a[132:135], v[88:91], v[148:151]
  v_mfma_f32_16x16x32_bf16 v[148:151], a[124:127], v[80:83], v[148:151]
  v_mfma_f32_16x16x32_bf16 v[168:171], a[136:139], v[72:75], 0
  v_mfma_f32_16x16x32_bf16 v[168:171], a[148:151], v[84:87], v[168:171]
  s_mov_b32 s70, 184320
  buffer_load_dwordx4 a[216:219], v3, s[4:7], s70 offen offset:0
  v_mfma_f32_16x16x32_bf16 v[168:171], a[140:143], v[76:79], v[168:171]
  ds_write_b128 v6, v[144:147] offset:0
  v_mfma_f32_16x16x32_bf16 v[168:171], a[152:155], v[88:91], v[168:171]
  v_mfma_f32_16x16x32_bf16 v[168:171], a[144:147], v[80:83], v[168:171]
  v_mfma_f32_16x16x32_bf16 v[172:175], a[156:159], v[72:75], 0
  buffer_load_dwordx4 a[220:223], v3, s[4:7], s70 offen offset:1024
  v_mfma_f32_16x16x32_bf16 v[172:175], a[168:171], v[84:87], v[172:175]
  ds_write_b128 v6, v[148:151] offset:1024
  v_mfma_f32_16x16x32_bf16 v[172:175], a[160:163], v[76:79], v[172:175]
  v_mfma_f32_16x16x32_bf16 v[172:175], a[172:175], v[88:91], v[172:175]
  v_mfma_f32_16x16x32_bf16 v[172:175], a[164:167], v[80:83], v[172:175]
  buffer_load_dwordx4 a[224:227], v3, s[4:7], s70 offen offset:2048
  ds_write_b128 v6, v[168:171] offset:2048
  buffer_load_dwordx4 a[228:231], v3, s[4:7], s70 offen offset:3072
  s_nop 4
  ds_write_b128 v6, v[172:175] offset:3072
  s_mov_b32 s70, 188416
  buffer_load_dwordx4 a[232:235], v3, s[4:7], s70 offen offset:0
  buffer_load_dwordx4 a[236:239], v3, s[4:7], s70 offen offset:1024
  s_waitcnt vmcnt(12)
  v_bitop3_b32 v27, v112, v114, v14 bitop3:0xa8
  v_cmp_ne_u32 vcc, 0, v27
  s_nop 0
  s_cbranch_vccz L_ok_96
L_retry_95:
  s_sub_u32 s69, s69, 1
  s_cbranch_scc1 L_retry_95_to
  buffer_load_dwordx2 v[112:113], v15, s[4:7], s56 offen offset:0 sc1
  buffer_load_dwordx2 v[114:115], v15, s[4:7], s56 offen offset:512 sc1
  s_waitcnt vmcnt(0)
  v_bitop3_b32 v27, v112, v114, v14 bitop3:0xa8
  v_cmp_ne_u32 vcc, 0, v27
  s_nop 1
  s_cbranch_vccnz L_retry_95
  v_bitop3_b32 v27, v92, v104, v96 bitop3:0xfe
  v_bitop3_b32 v27, v27, v108, v100 bitop3:0xfe
  v_bitop3_b32 v27, v27, v27, v14 bitop3:0xa8
  v_cmp_ne_u32 vcc, 0, v27
  s_nop 1
  s_cbranch_vccz L_ok_96
  buffer_load_dwordx4 v[92:95], v1, s[4:7], s19 offen offset:0 sc1
  buffer_load_dwordx4 v[104:107], v1, s[4:7], s19 offen offset:3072 sc1
  buffer_load_dwordx4 v[96:99], v1, s[4:7], s19 offen offset:1024 sc1
  buffer_load_dwordx4 v[108:111], v1, s[4:7], s27 offen offset:0 sc1
  buffer_load_dwordx4 v[100:103], v1, s[4:7], s19 offen offset:2048 sc1
  buffer_load_dword a253, v26, s[4:7], s76 offen
  buffer_load_dword a253, v26, s[4:7], s76 offen
  buffer_load_dword a253, v26, s[4:7], s76 offen
  buffer_load_dword a253, v26, s[4:7], s76 offen
  buffer_load_dword a253, v26, s[4:7], s76 offen
  buffer_load_dword a253, v26, s[4:7], s76 offen
  buffer_load_dword a253, v26, s[4:7], s76 offen
L_ok_96:
  v_add_f32 v112, v112, v114
  v_mov_b32 v114, v112
  v_add_f32 v113, v113, v115
  v_mov_b32 v115, v113
  v_permlane16_swap_b32 v112, v114
  buffer_load_dwordx4 a[240:243], v3, s[4:7], s70 offen offset:2048
  v_add_f32 v112, v112, v114
  v_mov_b32 v114, v112
  v_permlane16_swap_b32 v113, v115
  v_add_f32 v113, v113, v115
  v_permlane32_swap_b32 v112, v114
  v_add_f32 v112, v112, v114
  v_mul_f32 v28, 0xbacccccd, v112
  s_waitcnt lgkmcnt(15)
  v_mul_f32 v200, v28, v200
  v_mul_f32 v201, v28, v201
  v_mul_f32 v202, v28, v202
  v_mul_f32 v203, v28, v203
  v_mul_f32 v204, v28, v204
  v_mul_f32 v205, v28, v205
  v_mul_f32 v206, v28, v206
  buffer_load_dwordx4 a[244:247], v3, s[4:7], s70 offen offset:3072
  v_mul_f32 v207, v28, v207
  v_mul_f32 v228, v28, v228
  v_mul_f32 v229, v28, v229
  v_mul_f32 v230, v28, v230
  v_mul_f32 v231, v28, v231
  v_mul_f32 v232, v28, v232
  v_mul_f32 v233, v28, v233
  v_mul_f32 v234, v28, v234
  v_mul_f32 v235, v28, v235
  v_mov_b32 v115, v113
  v_mul_f32 v236, v28, v236
  v_mul_f32 v237, v28, v237
  v_permlane32_swap_b32 v113, v115
  v_add_f32 v113, v113, v115
  v_mul_f32 v113, 0x3acccccd, v113
  s_mov_b32 s70, 192512
  buffer_load_dwordx4 a[248:251], v3, s[4:7], s70 offen offset:0
  v_fma_f32 v29, -v28, v28, v113
  v_max_f32 v29, 0, v29
  v_add_f32 v31, 0x3727c5ac, v29
  v_rsq_f32 v30, v31
  s_waitcnt vmcnt(12)
  v_bitop3_b32 v27, v92, v104, v96 bitop3:0xfe
  v_mul_f32 v250, v30, v30
  v_mul_f32 v250, v250, v30
  v_mul_f32 v248, s79, v30
  v_mul_f32 v250, s80, v250
  v_rcp_f32 v252, v30
  v_mul_f32 v238, v28, v238
  v_mul_f32 v239, v28, v239
  v_mul_f32 v240, v28, v240
  buffer_load_dwordx4 a[0:3], v3, s[4:7], s70 offen offset:1024
  v_mul_f32 v241, v28, v241
  v_mul_f32 v242, v28, v242
  v_mul_f32 v243, v28, v243
  buffer_load_dwordx4 a[4:7], v3, s[4:7], s70 offen offset:2048
  s_waitcnt vmcnt(12)
  v_bitop3_b32 v27, v27, v108, v100 bitop3:0xfe
  v_bitop3_b32 v27, v27, v27, v14 bitop3:0xa8
  v_cmp_ne_u32 vcc, 0, v27
  s_nop 0
  s_cbranch_vccnz L_retry_97
L_ok_98:
  v_mfma_f32_16x16x32_bf16 v[200:203], a[96:99], v[92:95], v[200:203]
  s_waitcnt lgkmcnt(0)
  s_barrier
  s_mov_b32 s81, 40960
  buffer_load_dword a254, v2, s[96:99], s81 offen
  v_mfma_f32_16x16x32_bf16 v[200:203], a[108:111], v[104:107], v[200:203]
  ds_read_b128 v[128:131], v7 offset:0
  v_mfma_f32_16x16x32_bf16 v[200:203], a[100:103], v[96:99], v[200:203]
  ds_read_b128 v[136:139], v7 offset:5120
  v_mfma_f32_16x16x32_bf16 v[200:203], a[112:115], v[108:111], v[200:203]
  ds_read_b128 v[144:147], v7 offset:10240
  v_mfma_f32_16x16x32_bf16 v[200:203], a[104:107], v[100:103], v[200:203]
  ds_read_b128 v[132:135], v7 offset:1024
  v_mfma_f32_16x16x32_bf16 v[204:207], a[116:119], v[92:95], v[204:207]
  buffer_load_dwordx4 a[8:11], v3, s[4:7], s70 offen offset:3072
  v_mfma_f32_16x16x32_bf16 v[204:207], a[128:131], v[104:107], v[204:207]
  ds_read_b128 v[140:143], v7 offset:6144
  v_mfma_f32_16x16x32_bf16 v[204:207], a[120:123], v[96:99], v[204:207]
  ds_read_b128 v[148:151], v7 offset:11264
  v_mfma_f32_16x16x32_bf16 v[204:207], a[132:135], v[108:111], v[204:207]
  ds_read_b128 v[152:155], v7 offset:2048
  v_mfma_f32_16x16x32_bf16 v[204:207], a[124:127], v[100:103], v[204:207]
  ds_read_b128 v[160:163], v7 offset:7168
  s_mov_b32 s70, 196608
  buffer_load_dwordx4 a[12:15], v3, s[4:7], s70 offen offset:0
  v_mfma_f32_16x16x32_bf16 v[228:231], a[136:139], v[92:95], v[228:231]
  ds_read_b128 v[168:171], v7 offset:12288
  v_mfma_f32_16x16x32_bf16 v[228:231], a[148:151], v[104:107], v[228:231]
  ds_read_b128 v[156:159], v7 offset:3072
  v_mfma_f32_16x16x32_bf16 v[228:231], a[140:143], v[96:99], v[228:231]
  s_waitcnt lgkmcnt(8)
  v_add_f32 v128, v128, v136
  v_add_f32 v129, v129, v137
  v_mfma_f32_16x16x32_bf16 v[228:231], a[152:155], v[108:111], v[228:231]
  v_add_f32 v130, v130, v138
  buffer_load_dwordx4 a[16:19], v3, s[4:7], s70 offen offset:1024
  v_mfma_f32_16x16x32_bf16 v[228:231], a[144:147], v[100:103], v[228:231]
  v_add_f32 v131, v131, v139
  s_waitcnt lgkmcnt(7)
  v_add_f32 v200, v200, v144
  v_mfma_f32_16x16x32_bf16 v[232:235], a[156:159], v[92:95], v[232:235]
  v_add_f32 v201, v201, v145
  v_add_f32 v202, v202, v146
  v_mfma_f32_16x16x32_bf16 v[232:235], a[168:171], v[104:107], v[232:235]
  v_add_f32 v203, v203, v147
  s_waitcnt lgkmcnt(5)
  v_add_f32 v132, v132, v140
  v_mfma_f32_16x16x32_bf16 v[232:235], a[160:163], v[96:99], v[232:235]
  v_add_f32 v133, v133, v141
  v_add_f32 v134, v134, v142
  v_mfma_f32_16x16x32_bf16 v[232:235], a[172:175], v[108:111], v[232:235]
  buffer_load_dwordx4 a[20:23], v3, s[4:7], s70 offen offset:2048
  v_mfma_f32_16x16x32_bf16 v[232:235], a[164:167], v[100:103], v[232:235]
  v_add_f32 v135, v135, v143
  s_waitcnt lgkmcnt(4)
  v_add_f32 v204, v204, v148
  v_mfma_f32_16x16x32_bf16 v[176:179], a[176:179], v[32:35], 0
  v_add_f32 v205, v205, v149
  v_add_f32 v206, v206, v150
  v_mfma_f32_16x16x32_bf16 v[176:179], a[180:183], v[36:39], v[176:179]
  v_add_f32 v207, v207, v151
  v_add_f32 v200, v200, v128
  v_mfma_f32_16x16x32_bf16 v[176:179], a[184:187], v[40:43], v[176:179]
  v_add_f32 v201, v201, v129
  s_mov_b32 s70, 221184
  buffer_load_dwordx4 a[108:111], v3, s[4:7], s70 offen offset:0
  v_mfma_f32_16x16x32_bf16 v[176:179], a[188:191], v[44:47], v[176:179]
  v_add_f32 v202, v202, v130
  v_add_f32 v203, v203, v131
  v_mfma_f32_16x16x32_bf16 v[176:179], a[192:195], v[48:51], v[176:179]
  v_add_f32 v204, v204, v132
  v_add_f32 v205, v205, v133
  v_mfma_f32_16x16x32_bf16 v[180:183], a[196:199], v[32:35], 0
  v_add_f32 v206, v206, v134
  v_add_f32 v207, v207, v135
  v_pk_mul_f32 v[144:145], v[200:201], v[200:201]
  v_pk_fma_f32 v[144:145], v[144:145], v[250:251], v[248:249] op_sel_hi:[1,0,0]
  v_pk_mul_f32 v[144:145], v[144:145], v[200:201]
  v_pk_mul_f32 v[146:147], v[202:203], v[202:203]
  v_pk_fma_f32 v[146:147], v[146:147], v[250:251], v[248:249] op_sel_hi:[1,0,0]
  v_pk_mul_f32 v[146:147], v[146:147], v[202:203]
  v_pk_mul_f32 v[148:149], v[204:205], v[204:205]
  v_pk_fma_f32 v[148:149], v[148:149], v[250:251], v[248:249] op_sel_hi:[1,0,0]
  v_pk_mul_f32 v[148:149], v[148:149], v[204:205]
  v_pk_mul_f32 v[150:151], v[206:207], v[206:207]
  v_pk_fma_f32 v[150:151], v[150:151], v[250:251], v[248:249] op_sel_hi:[1,0,0]
  v_pk_mul_f32 v[150:151], v[150:151], v[206:207]
  buffer_load_dwordx4 a[112:115], v3, s[4:7], s70 offen offset:1024
  v_mfma_f32_16x16x32_bf16 v[180:183], a[200:203], v[36:39], v[180:183]
  ds_read_b128 v[164:167], v7 offset:8192
  s_waitcnt lgkmcnt(3)
  v_add_f32 v152, v152, v160
  v_mfma_f32_16x16x32_bf16 v[180:183], a[204:207], v[40:43], v[180:183]
  ds_read_b128 v[172:175], v7 offset:13312
  v_add_f32 v153, v153, v161
  v_mfma_f32_16x16x32_bf16 v[180:183], a[208:211], v[44:47], v[180:183]
  v_exp_f32 v144, v144
  s_waitcnt vmcnt(18)
  v_mfma_f32_16x16x32_bf16 v[180:183], a[212:215], v[48:51], v[180:183]
  v_exp_f32 v145, v145
  v_mfma_f32_16x16x32_bf16 v[184:187], a[176:179], v[52:55], 0
  buffer_load_dwordx4 a[116:119], v3, s[4:7], s70 offen offset:2048
  v_mfma_f32_16x16x32_bf16 v[184:187], a[180:183], v[56:59], v[184:187]
  v_exp_f32 v146, v146
  v_mfma_f32_16x16x32_bf16 v[184:187], a[184:187], v[60:63], v[184:187]
  v_exp_f32 v147, v147
  v_mfma_f32_16x16x32_bf16 v[184:187], a[188:191], v[64:67], v[184:187]
  v_exp_f32 v148, v148
  v_mfma_f32_16x16x32_bf16 v[184:187], a[192:195], v[68:71], v[184:187]
  v_exp_f32 v149, v149
  v_mfma_f32_16x16x32_bf16 v[188:191], a[196:199], v[52:55], 0
  buffer_load_dwordx4 a[120:123], v3, s[4:7], s70 offen offset:3072
  v_mfma_f32_16x16x32_bf16 v[188:191], a[200:203], v[56:59], v[188:191]
  v_exp_f32 v150, v150
  v_mfma_f32_16x16x32_bf16 v[188:191], a[204:207], v[60:63], v[188:191]
  v_exp_f32 v151, v151
  v_mfma_f32_16x16x32_bf16 v[188:191], a[208:211], v[64:67], v[188:191]
  v_fma_f32 v144, v144, v252, v252
  v_mfma_f32_16x16x32_bf16 v[188:191], a[212:215], v[68:71], v[188:191]
  v_fma_f32 v145, v145, v252, v252
  v_mfma_f32_16x16x32_bf16 v[192:195], a[176:179], v[72:75], 0
  s_mov_b32 s70, 225280
  buffer_load_dwordx4 a[124:127], v3, s[4:7], s70 offen offset:0
  v_mfma_f32_16x16x32_bf16 v[192:195], a[180:183], v[76:79], v[192:195]
  v_fma_f32 v146, v146, v252, v252
  v_mfma_f32_16x16x32_bf16 v[192:195], a[184:187], v[80:83], v[192:195]
  v_fma_f32 v147, v147, v252, v252
  v_mfma_f32_16x16x32_bf16 v[192:195], a[188:191], v[84:87], v[192:195]
  v_fma_f32 v148, v148, v252, v252
  v_mfma_f32_16x16x32_bf16 v[192:195], a[192:195], v[88:91], v[192:195]
  v_fma_f32 v149, v149, v252, v252
  v_fma_f32 v150, v150, v252, v252
  v_fma_f32 v151, v151, v252, v252
  v_rcp_f32 v144, v144
  buffer_load_dwordx4 a[128:131], v3, s[4:7], s70 offen offset:1024
  v_rcp_f32 v145, v145
  v_rcp_f32 v146, v146
  v_rcp_f32 v147, v147
  v_rcp_f32 v148, v148
  v_rcp_f32 v149, v149
  v_rcp_f32 v150, v150
  v_rcp_f32 v151, v151
  v_mul_f32 v200, v200, v144
  v_mul_f32 v201, v201, v145
  v_mfma_f32_16x16x32_bf16 v[196:199], a[196:199], v[72:75], 0
  buffer_load_dwordx4 a[132:135], v3, s[4:7], s70 offen offset:2048
  v_cvt_pk_bf16_f32 v244, v200, v201
  v_mul_f32 v202, v202, v146
  v_mul_f32 v203, v203, v147
  v_mul_f32 v204, v204, v148
  v_mul_f32 v205, v205, v149
  v_mul_f32 v206, v206, v150
  v_mul_f32 v207, v207, v151
  v_bitop3_b32 v244, v244, v14, v14 bitop3:0x30
  v_cvt_pk_bf16_f32 v245, v202, v203
  v_cvt_pk_bf16_f32 v246, v204, v205
  v_cvt_pk_bf16_f32 v247, v206, v207
  buffer_store_dwordx4 v[244:247], v1, s[4:7], s52 offen offset:0 sc1
  v_mfma_f32_16x16x32_bf16 v[196:199], a[200:203], v[76:79], v[196:199]
  v_add_f32 v154, v154, v162
  v_add_f32 v155, v155, v163
  v_mfma_f32_16x16x32_bf16 v[196:199], a[204:207], v[80:83], v[196:199]
  s_waitcnt lgkmcnt(3)
  v_add_f32 v228, v228, v168
  v_add_f32 v229, v229, v169
  v_mfma_f32_16x16x32_bf16 v[196:199], a[208:211], v[84:87], v[196:199]
  v_add_f32 v230, v230, v170
  v_add_f32 v231, v231, v171
  v_mfma_f32_16x16x32_bf16 v[196:199], a[212:215], v[88:91], v[196:199]
  buffer_load_dwordx4 a[136:139], v3, s[4:7], s70 offen offset:3072
  v_mfma_f32_16x16x32_bf16 v[236:239], a[176:179], v[92:95], v[236:239]
  s_waitcnt lgkmcnt(1)
  v_add_f32 v156, v156, v164
  v_add_f32 v157, v157, v165
  v_add_f32 v158, v158, v166
  v_add_f32 v159, v159, v167
  s_waitcnt lgkmcnt(0)
  v_add_f32 v232, v232, v172
  v_add_f32 v233, v233, v173
  v_add_f32 v234, v234, v174
  v_add_f32 v235, v235, v175
  v_add_f32 v228, v228, v152
  v_add_f32 v229, v229, v153
  v_add_f32 v230, v230, v154
  v_add_f32 v231, v231, v155
  v_add_f32 v232, v232, v156
  v_add_f32 v233, v233, v157
  v_add_f32 v234, v234, v158
  v_add_f32 v235, v235, v159
  s_mov_b32 s70, 229376
  buffer_load_dwordx4 a[140:143], v3, s[4:7], s70 offen offset:0
  v_pk_mul_f32 v[168:169], v[228:229], v[228:229]
  v_pk_fma_f32 v[168:169], v[168:169], v[250:251], v[248:249] op_sel_hi:[1,0,0]
  v_pk_mul_f32 v[168:169], v[168:169], v[228:229]
  v_pk_mul_f32 v[170:171], v[230:231], v[230:231]
  v_pk_fma_f32 v[170:171], v[170:171], v[250:251], v[248:249] op_sel_hi:[1,0,0]
  v_pk_mul_f32 v[170:171], v[170:171], v[230:231]
  v_pk_mul_f32 v[172:173], v[232:233], v[232:233]
  v_pk_fma_f32 v[172:173], v[172:173], v[250:251], v[248:249] op_sel_hi:[1,0,0]
  v_pk_mul_f32 v[172:173], v[172:173], v[232:233]
  v_pk_mul_f32 v[174:175], v[234:235], v[234:235]
  v_pk_fma_f32 v[174:175], v[174:175], v[250:251], v[248:249] op_sel_hi:[1,0,0]
  v_pk_mul_f32 v[174:175], v[174:175], v[234:235]
  buffer_load_dwordx4 a[144:147], v3, s[4:7], s70 offen offset:1024
  v_mfma_f32_16x16x32_bf16 v[236:239], a[180:183], v[96:99], v[236:239]
  v_exp_f32 v168, v168
  v_mfma_f32_16x16x32_bf16 v[236:239], a[184:187], v[100:103], v[236:239]
  v_exp_f32 v169, v169
  v_mfma_f32_16x16x32_bf16 v[236:239], a[188:191], v[104:107], v[236:239]
  v_exp_f32 v170, v170
  v_mfma_f32_16x16x32_bf16 v[236:239], a[192:195], v[108:111], v[236:239]
  v_exp_f32 v171, v171
  v_exp_f32 v172, v172
  v_exp_f32 v173, v173
  buffer_load_dwordx4 a[148:151], v3, s[4:7], s70 offen offset:2048
  v_exp_f32 v174, v174
  v_exp_f32 v175, v175
  v_fma_f32 v168, v168, v252, v252
  v_fma_f32 v169, v169, v252, v252
  v_fma_f32 v170, v170, v252, v252
  v_fma_f32 v171, v171, v252, v252
  v_fma_f32 v172, v172, v252, v252
  v_fma_f32 v173, v173, v252, v252
  v_fma_f32 v174, v174, v252, v252
  v_fma_f32 v175, v175, v252, v252
  v_rcp_f32 v168, v168
  v_rcp_f32 v169, v169
  v_mfma_f32_16x16x32_bf16 v[240:243], a[196:199], v[92:95], v[240:243]
  buffer_load_dwordx4 a[152:155], v3, s[4:7], s70 offen offset:3072
  v_rcp_f32 v170, v170
  v_rcp_f32 v171, v171
  v_rcp_f32 v172, v172
  v_rcp_f32 v173, v173
  v_rcp_f32 v174, v174
  v_rcp_f32 v175, v175
  v_mul_f32 v228, v228, v168
  v_mul_f32 v229, v229, v169
  v_cvt_pk_bf16_f32 v244, v228, v229
  v_mul_f32 v230, v230, v170
  v_mul_f32 v231, v231, v171
  v_mul_f32 v232, v232, v172
  v_mul_f32 v233, v233, v173
  s_mov_b32 s70, 233472
  buffer_load_dwordx4 a[156:159], v3, s[4:7], s70 offen offset:0
  v_mul_f32 v234, v234, v174
  v_mul_f32 v235, v235, v175
  v_bitop3_b32 v244, v244, v14, v14 bitop3:0x30
  v_cvt_pk_bf16_f32 v245, v230, v231
  v_cvt_pk_bf16_f32 v246, v232, v233
  v_cvt_pk_bf16_f32 v247, v234, v235
  v_mfma_f32_16x16x32_bf16 v[240:243], a[200:203], v[96:99], v[240:243]
  buffer_store_dwordx4 v[244:247], v1, s[4:7], s52 offen offset:1024 sc1
  v_mfma_f32_16x16x32_bf16 v[240:243], a[204:207], v[100:103], v[240:243]
  ds_read_b128 v[200:203], v13 offset:96
  v_mfma_f32_16x16x32_bf16 v[240:243], a[208:211], v[104:107], v[240:243]
  ds_read_b128 v[204:207], v13 offset:112
  v_mfma_f32_16x16x32_bf16 v[240:243], a[212:215], v[108:111], v[240:243]
  s_barrier
  buffer_load_dwordx4 a[160:163], v3, s[4:7], s70 offen offset:1024
  s_waitcnt vmcnt(31)
  v_mfma_f32_16x16x32_bf16 v[128:131], a[216:219], v[32:35], 0
  ds_write_b128 v4, v[176:179] offset:0
  s_waitcnt vmcnt(30)
  v_mfma_f32_16x16x32_bf16 v[128:131], a[220:223], v[36:39], v[128:131]
  ds_read_b128 v[228:231], v13 offset:128
  s_waitcnt vmcnt(29)
  v_mfma_f32_16x16x32_bf16 v[128:131], a[224:227], v[40:43], v[128:131]
  ds_read_b128 v[232:235], v13 offset:144
  s_waitcnt vmcnt(28)
  v_mfma_f32_16x16x32_bf16 v[128:131], a[228:231], v[44:47], v[128:131]
  buffer_load_dwordx4 a[164:167], v3, s[4:7], s70 offen offset:2048
  s_waitcnt vmcnt(28)
  v_mfma_f32_16x16x32_bf16 v[128:131], a[232:235], v[48:51], v[128:131]
  ds_write_b128 v4, v[180:183] offset:1024
  s_waitcnt vmcnt(27)
  v_mfma_f32_16x16x32_bf16 v[132:135], a[236:239], v[32:35], 0
  s_waitcnt lgkmcnt(5)
  v_mul_f32 v200, v28, v200
  v_mul_f32 v201, v28, v201
  s_waitcnt vmcnt(26)
  v_mfma_f32_16x16x32_bf16 v[132:135], a[240:243], v[36:39], v[132:135]
  v_mul_f32 v202, v28, v202
  v_mul_f32 v203, v28, v203
  s_waitcnt vmcnt(25)
  v_mfma_f32_16x16x32_bf16 v[132:135], a[244:247], v[40:43], v[132:135]
  buffer_load_dwordx4 a[168:171], v3, s[4:7], s70 offen offset:3072
  s_waitcnt vmcnt(25)
  v_mfma_f32_16x16x32_bf16 v[132:135], a[248:251], v[44:47], v[132:135]
  s_waitcnt lgkmcnt(4)
  v_mul_f32 v204, v28, v204
  v_mul_f32 v205, v28, v205
  s_waitcnt vmcnt(24)
  v_mfma_f32_16x16x32_bf16 v[132:135], a[0:3], v[48:51], v[132:135]
  v_mul_f32 v206, v28, v206
  v_mul_f32 v207, v28, v207
  v_mfma_f32_16x16x32_bf16 v[136:139], a[216:219], v[52:55], 0
  ds_write_b128 v5, v[184:187] offset:0
  v_mfma_f32_16x16x32_bf16 v[136:139], a[220:223], v[56:59], v[136:139]
  s_mov_b32 s70, 237568
  buffer_load_dwordx4 a[172:175], v3, s[4:7], s70 offen offset:0
  v_mfma_f32_16x16x32_bf16 v[136:139], a[224:227], v[60:63], v[136:139]
  s_waitcnt lgkmcnt(3)
  v_mul_f32 v228, v28, v228
  v_mul_f32 v229, v28, v229
  v_mfma_f32_16x16x32_bf16 v[136:139], a[228:231], v[64:67], v[136:139]
  ds_write_b128 v5, v[188:191] offset:1024
  v_mfma_f32_16x16x32_bf16 v[136:139], a[232:235], v[68:71], v[136:139]
  v_mul_f32 v230, v28, v230
  v_mul_f32 v231, v28, v231
  v_mfma_f32_16x16x32_bf16 v[140:143], a[236:239], v[52:55], 0
  buffer_load_dwordx4 a[176:179], v3, s[4:7], s70 offen offset:1024
  v_mfma_f32_16x16x32_bf16 v[140:143], a[240:243], v[56:59], v[140:143]
  ds_write_b128 v6, v[192:195] offset:0
  v_mfma_f32_16x16x32_bf16 v[140:143], a[244:247], v[60:63], v[140:143]
  s_waitcnt lgkmcnt(4)
  v_mul_f32 v232, v28, v232
  v_mul_f32 v233, v28, v233
  v_mfma_f32_16x16x32_bf16 v[140:143], a[248:251], v[64:67], v[140:143]
  v_mul_f32 v234, v28, v234
  v_mul_f32 v235, v28, v235
  v_mfma_f32_16x16x32_bf16 v[140:143], a[0:3], v[68:71], v[140:143]
  buffer_load_dwordx4 a[180:183], v3, s[4:7], s70 offen offset:2048
  v_mfma_f32_16x16x32_bf16 v[144:147], a[216:219], v[72:75], 0
  ds_write_b128 v6, v[196:199] offset:1024
  v_mfma_f32_16x16x32_bf16 v[144:147], a[220:223], v[76:79], v[144:147]
  ds_read_b128 a[96:99], v251 offset:6144
  v_mfma_f32_16x16x32_bf16 v[144:147], a[224:227], v[80:83], v[144:147]
  ds_read_b128 a[100:103], v251 offset:7168
  v_mfma_f32_16x16x32_bf16 v[144:147], a[228:231], v[84:87], v[144:147]
  buffer_load_dwordx4 a[184:187], v3, s[4:7], s70 offen offset:3072
  v_mfma_f32_16x16x32_bf16 v[144:147], a[232:235], v[88:91], v[144:147]
  ds_write_b128 v4, v[128:131] offset:2048
  v_mfma_f32_16x16x32_bf16 v[148:151], a[236:239], v[72:75], 0
  ds_read_b128 a[104:107], v251 offset:8192
  v_mfma_f32_16x16x32_bf16 v[148:151], a[240:243], v[76:79], v[148:151]
  v_mfma_f32_16x16x32_bf16 v[148:151], a[244:247], v[80:83], v[148:151]
  buffer_load_dwordx4 v[112:115], v1, s[4:7], s36 offen offset:0 sc1
  v_mfma_f32_16x16x32_bf16 v[148:151], a[248:251], v[84:87], v[148:151]
  ds_write_b128 v4, v[132:135] offset:3072
  v_mfma_f32_16x16x32_bf16 v[148:151], a[0:3], v[88:91], v[148:151]
  s_waitcnt lgkmcnt(5)
  s_barrier
  v_mfma_f32_16x16x32_bf16 v[200:203], a[216:219], v[92:95], v[200:203]
  s_mov_b32 s70, 241664
  buffer_load_dwordx4 a[188:191], v3, s[4:7], s70 offen offset:0
  v_mfma_f32_16x16x32_bf16 v[200:203], a[220:223], v[96:99], v[200:203]
  ds_write_b128 v5, v[136:139] offset:2048
  v_mfma_f32_16x16x32_bf16 v[200:203], a[224:227], v[100:103], v[200:203]
  ds_read_b128 v[176:179], v7 offset:0
  v_mfma_f32_16x16x32_bf16 v[200:203], a[228:231], v[104:107], v[200:203]
  ds_read_b128 v[184:187], v7 offset:5120
  v_mfma_f32_16x16x32_bf16 v[200:203], a[232:235], v[108:111], v[200:203]
  buffer_load_dwordx4 a[192:195], v3, s[4:7], s70 offen offset:1024
  v_mfma_f32_16x16x32_bf16 v[204:207], a[236:239], v[92:95], v[204:207]
  ds_write_b128 v5, v[140:143] offset:3072
  v_mfma_f32_16x16x32_bf16 v[204:207], a[240:243], v[96:99], v[204:207]
  ds_read_b128 v[192:195], v7 offset:10240
  v_mfma_f32_16x16x32_bf16 v[204:207], a[244:247], v[100:103], v[204:207]
  ds_read_b128 v[180:183], v7 offset:1024
  v_mfma_f32_16x16x32_bf16 v[204:207], a[248:251], v[104:107], v[204:207]
  buffer_load_dwordx4 a[196:199], v3, s[4:7], s70 offen offset:2048
  v_mfma_f32_16x16x32_bf16 v[204:207], a[0:3], v[108:111], v[204:207]
  ds_write_b128 v6, v[144:147] offset:2048
  s_waitcnt vmcnt(31)
  v_mfma_f32_16x16x32_bf16 v[152:155], a[4:7], v[32:35], 0
  ds_read_b128 v[188:191], v7 offset:6144
  s_waitcnt vmcnt(29)
  v_mfma_f32_16x16x32_bf16 v[152:155], a[8:11], v[36:39], v[152:155]
  ds_read_b128 v[196:199], v7 offset:11264
  s_waitcnt lgkmcnt(6)
  v_add_f32 v176, v176, v184
  s_waitcnt vmcnt(28)
  v_mfma_f32_16x16x32_bf16 v[152:155], a[12:15], v[40:43], v[152:155]
  buffer_load_dwordx4 a[200:203], v3, s[4:7], s70 offen offset:3072
  s_waitcnt vmcnt(28)
  v_mfma_f32_16x16x32_bf16 v[152:155], a[16:19], v[44:47], v[152:155]
  ds_write_b128 v6, v[148:151] offset:3072
  s_waitcnt vmcnt(27)
  v_mfma_f32_16x16x32_bf16 v[152:155], a[20:23], v[48:51], v[152:155]
  v_add_f32 v177, v177, v185
  v_add_f32 v178, v178, v186
  v_mfma_f32_16x16x32_bf16 v[156:159], a[24:27], v[32:35], 0
  v_add_f32 v179, v179, v187
  s_waitcnt lgkmcnt(5)
  v_add_f32 v236, v236, v192
  v_mfma_f32_16x16x32_bf16 v[156:159], a[28:31], v[36:39], v[156:159]
  s_mov_b32 s70, 245760
  buffer_load_dwordx4 a[204:207], v3, s[4:7], s70 offen offset:0
  v_mfma_f32_16x16x32_bf16 v[156:159], a[32:35], v[40:43], v[156:159]
  v_add_f32 v237, v237, v193
  v_add_f32 v238, v238, v194
  v_mfma_f32_16x16x32_bf16 v[156:159], a[36:39], v[44:47], v[156:159]
  v_add_f32 v239, v239, v195
  v_add_f32 v236, v236, v176
  v_mfma_f32_16x16x32_bf16 v[156:159], a[40:43], v[48:51], v[156:159]
  s_waitcnt lgkmcnt(2)
  v_add_f32 v180, v180, v188
  v_add_f32 v181, v181, v189
  v_mfma_f32_16x16x32_bf16 v[160:163], a[4:7], v[52:55], 0
  v_add_f32 v182, v182, v190
  buffer_load_dwordx4 v[116:119], v1, s[4:7], s36 offen offset:1024 sc1
  v_mfma_f32_16x16x32_bf16 v[160:163], a[8:11], v[56:59], v[160:163]
  v_add_f32 v183, v183, v191
  s_waitcnt lgkmcnt(1)
  v_add_f32 v240, v240, v196
  v_mfma_f32_16x16x32_bf16 v[160:163], a[12:15], v[60:63], v[160:163]
  v_add_f32 v241, v241, v197
  v_add_f32 v242, v242, v198
  v_mfma_f32_16x16x32_bf16 v[160:163], a[16:19], v[64:67], v[160:163]
  s_waitcnt lgkmcnt(0)
  s_barrier
  v_mfma_f32_16x16x32_bf16 v[160:163], a[20:23], v[68:71], v[160:163]
  buffer_load_dwordx4 v[120:123], v1, s[4:7], s37 offen offset:2048 sc1
  v_mfma_f32_16x16x32_bf16 v[164:167], a[24:27], v[52:55], 0
  v_add_f32 v243, v243, v199
  v_add_f32 v237, v237, v177
  v_mfma_f32_16x16x32_bf16 v[164:167], a[28:31], v[56:59], v[164:167]
  v_add_f32 v238, v238, v178
  v_add_f32 v239, v239, v179
  v_mfma_f32_16x16x32_bf16 v[164:167], a[32:35], v[60:63], v[164:167]
  v_add_f32 v240, v240, v180
  v_add_f32 v241, v241, v181
  v_mfma_f32_16x16x32_bf16 v[164:167], a[36:39], v[64:67], v[164:167]
  v_add_f32 v242, v242, v182
  v_add_f32 v243, v243, v183
  v_pk_mul_f32 v[192:193], v[236:237], v[236:237]
  v_pk_fma_f32 v[192:193], v[192:193], v[250:251], v[248:249] op_sel_hi:[1,0,0]
  v_pk_mul_f32 v[192:193], v[192:193], v[236:237]
  v_pk_mul_f32 v[194:195], v[238:239], v[238:239]
  v_pk_fma_f32 v[194:195], v[194:195], v[250:251], v[248:249] op_sel_hi:[1,0,0]
  v_pk_mul_f32 v[194:195], v[194:195], v[238:239]
  v_pk_mul_f32 v[196:197], v[240:241], v[240:241]
  v_pk_fma_f32 v[196:197], v[196:197], v[250:251], v[248:249] op_sel_hi:[1,0,0]
  v_pk_mul_f32 v[196:197], v[196:197], v[240:241]
  v_pk_mul_f32 v[198:199], v[242:243], v[242:243]
  v_pk_fma_f32 v[198:199], v[198:199], v[250:251], v[248:249] op_sel_hi:[1,0,0]
  v_pk_mul_f32 v[198:199], v[198:199], v[242:243]
  buffer_load_dwordx4 v[124:127], v1, s[4:7], s37 offen offset:3072 sc1
  v_mfma_f32_16x16x32_bf16 v[164:167], a[40:43], v[68:71], v[164:167]
  ds_read_b128 v[128:131], v7 offset:2048
  v_mfma_f32_16x16x32_bf16 v[168:171], a[4:7], v[72:75], 0
  ds_read_b128 v[136:139], v7 offset:7168
  v_mfma_f32_16x16x32_bf16 v[168:171], a[8:11], v[76:79], v[168:171]
  ds_read_b128 v[144:147], v7 offset:12288
  v_mfma_f32_16x16x32_bf16 v[168:171], a[12:15], v[80:83], v[168:171]
  ds_read_b128 v[132:135], v7 offset:3072
  v_mfma_f32_16x16x32_bf16 v[168:171], a[16:19], v[84:87], v[168:171]
  buffer_load_dwordx4 a[208:211], v3, s[4:7], s70 offen offset:1024
  ds_read_b128 v[140:143], v7 offset:8192
  v_exp_f32 v192, v192
  v_exp_f32 v193, v193
  ds_read_b128 v[148:151], v7 offset:13312
  v_exp_f32 v194, v194
  v_exp_f32 v195, v195
  v_exp_f32 v196, v196
  v_exp_f32 v197, v197
  v_exp_f32 v198, v198
  v_exp_f32 v199, v199
  v_mfma_f32_16x16x32_bf16 v[168:171], a[20:23], v[88:91], v[168:171]
  buffer_load_dwordx4 a[212:215], v3, s[4:7], s70 offen offset:2048
  v_fma_f32 v192, v192, v252, v252
  v_fma_f32 v193, v193, v252, v252
  v_fma_f32 v194, v194, v252, v252
  v_fma_f32 v195, v195, v252, v252
  v_fma_f32 v196, v196, v252, v252
  v_fma_f32 v197, v197, v252, v252
  v_fma_f32 v198, v198, v252, v252
  v_fma_f32 v199, v199, v252, v252
  v_rcp_f32 v192, v192
  v_rcp_f32 v193, v193
  v_rcp_f32 v194, v194
  v_rcp_f32 v195, v195
  v_rcp_f32 v196, v196
  buffer_load_dwordx4 a[216:219], v3, s[4:7], s70 offen offset:3072
  v_rcp_f32 v197, v197
  v_rcp_f32 v198, v198
  v_rcp_f32 v199, v199
  v_mul_f32 v236, v236, v192
  v_mul_f32 v237, v237, v193
  v_mfma_f32_16x16x32_bf16 v[172:175], a[24:27], v[72:75], 0
  v_cvt_pk_bf16_f32 v244, v236, v237
  v_mul_f32 v238, v238, v194
  v_mul_f32 v239, v239, v195
  v_mul_f32 v240, v240, v196
  v_mul_f32 v241, v241, v197
  v_mul_f32 v242, v242, v198
  v_mul_f32 v243, v243, v199
  v_bitop3_b32 v244, v244, v14, v14 bitop3:0x30
  s_mov_b32 s70, 249856
  buffer_load_dwordx4 a[220:223], v3, s[4:7], s70 offen offset:0
  v_cvt_pk_bf16_f32 v245, v238, v239
  v_cvt_pk_bf16_f32 v246, v240, v241
  v_cvt_pk_bf16_f32 v247, v242, v243
  v_mfma_f32_16x16x32_bf16 v[172:175], a[28:31], v[76:79], v[172:175]
  buffer_store_dwordx4 v[244:247], v1, s[4:7], s52 offen offset:2048 sc1
  v_mfma_f32_16x16x32_bf16 v[172:175], a[32:35], v[80:83], v[172:175]
  s_waitcnt lgkmcnt(4)
  v_add_f32 v128, v128, v136
  v_add_f32 v129, v129, v137
  v_mfma_f32_16x16x32_bf16 v[172:175], a[36:39], v[84:87], v[172:175]
  v_add_f32 v130, v130, v138
  v_add_f32 v131, v131, v139
  v_mfma_f32_16x16x32_bf16 v[172:175], a[40:43], v[88:91], v[172:175]
  s_waitcnt lgkmcnt(3)
  v_add_f32 v200, v200, v144
  v_add_f32 v201, v201, v145
  v_mfma_f32_16x16x32_bf16 v[228:231], a[4:7], v[92:95], v[228:231]
  buffer_load_dwordx4 a[224:227], v3, s[4:7], s70 offen offset:1024
  v_add_f32 v202, v202, v146
  v_add_f32 v203, v203, v147
  s_waitcnt lgkmcnt(1)
  v_add_f32 v132, v132, v140
  v_add_f32 v133, v133, v141
  v_add_f32 v134, v134, v142
  v_add_f32 v135, v135, v143
  s_waitcnt lgkmcnt(0)
  v_add_f32 v204, v204, v148
  v_add_f32 v205, v205, v149
  v_add_f32 v206, v206, v150
  v_add_f32 v207, v207, v151
  v_add_f32 v200, v200, v128
  v_add_f32 v201, v201, v129
  v_add_f32 v202, v202, v130
  v_add_f32 v203, v203, v131
  v_add_f32 v204, v204, v132
  v_add_f32 v205, v205, v133
  v_add_f32 v206, v206, v134
  v_add_f32 v207, v207, v135
  v_pk_mul_f32 v[144:145], v[200:201], v[200:201]
  v_pk_fma_f32 v[144:145], v[144:145], v[250:251], v[248:249] op_sel_hi:[1,0,0]
  v_pk_mul_f32 v[144:145], v[144:145], v[200:201]
  v_pk_mul_f32 v[146:147], v[202:203], v[202:203]
  v_pk_fma_f32 v[146:147], v[146:147], v[250:251], v[248:249] op_sel_hi:[1,0,0]
  v_pk_mul_f32 v[146:147], v[146:147], v[202:203]
  v_pk_mul_f32 v[148:149], v[204:205], v[204:205]
  v_pk_fma_f32 v[148:149], v[148:149], v[250:251], v[248:249] op_sel_hi:[1,0,0]
  v_pk_mul_f32 v[148:149], v[148:149], v[204:205]
  v_pk_mul_f32 v[150:151], v[206:207], v[206:207]
  v_pk_fma_f32 v[150:151], v[150:151], v[250:251], v[248:249] op_sel_hi:[1,0,0]
  v_pk_mul_f32 v[150:151], v[150:151], v[206:207]
  buffer_load_dwordx4 a[228:231], v3, s[4:7], s70 offen offset:2048
  v_mfma_f32_16x16x32_bf16 v[228:231], a[8:11], v[96:99], v[228:231]
  v_exp_f32 v144, v144
  v_mfma_f32_16x16x32_bf16 v[228:231], a[12:15], v[100:103], v[228:231]
  v_exp_f32 v145, v145
  v_mfma_f32_16x16x32_bf16 v[228:231], a[16:19], v[104:107], v[228:231]
  v_exp_f32 v146, v146
  v_mfma_f32_16x16x32_bf16 v[228:231], a[20:23], v[108:111], v[228:231]
  v_exp_f32 v147, v147
  v_exp_f32 v148, v148
  v_exp_f32 v149, v149
  buffer_load_dwordx4 a[232:235], v3, s[4:7], s70 offen offset:3072
  v_exp_f32 v150, v150
  v_exp_f32 v151, v151
  v_fma_f32 v144, v144, v252, v252
  v_fma_f32 v145, v145, v252, v252
  v_fma_f32 v146, v146, v252, v252
  v_fma_f32 v147, v147, v252, v252
  v_fma_f32 v148, v148, v252, v252
  v_fma_f32 v149, v149, v252, v252
  v_fma_f32 v150, v150, v252, v252
  v_fma_f32 v151, v151, v252, v252
  v_rcp_f32 v144, v144
  v_rcp_f32 v145, v145
  v_mfma_f32_16x16x32_bf16 v[232:235], a[24:27], v[92:95], v[232:235]
  s_mov_b32 s70, 253952
  buffer_load_dwordx4 a[236:239], v3, s[4:7], s70 offen offset:0
  v_rcp_f32 v146, v146
  v_rcp_f32 v147, v147
  v_rcp_f32 v148, v148
  v_rcp_f32 v149, v149
  v_rcp_f32 v150, v150
  v_rcp_f32 v151, v151
  v_mul_f32 v200, v200, v144
  v_mul_f32 v201, v201, v145
  v_cvt_pk_bf16_f32 v244, v200, v201
  v_mul_f32 v202, v202, v146
  v_mul_f32 v203, v203, v147
  v_mul_f32 v204, v204, v148
  buffer_load_dwordx4 a[240:243], v3, s[4:7], s70 offen offset:1024
  v_mul_f32 v205, v205, v149
  v_mul_f32 v206, v206, v150
  v_mul_f32 v207, v207, v151
  v_bitop3_b32 v244, v244, v14, v14 bitop3:0x30
  v_cvt_pk_bf16_f32 v245, v202, v203
  v_cvt_pk_bf16_f32 v246, v204, v205
  v_cvt_pk_bf16_f32 v247, v206, v207
  v_mfma_f32_16x16x32_bf16 v[232:235], a[28:31], v[96:99], v[232:235]
  buffer_store_dwordx4 v[244:247], v1, s[4:7], s52 offen offset:3072 sc1
  v_mfma_f32_16x16x32_bf16 v[232:235], a[32:35], v[100:103], v[232:235]
  ds_read_b128 v[236:239], v13 offset:160
  v_mfma_f32_16x16x32_bf16 v[232:235], a[36:39], v[104:107], v[232:235]
  ds_read_b128 v[240:243], v13 offset:176
  v_mfma_f32_16x16x32_bf16 v[232:235], a[40:43], v[108:111], v[232:235]
  ds_write_b128 v4, v[152:155] offset:0
  v_mfma_f32_16x16x32_bf16 v[176:179], a[44:47], v[32:35], 0
  buffer_load_dwordx4 a[244:247], v3, s[4:7], s70 offen offset:2048
  v_mfma_f32_16x16x32_bf16 v[176:179], a[48:51], v[36:39], v[176:179]
  s_waitcnt vmcnt(13)
  v_bitop3_b32 v27, v112, v116, v120 bitop3:0xfe
  v_mfma_f32_16x16x32_bf16 v[176:179], a[52:55], v[40:43], v[176:179]
  ds_write_b128 v4, v[156:159] offset:1024
  v_mfma_f32_16x16x32_bf16 v[176:179], a[56:59], v[44:47], v[176:179]
  s_waitcnt vmcnt(12)
  v_bitop3_b32 v27, v27, v124, v14 bitop3:0xa8
  v_mfma_f32_16x16x32_bf16 v[176:179], a[60:63], v[48:51], v[176:179]
  buffer_load_dwordx4 a[248:251], v3, s[4:7], s70 offen offset:3072
  v_mfma_f32_16x16x32_bf16 v[180:183], a[64:67], v[32:35], 0
  ds_write_b128 v5, v[160:163] offset:0
  v_mfma_f32_16x16x32_bf16 v[180:183], a[68:71], v[36:39], v[180:183]
  s_waitcnt lgkmcnt(4)
  v_mul_f32 v236, v28, v236
  v_mul_f32 v237, v28, v237
  v_mfma_f32_16x16x32_bf16 v[180:183], a[72:75], v[40:43], v[180:183]
  v_mul_f32 v238, v28, v238
  v_mul_f32 v239, v28, v239
  buffer_load_dwordx4 v[32:35], v1, s[4:7], s39 offen offset:0 sc1
  v_mfma_f32_16x16x32_bf16 v[180:183], a[76:79], v[44:47], v[180:183]
  s_waitcnt lgkmcnt(3)
  v_mul_f32 v240, v28, v240
  v_mul_f32 v241, v28, v241
  v_mfma_f32_16x16x32_bf16 v[180:183], a[80:83], v[48:51], v[180:183]
  v_mul_f32 v242, v28, v242
  v_mul_f32 v243, v28, v243
  v_mfma_f32_16x16x32_bf16 v[184:187], a[44:47], v[52:55], 0
  ds_write_b128 v5, v[164:167] offset:1024
  v_mfma_f32_16x16x32_bf16 v[184:187], a[48:51], v[56:59], v[184:187]
  buffer_load_dwordx4 v[36:39], v1, s[4:7], s39 offen offset:1024 sc1
  v_mfma_f32_16x16x32_bf16 v[184:187], a[52:55], v[60:63], v[184:187]
  v_cmp_ne_u32 vcc, 0, v27
  v_mfma_f32_16x16x32_bf16 v[184:187], a[56:59], v[64:67], v[184:187]
  ds_write_b128 v6, v[168:171] offset:0
  v_mfma_f32_16x16x32_bf16 v[184:187], a[60:63], v[68:71], v[184:187]
  s_cbranch_vccnz L_retry_99
L_ok_100:
  v_mfma_f32_16x16x32_bf16 v[188:191], a[64:67], v[52:55], 0
  buffer_load_dwordx4 v[40:43], v1, s[4:7], s40 offen offset:2048 sc1
  v_mfma_f32_16x16x32_bf16 v[188:191], a[68:71], v[56:59], v[188:191]
  ds_write_b128 v6, v[172:175] offset:1024
  v_mfma_f32_16x16x32_bf16 v[188:191], a[72:75], v[60:63], v[188:191]
  v_mfma_f32_16x16x32_bf16 v[188:191], a[76:79], v[64:67], v[188:191]
  v_mfma_f32_16x16x32_bf16 v[188:191], a[80:83], v[68:71], v[188:191]
  buffer_load_dwordx4 v[44:47], v1, s[4:7], s40 offen offset:3072 sc1
  v_mfma_f32_16x16x32_bf16 v[192:195], a[44:47], v[72:75], 0
  v_mfma_f32_16x16x32_bf16 v[192:195], a[48:51], v[76:79], v[192:195]
  v_mfma_f32_16x16x32_bf16 v[192:195], a[52:55], v[80:83], v[192:195]
  v_mfma_f32_16x16x32_bf16 v[192:195], a[56:59], v[84:87], v[192:195]
  buffer_load_dwordx4 v[48:51], v1, s[4:7], s42 offen offset:0 sc1
  v_mfma_f32_16x16x32_bf16 v[192:195], a[60:63], v[88:91], v[192:195]
  v_mfma_f32_16x16x32_bf16 v[196:199], a[64:67], v[72:75], 0
  v_mfma_f32_16x16x32_bf16 v[196:199], a[68:71], v[76:79], v[196:199]
  s_waitcnt lgkmcnt(0)
  s_barrier
  buffer_load_dwordx4 v[52:55], v1, s[4:7], s42 offen offset:1024 sc1
  v_mfma_f32_16x16x32_bf16 v[196:199], a[72:75], v[80:83], v[196:199]
  ds_read_b128 v[152:155], v7 offset:0
  v_mfma_f32_16x16x32_bf16 v[196:199], a[76:79], v[84:87], v[196:199]
  ds_read_b128 v[160:163], v7 offset:5120
  v_mfma_f32_16x16x32_bf16 v[196:199], a[80:83], v[88:91], v[196:199]
  ds_read_b128 v[168:171], v7 offset:10240
  v_mfma_f32_16x16x32_bf16 v[236:239], a[44:47], v[92:95], v[236:239]
  ds_read_b128 v[156:159], v7 offset:1024
  buffer_load_dwordx4 v[56:59], v1, s[4:7], s43 offen offset:2048 sc1
  v_mfma_f32_16x16x32_bf16 v[236:239], a[48:51], v[96:99], v[236:239]
  ds_read_b128 v[164:167], v7 offset:6144
  v_mfma_f32_16x16x32_bf16 v[236:239], a[52:55], v[100:103], v[236:239]
  ds_read_b128 v[172:175], v7 offset:11264
  v_mfma_f32_16x16x32_bf16 v[236:239], a[56:59], v[104:107], v[236:239]
  ds_write_b128 v4, v[176:179] offset:2048
  v_mfma_f32_16x16x32_bf16 v[236:239], a[60:63], v[108:111], v[236:239]
  buffer_load_dwordx4 v[60:63], v1, s[4:7], s43 offen offset:3072 sc1
  v_mfma_f32_16x16x32_bf16 v[240:243], a[64:67], v[92:95], v[240:243]
  v_mfma_f32_16x16x32_bf16 v[240:243], a[68:71], v[96:99], v[240:243]
  ds_write_b128 v4, v[180:183] offset:3072
  v_mfma_f32_16x16x32_bf16 v[240:243], a[72:75], v[100:103], v[240:243]
  s_waitcnt lgkmcnt(6)
  v_add_f32 v152, v152, v160
  v_add_f32 v153, v153, v161
  v_mfma_f32_16x16x32_bf16 v[240:243], a[76:79], v[104:107], v[240:243]
  buffer_load_dwordx4 v[64:67], v1, s[4:7], s45 offen offset:0 sc1
  v_mfma_f32_16x16x32_bf16 v[240:243], a[80:83], v[108:111], v[240:243]
  ds_write_b128 v5, v[184:187] offset:2048
  v_mfma_f32_16x16x32_bf16 v[128:131], a[84:87], v[112:115], 0
  v_add_f32 v154, v154, v162
  v_add_f32 v155, v155, v163
  v_mfma_f32_16x16x32_bf16 v[128:131], a[88:91], v[116:119], v[128:131]
  s_waitcnt lgkmcnt(6)
  v_add_f32 v228, v228, v168
  v_add_f32 v229, v229, v169
  v_mfma_f32_16x16x32_bf16 v[128:131], a[92:95], v[120:123], v[128:131]
  buffer_load_dwordx4 v[68:71], v1, s[4:7], s45 offen offset:1024 sc1
  v_mfma_f32_16x16x32_bf16 v[128:131], a[96:99], v[124:127], v[128:131]
  ds_write_b128 v5, v[188:191] offset:3072
  v_mfma_f32_16x16x32_bf16 v[132:135], a[100:103], v[112:115], 0
  v_add_f32 v230, v230, v170
  v_add_f32 v231, v231, v171
  v_mfma_f32_16x16x32_bf16 v[132:135], a[104:107], v[116:119], v[132:135]
  s_waitcnt lgkmcnt(5)
  v_add_f32 v156, v156, v164
  v_add_f32 v157, v157, v165
  v_mfma_f32_16x16x32_bf16 v[132:135], a[108:111], v[120:123], v[132:135]
  buffer_load_dwordx4 v[72:75], v1, s[4:7], s46 offen offset:2048 sc1
  v_mfma_f32_16x16x32_bf16 v[132:135], a[112:115], v[124:127], v[132:135]
  ds_write_b128 v6, v[192:195] offset:2048
  v_mfma_f32_16x16x32_bf16 v[136:139], a[116:119], v[112:115], 0
  v_add_f32 v158, v158, v166
  v_add_f32 v159, v159, v167
  v_mfma_f32_16x16x32_bf16 v[136:139], a[120:123], v[116:119], v[136:139]
  s_waitcnt lgkmcnt(5)
  v_add_f32 v232, v232, v172
  v_add_f32 v233, v233, v173
  ds_write_b128 v6, v[196:199] offset:3072
  buffer_load_dwordx4 v[76:79], v1, s[4:7], s46 offen offset:3072 sc1
  v_mfma_f32_16x16x32_bf16 v[136:139], a[124:127], v[120:123], v[136:139]
  v_add_f32 v234, v234, v174
  v_add_f32 v235, v235, v175
  v_mfma_f32_16x16x32_bf16 v[136:139], a[128:131], v[124:127], v[136:139]
  v_add_f32 v228, v228, v152
  v_add_f32 v229, v229, v153
  v_mfma_f32_16x16x32_bf16 v[140:143], a[132:135], v[112:115], 0
  v_add_f32 v230, v230, v154
  v_add_f32 v231, v231, v155
  v_mfma_f32_16x16x32_bf16 v[140:143], a[136:139], v[116:119], v[140:143]
  v_add_f32 v232, v232, v156
  v_add_f32 v233, v233, v157
  v_mfma_f32_16x16x32_bf16 v[140:143], a[140:143], v[120:123], v[140:143]
  buffer_load_dwordx4 v[80:83], v1, s[4:7], s36 offen offset:2048 sc1
  v_mfma_f32_16x16x32_bf16 v[140:143], a[144:147], v[124:127], v[140:143]
  v_add_f32 v234, v234, v158
  v_add_f32 v235, v235, v159
  v_pk_mul_f32 v[168:169], v[228:229], v[228:229]
  v_pk_fma_f32 v[168:169], v[168:169], v[250:251], v[248:249] op_sel_hi:[1,0,0]
  v_pk_mul_f32 v[168:169], v[168:169], v[228:229]
  v_pk_mul_f32 v[170:171], v[230:231], v[230:231]
  v_pk_fma_f32 v[170:171], v[170:171], v[250:251], v[248:249] op_sel_hi:[1,0,0]
  v_pk_mul_f32 v[170:171], v[170:171], v[230:231]
  v_pk_mul_f32 v[172:173], v[232:233], v[232:233]
  v_pk_fma_f32 v[172:173], v[172:173], v[250:251], v[248:249] op_sel_hi:[1,0,0]
  v_pk_mul_f32 v[172:173], v[172:173], v[232:233]
  v_pk_mul_f32 v[174:175], v[234:235], v[234:235]
  v_pk_fma_f32 v[174:175], v[174:175], v[250:251], v[248:249] op_sel_hi:[1,0,0]
  v_pk_mul_f32 v[174:175], v[174:175], v[234:235]
  buffer_load_dwordx4 v[84:87], v1, s[4:7], s36 offen offset:3072 sc1
  v_mfma_f32_16x16x32_bf16 v[144:147], a[148:151], v[112:115], 0
  s_waitcnt lgkmcnt(0)
  s_barrier
  v_mfma_f32_16x16x32_bf16 v[144:147], a[152:155], v[116:119], v[144:147]
  s_waitcnt vmcnt(11)
  v_bitop3_b32 v27, v32, v36, v40 bitop3:0xfe
  v_mfma_f32_16x16x32_bf16 v[144:147], a[156:159], v[120:123], v[144:147]
  v_exp_f32 v168, v168
  v_mfma_f32_16x16x32_bf16 v[144:147], a[160:163], v[124:127], v[144:147]
  buffer_load_dwordx4 v[88:91], v1, s[4:7], s38 offen offset:0 sc1
  v_exp_f32 v169, v169
  v_exp_f32 v170, v170
  v_exp_f32 v171, v171
  v_exp_f32 v172, v172
  v_exp_f32 v173, v173
  s_waitcnt vmcnt(11)
  v_bitop3_b32 v27, v27, v44, v14 bitop3:0xa8
  v_cmp_ne_u32 vcc, 0, v27
  v_exp_f32 v174, v174
  s_cbranch_vccnz L_retry_101
L_ok_102:
  v_mfma_f32_16x16x32_bf16 v[148:151], a[84:87], v[32:35], 0
  buffer_load_dwordx4 v[92:95], v1, s[4:7], s38 offen offset:1024 sc1
  v_exp_f32 v175, v175
  ds_read_b128 v[176:179], v7 offset:2048
  v_fma_f32 v168, v168, v252, v252
  v_fma_f32 v169, v169, v252, v252
  v_fma_f32 v170, v170, v252, v252
  ds_read_b128 v[184:187], v7 offset:7168
  v_fma_f32 v171, v171, v252, v252
  v_fma_f32 v172, v172, v252, v252
  v_fma_f32 v173, v173, v252, v252
  ds_read_b128 v[192:195], v7 offset:12288
  v_fma_f32 v174, v174, v252, v252
  v_fma_f32 v175, v175, v252, v252
  v_rcp_f32 v168, v168
  ds_read_b128 v[180:183], v7 offset:3072
  v_rcp_f32 v169, v169
  buffer_load_dwordx4 v[96:99], v1, s[4:7], s39 offen offset:2048 sc1
  ds_read_b128 v[188:191], v7 offset:8192
  v_mfma_f32_16x16x32_bf16 v[148:151], a[88:91], v[36:39], v[148:151]
  v_rcp_f32 v170, v170
  ds_read_b128 v[196:199], v7 offset:13312
  v_rcp_f32 v171, v171
  v_rcp_f32 v172, v172
  v_rcp_f32 v173, v173
  v_rcp_f32 v174, v174
  v_rcp_f32 v175, v175
  v_mul_f32 v228, v228, v168
  v_mul_f32 v229, v229, v169
  v_cvt_pk_bf16_f32 v244, v228, v229
  buffer_load_dwordx4 v[100:103], v1, s[4:7], s39 offen offset:3072 sc1
  v_mul_f32 v230, v230, v170
  v_mul_f32 v231, v231, v171
  v_mul_f32 v232, v232, v172
  v_mul_f32 v233, v233, v173
  v_mul_f32 v234, v234, v174
  v_mul_f32 v235, v235, v175
  v_bitop3_b32 v244, v244, v14, v14 bitop3:0x30
  v_cvt_pk_bf16_f32 v245, v230, v231
  v_cvt_pk_bf16_f32 v246, v232, v233
  v_cvt_pk_bf16_f32 v247, v234, v235
  v_mfma_f32_16x16x32_bf16 v[148:151], a[92:95], v[40:43], v[148:151]
  buffer_store_dwordx4 v[244:247], v1, s[4:7], s53 offen offset:0 sc1
  v_mfma_f32_16x16x32_bf16 v[148:151], a[96:99], v[44:47], v[148:151]
  s_waitcnt lgkmcnt(4)
  v_add_f32 v176, v176, v184
  v_add_f32 v177, v177, v185
  v_mfma_f32_16x16x32_bf16 v[152:155], a[100:103], v[32:35], 0
  s_waitcnt lgkmcnt(3)
  v_add_f32 v236, v236, v192
  v_add_f32 v237, v237, v193
  v_mfma_f32_16x16x32_bf16 v[152:155], a[104:107], v[36:39], v[152:155]
  v_add_f32 v236, v236, v176
  v_add_f32 v237, v237, v177
  v_mfma_f32_16x16x32_bf16 v[152:155], a[108:111], v[40:43], v[152:155]
  buffer_load_dwordx4 v[104:107], v1, s[4:7], s41 offen offset:0 sc1
  v_mfma_f32_16x16x32_bf16 v[152:155], a[112:115], v[44:47], v[152:155]
  v_add_f32 v178, v178, v186
  v_add_f32 v179, v179, v187
  v_mfma_f32_16x16x32_bf16 v[156:159], a[116:119], v[32:35], 0
  v_add_f32 v238, v238, v194
  v_add_f32 v239, v239, v195
  v_mfma_f32_16x16x32_bf16 v[156:159], a[120:123], v[36:39], v[156:159]
  s_waitcnt lgkmcnt(1)
  v_add_f32 v180, v180, v188
  v_add_f32 v181, v181, v189
  v_add_f32 v182, v182, v190
  v_add_f32 v183, v183, v191
  s_waitcnt lgkmcnt(0)
  v_add_f32 v240, v240, v196
  v_add_f32 v241, v241, v197
  v_add_f32 v242, v242, v198
  v_add_f32 v243, v243, v199
  v_mfma_f32_16x16x32_bf16 v[156:159], a[124:127], v[40:43], v[156:159]
  buffer_load_dwordx4 v[108:111], v1, s[4:7], s41 offen offset:1024 sc1
  v_mul_f32 v192, v236, v236
  v_mul_f32 v193, v237, v237
  v_add_f32 v238, v238, v178
  v_add_f32 v239, v239, v179
  v_add_f32 v240, v240, v180
  v_add_f32 v241, v241, v181
  v_add_f32 v242, v242, v182
  v_add_f32 v243, v243, v183
  v_fma_f32 v192, v192, v250, v248
  v_fma_f32 v193, v193, v250, v248
  v_mul_f32 v194, v238, v238
  v_mul_f32 v195, v239, v239
  v_mul_f32 v196, v240, v240
  v_mul_f32 v197, v241, v241
  v_mul_f32 v198, v242, v242
  v_mul_f32 v199, v243, v243
  v_mul_f32 v192, v192, v236
  v_mul_f32 v193, v193, v237
  v_fma_f32 v194, v194, v250, v248
  buffer_load_dwordx4 v[112:115], v1, s[4:7], s42 offen offset:2048 sc1
  v_fma_f32 v195, v195, v250, v248
  v_fma_f32 v196, v196, v250, v248
  v_fma_f32 v197, v197, v250, v248
  v_fma_f32 v198, v198, v250, v248
  v_fma_f32 v199, v199, v250, v248
  v_exp_f32 v192, v192
  v_exp_f32 v193, v193
  v_mul_f32 v194, v194, v238
  v_mul_f32 v195, v195, v239
  v_mul_f32 v196, v196, v240
  v_mul_f32 v197, v197, v241
  v_mul_f32 v198, v198, v242
  v_mul_f32 v199, v199, v243
  v_mfma_f32_16x16x32_bf16 v[156:159], a[128:131], v[44:47], v[156:159]
  buffer_load_dwordx4 v[116:119], v1, s[4:7], s42 offen offset:3072 sc1
  v_exp_f32 v194, v194
  v_exp_f32 v195, v195
  v_exp_f32 v196, v196
  v_exp_f32 v197, v197
  v_exp_f32 v198, v198
  v_exp_f32 v199, v199
  v_fma_f32 v192, v192, v252, v252
  v_fma_f32 v193, v193, v252, v252
  v_fma_f32 v194, v194, v252, v252
  v_fma_f32 v195, v195, v252, v252
  v_fma_f32 v196, v196, v252, v252
  v_fma_f32 v197, v197, v252, v252
  buffer_load_dwordx4 v[120:123], v1, s[4:7], s44 offen offset:0 sc1
  v_fma_f32 v198, v198, v252, v252
  v_fma_f32 v199, v199, v252, v252
  v_rcp_f32 v192, v192
  v_rcp_f32 v193, v193
  v_rcp_f32 v194, v194
  v_rcp_f32 v195, v195
  v_rcp_f32 v196, v196
  v_rcp_f32 v197, v197
  v_rcp_f32 v198, v198
  v_rcp_f32 v199, v199
  v_mfma_f32_16x16x32_bf16 v[160:163], a[132:135], v[32:35], 0
  buffer_load_dwordx4 v[124:127], v1, s[4:7], s44 offen offset:1024 sc1
  v_mul_f32 v236, v236, v192
  v_mul_f32 v237, v237, v193
  v_cvt_pk_bf16_f32 v244, v236, v237
  v_mul_f32 v238, v238, v194
  v_mul_f32 v239, v239, v195
  v_mul_f32 v240, v240, v196
  v_mul_f32 v241, v241, v197
  v_mul_f32 v242, v242, v198
  v_mul_f32 v243, v243, v199
  v_bitop3_b32 v244, v244, v14, v14 bitop3:0x30
  v_cvt_pk_bf16_f32 v245, v238, v239
  v_cvt_pk_bf16_f32 v246, v240, v241
  v_cvt_pk_bf16_f32 v247, v242, v243
  buffer_store_dwordx4 v[244:247], v1, s[4:7], s53 offen offset:1024 sc1
  v_mfma_f32_16x16x32_bf16 v[160:163], a[136:139], v[36:39], v[160:163]
  s_waitcnt vmcnt(19)
  v_bitop3_b32 v27, v48, v52, v56 bitop3:0xfe
  v_mfma_f32_16x16x32_bf16 v[160:163], a[140:143], v[40:43], v[160:163]
  s_waitcnt vmcnt(18)
  v_bitop3_b32 v27, v27, v60, v14 bitop3:0xa8
  v_mfma_f32_16x16x32_bf16 v[160:163], a[144:147], v[44:47], v[160:163]
  v_cmp_ne_u32 vcc, 0, v27
  v_mfma_f32_16x16x32_bf16 v[164:167], a[148:151], v[32:35], 0
  buffer_load_dwordx4 v[32:35], v1, s[4:7], s45 offen offset:2048 sc1
  v_mfma_f32_16x16x32_bf16 v[164:167], a[152:155], v[36:39], v[164:167]
  s_cbranch_vccnz L_retry_103
L_ok_104:
  v_mfma_f32_16x16x32_bf16 v[164:167], a[156:159], v[40:43], v[164:167]
  s_waitcnt vmcnt(16)
  v_bitop3_b32 v27, v64, v68, v72 bitop3:0xfe
  v_mfma_f32_16x16x32_bf16 v[164:167], a[160:163], v[44:47], v[164:167]
  s_waitcnt vmcnt(15)
  v_bitop3_b32 v27, v27, v76, v14 bitop3:0xa8
  v_mfma_f32_16x16x32_bf16 v[168:171], a[84:87], v[48:51], 0
  v_cmp_ne_u32 vcc, 0, v27
  v_mfma_f32_16x16x32_bf16 v[168:171], a[88:91], v[52:55], v[168:171]
  buffer_load_dwordx4 v[36:39], v1, s[4:7], s45 offen offset:3072 sc1
  v_mfma_f32_16x16x32_bf16 v[168:171], a[92:95], v[56:59], v[168:171]
  s_cbranch_vccnz L_retry_105
L_ok_106:
  v_mfma_f32_16x16x32_bf16 v[168:171], a[96:99], v[60:63], v[168:171]
  s_waitcnt vmcnt(13)
  v_bitop3_b32 v27, v80, v84, v88 bitop3:0xfe
  v_mfma_f32_16x16x32_bf16 v[172:175], a[100:103], v[48:51], 0
  s_waitcnt vmcnt(12)
  v_bitop3_b32 v27, v27, v92, v14 bitop3:0xa8
  v_mfma_f32_16x16x32_bf16 v[172:175], a[104:107], v[52:55], v[172:175]
  v_cmp_ne_u32 vcc, 0, v27
  v_mfma_f32_16x16x32_bf16 v[172:175], a[108:111], v[56:59], v[172:175]
  buffer_load_dwordx4 v[40:43], v1, s[4:7], s47 offen offset:0 sc1
  v_mfma_f32_16x16x32_bf16 v[172:175], a[112:115], v[60:63], v[172:175]
  s_cbranch_vccnz L_retry_107
L_ok_108:
  v_mfma_f32_16x16x32_bf16 v[176:179], a[116:119], v[48:51], 0
  s_barrier
  v_mfma_f32_16x16x32_bf16 v[176:179], a[120:123], v[52:55], v[176:179]
  buffer_load_dwordx4 v[44:47], v1, s[4:7], s47 offen offset:1024 sc1
  v_mfma_f32_16x16x32_bf16 v[176:179], a[124:127], v[56:59], v[176:179]
  v_mfma_f32_16x16x32_bf16 v[176:179], a[128:131], v[60:63], v[176:179]
  v_mfma_f32_16x16x32_bf16 v[180:183], a[132:135], v[48:51], 0
  v_mfma_f32_16x16x32_bf16 v[180:183], a[136:139], v[52:55], v[180:183]
  v_mfma_f32_16x16x32_bf16 v[180:183], a[140:143], v[56:59], v[180:183]
  s_mov_b32 s70, 258048
  buffer_load_dwordx4 a[0:3], v3, s[4:7], s70 offen offset:0
  v_mfma_f32_16x16x32_bf16 v[180:183], a[144:147], v[60:63], v[180:183]
  v_mfma_f32_16x16x32_bf16 v[184:187], a[148:151], v[48:51], 0
  s_waitcnt vmcnt(11)
  v_bitop3_b32 v27, v96, v100, v104 bitop3:0xfe
  v_mfma_f32_16x16x32_bf16 v[184:187], a[152:155], v[52:55], v[184:187]
  v_mfma_f32_16x16x32_bf16 v[184:187], a[156:159], v[56:59], v[184:187]
  v_mfma_f32_16x16x32_bf16 v[184:187], a[160:163], v[60:63], v[184:187]
  buffer_load_dwordx4 a[4:7], v3, s[4:7], s70 offen offset:1024
  v_mfma_f32_16x16x32_bf16 v[188:191], a[84:87], v[64:67], v[208:211]
  v_mfma_f32_16x16x32_bf16 v[188:191], a[88:91], v[68:71], v[188:191]
  s_waitcnt vmcnt(11)
  v_bitop3_b32 v27, v27, v108, v14 bitop3:0xa8
  v_mfma_f32_16x16x32_bf16 v[188:191], a[92:95], v[72:75], v[188:191]
  v_cmp_ne_u32 vcc, 0, v27
  v_mfma_f32_16x16x32_bf16 v[188:191], a[96:99], v[76:79], v[188:191]
  s_cbranch_vccnz L_retry_109
L_ok_110:
  v_mfma_f32_16x16x32_bf16 v[192:195], a[100:103], v[64:67], v[212:215]
  buffer_load_dwordx4 v[48:51], v1, s[4:7], s37 offen offset:0 sc1
  v_mfma_f32_16x16x32_bf16 v[192:195], a[104:107], v[68:71], v[192:195]
  v_mfma_f32_16x16x32_bf16 v[192:195], a[108:111], v[72:75], v[192:195]
  v_mfma_f32_16x16x32_bf16 v[192:195], a[112:115], v[76:79], v[192:195]
  v_mfma_f32_16x16x32_bf16 v[196:199], a[116:119], v[64:67], v[216:219]
  v_mfma_f32_16x16x32_bf16 v[196:199], a[120:123], v[68:71], v[196:199]
  buffer_load_dwordx4 a[8:11], v3, s[4:7], s70 offen offset:2048
  v_mfma_f32_16x16x32_bf16 v[196:199], a[124:127], v[72:75], v[196:199]
  v_mfma_f32_16x16x32_bf16 v[196:199], a[128:131], v[76:79], v[196:199]
  v_mfma_f32_16x16x32_bf16 v[200:203], a[132:135], v[64:67], v[220:223]
  v_mfma_f32_16x16x32_bf16 v[200:203], a[136:139], v[68:71], v[200:203]
  v_mfma_f32_16x16x32_bf16 v[200:203], a[140:143], v[72:75], v[200:203]
  buffer_load_dwordx4 a[12:15], v3, s[4:7], s70 offen offset:3072
  v_mfma_f32_16x16x32_bf16 v[200:203], a[144:147], v[76:79], v[200:203]
  v_mfma_f32_16x16x32_bf16 v[204:207], a[148:151], v[64:67], v[224:227]
  v_mfma_f32_16x16x32_bf16 v[204:207], a[152:155], v[68:71], v[204:207]
  s_waitcnt vmcnt(11)
  v_bitop3_b32 v27, v112, v116, v120 bitop3:0xfe
  v_mfma_f32_16x16x32_bf16 v[204:207], a[156:159], v[72:75], v[204:207]
  v_mfma_f32_16x16x32_bf16 v[204:207], a[160:163], v[76:79], v[204:207]
  s_mov_b32 s70, 262144
  buffer_load_dwordx4 a[16:19], v3, s[4:7], s70 offen offset:0
  v_mfma_f32_16x16x32_bf16 v[128:131], a[164:167], v[80:83], v[128:131]
  v_mfma_f32_16x16x32_bf16 v[128:131], a[168:171], v[84:87], v[128:131]
  v_mfma_f32_16x16x32_bf16 v[128:131], a[172:175], v[88:91], v[128:131]
  s_waitcnt vmcnt(11)
  v_bitop3_b32 v27, v27, v124, v14 bitop3:0xa8
  v_mfma_f32_16x16x32_bf16 v[128:131], a[176:179], v[92:95], v[128:131]
  v_cmp_ne_u32 vcc, 0, v27
  buffer_load_dwordx4 a[20:23], v3, s[4:7], s70 offen offset:1024
  v_mfma_f32_16x16x32_bf16 v[132:135], a[180:183], v[80:83], v[132:135]
  s_cbranch_vccnz L_retry_111
L_ok_112:
  v_mfma_f32_16x16x32_bf16 v[132:135], a[184:187], v[84:87], v[132:135]
  v_mfma_f32_16x16x32_bf16 v[132:135], a[188:191], v[88:91], v[132:135]
  v_mfma_f32_16x16x32_bf16 v[132:135], a[192:195], v[92:95], v[132:135]
  v_mfma_f32_16x16x32_bf16 v[136:139], a[196:199], v[80:83], v[136:139]
  buffer_load_dwordx4 a[24:27], v3, s[4:7], s70 offen offset:2048
  v_mfma_f32_16x16x32_bf16 v[136:139], a[200:203], v[84:87], v[136:139]
  v_mfma_f32_16x16x32_bf16 v[136:139], a[204:207], v[88:91], v[136:139]
  v_mfma_f32_16x16x32_bf16 v[136:139], a[208:211], v[92:95], v[136:139]
  v_mfma_f32_16x16x32_bf16 v[140:143], a[212:215], v[80:83], v[140:143]
  v_mfma_f32_16x16x32_bf16 v[140:143], a[216:219], v[84:87], v[140:143]
  buffer_load_dwordx4 a[28:31], v3, s[4:7], s70 offen offset:3072
  v_mfma_f32_16x16x32_bf16 v[140:143], a[220:223], v[88:91], v[140:143]
  v_mfma_f32_16x16x32_bf16 v[140:143], a[224:227], v[92:95], v[140:143]
  v_mfma_f32_16x16x32_bf16 v[144:147], a[228:231], v[80:83], v[144:147]
  v_mfma_f32_16x16x32_bf16 v[144:147], a[232:235], v[84:87], v[144:147]
  buffer_load_dwordx4 v[52:55], v1, s[4:7], s37 offen offset:1024 sc1
  v_mfma_f32_16x16x32_bf16 v[144:147], a[236:239], v[88:91], v[144:147]
  v_mfma_f32_16x16x32_bf16 v[144:147], a[240:243], v[92:95], v[144:147]
  v_mfma_f32_16x16x32_bf16 v[148:151], a[164:167], v[96:99], v[148:151]
  v_mfma_f32_16x16x32_bf16 v[148:151], a[168:171], v[100:103], v[148:151]
  s_waitcnt vmcnt(11)
  v_bitop3_b32 v27, v32, v36, v40 bitop3:0xfe
  v_mfma_f32_16x16x32_bf16 v[148:151], a[172:175], v[104:107], v[148:151]
  buffer_load_dwordx4 v[56:59], v1, s[4:7], s38 offen offset:2048 sc1
  v_mfma_f32_16x16x32_bf16 v[148:151], a[176:179], v[108:111], v[148:151]
  v_mfma_f32_16x16x32_bf16 v[152:155], a[180:183], v[96:99], v[152:155]
  v_mfma_f32_16x16x32_bf16 v[152:155], a[184:187], v[100:103], v[152:155]
  s_waitcnt vmcnt(11)
  v_bitop3_b32 v27, v27, v44, v14 bitop3:0xa8
  v_mfma_f32_16x16x32_bf16 v[152:155], a[188:191], v[104:107], v[152:155]
  v_cmp_ne_u32 vcc, 0, v27
  buffer_load_dwordx4 v[60:63], v1, s[4:7], s38 offen offset:3072 sc1
  v_mfma_f32_16x16x32_bf16 v[152:155], a[192:195], v[108:111], v[152:155]
  s_cbranch_vccnz L_retry_113
L_ok_114:
  v_mfma_f32_16x16x32_bf16 v[156:159], a[196:199], v[96:99], v[156:159]
  v_mfma_f32_16x16x32_bf16 v[156:159], a[200:203], v[100:103], v[156:159]
  v_mfma_f32_16x16x32_bf16 v[156:159], a[204:207], v[104:107], v[156:159]
  v_mfma_f32_16x16x32_bf16 v[156:159], a[208:211], v[108:111], v[156:159]
  s_mov_b32 s70, 266240
  buffer_load_dwordx4 a[32:35], v3, s[4:7], s70 offen offset:0
  v_mfma_f32_16x16x32_bf16 v[160:163], a[212:215], v[96:99], v[160:163]
  v_mfma_f32_16x16x32_bf16 v[160:163], a[216:219], v[100:103], v[160:163]
  v_mfma_f32_16x16x32_bf16 v[160:163], a[220:223], v[104:107], v[160:163]
  v_mfma_f32_16x16x32_bf16 v[160:163], a[224:227], v[108:111], v[160:163]
  buffer_load_dwordx4 a[36:39], v3, s[4:7], s70 offen offset:1024
  v_mfma_f32_16x16x32_bf16 v[164:167], a[228:231], v[96:99], v[164:167]
  v_mfma_f32_16x16x32_bf16 v[164:167], a[232:235], v[100:103], v[164:167]
  v_mfma_f32_16x16x32_bf16 v[164:167], a[236:239], v[104:107], v[164:167]
  v_mfma_f32_16x16x32_bf16 v[164:167], a[240:243], v[108:111], v[164:167]
  buffer_load_dwordx4 a[40:43], v3, s[4:7], s70 offen offset:2048
  v_mfma_f32_16x16x32_bf16 v[168:171], a[164:167], v[112:115], v[168:171]
  v_mfma_f32_16x16x32_bf16 v[168:171], a[168:171], v[116:119], v[168:171]
  v_mfma_f32_16x16x32_bf16 v[168:171], a[172:175], v[120:123], v[168:171]
  v_mfma_f32_16x16x32_bf16 v[168:171], a[176:179], v[124:127], v[168:171]
  buffer_load_dwordx4 a[44:47], v3, s[4:7], s70 offen offset:3072
  v_mfma_f32_16x16x32_bf16 v[172:175], a[180:183], v[112:115], v[172:175]
  v_mfma_f32_16x16x32_bf16 v[172:175], a[184:187], v[116:119], v[172:175]
  v_mfma_f32_16x16x32_bf16 v[172:175], a[188:191], v[120:123], v[172:175]
  v_mfma_f32_16x16x32_bf16 v[172:175], a[192:195], v[124:127], v[172:175]
  s_mov_b32 s70, 270336
  buffer_load_dwordx4 a[48:51], v3, s[4:7], s70 offen offset:0
  v_mfma_f32_16x16x32_bf16 v[176:179], a[196:199], v[112:115], v[176:179]
  v_mfma_f32_16x16x32_bf16 v[176:179], a[200:203], v[116:119], v[176:179]
  v_mfma_f32_16x16x32_bf16 v[176:179], a[204:207], v[120:123], v[176:179]
  v_mfma_f32_16x16x32_bf16 v[176:179], a[208:211], v[124:127], v[176:179]
  buffer_load_dwordx4 a[52:55], v3, s[4:7], s70 offen offset:1024
  v_mfma_f32_16x16x32_bf16 v[180:183], a[212:215], v[112:115], v[180:183]
  v_mfma_f32_16x16x32_bf16 v[180:183], a[216:219], v[116:119], v[180:183]
  v_mfma_f32_16x16x32_bf16 v[180:183], a[220:223], v[120:123], v[180:183]
  v_mfma_f32_16x16x32_bf16 v[180:183], a[224:227], v[124:127], v[180:183]
  buffer_load_dwordx4 a[56:59], v3, s[4:7], s70 offen offset:2048
  v_mfma_f32_16x16x32_bf16 v[184:187], a[228:231], v[112:115], v[184:187]
  v_mfma_f32_16x16x32_bf16 v[184:187], a[232:235], v[116:119], v[184:187]
  v_mfma_f32_16x16x32_bf16 v[184:187], a[236:239], v[120:123], v[184:187]
  v_and_b32 v120, 7, v0
  v_lshrrev_b32 v121, 4, v0
  v_mfma_f32_16x16x32_bf16 v[184:187], a[240:243], v[124:127], v[184:187]
  v_lshlrev_b32 v120, 4, v120
  v_mov_b32 v122, 0x80000000
  buffer_load_dwordx4 a[60:63], v3, s[4:7], s70 offen offset:3072
  v_mfma_f32_16x16x32_bf16 v[188:191], a[164:167], v[32:35], v[188:191]
  v_lshrrev_b32 v124, 2, v0
  v_and_b32 v125, 48, v1
  v_mfma_f32_16x16x32_bf16 v[188:191], a[168:171], v[36:39], v[188:191]
  v_lshl_add_u32 v124, v124, 11, v125
  v_lshl_add_u32 v125, v121, 2, v125
  v_mfma_f32_16x16x32_bf16 v[188:191], a[172:175], v[40:43], v[188:191]
  v_lshlrev_b32 v127, 15, v14
  v_mfma_f32_16x16x32_bf16 v[188:191], a[176:179], v[44:47], v[188:191]
  buffer_load_dwordx4 v[64:67], v1, s[4:7], s40 offen offset:0 sc1
  v_mfma_f32_16x16x32_bf16 v[192:195], a[180:183], v[32:35], v[192:195]
  v_mfma_f32_16x16x32_bf16 v[192:195], a[184:187], v[36:39], v[192:195]
  v_mfma_f32_16x16x32_bf16 v[192:195], a[188:191], v[40:43], v[192:195]
  v_mfma_f32_16x16x32_bf16 v[192:195], a[192:195], v[44:47], v[192:195]
  s_mov_b32 s70, 274432
  buffer_load_dwordx4 a[64:67], v3, s[4:7], s70 offen offset:0
  v_mfma_f32_16x16x32_bf16 v[196:199], a[196:199], v[32:35], v[196:199]
  v_mfma_f32_16x16x32_bf16 v[196:199], a[200:203], v[36:39], v[196:199]
  v_mfma_f32_16x16x32_bf16 v[196:199], a[204:207], v[40:43], v[196:199]
  v_mfma_f32_16x16x32_bf16 v[196:199], a[208:211], v[44:47], v[196:199]
  buffer_load_dwordx4 v[68:71], v1, s[4:7], s40 offen offset:1024 sc1
  v_mfma_f32_16x16x32_bf16 v[200:203], a[212:215], v[32:35], v[200:203]
  v_mfma_f32_16x16x32_bf16 v[200:203], a[216:219], v[36:39], v[200:203]
  v_mfma_f32_16x16x32_bf16 v[200:203], a[220:223], v[40:43], v[200:203]
  v_mfma_f32_16x16x32_bf16 v[200:203], a[224:227], v[44:47], v[200:203]
  s_waitcnt vmcnt(12)
  v_bitop3_b32 v27, v48, v52, v56 bitop3:0xfe
  buffer_load_dwordx4 v[72:75], v1, s[4:7], s41 offen offset:2048 sc1
  v_mfma_f32_16x16x32_bf16 v[204:207], a[228:231], v[32:35], v[204:207]
  v_mfma_f32_16x16x32_bf16 v[204:207], a[232:235], v[36:39], v[204:207]
  v_mfma_f32_16x16x32_bf16 v[204:207], a[236:239], v[40:43], v[204:207]
  v_mfma_f32_16x16x32_bf16 v[204:207], a[240:243], v[44:47], v[204:207]
  s_waitcnt vmcnt(12)
  v_bitop3_b32 v27, v27, v60, v14 bitop3:0xa8
  buffer_load_dwordx4 a[68:71], v3, s[4:7], s70 offen offset:1024
  v_cmp_ne_u32 vcc, 0, v27
  s_nop 0
  s_cbranch_vccnz L_retry_115
L_ok_116:
  v_mfma_f32_16x16x32_bf16 v[128:131], a[244:247], v[48:51], v[128:131]
  v_mfma_f32_16x16x32_bf16 v[128:131], a[248:251], v[52:55], v[128:131]
  v_mfma_f32_16x16x32_bf16 v[128:131], a[0:3], v[56:59], v[128:131]
  buffer_load_dwordx4 v[76:79], v1, s[4:7], s41 offen offset:3072 sc1
  v_mfma_f32_16x16x32_bf16 v[128:131], a[4:7], v[60:63], v[128:131]
  v_mfma_f32_16x16x32_bf16 v[132:135], a[8:11], v[48:51], v[132:135]
  v_mfma_f32_16x16x32_bf16 v[132:135], a[12:15], v[52:55], v[132:135]
  v_mfma_f32_16x16x32_bf16 v[132:135], a[16:19], v[56:59], v[132:135]
  buffer_load_dwordx4 v[80:83], v1, s[4:7], s43 offen offset:0 sc1
  v_mfma_f32_16x16x32_bf16 v[132:135], a[20:23], v[60:63], v[132:135]
  v_mfma_f32_16x16x32_bf16 v[136:139], a[24:27], v[48:51], v[136:139]
  v_mfma_f32_16x16x32_bf16 v[136:139], a[28:31], v[52:55], v[136:139]
  s_waitcnt vmcnt(14)
  v_mfma_f32_16x16x32_bf16 v[136:139], a[32:35], v[56:59], v[136:139]
  ds_write_b128 v4, v[128:131] offset:0
  buffer_load_dwordx4 v[84:87], v1, s[4:7], s43 offen offset:1024 sc1
  s_waitcnt vmcnt(14)
  v_mfma_f32_16x16x32_bf16 v[136:139], a[36:39], v[60:63], v[136:139]
  s_waitcnt vmcnt(13)
  v_mfma_f32_16x16x32_bf16 v[140:143], a[40:43], v[48:51], v[140:143]
  ds_write_b128 v4, v[132:135] offset:1024
  s_waitcnt vmcnt(12)
  v_mfma_f32_16x16x32_bf16 v[140:143], a[44:47], v[52:55], v[140:143]
  buffer_load_dwordx4 v[88:91], v1, s[4:7], s44 offen offset:2048 sc1
  s_nop 1
  ds_write_b128 v4, v[136:139] offset:2048
  s_waitcnt vmcnt(12)
  v_mfma_f32_16x16x32_bf16 v[140:143], a[48:51], v[56:59], v[140:143]
  buffer_load_dwordx4 v[92:95], v1, s[4:7], s44 offen offset:3072 sc1
  s_waitcnt vmcnt(12)
  v_mfma_f32_16x16x32_bf16 v[140:143], a[52:55], v[60:63], v[140:143]
  s_mov_b32 s81, 49152
  buffer_load_dword a254, v2, s[96:99], s81 offen
  s_waitcnt vmcnt(12)
  v_mfma_f32_16x16x32_bf16 v[144:147], a[56:59], v[48:51], v[144:147]
  buffer_load_dwordx4 v[96:99], v1, s[4:7], s46 offen offset:0 sc1
  s_nop 2
  ds_write_b128 v4, v[140:143] offset:3072
  s_waitcnt vmcnt(12)
  v_mfma_f32_16x16x32_bf16 v[144:147], a[60:63], v[52:55], v[144:147]
  buffer_load_dwordx4 v[100:103], v1, s[4:7], s46 offen offset:1024 sc1
  buffer_load_dwordx4 v[104:107], v1, s[4:7], s47 offen offset:2048 sc1
  s_waitcnt vmcnt(12)
  v_mfma_f32_16x16x32_bf16 v[144:147], a[64:67], v[56:59], v[144:147]
  buffer_load_dwordx4 v[108:111], v1, s[4:7], s47 offen offset:3072 sc1
  s_mov_b32 s70, 0
  buffer_load_dwordx4 a[72:75], v3, s[4:7], s70 offen offset:0
  s_waitcnt vmcnt(12)
  v_bitop3_b32 v27, v64, v68, v72 bitop3:0xfe
  buffer_load_dwordx4 a[76:79], v3, s[4:7], s70 offen offset:1024
  s_waitcnt vmcnt(12)
  v_mfma_f32_16x16x32_bf16 v[144:147], a[68:71], v[60:63], v[144:147]
  buffer_load_dwordx4 a[80:83], v3, s[4:7], s70 offen offset:2048
  s_nop 6
  ds_write_b128 v4, v[144:147] offset:4096
  buffer_load_dwordx4 a[84:87], v3, s[4:7], s70 offen offset:3072
  s_waitcnt vmcnt(13)
  v_bitop3_b32 v27, v27, v76, v14 bitop3:0xa8
  v_cmp_ne_u32 vcc, 0, v27
  s_nop 0
  s_cbranch_vccnz L_retry_117
L_ok_118:
  v_mfma_f32_16x16x32_bf16 v[148:151], a[244:247], v[64:67], v[148:151]
  v_mfma_f32_16x16x32_bf16 v[148:151], a[248:251], v[68:71], v[148:151]
  v_mfma_f32_16x16x32_bf16 v[148:151], a[0:3], v[72:75], v[148:151]
  v_mfma_f32_16x16x32_bf16 v[148:151], a[4:7], v[76:79], v[148:151]
  s_mov_b32 s70, 4096
  buffer_load_dwordx4 a[88:91], v3, s[4:7], s70 offen offset:0
  v_mfma_f32_16x16x32_bf16 v[152:155], a[8:11], v[64:67], v[152:155]
  v_mfma_f32_16x16x32_bf16 v[152:155], a[12:15], v[68:71], v[152:155]
  v_mfma_f32_16x16x32_bf16 v[152:155], a[16:19], v[72:75], v[152:155]
  v_mfma_f32_16x16x32_bf16 v[152:155], a[20:23], v[76:79], v[152:155]
  v_mfma_f32_16x16x32_bf16 v[156:159], a[24:27], v[64:67], v[156:159]
  buffer_load_dwordx4 a[92:95], v3, s[4:7], s70 offen offset:1024
  v_mfma_f32_16x16x32_bf16 v[156:159], a[28:31], v[68:71], v[156:159]
  ds_write_b128 v5, v[148:151] offset:0
  v_mfma_f32_16x16x32_bf16 v[156:159], a[32:35], v[72:75], v[156:159]
  s_waitcnt vmcnt(12)
  v_bitop3_b32 v27, v80, v84, v88 bitop3:0xfe
  v_mfma_f32_16x16x32_bf16 v[156:159], a[36:39], v[76:79], v[156:159]
  v_mfma_f32_16x16x32_bf16 v[160:163], a[40:43], v[64:67], v[160:163]
  buffer_load_dwordx4 a[96:99], v3, s[4:7], s70 offen offset:2048
  v_mfma_f32_16x16x32_bf16 v[160:163], a[44:47], v[68:71], v[160:163]
  ds_write_b128 v5, v[152:155] offset:1024
  v_mfma_f32_16x16x32_bf16 v[160:163], a[48:51], v[72:75], v[160:163]
  s_waitcnt vmcnt(12)
  v_bitop3_b32 v27, v27, v92, v14 bitop3:0xa8
  v_mfma_f32_16x16x32_bf16 v[160:163], a[52:55], v[76:79], v[160:163]
  v_cmp_ne_u32 vcc, 0, v27
  v_mfma_f32_16x16x32_bf16 v[164:167], a[56:59], v[64:67], v[164:167]
  buffer_load_dwordx4 a[100:103], v3, s[4:7], s70 offen offset:3072
  v_mfma_f32_16x16x32_bf16 v[164:167], a[60:63], v[68:71], v[164:167]
  s_cbranch_vccnz L_retry_119
L_ok_120:
  v_mfma_f32_16x16x32_bf16 v[164:167], a[64:67], v[72:75], v[164:167]
  ds_write_b128 v5, v[156:159] offset:2048
  v_mfma_f32_16x16x32_bf16 v[164:167], a[68:71], v[76:79], v[164:167]
  v_mfma_f32_16x16x32_bf16 v[168:171], a[244:247], v[80:83], v[168:171]
  s_mov_b32 s70, 8192
  buffer_load_dwordx4 a[104:107], v3, s[4:7], s70 offen offset:0
  v_mfma_f32_16x16x32_bf16 v[168:171], a[248:251], v[84:87], v[168:171]
  ds_write_b128 v5, v[160:163] offset:3072
  v_mfma_f32_16x16x32_bf16 v[168:171], a[0:3], v[88:91], v[168:171]
  v_mfma_f32_16x16x32_bf16 v[168:171], a[4:7], v[92:95], v[168:171]
  v_mfma_f32_16x16x32_bf16 v[172:175], a[8:11], v[80:83], v[172:175]
  buffer_load_dwordx4 a[108:111], v3, s[4:7], s70 offen offset:1024
  v_mfma_f32_16x16x32_bf16 v[172:175], a[12:15], v[84:87], v[172:175]
  ds_write_b128 v5, v[164:167] offset:4096
  v_mfma_f32_16x16x32_bf16 v[172:175], a[16:19], v[88:91], v[172:175]
  v_mfma_f32_16x16x32_bf16 v[172:175], a[20:23], v[92:95], v[172:175]
  v_mfma_f32_16x16x32_bf16 v[176:179], a[24:27], v[80:83], v[176:179]
  buffer_load_dwordx4 a[112:115], v3, s[4:7], s70 offen offset:2048
  v_mfma_f32_16x16x32_bf16 v[176:179], a[28:31], v[84:87], v[176:179]
  ds_write_b128 v6, v[168:171] offset:0
  v_mfma_f32_16x16x32_bf16 v[176:179], a[32:35], v[88:91], v[176:179]
  s_waitcnt vmcnt(12)
  v_bitop3_b32 v27, v96, v100, v104 bitop3:0xfe
  v_mfma_f32_16x16x32_bf16 v[176:179], a[36:39], v[92:95], v[176:179]
  v_mfma_f32_16x16x32_bf16 v[180:183], a[40:43], v[80:83], v[180:183]
  buffer_load_dwordx4 a[116:119], v3, s[4:7], s70 offen offset:3072
  v_mfma_f32_16x16x32_bf16 v[180:183], a[44:47], v[84:87], v[180:183]
  ds_write_b128 v6, v[172:175] offset:1024
  v_mfma_f32_16x16x32_bf16 v[180:183], a[48:51], v[88:91], v[180:183]
  s_waitcnt lgkmcnt(2)
  s_barrier
  v_mfma_f32_16x16x32_bf16 v[180:183], a[52:55], v[92:95], v[180:183]
  s_mov_b32 s70, 12288
  buffer_load_dwordx4 a[120:123], v3, s[4:7], s70 offen offset:0
  v_mfma_f32_16x16x32_bf16 v[184:187], a[56:59], v[80:83], v[184:187]
  ds_write_b128 v6, v[176:179] offset:2048
  v_mfma_f32_16x16x32_bf16 v[184:187], a[60:63], v[84:87], v[184:187]
  ds_read_b128 v[132:135], v7 offset:1024
  v_mfma_f32_16x16x32_bf16 v[184:187], a[64:67], v[88:91], v[184:187]
  ds_read_b128 v[152:155], v7 offset:6144
  v_mfma_f32_16x16x32_bf16 v[184:187], a[68:71], v[92:95], v[184:187]
  buffer_load_dwordx4 a[124:127], v3, s[4:7], s70 offen offset:1024
  ds_write_b128 v6, v[180:183] offset:3072
  ds_read_b128 v[136:139], v7 offset:2048
  s_waitcnt vmcnt(14)
  v_bitop3_b32 v27, v27, v108, v14 bitop3:0xa8
  v_cmp_ne_u32 vcc, 0, v27
  ds_read_b128 v[156:159], v7 offset:7168
  s_cbranch_vccnz L_retry_121
L_ok_122:
  v_mfma_f32_16x16x32_bf16 v[188:191], a[244:247], v[96:99], v[188:191]
  ds_write_b128 v6, v[184:187] offset:4096
  buffer_load_dwordx4 a[128:131], v3, s[4:7], s70 offen offset:2048
  ds_read_b128 v[140:143], v7 offset:3072
  v_mfma_f32_16x16x32_bf16 v[188:191], a[248:251], v[100:103], v[188:191]
  ds_read_b128 v[160:163], v7 offset:8192
  v_mfma_f32_16x16x32_bf16 v[188:191], a[0:3], v[104:107], v[188:191]
  ds_read_b128 v[144:147], v7 offset:4096
  v_mfma_f32_16x16x32_bf16 v[188:191], a[4:7], v[108:111], v[188:191]
  ds_read_b128 v[164:167], v7 offset:9216
  v_mfma_f32_16x16x32_bf16 v[192:195], a[8:11], v[96:99], v[192:195]
  s_waitcnt lgkmcnt(8)
  v_add_f32 v132, v132, v152
  buffer_load_dwordx4 a[132:135], v3, s[4:7], s70 offen offset:3072
  ds_read_b128 v[128:131], v7 offset:0
  v_mfma_f32_16x16x32_bf16 v[192:195], a[12:15], v[100:103], v[192:195]
  v_add_f32 v133, v133, v153
  ds_read_b128 v[148:151], v7 offset:5120
  v_mfma_f32_16x16x32_bf16 v[192:195], a[16:19], v[104:107], v[192:195]
  v_add_f32 v134, v134, v154
  v_add_f32 v135, v135, v155
  v_mfma_f32_16x16x32_bf16 v[192:195], a[20:23], v[108:111], v[192:195]
  s_waitcnt lgkmcnt(7)
  v_add_f32 v136, v136, v156
  v_add_f32 v137, v137, v157
  v_mfma_f32_16x16x32_bf16 v[196:199], a[24:27], v[96:99], v[196:199]
  v_add_f32 v138, v138, v158
  s_mov_b32 s70, 16384
  buffer_load_dwordx4 a[136:139], v3, s[4:7], s70 offen offset:0
  v_mfma_f32_16x16x32_bf16 v[196:199], a[28:31], v[100:103], v[196:199]
  v_add_f32 v139, v139, v159
  v_add_f32 v192, v192, v132
  v_add_f32 v193, v193, v133
  v_add_f32 v194, v194, v134
  v_add_f32 v195, v195, v135
  v_mfma_f32_16x16x32_bf16 v[196:199], a[32:35], v[104:107], v[196:199]
  s_waitcnt lgkmcnt(4)
  v_add_f32 v140, v140, v160
  v_add_f32 v141, v141, v161
  v_mfma_f32_16x16x32_bf16 v[196:199], a[36:39], v[108:111], v[196:199]
  v_add_f32 v142, v142, v162
  v_add_f32 v143, v143, v163
  v_mfma_f32_16x16x32_bf16 v[200:203], a[40:43], v[96:99], v[200:203]
  buffer_load_dwordx4 a[140:143], v3, s[4:7], s70 offen offset:1024
  v_mfma_f32_16x16x32_bf16 v[200:203], a[44:47], v[100:103], v[200:203]
  s_waitcnt lgkmcnt(2)
  v_add_f32 v144, v144, v164
  v_add_f32 v145, v145, v165
  v_mfma_f32_16x16x32_bf16 v[200:203], a[48:51], v[104:107], v[200:203]
  s_waitcnt lgkmcnt(0)
  s_barrier
  ds_read_b128 v[172:175], v7 offset:11264
  v_add_f32 v128, v128, v148
  v_add_f32 v129, v129, v149
  v_add_f32 v130, v130, v150
  ds_read_b128 v[168:171], v7 offset:10240
  buffer_load_dwordx4 a[144:147], v3, s[4:7], s70 offen offset:2048
  v_add_f32 v131, v131, v151
  v_add_f32 v188, v188, v128
  v_add_f32 v189, v189, v129
  v_add_f32 v190, v190, v130
  v_add_f32 v191, v191, v131
  ds_read_b128 v[176:179], v7 offset:12288
  v_mfma_f32_16x16x32_bf16 v[200:203], a[52:55], v[108:111], v[200:203]
  v_add_f32 v196, v196, v136
  ds_read_b128 v[180:183], v7 offset:13312
  v_add_f32 v197, v197, v137
  v_add_f32 v198, v198, v138
  v_add_f32 v199, v199, v139
  ds_read_b128 v[184:187], v7 offset:14336
  v_mfma_f32_16x16x32_bf16 v[204:207], a[56:59], v[96:99], v[204:207]
  buffer_load_dwordx4 a[148:151], v3, s[4:7], s70 offen offset:3072
  v_add_f32 v200, v200, v140
  v_add_f32 v201, v201, v141
  v_add_f32 v202, v202, v142
  v_add_f32 v203, v203, v143
  v_mfma_f32_16x16x32_bf16 v[204:207], a[60:63], v[100:103], v[204:207]
  v_add_f32 v146, v146, v166
  v_add_f32 v147, v147, v167
  v_mfma_f32_16x16x32_bf16 v[204:207], a[64:67], v[104:107], v[204:207]
  v_mfma_f32_16x16x32_bf16 v[204:207], a[68:71], v[108:111], v[204:207]
  s_mov_b32 s70, 20480
  buffer_load_dwordx4 a[152:155], v3, s[4:7], s70 offen offset:0
  s_waitcnt lgkmcnt(4)
  v_pk_add_f32 v[192:193], v[192:193], v[172:173]
  v_pk_add_f32 v[194:195], v[194:195], v[174:175]
  s_waitcnt lgkmcnt(3)
  v_add_f32 v188, v188, v168
  v_add_f32 v189, v189, v169
  v_add_f32 v190, v190, v170
  v_add_f32 v191, v191, v171
  v_cvt_pk_bf16_f32 v148, v188, v189
  v_cvt_pk_bf16_f32 v150, v192, v193
  v_cvt_pk_bf16_f32 v151, v194, v195
  v_cvt_pk_bf16_f32 v149, v190, v191
  v_or_b32 v148, v14, v148
  s_cmp_eq_u32 s71, 0
  s_cbranch_scc1 L_slow_123
  buffer_store_dwordx4 v[148:151], v1, s[4:7], s49 offen offset:1024
L_back_124:
  s_waitcnt lgkmcnt(2)
  v_pk_add_f32 v[196:197], v[196:197], v[176:177]
  v_pk_add_f32 v[198:199], v[198:199], v[178:179]
  s_waitcnt lgkmcnt(1)
  v_pk_add_f32 v[200:201], v[200:201], v[180:181]
  v_pk_add_f32 v[202:203], v[202:203], v[182:183]
  v_cvt_pk_bf16_f32 v152, v196, v197
  v_cvt_pk_bf16_f32 v153, v198, v199
  v_cvt_pk_bf16_f32 v154, v200, v201
  v_cvt_pk_bf16_f32 v155, v202, v203
  buffer_load_dwordx4 a[156:159], v3, s[4:7], s70 offen offset:1024
  v_or_b32 v152, v14, v152
  v_add_f32 v204, v204, v144
  v_add_f32 v205, v205, v145
  v_add_f32 v206, v206, v146
  v_add_f32 v207, v207, v147
  v_pk_add_f32 v[116:117], v[188:189], v[190:191]
  v_pk_mul_f32 v[118:119], v[188:189], v[188:189]
  v_pk_fma_f32 v[118:119], v[190:191], v[190:191], v[118:119]
  v_pk_add_f32 v[116:117], v[116:117], v[192:193]
  v_pk_fma_f32 v[118:119], v[192:193], v[192:193], v[118:119]
  s_cmp_eq_u32 s71, 0
  s_cbranch_scc1 L_slow_125
  buffer_store_dwordx4 v[152:155], v1, s[4:7], s49 offen offset:2048
L_back_126:
  s_waitcnt lgkmcnt(0)
  v_pk_add_f32 v[204:205], v[204:205], v[184:185]
  v_pk_add_f32 v[206:207], v[206:207], v[186:187]
  v_cvt_pk_bf16_f32 v156, v204, v205
  v_cvt_pk_bf16_f32 v157, v206, v207
  v_pk_add_f32 v[116:117], v[116:117], v[194:195]
  v_pk_fma_f32 v[118:119], v[194:195], v[194:195], v[118:119]
  v_pk_add_f32 v[116:117], v[116:117], v[196:197]
  v_pk_fma_f32 v[118:119], v[196:197], v[196:197], v[118:119]
  v_pk_add_f32 v[116:117], v[116:117], v[198:199]
  buffer_load_dwordx4 a[160:163], v3, s[4:7], s70 offen offset:2048
  v_permlane32_swap_b32 v156, v158
  v_permlane32_swap_b32 v157, v159
  v_or_b32 v156, v14, v156
  v_pk_fma_f32 v[118:119], v[198:199], v[198:199], v[118:119]
  v_pk_add_f32 v[116:117], v[116:117], v[200:201]
  v_pk_fma_f32 v[118:119], v[200:201], v[200:201], v[118:119]
  v_pk_add_f32 v[116:117], v[116:117], v[202:203]
  v_pk_fma_f32 v[118:119], v[202:203], v[202:203], v[118:119]
  s_cmp_eq_u32 s71, 0
  s_cbranch_scc1 L_slow_127
  buffer_store_dwordx4 v[156:159], v254, s[4:7], s49 offen
L_back_128:
  v_pk_add_f32 v[116:117], v[116:117], v[204:205]
  v_pk_fma_f32 v[118:119], v[204:205], v[204:205], v[118:119]
  v_pk_add_f32 v[116:117], v[116:117], v[206:207]
  v_pk_fma_f32 v[118:119], v[206:207], v[206:207], v[118:119]
  v_add_f32 v116, v116, v117
  v_add_f32 v118, v118, v119
  v_mov_b64 v[208:209], v[188:189]
  v_mov_b64 v[210:211], v[190:191]
  v_mov_b64 v[212:213], v[192:193]
  v_mov_b64 v[214:215], v[194:195]
  v_mov_b64 v[216:217], v[196:197]
  v_mov_b64 v[218:219], v[198:199]
  v_mov_b64 v[220:221], v[200:201]
  v_mov_b64 v[222:223], v[202:203]
  v_mov_b64 v[224:225], v[204:205]
  v_mov_b64 v[226:227], v[206:207]
  buffer_load_dwordx4 a[164:167], v3, s[4:7], s70 offen offset:3072
  v_permlane16_swap_b32 v116, v118
  v_add_f32 v116, v116, v118
  v_mov_b32 v117, v116
  ds_read_b128 v[188:191], v12 offset:0
  s_nop 0
  v_permlane32_swap_b32 v116, v117
  v_add_f32 v116, v116, v117
  v_or_b32 v116, 1, v116
  s_cmp_eq_u32 s71, 0
  s_cbranch_scc1 L_slow_129
  buffer_store_dword v116, v26, s[4:7], s57 offen
L_back_130:
  ds_read_b128 v[192:195], v12 offset:16
  v_lshl_add_u32 v117, v121, 7, v120
  v_and_b32 v120, 8, v0
  v_mov_b32 v121, 0x3727c5ac
  ds_read_b128 v[196:199], v12 offset:32
  ds_read_b128 v[200:203], v12 offset:48
  s_mov_b32 s70, 24576
  buffer_load_dwordx4 a[168:171], v3, s[4:7], s70 offen offset:0
  ds_read_b128 v[204:207], v12 offset:64
  buffer_load_dwordx4 v[32:35], v1, s[4:7], s20 offen offset:0 sc1
  buffer_load_dwordx4 v[44:47], v1, s[4:7], s20 offen offset:3072 sc1
  buffer_load_dwordx4 v[36:39], v1, s[4:7], s20 offen offset:1024 sc1
  buffer_load_dwordx4 v[48:51], v1, s[4:7], s28 offen offset:0 sc1
  buffer_load_dwordx4 v[40:43], v1, s[4:7], s20 offen offset:2048 sc1
  buffer_load_dwordx4 v[52:55], v1, s[4:7], s21 offen offset:0 sc1
  buffer_load_dwordx4 v[64:67], v1, s[4:7], s21 offen offset:3072 sc1
  buffer_load_dwordx4 v[56:59], v1, s[4:7], s21 offen offset:1024 sc1
  buffer_load_dwordx4 v[68:71], v1, s[4:7], s29 offen offset:0 sc1
  buffer_load_dwordx4 v[60:63], v1, s[4:7], s21 offen offset:2048 sc1
  buffer_load_dwordx4 v[72:75], v1, s[4:7], s22 offen offset:0 sc1
  buffer_load_dwordx4 v[84:87], v1, s[4:7], s22 offen offset:3072 sc1
  buffer_load_dwordx4 v[76:79], v1, s[4:7], s22 offen offset:1024 sc1
  buffer_load_dwordx4 v[88:91], v1, s[4:7], s30 offen offset:0 sc1
  s_waitcnt vmcnt(12)
  v_bitop3_b32 v27, v32, v44, v14 bitop3:0x2a
  v_cmp_ne_u32 vcc, 0, v27
  buffer_load_dwordx4 v[80:83], v1, s[4:7], s22 offen offset:2048 sc1
  s_cbranch_vccz L_ok_132
L_retry_131:
  s_sub_u32 s69, s69, 1
  s_cbranch_scc1 L_retry_131_to
  buffer_load_dwordx4 v[32:35], v1, s[4:7], s20 offen offset:0 sc1
  buffer_load_dwordx4 v[44:47], v1, s[4:7], s20 offen offset:3072 sc1
  s_waitcnt vmcnt(0)
  v_bitop3_b32 v27, v32, v44, v14 bitop3:0x2a
  v_cmp_ne_u32 vcc, 0, v27
  s_nop 1
  s_cbranch_vccnz L_retry_131
  v_bitop3_b32 v27, v36, v48, v40 bitop3:0x80
  v_bitop3_b32 v27, v27, v52, v64 bitop3:0x80
  v_bitop3_b32 v27, v27, v56, v68 bitop3:0x80
  v_bitop3_b32 v27, v27, v60, v72 bitop3:0x80
  v_bitop3_b32 v27, v27, v84, v76 bitop3:0x80
  v_bitop3_b32 v27, v27, v88, v80 bitop3:0x80
  v_bitop3_b32 v27, v27, v27, v14 bitop3:0x2a
  v_cmp_ne_u32 vcc, 0, v27
  s_nop 1
  s_cbranch_vccz L_ok_132
  buffer_load_dwordx4 v[36:39], v1, s[4:7], s20 offen offset:1024 sc1
  buffer_load_dwordx4 v[48:51], v1, s[4:7], s28 offen offset:0 sc1
  buffer_load_dwordx4 v[40:43], v1, s[4:7], s20 offen offset:2048 sc1
  buffer_load_dwordx4 v[52:55], v1, s[4:7], s21 offen offset:0 sc1
  buffer_load_dwordx4 v[64:67], v1, s[4:7], s21 offen offset:3072 sc1
  buffer_load_dwordx4 v[56:59], v1, s[4:7], s21 offen offset:1024 sc1
  buffer_load_dwordx4 v[68:71], v1, s[4:7], s29 offen offset:0 sc1
  buffer_load_dwordx4 v[60:63], v1, s[4:7], s21 offen offset:2048 sc1
  buffer_load_dwordx4 v[72:75], v1, s[4:7], s22 offen offset:0 sc1
  buffer_load_dwordx4 v[84:87], v1, s[4:7], s22 offen offset:3072 sc1
  buffer_load_dwordx4 v[76:79], v1, s[4:7], s22 offen offset:1024 sc1
  buffer_load_dwordx4 v[88:91], v1, s[4:7], s30 offen offset:0 sc1
  buffer_load_dwordx4 v[80:83], v1, s[4:7], s22 offen offset:2048 sc1
L_ok_132:
  v_mfma_f32_16x16x32_bf16 v[128:131], a[72:75], v[32:35], 0
  v_mfma_f32_16x16x32_bf16 v[132:135], a[92:95], v[32:35], 0
  v_mfma_f32_16x16x32_bf16 v[136:139], a[112:115], v[32:35], 0
  v_mfma_f32_16x16x32_bf16 v[140:143], a[132:135], v[32:35], 0
  buffer_load_dwordx2 v[112:113], v15, s[4:7], s54 offen offset:0 sc1
  v_mfma_f32_16x16x32_bf16 v[144:147], a[152:155], v[32:35], 0
  v_mfma_f32_16x16x32_bf16 v[128:131], a[84:87], v[44:47], v[128:131]
  v_mfma_f32_16x16x32_bf16 v[132:135], a[104:107], v[44:47], v[132:135]
  v_mfma_f32_16x16x32_bf16 v[136:139], a[124:127], v[44:47], v[136:139]
  s_waitcnt vmcnt(12)
  v_bitop3_b32 v27, v36, v48, v14 bitop3:0x2a
  v_mfma_f32_16x16x32_bf16 v[140:143], a[144:147], v[44:47], v[140:143]
  buffer_load_dwordx2 v[114:115], v15, s[4:7], s54 offen offset:512 sc1
  v_mfma_f32_16x16x32_bf16 v[144:147], a[164:167], v[44:47], v[144:147]
  v_cmp_ne_u32 vcc, 0, v27
  s_nop 0
  s_cbranch_vccz L_ok_134
L_retry_133:
  s_sub_u32 s69, s69, 1
  s_cbranch_scc1 L_retry_133_to
  buffer_load_dwordx4 v[36:39], v1, s[4:7], s20 offen offset:1024 sc1
  buffer_load_dwordx4 v[48:51], v1, s[4:7], s28 offen offset:0 sc1
  s_waitcnt vmcnt(0)
  v_bitop3_b32 v27, v36, v48, v14 bitop3:0x2a
  v_cmp_ne_u32 vcc, 0, v27
  s_nop 1
  s_cbranch_vccnz L_retry_133
  v_bitop3_b32 v27, v40, v52, v64 bitop3:0x80
  v_bitop3_b32 v27, v27, v56, v68 bitop3:0x80
  v_bitop3_b32 v27, v27, v60, v72 bitop3:0x80
  v_bitop3_b32 v27, v27, v84, v76 bitop3:0x80
  v_bitop3_b32 v27, v27, v88, v80 bitop3:0x80
  v_bitop3_b32 v27, v27, v112, v114 bitop3:0x80
  v_bitop3_b32 v27, v27, v27, v14 bitop3:0x2a
  v_cmp_ne_u32 vcc, 0, v27
  s_nop 1
  s_cbranch_vccz L_ok_134
  buffer_load_dwordx4 v[40:43], v1, s[4:7], s20 offen offset:2048 sc1
  buffer_load_dwordx4 v[52:55], v1, s[4:7], s21 offen offset:0 sc1
  buffer_load_dwordx4 v[64:67], v1, s[4:7], s21 offen offset:3072 sc1
  buffer_load_dwordx4 v[56:59], v1, s[4:7], s21 offen offset:1024 sc1
  buffer_load_dwordx4 v[68:71], v1, s[4:7], s29 offen offset:0 sc1
  buffer_load_dwordx4 v[60:63], v1, s[4:7], s21 offen offset:2048 sc1
  buffer_load_dwordx4 v[72:75], v1, s[4:7], s22 offen offset:0 sc1
  buffer_load_dwordx4 v[84:87], v1, s[4:7], s22 offen offset:3072 sc1
  buffer_load_dwordx4 v[76:79], v1, s[4:7], s22 offen offset:1024 sc1
  buffer_load_dwordx4 v[88:91], v1, s[4:7], s30 offen offset:0 sc1
  buffer_load_dwordx4 v[80:83], v1, s[4:7], s22 offen offset:2048 sc1
  buffer_load_dwordx2 v[112:113], v15, s[4:7], s54 offen offset:0 sc1
  buffer_load_dwordx2 v[114:115], v15, s[4:7], s54 offen offset:512 sc1
L_ok_134:
  v_mfma_f32_16x16x32_bf16 v[128:131], a[76:79], v[36:39], v[128:131]
  v_mfma_f32_16x16x32_bf16 v[132:135], a[96:99], v[36:39], v[132:135]
  s_waitcnt vmcnt(12)
  v_bitop3_b32 v27, v40, v40, v14 bitop3:0x2a
  v_mfma_f32_16x16x32_bf16 v[136:139], a[116:119], v[36:39], v[136:139]
  buffer_load_dwordx4 v[92:95], v1, s[4:7], s23 offen offset:0 sc1
  v_mfma_f32_16x16x32_bf16 v[140:143], a[136:139], v[36:39], v[140:143]
  v_cmp_ne_u32 vcc, 0, v27
  v_mfma_f32_16x16x32_bf16 v[144:147], a[156:159], v[36:39], v[144:147]
  s_cbranch_vccz L_ok_136
L_retry_135:
  s_sub_u32 s69, s69, 1
  s_cbranch_scc1 L_retry_135_to
  buffer_load_dwordx4 v[40:43], v1, s[4:7], s20 offen offset:2048 sc1
  s_waitcnt vmcnt(0)
  v_bitop3_b32 v27, v40, v40, v14 bitop3:0x2a
  v_cmp_ne_u32 vcc, 0, v27
  s_nop 1
  s_cbranch_vccnz L_retry_135
  v_bitop3_b32 v27, v52, v64, v56 bitop3:0x80
  v_bitop3_b32 v27, v27, v68, v60 bitop3:0x80
  v_bitop3_b32 v27, v27, v72, v84 bitop3:0x80
  v_bitop3_b32 v27, v27, v76, v88 bitop3:0x80
  v_bitop3_b32 v27, v27, v80, v112 bitop3:0x80
  v_bitop3_b32 v27, v27, v114, v92 bitop3:0x80
  v_bitop3_b32 v27, v27, v27, v14 bitop3:0x2a
  v_cmp_ne_u32 vcc, 0, v27
  s_nop 1
  s_cbranch_vccz L_ok_136
  buffer_load_dwordx4 v[52:55], v1, s[4:7], s21 offen offset:0 sc1
  buffer_load_dwordx4 v[64:67], v1, s[4:7], s21 offen offset:3072 sc1
  buffer_load_dwordx4 v[56:59], v1, s[4:7], s21 offen offset:1024 sc1
  buffer_load_dwordx4 v[68:71], v1, s[4:7], s29 offen offset:0 sc1
  buffer_load_dwordx4 v[60:63], v1, s[4:7], s21 offen offset:2048 sc1
  buffer_load_dwordx4 v[72:75], v1, s[4:7], s22 offen offset:0 sc1
  buffer_load_dwordx4 v[84:87], v1, s[4:7], s22 offen offset:3072 sc1
  buffer_load_dwordx4 v[76:79], v1, s[4:7], s22 offen offset:1024 sc1
  buffer_load_dwordx4 v[88:91], v1, s[4:7], s30 offen offset:0 sc1
  buffer_load_dwordx4 v[80:83], v1, s[4:7], s22 offen offset:2048 sc1
  buffer_load_dwordx2 v[112:113], v15, s[4:7], s54 offen offset:0 sc1
  buffer_load_dwordx2 v[114:115], v15, s[4:7], s54 offen offset:512 sc1
  buffer_load_dwordx4 v[92:95], v1, s[4:7], s23 offen offset:0 sc1
L_ok_136:
  v_mfma_f32_16x16x32_bf16 v[128:131], a[88:91], v[48:51], v[128:131]
  v_mfma_f32_16x16x32_bf16 v[132:135], a[108:111], v[48:51], v[132:135]
  v_mfma_f32_16x16x32_bf16 v[136:139], a[128:131], v[48:51], v[136:139]
  buffer_load_dwordx4 v[104:107], v1, s[4:7], s23 offen offset:3072 sc1
  v_mfma_f32_16x16x32_bf16 v[140:143], a[148:151], v[48:51], v[140:143]
  v_mfma_f32_16x16x32_bf16 v[144:147], a[168:171], v[48:51], v[144:147]
  s_waitcnt vmcnt(12)
  v_bitop3_b32 v27, v52, v64, v14 bitop3:0x2a
  v_mfma_f32_16x16x32_bf16 v[128:131], a[80:83], v[40:43], v[128:131]
  v_cmp_ne_u32 vcc, 0, v27
  v_mfma_f32_16x16x32_bf16 v[132:135], a[100:103], v[40:43], v[132:135]
  s_cbranch_vccz L_ok_138
L_retry_137:
  s_sub_u32 s69, s69, 1
  s_cbranch_scc1 L_retry_137_to
  buffer_load_dwordx4 v[52:55], v1, s[4:7], s21 offen offset:0 sc1
  buffer_load_dwordx4 v[64:67], v1, s[4:7], s21 offen offset:3072 sc1
  s_waitcnt vmcnt(0)
  v_bitop3_b32 v27, v52, v64, v14 bitop3:0x2a
  v_cmp_ne_u32 vcc, 0, v27
  s_nop 1
  s_cbranch_vccnz L_retry_137
  v_bitop3_b32 v27, v56, v68, v60 bitop3:0x80
  v_bitop3_b32 v27, v27, v72, v84 bitop3:0x80
  v_bitop3_b32 v27, v27, v76, v88 bitop3:0x80
  v_bitop3_b32 v27, v27, v80, v112 bitop3:0x80
  v_bitop3_b32 v27, v27, v114, v92 bitop3:0x80
  v_bitop3_b32 v27, v27, v104, v14 bitop3:0x2a
  v_cmp_ne_u32 vcc, 0, v27
  s_nop 1
  s_cbranch_vccz L_ok_138
  buffer_load_dwordx4 v[56:59], v1, s[4:7], s21 offen offset:1024 sc1
  buffer_load_dwordx4 v[68:71], v1, s[4:7], s29 offen offset:0 sc1
  buffer_load_dwordx4 v[60:63], v1, s[4:7], s21 offen offset:2048 sc1
  buffer_load_dwordx4 v[72:75], v1, s[4:7], s22 offen offset:0 sc1
  buffer_load_dwordx4 v[84:87], v1, s[4:7], s22 offen offset:3072 sc1
  buffer_load_dwordx4 v[76:79], v1, s[4:7], s22 offen offset:1024 sc1
  buffer_load_dwordx4 v[88:91], v1, s[4:7], s30 offen offset:0 sc1
  buffer_load_dwordx4 v[80:83], v1, s[4:7], s22 offen offset:2048 sc1
  buffer_load_dwordx2 v[112:113], v15, s[4:7], s54 offen offset:0 sc1
  buffer_load_dwordx2 v[114:115], v15, s[4:7], s54 offen offset:512 sc1
  buffer_load_dwordx4 v[92:95], v1, s[4:7], s23 offen offset:0 sc1
  buffer_load_dwordx4 v[104:107], v1, s[4:7], s23 offen offset:3072 sc1
L_ok_138:
  v_mfma_f32_16x16x32_bf16 v[136:139], a[120:123], v[40:43], v[136:139]
  buffer_load_dwordx4 v[96:99], v1, s[4:7], s23 offen offset:1024 sc1
  v_mfma_f32_16x16x32_bf16 v[140:143], a[140:143], v[40:43], v[140:143]
  v_mfma_f32_16x16x32_bf16 v[144:147], a[160:163], v[40:43], v[144:147]
  v_mfma_f32_16x16x32_bf16 v[148:151], a[72:75], v[52:55], 0
  ds_write_b128 v4, v[128:131] offset:0
  v_mfma_f32_16x16x32_bf16 v[152:155], a[92:95], v[52:55], 0
  buffer_load_dwordx4 v[108:111], v1, s[4:7], s31 offen offset:0 sc1
  v_mfma_f32_16x16x32_bf16 v[156:159], a[112:115], v[52:55], 0
  v_mfma_f32_16x16x32_bf16 v[160:163], a[132:135], v[52:55], 0
  ds_write_b128 v4, v[132:135] offset:1024
  v_mfma_f32_16x16x32_bf16 v[164:167], a[152:155], v[52:55], 0
  v_mfma_f32_16x16x32_bf16 v[148:151], a[84:87], v[64:67], v[148:151]
  buffer_load_dwordx4 v[100:103], v1, s[4:7], s23 offen offset:2048 sc1
  v_mfma_f32_16x16x32_bf16 v[152:155], a[104:107], v[64:67], v[152:155]
  s_waitcnt vmcnt(12)
  v_bitop3_b32 v27, v56, v68, v60 bitop3:0x80
  v_mfma_f32_16x16x32_bf16 v[156:159], a[124:127], v[64:67], v[156:159]
  v_bitop3_b32 v27, v27, v27, v14 bitop3:0x2a
  v_mfma_f32_16x16x32_bf16 v[160:163], a[144:147], v[64:67], v[160:163]
  v_cmp_ne_u32 vcc, 0, v27
  v_mfma_f32_16x16x32_bf16 v[164:167], a[164:167], v[64:67], v[164:167]
  s_cbranch_vccz L_ok_140
L_retry_139:
  s_sub_u32 s69, s69, 1
  s_cbranch_scc1 L_retry_139_to
  buffer_load_dwordx4 v[56:59], v1, s[4:7], s21 offen offset:1024 sc1
  buffer_load_dwordx4 v[68:71], v1, s[4:7], s29 offen offset:0 sc1
  buffer_load_dwordx4 v[60:63], v1, s[4:7], s21 offen offset:2048 sc1
  s_waitcnt vmcnt(0)
  v_bitop3_b32 v27, v56, v68, v60 bitop3:0x80
  v_bitop3_b32 v27, v27, v27, v14 bitop3:0x2a
  v_cmp_ne_u32 vcc, 0, v27
  s_nop 1
  s_cbranch_vccnz L_retry_139
  v_bitop3_b32 v27, v72, v84, v76 bitop3:0x80
  v_bitop3_b32 v27, v27, v88, v80 bitop3:0x80
  v_bitop3_b32 v27, v27, v112, v114 bitop3:0x80
  v_bitop3_b32 v27, v27, v92, v104 bitop3:0x80
  v_bitop3_b32 v27, v27, v96, v108 bitop3:0x80
  v_bitop3_b32 v27, v27, v100, v14 bitop3:0x2a
  v_cmp_ne_u32 vcc, 0, v27
  s_nop 1
  s_cbranch_vccz L_ok_140
  buffer_load_dwordx4 v[72:75], v1, s[4:7], s22 offen offset:0 sc1
  buffer_load_dwordx4 v[84:87], v1, s[4:7], s22 offen offset:3072 sc1
  buffer_load_dwordx4 v[76:79], v1, s[4:7], s22 offen offset:1024 sc1
  buffer_load_dwordx4 v[88:91], v1, s[4:7], s30 offen offset:0 sc1
  buffer_load_dwordx4 v[80:83], v1, s[4:7], s22 offen offset:2048 sc1
  buffer_load_dwordx2 v[112:113], v15, s[4:7], s54 offen offset:0 sc1
  buffer_load_dwordx2 v[114:115], v15, s[4:7], s54 offen offset:512 sc1
  buffer_load_dwordx4 v[92:95], v1, s[4:7], s23 offen offset:0 sc1
  buffer_load_dwordx4 v[104:107], v1, s[4:7], s23 offen offset:3072 sc1
  buffer_load_dwordx4 v[96:99], v1, s[4:7], s23 offen offset:1024 sc1
  buffer_load_dwordx4 v[108:111], v1, s[4:7], s31 offen offset:0 sc1
  buffer_load_dwordx4 v[100:103], v1, s[4:7], s23 offen offset:2048 sc1
L_ok_140:
  v_mfma_f32_16x16x32_bf16 v[148:151], a[76:79], v[56:59], v[148:151]
  buffer_load_dwordx4 a[172:175], v3, s[4:7], s70 offen offset:1024
  v_mfma_f32_16x16x32_bf16 v[148:151], a[88:91], v[68:71], v[148:151]
  ds_write_b128 v4, v[136:139] offset:2048
  v_mfma_f32_16x16x32_bf16 v[148:151], a[80:83], v[60:63], v[148:151]
  v_mfma_f32_16x16x32_bf16 v[152:155], a[96:99], v[56:59], v[152:155]
  v_mfma_f32_16x16x32_bf16 v[152:155], a[108:111], v[68:71], v[152:155]
  buffer_load_dwordx4 a[176:179], v3, s[4:7], s70 offen offset:2048
  v_mfma_f32_16x16x32_bf16 v[152:155], a[100:103], v[60:63], v[152:155]
  ds_write_b128 v4, v[140:143] offset:3072
  v_mfma_f32_16x16x32_bf16 v[156:159], a[116:119], v[56:59], v[156:159]
  v_mfma_f32_16x16x32_bf16 v[156:159], a[128:131], v[68:71], v[156:159]
  s_waitcnt vmcnt(11)
  v_bitop3_b32 v27, v72, v84, v76 bitop3:0x80
  v_mfma_f32_16x16x32_bf16 v[156:159], a[120:123], v[60:63], v[156:159]
  buffer_load_dwordx4 a[180:183], v3, s[4:7], s70 offen offset:3072
  v_mfma_f32_16x16x32_bf16 v[160:163], a[136:139], v[56:59], v[160:163]
  ds_write_b128 v4, v[144:147] offset:4096
  v_mfma_f32_16x16x32_bf16 v[160:163], a[148:151], v[68:71], v[160:163]
  v_mfma_f32_16x16x32_bf16 v[160:163], a[140:143], v[60:63], v[160:163]
  v_mfma_f32_16x16x32_bf16 v[164:167], a[156:159], v[56:59], v[164:167]
  s_mov_b32 s70, 28672
  buffer_load_dwordx4 a[184:187], v3, s[4:7], s70 offen offset:0
  v_mfma_f32_16x16x32_bf16 v[164:167], a[168:171], v[68:71], v[164:167]
  ds_write_b128 v5, v[148:151] offset:0
  v_mfma_f32_16x16x32_bf16 v[164:167], a[160:163], v[60:63], v[164:167]
  s_waitcnt vmcnt(11)
  v_bitop3_b32 v27, v27, v88, v80 bitop3:0x80
  v_bitop3_b32 v27, v27, v27, v14 bitop3:0x2a
  v_cmp_ne_u32 vcc, 0, v27
  ds_write_b128 v5, v[152:155] offset:1024
  buffer_load_dwordx4 a[188:191], v3, s[4:7], s70 offen offset:1024
  s_cbranch_vccnz L_retry_141
L_ok_142:
  v_mfma_f32_16x16x32_bf16 v[168:171], a[72:75], v[72:75], 0
  v_mfma_f32_16x16x32_bf16 v[168:171], a[84:87], v[84:87], v[168:171]
  ds_write_b128 v5, v[156:159] offset:2048
  v_mfma_f32_16x16x32_bf16 v[168:171], a[76:79], v[76:79], v[168:171]
  buffer_load_dwordx4 a[192:195], v3, s[4:7], s70 offen offset:2048
  v_mfma_f32_16x16x32_bf16 v[168:171], a[88:91], v[88:91], v[168:171]
  v_mfma_f32_16x16x32_bf16 v[168:171], a[80:83], v[80:83], v[168:171]
  ds_write_b128 v5, v[160:163] offset:3072
  v_mfma_f32_16x16x32_bf16 v[172:175], a[92:95], v[72:75], 0
  s_waitcnt vmcnt(11)
  v_bitop3_b32 v27, v112, v114, v14 bitop3:0x2a
  v_mfma_f32_16x16x32_bf16 v[172:175], a[104:107], v[84:87], v[172:175]
  buffer_load_dwordx4 a[196:199], v3, s[4:7], s70 offen offset:3072
  v_mfma_f32_16x16x32_bf16 v[172:175], a[96:99], v[76:79], v[172:175]
  ds_write_b128 v5, v[164:167] offset:4096
  v_mfma_f32_16x16x32_bf16 v[172:175], a[108:111], v[88:91], v[172:175]
  v_cmp_ne_u32 vcc, 0, v27
  v_mfma_f32_16x16x32_bf16 v[172:175], a[100:103], v[80:83], v[172:175]
  s_cbranch_vccz L_ok_144
L_retry_143:
  s_sub_u32 s69, s69, 1
  s_cbranch_scc1 L_retry_143_to
  buffer_load_dwordx2 v[112:113], v15, s[4:7], s54 offen offset:0 sc1
  buffer_load_dwordx2 v[114:115], v15, s[4:7], s54 offen offset:512 sc1
  s_waitcnt vmcnt(0)
  v_bitop3_b32 v27, v112, v114, v14 bitop3:0x2a
  v_cmp_ne_u32 vcc, 0, v27
  s_nop 1
  s_cbranch_vccnz L_retry_143
  v_bitop3_b32 v27, v92, v104, v96 bitop3:0x80
  v_bitop3_b32 v27, v27, v108, v100 bitop3:0x80
  v_bitop3_b32 v27, v27, v27, v14 bitop3:0x2a
  v_cmp_ne_u32 vcc, 0, v27
  s_nop 1
  s_cbranch_vccz L_ok_144
  buffer_load_dwordx4 v[92:95], v1, s[4:7], s23 offen offset:0 sc1
  buffer_load_dwordx4 v[104:107], v1, s[4:7], s23 offen offset:3072 sc1
  buffer_load_dwordx4 v[96:99], v1, s[4:7], s23 offen offset:1024 sc1
  buffer_load_dwordx4 v[108:111], v1, s[4:7], s31 offen offset:0 sc1
  buffer_load_dwordx4 v[100:103], v1, s[4:7], s23 offen offset:2048 sc1
  buffer_load_dword a253, v26, s[4:7], s76 offen
  buffer_load_dword a253, v26, s[4:7], s76 offen
  buffer_load_dword a253, v26, s[4:7], s76 offen
  buffer_load_dword a253, v26, s[4:7], s76 offen
  buffer_load_dword a253, v26, s[4:7], s76 offen
  buffer_load_dword a253, v26, s[4:7], s76 offen
  buffer_load_dword a253, v26, s[4:7], s76 offen
L_ok_144:
  v_mfma_f32_16x16x32_bf16 v[176:179], a[112:115], v[72:75], 0
  s_mov_b32 s70, 32768
  buffer_load_dwordx4 a[200:203], v3, s[4:7], s70 offen offset:0
  v_mfma_f32_16x16x32_bf16 v[176:179], a[124:127], v[84:87], v[176:179]
  v_add_f32 v112, v112, v114
  v_mov_b32 v114, v112
  v_mfma_f32_16x16x32_bf16 v[176:179], a[116:119], v[76:79], v[176:179]
  v_add_f32 v113, v113, v115
  v_mov_b32 v115, v113
  v_mfma_f32_16x16x32_bf16 v[176:179], a[128:131], v[88:91], v[176:179]
  v_permlane16_swap_b32 v112, v114
  v_mfma_f32_16x16x32_bf16 v[176:179], a[120:123], v[80:83], v[176:179]
  v_add_f32 v112, v112, v114
  buffer_load_dwordx4 a[204:207], v3, s[4:7], s70 offen offset:1024
  v_mfma_f32_16x16x32_bf16 v[180:183], a[132:135], v[72:75], 0
  v_mov_b32 v114, v112
  v_mfma_f32_16x16x32_bf16 v[180:183], a[144:147], v[84:87], v[180:183]
  v_permlane16_swap_b32 v113, v115
  v_mfma_f32_16x16x32_bf16 v[180:183], a[136:139], v[76:79], v[180:183]
  s_waitcnt lgkmcnt(0)
  s_barrier
  v_mfma_f32_16x16x32_bf16 v[180:183], a[148:151], v[88:91], v[180:183]
  buffer_load_dwordx4 a[208:211], v3, s[4:7], s70 offen offset:2048
  v_mfma_f32_16x16x32_bf16 v[180:183], a[140:143], v[80:83], v[180:183]
  ds_read_b128 v[132:135], v7 offset:1024
  v_add_f32 v113, v113, v115
  v_mfma_f32_16x16x32_bf16 v[184:187], a[152:155], v[72:75], 0
  ds_read_b128 v[152:155], v7 offset:6144
  v_mov_b32 v115, v113
  v_mfma_f32_16x16x32_bf16 v[184:187], a[164:167], v[84:87], v[184:187]
  s_waitcnt vmcnt(12)
  v_bitop3_b32 v27, v92, v104, v96 bitop3:0x80
  v_mfma_f32_16x16x32_bf16 v[184:187], a[156:159], v[76:79], v[184:187]
  v_permlane32_swap_b32 v112, v114
  v_mfma_f32_16x16x32_bf16 v[184:187], a[168:171], v[88:91], v[184:187]
  buffer_load_dwordx4 a[212:215], v3, s[4:7], s70 offen offset:3072
  v_mfma_f32_16x16x32_bf16 v[184:187], a[160:163], v[80:83], v[184:187]
  s_waitcnt vmcnt(11)
  v_bitop3_b32 v27, v27, v108, v100 bitop3:0x80
  v_bitop3_b32 v27, v27, v27, v14 bitop3:0x2a
  v_add_f32 v112, v112, v114
  v_cmp_ne_u32 vcc, 0, v27
  v_mul_f32 v28, 0xbacccccd, v112
  s_cbranch_vccnz L_retry_145
L_ok_146:
  v_mul_f32 v188, v28, v188
  v_mul_f32 v189, v28, v189
  v_mul_f32 v190, v28, v190
  v_mul_f32 v191, v28, v191
  ds_read_b128 v[136:139], v7 offset:2048
  v_cmp_ne_u32 vcc, 0, v120
  v_mfma_f32_16x16x32_bf16 v[188:191], a[72:75], v[92:95], v[188:191]
  s_mov_b32 s70, 36864
  buffer_load_dwordx4 a[216:219], v3, s[4:7], s70 offen offset:0
  ds_read_b128 v[156:159], v7 offset:7168
  v_mfma_f32_16x16x32_bf16 v[188:191], a[84:87], v[104:107], v[188:191]
  ds_write_b128 v6, v[168:171] offset:0
  v_mfma_f32_16x16x32_bf16 v[188:191], a[76:79], v[96:99], v[188:191]
  ds_read_b128 v[140:143], v7 offset:3072
  s_waitcnt lgkmcnt(4)
  v_add_f32 v132, v132, v152
  v_mfma_f32_16x16x32_bf16 v[188:191], a[88:91], v[108:111], v[188:191]
  ds_read_b128 v[160:163], v7 offset:8192
  buffer_load_dwordx4 a[220:223], v3, s[4:7], s70 offen offset:1024
  ds_write_b128 v6, v[172:175] offset:1024
  ds_read_b128 v[144:147], v7 offset:4096
  v_mfma_f32_16x16x32_bf16 v[188:191], a[80:83], v[100:103], v[188:191]
  v_add_f32 v133, v133, v153
  ds_read_b128 v[164:167], v7 offset:9216
  v_add_f32 v134, v134, v154
  v_add_f32 v135, v135, v155
  v_fmac_f32 v132, v28, v192
  ds_write_b128 v6, v[176:179] offset:2048
  buffer_load_dwordx4 a[224:227], v3, s[4:7], s70 offen offset:2048
  ds_read_b128 v[128:131], v7 offset:0
  v_fmac_f32 v133, v28, v193
  v_fmac_f32 v134, v28, v194
  v_fmac_f32 v135, v28, v195
  ds_read_b128 v[148:151], v7 offset:5120
  s_waitcnt lgkmcnt(9)
  v_add_f32 v136, v136, v156
  v_mfma_f32_16x16x32_bf16 v[192:195], a[92:95], v[92:95], v[132:135]
  ds_write_b128 v6, v[180:183] offset:3072
  v_mfma_f32_16x16x32_bf16 v[192:195], a[104:107], v[104:107], v[192:195]
  v_add_f32 v137, v137, v157
  buffer_load_dwordx4 a[228:231], v3, s[4:7], s70 offen offset:3072
  v_mfma_f32_16x16x32_bf16 v[192:195], a[96:99], v[96:99], v[192:195]
  v_add_f32 v138, v138, v158
  v_add_f32 v139, v139, v159
  ds_write_b128 v6, v[184:187] offset:4096
  v_mfma_f32_16x16x32_bf16 v[192:195], a[108:111], v[108:111], v[192:195]
  v_fmac_f32 v136, v28, v196
  v_fmac_f32 v137, v28, v197
  v_mfma_f32_16x16x32_bf16 v[192:195], a[100:103], v[100:103], v[192:195]
  v_fmac_f32 v138, v28, v198
  s_mov_b32 s70, 40960
  buffer_load_dwordx4 a[232:235], v3, s[4:7], s70 offen offset:0
  v_fmac_f32 v139, v28, v199
  s_waitcnt lgkmcnt(8)
  v_add_f32 v140, v140, v160
  v_add_f32 v141, v141, v161
  v_mfma_f32_16x16x32_bf16 v[196:199], a[112:115], v[92:95], v[136:139]
  v_add_f32 v142, v142, v162
  v_add_f32 v143, v143, v163
  v_mfma_f32_16x16x32_bf16 v[196:199], a[124:127], v[104:107], v[196:199]
  v_fmac_f32 v140, v28, v200
  v_fmac_f32 v141, v28, v201
  v_mfma_f32_16x16x32_bf16 v[196:199], a[116:119], v[96:99], v[196:199]
  v_fmac_f32 v142, v28, v202
  v_fmac_f32 v143, v28, v203
  buffer_load_dwordx4 a[236:239], v3, s[4:7], s70 offen offset:1024
  v_mfma_f32_16x16x32_bf16 v[196:199], a[128:131], v[108:111], v[196:199]
  s_waitcnt lgkmcnt(2)
  v_add_f32 v128, v128, v148
  v_add_f32 v129, v129, v149
  v_mfma_f32_16x16x32_bf16 v[196:199], a[120:123], v[100:103], v[196:199]
  v_add_f32 v130, v130, v150
  v_add_f32 v131, v131, v151
  v_mfma_f32_16x16x32_bf16 v[200:203], a[132:135], v[92:95], v[140:143]
  ds_read_b128 v[148:151], v8 offset:0
  v_add_f32 v144, v144, v164
  s_waitcnt lgkmcnt(1)
  s_barrier
  buffer_load_dwordx4 a[240:243], v3, s[4:7], s70 offen offset:2048
  ds_read_b128 v[168:171], v7 offset:10240
  v_mfma_f32_16x16x32_bf16 v[200:203], a[144:147], v[104:107], v[200:203]
  v_add_f32 v145, v145, v165
  ds_read_b128 v[172:175], v7 offset:11264
  v_mfma_f32_16x16x32_bf16 v[200:203], a[136:139], v[96:99], v[200:203]
  v_add_f32 v146, v146, v166
  ds_read_b128 v[176:179], v7 offset:12288
  v_mfma_f32_16x16x32_bf16 v[200:203], a[148:151], v[108:111], v[200:203]
  v_add_f32 v147, v147, v167
  ds_read_b128 v[180:183], v7 offset:13312
  v_mfma_f32_16x16x32_bf16 v[200:203], a[140:143], v[100:103], v[200:203]
  v_fmac_f32 v144, v28, v204
  buffer_load_dwordx4 a[244:247], v3, s[4:7], s70 offen offset:3072
  ds_read_b128 v[184:187], v7 offset:14336
  v_fmac_f32 v145, v28, v205
  v_fmac_f32 v146, v28, v206
  v_fmac_f32 v147, v28, v207
  ds_read_b128 v[152:155], v8 offset:192
  v_add_f32 v188, v188, v128
  v_mfma_f32_16x16x32_bf16 v[204:207], a[152:155], v[92:95], v[144:147]
  ds_read_b128 v[156:159], v8 offset:384
  v_add_f32 v189, v189, v129
  v_mfma_f32_16x16x32_bf16 v[204:207], a[164:167], v[104:107], v[204:207]
  ds_read_b128 v[160:163], v8 offset:576
  v_add_f32 v190, v190, v130
  v_mfma_f32_16x16x32_bf16 v[204:207], a[156:159], v[96:99], v[204:207]
  s_mov_b32 s70, 45056
  buffer_load_dwordx4 a[248:251], v3, s[4:7], s70 offen offset:0
  ds_read_b128 v[164:167], v8 offset:768
  v_mfma_f32_16x16x32_bf16 v[204:207], a[168:171], v[108:111], v[204:207]
  v_add_f32 v191, v191, v131
  s_waitcnt lgkmcnt(8)
  v_add_f32 v188, v188, v168
  v_add_f32 v189, v189, v169
  v_add_f32 v190, v190, v170
  v_add_f32 v191, v191, v171
  ds_read_b128 v[168:171], v8 offset:16
  v_mfma_f32_16x16x32_bf16 v[204:207], a[160:163], v[100:103], v[204:207]
  v_cvt_pk_bf16_f32 v128, v188, v189
  v_cvt_pk_bf16_f32 v129, v190, v191
  s_waitcnt lgkmcnt(8)
  v_pk_add_f32 v[192:193], v[192:193], v[172:173]
  v_pk_add_f32 v[194:195], v[194:195], v[174:175]
  buffer_load_dwordx4 a[0:3], v3, s[4:7], s70 offen offset:1024
  ds_read_b128 v[172:175], v8 offset:208
  s_waitcnt lgkmcnt(8)
  v_pk_add_f32 v[196:197], v[196:197], v[176:177]
  v_pk_add_f32 v[198:199], v[198:199], v[178:179]
  s_waitcnt lgkmcnt(7)
  v_pk_add_f32 v[200:201], v[200:201], v[180:181]
  v_pk_add_f32 v[202:203], v[202:203], v[182:183]
  ds_read_b128 v[176:179], v8 offset:400
  s_waitcnt lgkmcnt(7)
  v_pk_add_f32 v[204:205], v[204:205], v[184:185]
  v_pk_add_f32 v[206:207], v[206:207], v[186:187]
  v_cvt_pk_bf16_f32 v130, v192, v193
  ds_read_b128 v[180:183], v8 offset:592
  v_cvt_pk_bf16_f32 v131, v194, v195
  v_cvt_pk_bf16_f32 v132, v196, v197
  v_mov_b32 v138, 0
  ds_read_b128 v[184:187], v8 offset:784
  buffer_load_dwordx4 a[4:7], v3, s[4:7], s70 offen offset:2048
  v_mfma_f32_16x16x32_bf16 v[228:231], v[148:151], v[128:131], 0
  ds_read_b128 v[148:151], v8 offset:32
  v_mov_b32 v139, 0
  s_waitcnt lgkmcnt(9)
  v_mfma_f32_16x16x32_bf16 v[232:235], v[152:155], v[128:131], 0
  ds_read_b128 v[152:155], v8 offset:224
  v_cndmask_b32 v117, v122, v117, vcc
  s_waitcnt lgkmcnt(9)
  v_mfma_f32_16x16x32_bf16 v[236:239], v[156:159], v[128:131], 0
  ds_read_b128 v[156:159], v8 offset:416
  v_cmp_gt_u32 vcc, 32, v0
  s_waitcnt lgkmcnt(9)
  v_mfma_f32_16x16x32_bf16 v[240:243], v[160:163], v[128:131], 0
  ds_read_b128 v[160:163], v8 offset:608
  v_cndmask_b32 v118, v122, v1, vcc
  buffer_load_dwordx4 a[8:11], v3, s[4:7], s70 offen offset:3072
  s_waitcnt lgkmcnt(9)
  v_mfma_f32_16x16x32_bf16 v[244:247], v[164:167], v[128:131], 0
  v_cvt_pk_bf16_f32 v133, v198, v199
  v_cvt_pk_bf16_f32 v134, v200, v201
  v_cvt_pk_bf16_f32 v135, v202, v203
  ds_read_b128 v[164:167], v8 offset:800
  v_and_b32 v120, 12, v0
  s_waitcnt lgkmcnt(9)
  v_mfma_f32_16x16x32_bf16 v[228:231], v[168:171], v[132:135], v[228:231]
  v_cvt_pk_bf16_f32 v136, v204, v205
  s_waitcnt lgkmcnt(8)
  v_mfma_f32_16x16x32_bf16 v[232:235], v[172:175], v[132:135], v[232:235]
  v_cvt_pk_bf16_f32 v137, v206, v207
  s_mov_b32 s70, 49152
  buffer_load_dwordx4 a[12:15], v3, s[4:7], s70 offen offset:0
  s_waitcnt lgkmcnt(7)
  v_mfma_f32_16x16x32_bf16 v[236:239], v[176:179], v[132:135], v[236:239]
  v_permlane32_swap_b32 v113, v115
  s_waitcnt lgkmcnt(6)
  v_mfma_f32_16x16x32_bf16 v[240:243], v[180:183], v[132:135], v[240:243]
  v_add_f32 v113, v113, v115
  v_mul_f32 v113, 0x3acccccd, v113
  s_waitcnt lgkmcnt(5)
  v_mfma_f32_16x16x32_bf16 v[244:247], v[184:187], v[132:135], v[244:247]
  v_fma_f32 v29, -v28, v28, v113
  s_waitcnt lgkmcnt(4)
  v_mfma_f32_16x16x32_bf16 v[228:231], v[148:151], v[136:139], v[228:231]
  v_max_f32 v29, 0, v29
  buffer_load_dwordx4 a[16:19], v3, s[4:7], s70 offen offset:1024
  s_waitcnt lgkmcnt(3)
  v_mfma_f32_16x16x32_bf16 v[232:235], v[152:155], v[136:139], v[232:235]
  v_add_f32 v31, 0x3727c5ac, v29
  v_cmp_eq_u32 vcc, 0, v120
  s_waitcnt lgkmcnt(2)
  v_mfma_f32_16x16x32_bf16 v[236:239], v[156:159], v[136:139], v[236:239]
  v_rsq_f32 v30, v31
  s_waitcnt lgkmcnt(1)
  v_mfma_f32_16x16x32_bf16 v[240:243], v[160:163], v[136:139], v[240:243]
  v_max3_f32 v248, v228, v229, v230
  s_waitcnt lgkmcnt(0)
  v_mfma_f32_16x16x32_bf16 v[244:247], v[164:167], v[136:139], v[244:247]
  v_mul_f32 v252, s78, v30
  v_cndmask_b32 v125, v122, v125, vcc
  s_waitcnt vmcnt(24)
  v_mfma_f32_16x16x32_bf16 v[128:131], a[172:175], v[32:35], 0
  buffer_load_dwordx4 a[20:23], v3, s[4:7], s70 offen offset:2048
  s_waitcnt vmcnt(24)
  v_mfma_f32_16x16x32_bf16 v[128:131], a[176:179], v[36:39], v[128:131]
  v_max3_f32 v248, v248, v231, v232
  s_waitcnt vmcnt(23)
  v_mfma_f32_16x16x32_bf16 v[128:131], a[180:183], v[40:43], v[128:131]
  v_max3_f32 v248, v248, v233, v234
  s_waitcnt vmcnt(22)
  v_mfma_f32_16x16x32_bf16 v[128:131], a[184:187], v[44:47], v[128:131]
  v_max3_f32 v248, v248, v235, v236
  s_waitcnt vmcnt(21)
  v_mfma_f32_16x16x32_bf16 v[128:131], a[188:191], v[48:51], v[128:131]
  v_max3_f32 v248, v248, v237, v238
  s_waitcnt vmcnt(20)
  v_mfma_f32_16x16x32_bf16 v[132:135], a[192:195], v[32:35], 0
  buffer_load_dwordx4 a[24:27], v3, s[4:7], s70 offen offset:3072
  s_waitcnt vmcnt(20)
  v_mfma_f32_16x16x32_bf16 v[132:135], a[196:199], v[36:39], v[132:135]
  v_max3_f32 v248, v248, v239, v240
  s_waitcnt vmcnt(19)
  v_mfma_f32_16x16x32_bf16 v[132:135], a[200:203], v[40:43], v[132:135]
  v_max3_f32 v248, v248, v241, v242
  s_waitcnt vmcnt(18)
  v_mfma_f32_16x16x32_bf16 v[132:135], a[204:207], v[44:47], v[132:135]
  v_max3_f32 v248, v248, v243, v244
  s_waitcnt vmcnt(17)
  v_mfma_f32_16x16x32_bf16 v[132:135], a[208:211], v[48:51], v[132:135]
  v_max3_f32 v248, v248, v245, v246
  s_waitcnt vmcnt(16)
  v_mfma_f32_16x16x32_bf16 v[136:139], a[212:215], v[32:35], 0
  s_mov_b32 s70, 53248
  buffer_load_dwordx4 a[28:31], v3, s[4:7], s70 offen offset:0
  s_waitcnt vmcnt(16)
  v_mfma_f32_16x16x32_bf16 v[136:139], a[216:219], v[36:39], v[136:139]
  v_max_f32 v248, v248, v247
  v_mul_f32 v248, v252, v248
  v_pk_fma_f32 v[188:189], v[228:229], v[252:253], v[248:249] op_sel_hi:[1,0,0] neg_lo:[0,0,1] neg_hi:[0,0,1]
  v_pk_fma_f32 v[190:191], v[230:231], v[252:253], v[248:249] op_sel_hi:[1,0,0] neg_lo:[0,0,1] neg_hi:[0,0,1]
  v_pk_fma_f32 v[192:193], v[232:233], v[252:253], v[248:249] op_sel_hi:[1,0,0] neg_lo:[0,0,1] neg_hi:[0,0,1]
  v_pk_fma_f32 v[194:195], v[234:235], v[252:253], v[248:249] op_sel_hi:[1,0,0] neg_lo:[0,0,1] neg_hi:[0,0,1]
  v_pk_fma_f32 v[196:197], v[236:237], v[252:253], v[248:249] op_sel_hi:[1,0,0] neg_lo:[0,0,1] neg_hi:[0,0,1]
  v_pk_fma_f32 v[198:199], v[238:239], v[252:253], v[248:249] op_sel_hi:[1,0,0] neg_lo:[0,0,1] neg_hi:[0,0,1]
  v_pk_fma_f32 v[200:201], v[240:241], v[252:253], v[248:249] op_sel_hi:[1,0,0] neg_lo:[0,0,1] neg_hi:[0,0,1]
  v_pk_fma_f32 v[202:203], v[242:243], v[252:253], v[248:249] op_sel_hi:[1,0,0] neg_lo:[0,0,1] neg_hi:[0,0,1]
  v_pk_fma_f32 v[204:205], v[244:245], v[252:253], v[248:249] op_sel_hi:[1,0,0] neg_lo:[0,0,1] neg_hi:[0,0,1]
  v_pk_fma_f32 v[206:207], v[246:247], v[252:253], v[248:249] op_sel_hi:[1,0,0] neg_lo:[0,0,1] neg_hi:[0,0,1]
  buffer_load_dwordx4 a[32:35], v3, s[4:7], s70 offen offset:1024
  s_waitcnt vmcnt(16)
  v_mfma_f32_16x16x32_bf16 v[136:139], a[220:223], v[40:43], v[136:139]
  v_exp_f32 v188, v188
  s_waitcnt vmcnt(15)
  v_mfma_f32_16x16x32_bf16 v[136:139], a[224:227], v[44:47], v[136:139]
  v_exp_f32 v189, v189
  s_waitcnt vmcnt(14)
  v_mfma_f32_16x16x32_bf16 v[136:139], a[228:231], v[48:51], v[136:139]
  v_exp_f32 v190, v190
  s_waitcnt vmcnt(13)
  v_mfma_f32_16x16x32_bf16 v[140:143], a[232:235], v[32:35], 0
  v_exp_f32 v191, v191
  s_waitcnt vmcnt(12)
  v_mfma_f32_16x16x32_bf16 v[140:143], a[236:239], v[36:39], v[140:143]
  buffer_load_dwordx4 a[36:39], v3, s[4:7], s70 offen offset:2048
  s_waitcnt vmcnt(12)
  v_mfma_f32_16x16x32_bf16 v[140:143], a[240:243], v[40:43], v[140:143]
  v_exp_f32 v192, v192
  v_exp_f32 v193, v193
  v_exp_f32 v194, v194
  v_exp_f32 v195, v195
  v_exp_f32 v196, v196
  v_exp_f32 v197, v197
  v_exp_f32 v198, v198
  buffer_load_dwordx4 a[40:43], v3, s[4:7], s70 offen offset:3072
  s_waitcnt vmcnt(12)
  v_mfma_f32_16x16x32_bf16 v[140:143], a[244:247], v[44:47], v[140:143]
  v_exp_f32 v199, v199
  v_exp_f32 v200, v200
  v_exp_f32 v201, v201
  v_exp_f32 v202, v202
  v_exp_f32 v203, v203
  v_exp_f32 v204, v204
  v_exp_f32 v205, v205
  s_mov_b32 s70, 57344
  buffer_load_dwordx4 a[44:47], v3, s[4:7], s70 offen offset:0
  s_waitcnt vmcnt(12)
  v_mfma_f32_16x16x32_bf16 v[140:143], a[248:251], v[48:51], v[140:143]
  v_exp_f32 v206, v206
  v_exp_f32 v207, v207
  v_pk_add_f32 v[248:249], v[188:189], v[190:191]
  v_pk_add_f32 v[248:249], v[248:249], v[192:193]
  v_pk_add_f32 v[248:249], v[248:249], v[194:195]
  v_pk_add_f32 v[248:249], v[248:249], v[196:197]
  v_pk_add_f32 v[248:249], v[248:249], v[198:199]
  v_pk_add_f32 v[248:249], v[248:249], v[200:201]
  v_pk_add_f32 v[248:249], v[248:249], v[202:203]
  v_pk_add_f32 v[248:249], v[248:249], v[204:205]
  v_pk_add_f32 v[248:249], v[248:249], v[206:207]
  buffer_load_dwordx4 a[48:51], v3, s[4:7], s70 offen offset:1024
  s_waitcnt vmcnt(12)
  v_mfma_f32_16x16x32_bf16 v[144:147], a[0:3], v[32:35], 0
  ds_write_b128 v4, v[128:131] offset:0
  v_add_f32 v248, v248, v249
  v_rcp_f32 v248, v248
  s_nop 0
  v_pk_mul_f32 v[188:189], v[188:189], v[248:249] op_sel_hi:[1,0]
  v_pk_mul_f32 v[190:191], v[190:191], v[248:249] op_sel_hi:[1,0]
  v_pk_mul_f32 v[192:193], v[192:193], v[248:249] op_sel_hi:[1,0]
  v_pk_mul_f32 v[194:195], v[194:195], v[248:249] op_sel_hi:[1,0]
  v_pk_mul_f32 v[196:197], v[196:197], v[248:249] op_sel_hi:[1,0]
  v_pk_mul_f32 v[198:199], v[198:199], v[248:249] op_sel_hi:[1,0]
  v_pk_mul_f32 v[200:201], v[200:201], v[248:249] op_sel_hi:[1,0]
  v_pk_mul_f32 v[202:203], v[202:203], v[248:249] op_sel_hi:[1,0]
  v_pk_mul_f32 v[204:205], v[204:205], v[248:249] op_sel_hi:[1,0]
  v_pk_mul_f32 v[206:207], v[206:207], v[248:249] op_sel_hi:[1,0]
  buffer_load_dwordx4 a[52:55], v3, s[4:7], s70 offen offset:2048
  s_waitcnt vmcnt(12)
  v_mfma_f32_16x16x32_bf16 v[144:147], a[4:7], v[36:39], v[144:147]
  ds_write_b128 v4, v[132:135] offset:1024
  v_min3_f32 v250, v228, v229, v230
  v_min3_f32 v250, v250, v231, v232
  s_waitcnt vmcnt(11)
  v_mfma_f32_16x16x32_bf16 v[144:147], a[8:11], v[40:43], v[144:147]
  v_min3_f32 v250, v250, v233, v234
  v_min3_f32 v250, v250, v235, v236
  v_min3_f32 v250, v250, v237, v238
  buffer_load_dwordx4 a[56:59], v3, s[4:7], s70 offen offset:3072
  ds_write_b128 v4, v[136:139] offset:2048
  v_min3_f32 v250, v250, v239, v240
  v_min3_f32 v250, v250, v241, v242
  v_min3_f32 v250, v250, v243, v244
  v_cvt_pk_bf16_f32 v188, v188, v189
  s_waitcnt vmcnt(11)
  v_mfma_f32_16x16x32_bf16 v[144:147], a[12:15], v[44:47], v[144:147]
  v_min3_f32 v250, v250, v245, v246
  ds_write_b128 v4, v[140:143] offset:3072
  s_mov_b32 s70, 61440
  buffer_load_dwordx4 a[60:63], v3, s[4:7], s70 offen offset:0
  v_cvt_pk_bf16_f32 v189, v190, v191
  v_min_f32 v250, v250, v247
  v_cvt_pk_bf16_f32 v190, v192, v193
  v_cvt_pk_bf16_f32 v191, v194, v195
  v_mul_f32 v250, v252, v250
  v_pk_fma_f32 v[228:229], v[228:229], v[252:253], v[250:251] op_sel_hi:[1,0,0] neg_lo:[1,0,0] neg_hi:[1,0,0]
  v_pk_fma_f32 v[230:231], v[230:231], v[252:253], v[250:251] op_sel_hi:[1,0,0] neg_lo:[1,0,0] neg_hi:[1,0,0]
  v_pk_fma_f32 v[232:233], v[232:233], v[252:253], v[250:251] op_sel_hi:[1,0,0] neg_lo:[1,0,0] neg_hi:[1,0,0]
  v_pk_fma_f32 v[234:235], v[234:235], v[252:253], v[250:251] op_sel_hi:[1,0,0] neg_lo:[1,0,0] neg_hi:[1,0,0]
  v_pk_fma_f32 v[236:237], v[236:237], v[252:253], v[250:251] op_sel_hi:[1,0,0] neg_lo:[1,0,0] neg_hi:[1,0,0]
  v_pk_fma_f32 v[238:239], v[238:239], v[252:253], v[250:251] op_sel_hi:[1,0,0] neg_lo:[1,0,0] neg_hi:[1,0,0]
  v_pk_fma_f32 v[240:241], v[240:241], v[252:253], v[250:251] op_sel_hi:[1,0,0] neg_lo:[1,0,0] neg_hi:[1,0,0]
  v_pk_fma_f32 v[242:243], v[242:243], v[252:253], v[250:251] op_sel_hi:[1,0,0] neg_lo:[1,0,0] neg_hi:[1,0,0]
  v_pk_fma_f32 v[244:245], v[244:245], v[252:253], v[250:251] op_sel_hi:[1,0,0] neg_lo:[1,0,0] neg_hi:[1,0,0]
  v_pk_fma_f32 v[246:247], v[246:247], v[252:253], v[250:251] op_sel_hi:[1,0,0] neg_lo:[1,0,0] neg_hi:[1,0,0]
  buffer_load_dwordx4 a[64:67], v3, s[4:7], s70 offen offset:1024
  s_waitcnt vmcnt(12)
  v_mfma_f32_16x16x32_bf16 v[144:147], a[16:19], v[48:51], v[144:147]
  ds_write_b128 v10, v[188:191] offset:0
  v_mfma_f32_16x16x32_bf16 v[148:151], a[172:175], v[52:55], 0
  v_exp_f32 v228, v228
  v_mfma_f32_16x16x32_bf16 v[148:151], a[176:179], v[56:59], v[148:151]
  ds_read_b128 v[188:191], v12 offset:320
  v_mfma_f32_16x16x32_bf16 v[148:151], a[180:183], v[60:63], v[148:151]
  buffer_load_dwordx4 a[68:71], v3, s[4:7], s70 offen offset:2048
  v_mfma_f32_16x16x32_bf16 v[148:151], a[184:187], v[64:67], v[148:151]
  ds_write_b128 v4, v[144:147] offset:4096
  v_mfma_f32_16x16x32_bf16 v[148:151], a[188:191], v[68:71], v[148:151]
  v_exp_f32 v229, v229
  v_mfma_f32_16x16x32_bf16 v[152:155], a[192:195], v[52:55], 0
  v_exp_f32 v230, v230
  v_mfma_f32_16x16x32_bf16 v[152:155], a[196:199], v[56:59], v[152:155]
  buffer_load_dwordx4 a[72:75], v3, s[4:7], s70 offen offset:3072
  v_mfma_f32_16x16x32_bf16 v[152:155], a[200:203], v[60:63], v[152:155]
  v_exp_f32 v231, v231
  v_mfma_f32_16x16x32_bf16 v[152:155], a[204:207], v[64:67], v[152:155]
  ds_write_b128 v5, v[148:151] offset:0
  v_mfma_f32_16x16x32_bf16 v[152:155], a[208:211], v[68:71], v[152:155]
  v_exp_f32 v232, v232
  v_mfma_f32_16x16x32_bf16 v[156:159], a[212:215], v[52:55], 0
  s_mov_b32 s70, 65536
  buffer_load_dwordx4 a[76:79], v3, s[4:7], s70 offen offset:0
  v_mfma_f32_16x16x32_bf16 v[156:159], a[216:219], v[56:59], v[156:159]
  v_exp_f32 v233, v233
  v_mfma_f32_16x16x32_bf16 v[156:159], a[220:223], v[60:63], v[156:159]
  v_exp_f32 v234, v234
  v_mfma_f32_16x16x32_bf16 v[156:159], a[224:227], v[64:67], v[156:159]
  ds_write_b128 v5, v[152:155] offset:1024
  v_mfma_f32_16x16x32_bf16 v[156:159], a[228:231], v[68:71], v[156:159]
  buffer_load_dwordx4 a[80:83], v3, s[4:7], s70 offen offset:1024
  v_mfma_f32_16x16x32_bf16 v[160:163], a[232:235], v[52:55], 0
  v_exp_f32 v235, v235
  v_mfma_f32_16x16x32_bf16 v[160:163], a[236:239], v[56:59], v[160:163]
  v_exp_f32 v236, v236
  v_mfma_f32_16x16x32_bf16 v[160:163], a[240:243], v[60:63], v[160:163]
  v_exp_f32 v237, v237
  v_mfma_f32_16x16x32_bf16 v[160:163], a[244:247], v[64:67], v[160:163]
  ds_write_b128 v5, v[156:159] offset:2048
  buffer_load_dwordx4 a[84:87], v3, s[4:7], s70 offen offset:2048
  v_mfma_f32_16x16x32_bf16 v[160:163], a[248:251], v[68:71], v[160:163]
  v_exp_f32 v238, v238
  v_mfma_f32_16x16x32_bf16 v[164:167], a[0:3], v[52:55], 0
  v_exp_f32 v239, v239
  v_mfma_f32_16x16x32_bf16 v[164:167], a[4:7], v[56:59], v[164:167]
  v_exp_f32 v240, v240
  v_mfma_f32_16x16x32_bf16 v[164:167], a[8:11], v[60:63], v[164:167]
  v_exp_f32 v241, v241
  v_mfma_f32_16x16x32_bf16 v[164:167], a[12:15], v[64:67], v[164:167]
  buffer_load_dwordx4 a[88:91], v3, s[4:7], s70 offen offset:3072
  v_mfma_f32_16x16x32_bf16 v[164:167], a[16:19], v[68:71], v[164:167]
  ds_write_b128 v5, v[160:163] offset:3072
  v_mfma_f32_16x16x32_bf16 v[168:171], a[172:175], v[72:75], 0
  v_exp_f32 v242, v242
  v_mfma_f32_16x16x32_bf16 v[168:171], a[176:179], v[76:79], v[168:171]
  v_exp_f32 v243, v243
  v_mfma_f32_16x16x32_bf16 v[168:171], a[180:183], v[80:83], v[168:171]
  s_mov_b32 s70, 69632
  buffer_load_dwordx4 a[92:95], v3, s[4:7], s70 offen offset:0
  v_mfma_f32_16x16x32_bf16 v[168:171], a[184:187], v[84:87], v[168:171]
  ds_write_b128 v5, v[164:167] offset:4096
  v_mfma_f32_16x16x32_bf16 v[168:171], a[188:191], v[88:91], v[168:171]
  v_exp_f32 v244, v244
  v_mfma_f32_16x16x32_bf16 v[172:175], a[192:195], v[72:75], 0
  v_exp_f32 v245, v245
  v_mfma_f32_16x16x32_bf16 v[172:175], a[196:199], v[76:79], v[172:175]
  buffer_load_dwordx4 a[96:99], v3, s[4:7], s70 offen offset:1024
  v_mfma_f32_16x16x32_bf16 v[172:175], a[200:203], v[80:83], v[172:175]
  v_exp_f32 v246, v246
  v_mfma_f32_16x16x32_bf16 v[172:175], a[204:207], v[84:87], v[172:175]
  v_exp_f32 v247, v247
  v_pk_add_f32 v[250:251], v[228:229], v[230:231]
  v_pk_add_f32 v[250:251], v[250:251], v[232:233]
  v_pk_add_f32 v[250:251], v[250:251], v[234:235]
  v_pk_add_f32 v[250:251], v[250:251], v[236:237]
  v_pk_add_f32 v[250:251], v[250:251], v[238:239]
  v_pk_add_f32 v[250:251], v[250:251], v[240:241]
  v_pk_add_f32 v[250:251], v[250:251], v[242:243]
  v_pk_add_f32 v[250:251], v[250:251], v[244:245]
  v_pk_add_f32 v[250:251], v[250:251], v[246:247]
  buffer_load_dwordx4 a[100:103], v3, s[4:7], s70 offen offset:2048
  v_mfma_f32_16x16x32_bf16 v[172:175], a[208:211], v[88:91], v[172:175]
  v_cvt_pk_bf16_f32 v192, v196, v197
  v_mfma_f32_16x16x32_bf16 v[176:179], a[212:215], v[72:75], 0
  s_waitcnt lgkmcnt(0)
  s_barrier
  v_mfma_f32_16x16x32_bf16 v[176:179], a[216:219], v[76:79], v[176:179]
  buffer_load_dwordx4 a[104:107], v3, s[4:7], s70 offen offset:3072
  v_mfma_f32_16x16x32_bf16 v[176:179], a[220:223], v[80:83], v[176:179]
  v_cvt_pk_bf16_f32 v193, v198, v199
  v_mfma_f32_16x16x32_bf16 v[176:179], a[224:227], v[84:87], v[176:179]
  v_cvt_pk_bf16_f32 v194, v200, v201
  v_mfma_f32_16x16x32_bf16 v[176:179], a[228:231], v[88:91], v[176:179]
  v_cvt_pk_bf16_f32 v195, v202, v203
  v_mfma_f32_16x16x32_bf16 v[180:183], a[232:235], v[72:75], 0
  ds_write_b128 v10, v[192:195] offset:16
  s_mov_b32 s70, 73728
  buffer_load_dwordx4 a[108:111], v3, s[4:7], s70 offen offset:0
  v_mfma_f32_16x16x32_bf16 v[180:183], a[236:239], v[76:79], v[180:183]
  ds_read_b128 v[132:135], v7 offset:1024
  v_add_f32 v250, v250, v251
  v_mfma_f32_16x16x32_bf16 v[180:183], a[240:243], v[80:83], v[180:183]
  ds_read_b128 v[152:155], v7 offset:6144
  v_mul_f32 v188, v28, v188
  v_mfma_f32_16x16x32_bf16 v[180:183], a[244:247], v[84:87], v[180:183]
  ds_read_b128 v[192:195], v12 offset:336
  v_mul_f32 v189, v28, v189
  v_mfma_f32_16x16x32_bf16 v[180:183], a[248:251], v[88:91], v[180:183]
  v_rcp_f32 v250, v250
  s_nop 0
  v_pk_mul_f32 v[228:229], v[228:229], v[250:251] op_sel_hi:[1,0]
  v_pk_mul_f32 v[230:231], v[230:231], v[250:251] op_sel_hi:[1,0]
  v_pk_mul_f32 v[232:233], v[232:233], v[250:251] op_sel_hi:[1,0]
  v_pk_mul_f32 v[234:235], v[234:235], v[250:251] op_sel_hi:[1,0]
  v_pk_mul_f32 v[236:237], v[236:237], v[250:251] op_sel_hi:[1,0]
  v_pk_mul_f32 v[238:239], v[238:239], v[250:251] op_sel_hi:[1,0]
  v_pk_mul_f32 v[240:241], v[240:241], v[250:251] op_sel_hi:[1,0]
  v_pk_mul_f32 v[242:243], v[242:243], v[250:251] op_sel_hi:[1,0]
  v_pk_mul_f32 v[244:245], v[244:245], v[250:251] op_sel_hi:[1,0]
  v_pk_mul_f32 v[246:247], v[246:247], v[250:251] op_sel_hi:[1,0]
  buffer_load_dwordx4 a[112:115], v3, s[4:7], s70 offen offset:1024
  v_mfma_f32_16x16x32_bf16 v[184:187], a[0:3], v[72:75], 0
  v_cvt_pk_bf16_f32 v196, v204, v205
  v_mfma_f32_16x16x32_bf16 v[184:187], a[4:7], v[76:79], v[184:187]
  v_cvt_pk_bf16_f32 v197, v206, v207
  v_mfma_f32_16x16x32_bf16 v[184:187], a[8:11], v[80:83], v[184:187]
  v_cvt_pk_bf16_f32 v198, v228, v229
  v_mfma_f32_16x16x32_bf16 v[184:187], a[12:15], v[84:87], v[184:187]
  v_cvt_pk_bf16_f32 v199, v230, v231
  v_mfma_f32_16x16x32_bf16 v[184:187], a[16:19], v[88:91], v[184:187]
  buffer_load_dwordx4 a[116:119], v3, s[4:7], s70 offen offset:2048
  ds_write_b128 v10, v[196:199] offset:32
  v_mul_f32 v190, v28, v190
  v_mul_f32 v191, v28, v191
  ds_read_b128 v[136:139], v7 offset:2048
  s_waitcnt lgkmcnt(3)
  v_add_f32 v132, v132, v152
  v_mfma_f32_16x16x32_bf16 v[188:191], a[172:175], v[92:95], v[188:191]
  ds_read_b128 v[156:159], v7 offset:7168
  v_add_f32 v133, v133, v153
  ds_write_b128 v6, v[168:171] offset:0
  ds_read_b128 v[196:199], v12 offset:352
  s_mov_b32 s81, 57344
  buffer_load_dword a254, v2, s[96:99], s81 offen
  v_mfma_f32_16x16x32_bf16 v[188:191], a[176:179], v[96:99], v[188:191]
  ds_read_b128 v[140:143], v7 offset:3072
  v_add_f32 v134, v134, v154
  v_mfma_f32_16x16x32_bf16 v[188:191], a[180:183], v[100:103], v[188:191]
  ds_write_b128 v6, v[172:175] offset:1024
  ds_read_b128 v[160:163], v7 offset:8192
  v_mfma_f32_16x16x32_bf16 v[188:191], a[184:187], v[104:107], v[188:191]
  v_cvt_pk_bf16_f32 v200, v232, v233
  ds_read_b128 v[144:147], v7 offset:4096
  v_mfma_f32_16x16x32_bf16 v[188:191], a[188:191], v[108:111], v[188:191]
  buffer_load_dwordx4 a[120:123], v3, s[4:7], s70 offen offset:3072
  ds_write_b128 v6, v[176:179] offset:2048
  ds_read_b128 v[164:167], v7 offset:9216
  v_cvt_pk_bf16_f32 v201, v234, v235
  v_cvt_pk_bf16_f32 v202, v236, v237
  v_cvt_pk_bf16_f32 v203, v238, v239
  ds_read_b128 v[128:131], v7 offset:0
  v_add_f32 v135, v135, v155
  s_waitcnt lgkmcnt(12)
  v_fmac_f32 v132, v28, v192
  v_fmac_f32 v133, v28, v193
  ds_write_b128 v6, v[180:183] offset:3072
  s_mov_b32 s70, 77824
  buffer_load_dwordx4 a[124:127], v3, s[4:7], s70 offen offset:0
  ds_read_b128 v[148:151], v7 offset:5120
  v_fmac_f32 v134, v28, v194
  v_fmac_f32 v135, v28, v195
  v_cvt_pk_bf16_f32 v204, v240, v241
  s_waitcnt lgkmcnt(11)
  v_add_f32 v136, v136, v156
  v_mfma_f32_16x16x32_bf16 v[192:195], a[192:195], v[92:95], v[132:135]
  ds_write_b128 v6, v[184:187] offset:4096
  v_mfma_f32_16x16x32_bf16 v[192:195], a[196:199], v[96:99], v[192:195]
  v_cvt_pk_bf16_f32 v205, v242, v243
  v_mfma_f32_16x16x32_bf16 v[192:195], a[200:203], v[100:103], v[192:195]
  buffer_load_dwordx4 a[128:131], v3, s[4:7], s70 offen offset:1024
  ds_write_b128 v10, v[200:203] offset:48
  v_mfma_f32_16x16x32_bf16 v[192:195], a[204:207], v[104:107], v[192:195]
  v_cvt_pk_bf16_f32 v206, v244, v245
  ds_read_b128 v[200:203], v12 offset:368
  v_mfma_f32_16x16x32_bf16 v[192:195], a[208:211], v[108:111], v[192:195]
  v_cvt_pk_bf16_f32 v207, v246, v247
  v_add_f32 v137, v137, v157
  v_add_f32 v138, v138, v158
  v_add_f32 v139, v139, v159
  buffer_load_dwordx4 a[132:135], v3, s[4:7], s70 offen offset:2048
  ds_write_b128 v10, v[204:207] offset:64
  s_waitcnt lgkmcnt(13)
  v_fmac_f32 v136, v28, v196
  v_fmac_f32 v137, v28, v197
  v_fmac_f32 v138, v28, v198
  v_fmac_f32 v139, v28, v199
  ds_read_b128 v[204:207], v12 offset:384
  s_waitcnt lgkmcnt(11)
  v_add_f32 v140, v140, v160
  v_mfma_f32_16x16x32_bf16 v[196:199], a[212:215], v[92:95], v[136:139]
  s_waitcnt lgkmcnt(4)
  s_barrier
  buffer_load_dwordx4 a[136:139], v3, s[4:7], s70 offen offset:3072
  v_mfma_f32_16x16x32_bf16 v[196:199], a[216:219], v[96:99], v[196:199]
  ds_read_b128 v[172:175], v7 offset:11264
  v_add_f32 v141, v141, v161
  v_mfma_f32_16x16x32_bf16 v[196:199], a[220:223], v[100:103], v[196:199]
  ds_read_b128 v[168:171], v7 offset:10240
  v_add_f32 v142, v142, v162
  v_mfma_f32_16x16x32_bf16 v[196:199], a[224:227], v[104:107], v[196:199]
  v_add_f32 v143, v143, v163
  s_waitcnt lgkmcnt(4)
  v_fmac_f32 v140, v28, v200
  v_mfma_f32_16x16x32_bf16 v[196:199], a[228:231], v[108:111], v[196:199]
  v_fmac_f32 v141, v28, v201
  v_fmac_f32 v142, v28, v202
  s_mov_b32 s70, 81920
  buffer_load_dwordx4 a[140:143], v3, s[4:7], s70 offen offset:0
  v_fmac_f32 v143, v28, v203
  ds_read_b128 v[176:179], v7 offset:12288
  v_add_f32 v144, v144, v164
  v_mfma_f32_16x16x32_bf16 v[200:203], a[232:235], v[92:95], v[140:143]
  ds_read_b128 v[180:183], v7 offset:13312
  v_add_f32 v145, v145, v165
  v_mfma_f32_16x16x32_bf16 v[200:203], a[236:239], v[96:99], v[200:203]
  ds_read_b128 v[184:187], v7 offset:14336
  v_add_f32 v146, v146, v166
  v_mfma_f32_16x16x32_bf16 v[200:203], a[240:243], v[100:103], v[200:203]
  v_add_f32 v147, v147, v167
  s_waitcnt lgkmcnt(5)
  v_fmac_f32 v144, v28, v204
  v_mfma_f32_16x16x32_bf16 v[200:203], a[244:247], v[104:107], v[200:203]
  buffer_load_dwordx4 a[144:147], v3, s[4:7], s70 offen offset:1024
  v_mfma_f32_16x16x32_bf16 v[200:203], a[248:251], v[108:111], v[200:203]
  v_fmac_f32 v145, v28, v205
  v_fmac_f32 v146, v28, v206
  v_fmac_f32 v147, v28, v207
  v_add_f32 v128, v128, v148
  v_add_f32 v129, v129, v149
  v_mfma_f32_16x16x32_bf16 v[204:207], a[0:3], v[92:95], v[144:147]
  v_add_f32 v130, v130, v150
  v_add_f32 v131, v131, v151
  v_mfma_f32_16x16x32_bf16 v[204:207], a[4:7], v[96:99], v[204:207]
  v_add_f32 v188, v188, v128
  v_add_f32 v189, v189, v129
  s_waitcnt lgkmcnt(4)
  v_pk_add_f32 v[192:193], v[192:193], v[172:173]
  v_pk_add_f32 v[194:195], v[194:195], v[174:175]
  buffer_load_dwordx4 a[148:151], v3, s[4:7], s70 offen offset:2048
  v_add_f32 v190, v190, v130
  v_add_f32 v191, v191, v131
  s_waitcnt lgkmcnt(3)
  v_add_f32 v188, v188, v168
  v_add_f32 v189, v189, v169
  v_add_f32 v190, v190, v170
  v_add_f32 v191, v191, v171
  v_pk_mul_f32 v[192:193], v[192:193], v[30:31] op_sel_hi:[1,0]
  v_pk_mul_f32 v[194:195], v[194:195], v[30:31] op_sel_hi:[1,0]
  v_pk_mul_f32 v[188:189], v[188:189], v[30:31] op_sel_hi:[1,0]
  v_pk_mul_f32 v[190:191], v[190:191], v[30:31] op_sel_hi:[1,0]
  v_mov_b32 v246, 0x3f80
  v_mfma_f32_16x16x32_bf16 v[204:207], a[8:11], v[100:103], v[204:207]
  v_cvt_pk_bf16_f32 v238, v192, v193
  v_cvt_pk_bf16_f32 v239, v194, v195
  v_cvt_pk_bf16_f32 v236, v188, v189
  v_cvt_pk_bf16_f32 v237, v190, v191
  buffer_load_dwordx4 a[152:155], v3, s[4:7], s70 offen offset:3072
  ds_write_b128 v10, v[236:239] offset:80
  v_mfma_f32_16x16x32_bf16 v[204:207], a[12:15], v[104:107], v[204:207]
  v_mov_b32 v247, 0
  ds_read_b128 v[192:195], v12 offset:656
  v_mfma_f32_16x16x32_bf16 v[204:207], a[16:19], v[108:111], v[204:207]
  s_waitcnt lgkmcnt(4)
  v_pk_add_f32 v[196:197], v[196:197], v[176:177]
  v_pk_add_f32 v[198:199], v[198:199], v[178:179]
  s_mov_b32 s70, 86016
  buffer_load_dwordx4 a[156:159], v3, s[4:7], s70 offen offset:0
  s_waitcnt lgkmcnt(3)
  v_pk_add_f32 v[200:201], v[200:201], v[180:181]
  v_pk_add_f32 v[202:203], v[202:203], v[182:183]
  v_pk_mul_f32 v[196:197], v[196:197], v[30:31] op_sel_hi:[1,0]
  v_pk_mul_f32 v[198:199], v[198:199], v[30:31] op_sel_hi:[1,0]
  v_pk_mul_f32 v[200:201], v[200:201], v[30:31] op_sel_hi:[1,0]
  v_pk_mul_f32 v[202:203], v[202:203], v[30:31] op_sel_hi:[1,0]
  v_cvt_pk_bf16_f32 v240, v196, v197
  v_cvt_pk_bf16_f32 v241, v198, v199
  v_cvt_pk_bf16_f32 v242, v200, v201
  v_cvt_pk_bf16_f32 v243, v202, v203
  ds_write_b128 v10, v[240:243] offset:96
  buffer_load_dwordx4 a[160:163], v3, s[4:7], s70 offen offset:1024
  s_waitcnt lgkmcnt(3)
  v_pk_add_f32 v[204:205], v[204:205], v[184:185]
  v_pk_add_f32 v[206:207], v[206:207], v[186:187]
  v_pk_mul_f32 v[204:205], v[204:205], v[30:31] op_sel_hi:[1,0]
  v_pk_mul_f32 v[206:207], v[206:207], v[30:31] op_sel_hi:[1,0]
  v_cvt_pk_bf16_f32 v244, v204, v205
  v_cvt_pk_bf16_f32 v245, v206, v207
  ds_write_b128 v10, v[244:247] offset:112
  ds_read_b128 v[196:199], v12 offset:672
  buffer_load_dwordx4 a[164:167], v3, s[4:7], s70 offen offset:2048
  ds_read_b128 v[200:203], v12 offset:688
  ds_read_b128 v[204:207], v12 offset:704
  buffer_load_dwordx4 a[168:171], v3, s[4:7], s70 offen offset:3072
  s_mov_b32 s70, 90112
  buffer_load_dwordx4 a[172:175], v3, s[4:7], s70 offen offset:0
  s_waitcnt lgkmcnt(3)
  s_barrier
  ds_read_b64_tr_b16 v[128:129], v11 offset:0
  ds_read_b64_tr_b16 v[130:131], v11 offset:576
  buffer_load_dwordx4 a[176:179], v3, s[4:7], s70 offen offset:1024
  ds_read_b64_tr_b16 v[140:141], v11 offset:80
  ds_read_b64_tr_b16 v[142:143], v11 offset:656
  ds_read_b64_tr_b16 v[144:145], v11 offset:96
  ds_read_b64_tr_b16 v[146:147], v11 offset:672
  buffer_load_dwordx4 a[180:183], v3, s[4:7], s70 offen offset:2048
  ds_read_b64_tr_b16 v[132:133], v11 offset:32
  ds_read_b64_tr_b16 v[134:135], v11 offset:608
  ds_read_b64_tr_b16 v[136:137], v11 offset:64
  ds_read_b64_tr_b16 v[138:139], v11 offset:640
  buffer_load_dwordx4 a[184:187], v3, s[4:7], s70 offen offset:3072
  ds_read_b64_tr_b16 v[148:149], v11 offset:4608
  ds_read_b64_tr_b16 v[150:151], v11 offset:5184
  ds_read_b64_tr_b16 v[160:161], v11 offset:4688
  s_waitcnt lgkmcnt(9)
  v_mfma_f32_16x16x32_bf16 v[168:171], v[128:131], v[140:143], 0
  ds_read_b64_tr_b16 v[162:163], v11 offset:5264
  ds_read_b64_tr_b16 v[164:165], v11 offset:4704
  s_waitcnt lgkmcnt(9)
  v_mfma_f32_16x16x32_bf16 v[172:175], v[128:131], v[144:147], 0
  s_mov_b32 s70, 94208
  buffer_load_dwordx4 a[188:191], v3, s[4:7], s70 offen offset:0
  ds_read_b64_tr_b16 v[166:167], v11 offset:5280
  ds_read_b64_tr_b16 v[152:153], v11 offset:4640
  s_waitcnt lgkmcnt(9)
  v_mfma_f32_16x16x32_bf16 v[176:179], v[132:135], v[140:143], 0
  ds_read_b64_tr_b16 v[154:155], v11 offset:5216
  v_mfma_f32_16x16x32_bf16 v[180:183], v[132:135], v[144:147], 0
  ds_read_b64_tr_b16 v[156:157], v11 offset:4672
  s_waitcnt lgkmcnt(9)
  v_mfma_f32_16x16x32_bf16 v[184:187], v[136:139], v[140:143], 0
  buffer_load_dwordx4 a[192:195], v3, s[4:7], s70 offen offset:1024
  ds_read_b64_tr_b16 v[158:159], v11 offset:5248
  v_mfma_f32_16x16x32_bf16 v[188:191], v[136:139], v[144:147], 0
  s_waitcnt lgkmcnt(6)
  v_mfma_f32_16x16x32_bf16 v[168:171], v[148:151], v[160:163], v[168:171]
  buffer_load_dwordx4 a[196:199], v3, s[4:7], s70 offen offset:2048
  s_waitcnt lgkmcnt(4)
  v_mfma_f32_16x16x32_bf16 v[172:175], v[148:151], v[164:167], v[172:175]
  s_waitcnt lgkmcnt(2)
  v_mfma_f32_16x16x32_bf16 v[176:179], v[152:155], v[160:163], v[176:179]
  buffer_load_dwordx4 a[200:203], v3, s[4:7], s70 offen offset:3072
  v_mfma_f32_16x16x32_bf16 v[180:183], v[152:155], v[164:167], v[180:183]
  s_waitcnt lgkmcnt(0)
  v_mfma_f32_16x16x32_bf16 v[184:187], v[156:159], v[160:163], v[184:187]
  v_mfma_f32_16x16x32_bf16 v[188:191], v[156:159], v[164:167], v[188:191]
  v_cvt_pk_bf16_f32 v228, v168, v169
  v_cvt_pk_bf16_f32 v229, v170, v171
  v_or_b32 v228, v14, v228
  v_cvt_pk_bf16_f32 v232, v172, v173
  v_cvt_pk_bf16_f32 v233, v174, v175
  v_cvt_pk_bf16_f32 v230, v176, v177
  s_mov_b32 s70, 98304
  buffer_load_dwordx4 a[204:207], v3, s[4:7], s70 offen offset:0
  v_cvt_pk_bf16_f32 v236, v184, v185
  v_cvt_pk_bf16_f32 v231, v178, v179
  v_cvt_pk_bf16_f32 v234, v180, v181
  v_cvt_pk_bf16_f32 v235, v182, v183
  v_cvt_pk_bf16_f32 v237, v186, v187
  v_cvt_pk_bf16_f32 v238, v188, v189
  v_cvt_pk_bf16_f32 v239, v190, v191
  v_or_b32 v232, v14, v232
  v_or_b32 v236, v14, v236
  buffer_store_dwordx4 v[228:231], v1, s[4:7], s62 offen offset:0 sc1
  s_waitcnt vmcnt(48)
  v_mfma_f32_16x16x32_bf16 v[128:131], a[20:23], v[32:35], 0
  ds_read_b128 v[188:191], v12 offset:640
  buffer_store_dwordx4 v[232:235], v117, s[4:7], s62 offen offset:1024 sc1
  s_waitcnt vmcnt(48)
  v_mfma_f32_16x16x32_bf16 v[128:131], a[24:27], v[36:39], v[128:131]
  buffer_store_dwordx4 v[236:239], v118, s[4:7], s62 offen offset:1536 sc1
  s_waitcnt vmcnt(48)
  v_mfma_f32_16x16x32_bf16 v[128:131], a[28:31], v[40:43], v[128:131]
  s_waitcnt vmcnt(47)
  v_mfma_f32_16x16x32_bf16 v[128:131], a[32:35], v[44:47], v[128:131]
  s_waitcnt vmcnt(46)
  v_mfma_f32_16x16x32_bf16 v[128:131], a[36:39], v[48:51], v[128:131]
  s_waitcnt vmcnt(45)
  v_mfma_f32_16x16x32_bf16 v[132:135], a[40:43], v[32:35], 0
  buffer_load_dwordx4 a[208:211], v3, s[4:7], s70 offen offset:1024
  s_waitcnt vmcnt(45)
  v_mfma_f32_16x16x32_bf16 v[132:135], a[44:47], v[36:39], v[132:135]
  s_waitcnt vmcnt(44)
  v_mfma_f32_16x16x32_bf16 v[132:135], a[48:51], v[40:43], v[132:135]
  s_waitcnt vmcnt(43)
  v_mfma_f32_16x16x32_bf16 v[132:135], a[52:55], v[44:47], v[132:135]
  s_waitcnt lgkmcnt(0)
  v_mul_f32 v188, v28, v188
  v_mul_f32 v189, v28, v189
  s_waitcnt vmcnt(42)
  v_mfma_f32_16x16x32_bf16 v[132:135], a[56:59], v[48:51], v[132:135]
  ds_write_b128 v4, v[128:131] offset:0
  buffer_load_dwordx4 a[212:215], v3, s[4:7], s70 offen offset:2048
  s_waitcnt vmcnt(42)
  v_mfma_f32_16x16x32_bf16 v[136:139], a[60:63], v[32:35], 0
  v_mul_f32 v190, v28, v190
  v_mul_f32 v191, v28, v191
  s_waitcnt vmcnt(41)
  v_mfma_f32_16x16x32_bf16 v[136:139], a[64:67], v[36:39], v[136:139]
  s_waitcnt vmcnt(40)
  v_mfma_f32_16x16x32_bf16 v[136:139], a[68:71], v[40:43], v[136:139]
  s_waitcnt vmcnt(39)
  v_mfma_f32_16x16x32_bf16 v[136:139], a[72:75], v[44:47], v[136:139]
  ds_write_b128 v4, v[132:135] offset:1024
  buffer_load_dwordx4 a[216:219], v3, s[4:7], s70 offen offset:3072
  s_waitcnt vmcnt(39)
  v_mfma_f32_16x16x32_bf16 v[136:139], a[76:79], v[48:51], v[136:139]
  s_waitcnt vmcnt(38)
  v_mfma_f32_16x16x32_bf16 v[140:143], a[80:83], v[32:35], 0
  s_waitcnt vmcnt(37)
  v_mfma_f32_16x16x32_bf16 v[140:143], a[84:87], v[36:39], v[140:143]
  s_waitcnt vmcnt(36)
  v_mfma_f32_16x16x32_bf16 v[140:143], a[88:91], v[40:43], v[140:143]
  s_waitcnt vmcnt(35)
  v_mfma_f32_16x16x32_bf16 v[140:143], a[92:95], v[44:47], v[140:143]
  s_mov_b32 s70, 102400
  buffer_load_dwordx4 a[220:223], v3, s[4:7], s70 offen offset:0
  s_waitcnt vmcnt(35)
  v_mfma_f32_16x16x32_bf16 v[140:143], a[96:99], v[48:51], v[140:143]
  s_waitcnt vmcnt(34)
  v_mfma_f32_16x16x32_bf16 v[144:147], a[100:103], v[32:35], 0
  ds_write_b128 v4, v[136:139] offset:2048
  s_waitcnt vmcnt(33)
  v_mfma_f32_16x16x32_bf16 v[144:147], a[104:107], v[36:39], v[144:147]
  s_waitcnt vmcnt(32)
  v_mfma_f32_16x16x32_bf16 v[144:147], a[108:111], v[40:43], v[144:147]
  buffer_load_dwordx4 a[224:227], v3, s[4:7], s70 offen offset:1024
  s_waitcnt vmcnt(32)
  v_mfma_f32_16x16x32_bf16 v[144:147], a[112:115], v[44:47], v[144:147]
  v_lshrrev_b32 v40, 2, v0
  v_and_b32 v45, 48, v1
  s_waitcnt vmcnt(31)
  v_mfma_f32_16x16x32_bf16 v[144:147], a[116:119], v[48:51], v[144:147]
  v_lshl_add_u32 v40, v40, 7, v45
  ds_read_b128 v[48:51], v8 offset:16
  v_mfma_f32_16x16x32_bf16 v[148:151], a[20:23], v[52:55], 0
  ds_write_b128 v4, v[140:143] offset:3072
  v_mfma_f32_16x16x32_bf16 v[148:151], a[24:27], v[56:59], v[148:151]
  buffer_load_dwordx4 a[228:231], v3, s[4:7], s70 offen offset:2048
  v_mfma_f32_16x16x32_bf16 v[148:151], a[28:31], v[60:63], v[148:151]
  v_and_b32 v41, 15, v0
  v_lshrrev_b32 v45, 4, v0
  v_mfma_f32_16x16x32_bf16 v[148:151], a[32:35], v[64:67], v[148:151]
  ds_write_b128 v4, v[144:147] offset:4096
  v_mfma_f32_16x16x32_bf16 v[148:151], a[36:39], v[68:71], v[148:151]
  v_mul_u32_u24 v41, 80, v41
  v_lshl_add_u32 v41, v45, 3, v41
  v_mfma_f32_16x16x32_bf16 v[152:155], a[40:43], v[52:55], 0
  buffer_load_dwordx4 a[232:235], v3, s[4:7], s70 offen offset:3072
  v_mfma_f32_16x16x32_bf16 v[152:155], a[44:47], v[56:59], v[152:155]
  v_and_b32 v45, 7, v0
  v_and_b32 v46, 24, v0
  v_mfma_f32_16x16x32_bf16 v[152:155], a[48:51], v[60:63], v[152:155]
  ds_write_b128 v5, v[148:151] offset:0
  v_mfma_f32_16x16x32_bf16 v[152:155], a[52:55], v[64:67], v[152:155]
  v_mul_u32_u24 v45, 80, v45
  v_add_u32 v41, s83, v41
  v_mfma_f32_16x16x32_bf16 v[152:155], a[56:59], v[68:71], v[152:155]
  buffer_load_dwordx4 v[240:243], v124, s[4:7], s65 offen sc1
  v_mfma_f32_16x16x32_bf16 v[156:159], a[60:63], v[52:55], 0
  v_add3_u32 v45, v45, v46, s83
  v_mfma_f32_16x16x32_bf16 v[156:159], a[64:67], v[56:59], v[156:159]
  v_add_u32 v45, 1280, v45
  v_add_u32 v46, 48, v41
  v_mfma_f32_16x16x32_bf16 v[156:159], a[68:71], v[60:63], v[156:159]
  v_mfma_f32_16x16x32_bf16 v[156:159], a[72:75], v[64:67], v[156:159]
  ds_write_b128 v5, v[152:155] offset:1024
  buffer_load_dwordx4 v[244:247], v124, s[4:7], s66 offen sc1
  v_mfma_f32_16x16x32_bf16 v[156:159], a[76:79], v[68:71], v[156:159]
  v_mfma_f32_16x16x32_bf16 v[160:163], a[80:83], v[52:55], 0
  v_mfma_f32_16x16x32_bf16 v[160:163], a[84:87], v[56:59], v[160:163]
  v_mfma_f32_16x16x32_bf16 v[160:163], a[88:91], v[60:63], v[160:163]
  v_mfma_f32_16x16x32_bf16 v[160:163], a[92:95], v[64:67], v[160:163]
  s_mov_b32 s70, 106496
  buffer_load_dwordx4 a[236:239], v3, s[4:7], s70 offen offset:0
  v_mfma_f32_16x16x32_bf16 v[160:163], a[96:99], v[68:71], v[160:163]
  v_mfma_f32_16x16x32_bf16 v[164:167], a[100:103], v[52:55], 0
  ds_write_b128 v5, v[156:159] offset:2048
  v_mfma_f32_16x16x32_bf16 v[164:167], a[104:107], v[56:59], v[164:167]
  ds_read_b128 v[52:55], v8 offset:208
  v_mfma_f32_16x16x32_bf16 v[164:167], a[108:111], v[60:63], v[164:167]
  buffer_load_dwordx4 a[240:243], v3, s[4:7], s70 offen offset:1024
  v_mfma_f32_16x16x32_bf16 v[164:167], a[112:115], v[64:67], v[164:167]
  ds_read_b128 v[56:59], v8 offset:400
  v_mfma_f32_16x16x32_bf16 v[164:167], a[116:119], v[68:71], v[164:167]
  ds_write_b128 v5, v[160:163] offset:3072
  v_mfma_f32_16x16x32_bf16 v[168:171], a[20:23], v[72:75], 0
  ds_read_b128 v[60:63], v8 offset:592
  v_mfma_f32_16x16x32_bf16 v[168:171], a[24:27], v[76:79], v[168:171]
  buffer_load_dwordx4 a[244:247], v3, s[4:7], s70 offen offset:2048
  v_mfma_f32_16x16x32_bf16 v[168:171], a[28:31], v[80:83], v[168:171]
  ds_read_b128 v[64:67], v8 offset:784
  v_mfma_f32_16x16x32_bf16 v[168:171], a[32:35], v[84:87], v[168:171]
  ds_write_b128 v5, v[164:167] offset:4096
  v_mfma_f32_16x16x32_bf16 v[168:171], a[36:39], v[88:91], v[168:171]
  ds_read_b128 v[68:71], v8 offset:32
  v_mfma_f32_16x16x32_bf16 v[172:175], a[40:43], v[72:75], 0
  buffer_load_dwordx4 a[248:251], v3, s[4:7], s70 offen offset:3072
  v_mfma_f32_16x16x32_bf16 v[172:175], a[44:47], v[76:79], v[172:175]
  v_mfma_f32_16x16x32_bf16 v[172:175], a[48:51], v[80:83], v[172:175]
  v_mfma_f32_16x16x32_bf16 v[172:175], a[52:55], v[84:87], v[172:175]
  v_mfma_f32_16x16x32_bf16 v[172:175], a[56:59], v[88:91], v[172:175]
  v_mfma_f32_16x16x32_bf16 v[176:179], a[60:63], v[72:75], 0
  s_mov_b32 s70, 110592
  buffer_load_dwordx4 a[0:3], v3, s[4:7], s70 offen offset:0
  v_mfma_f32_16x16x32_bf16 v[176:179], a[64:67], v[76:79], v[176:179]
  ds_write_b128 v6, v[168:171] offset:0
  v_mfma_f32_16x16x32_bf16 v[176:179], a[68:71], v[80:83], v[176:179]
  s_waitcnt lgkmcnt(2)
  s_barrier
  v_mfma_f32_16x16x32_bf16 v[176:179], a[72:75], v[84:87], v[176:179]
  buffer_load_dwordx4 a[4:7], v3, s[4:7], s70 offen offset:1024
  v_mfma_f32_16x16x32_bf16 v[176:179], a[76:79], v[88:91], v[176:179]
  ds_read_b128 v[132:135], v7 offset:1024
  v_mfma_f32_16x16x32_bf16 v[180:183], a[80:83], v[72:75], 0
  ds_read_b128 v[152:155], v7 offset:6144
  v_mfma_f32_16x16x32_bf16 v[180:183], a[84:87], v[76:79], v[180:183]
  ds_read_b128 v[136:139], v7 offset:2048
  v_mfma_f32_16x16x32_bf16 v[180:183], a[88:91], v[80:83], v[180:183]
  ds_read_b128 v[156:159], v7 offset:7168
  buffer_load_dwordx4 a[8:11], v3, s[4:7], s70 offen offset:2048
  v_mfma_f32_16x16x32_bf16 v[180:183], a[92:95], v[84:87], v[180:183]
  ds_write_b128 v6, v[172:175] offset:1024
  v_mfma_f32_16x16x32_bf16 v[180:183], a[96:99], v[88:91], v[180:183]
  ds_read_b128 v[140:143], v7 offset:3072
  v_mfma_f32_16x16x32_bf16 v[184:187], a[100:103], v[72:75], 0
  ds_read_b128 v[160:163], v7 offset:8192
  v_mfma_f32_16x16x32_bf16 v[184:187], a[104:107], v[76:79], v[184:187]
  buffer_load_dwordx4 a[12:15], v3, s[4:7], s70 offen offset:3072
  v_mfma_f32_16x16x32_bf16 v[184:187], a[108:111], v[80:83], v[184:187]
  ds_write_b128 v6, v[176:179] offset:2048
  v_mfma_f32_16x16x32_bf16 v[184:187], a[112:115], v[84:87], v[184:187]
  ds_read_b128 v[144:147], v7 offset:4096
  s_waitcnt lgkmcnt(7)
  v_add_f32 v132, v132, v152
  v_mfma_f32_16x16x32_bf16 v[184:187], a[116:119], v[88:91], v[184:187]
  ds_read_b128 v[164:167], v7 offset:9216
  v_add_f32 v133, v133, v153
  v_mfma_f32_16x16x32_bf16 v[188:191], a[20:23], v[92:95], v[188:191]
  s_mov_b32 s70, 114688
  buffer_load_dwordx4 a[16:19], v3, s[4:7], s70 offen offset:0
  v_mfma_f32_16x16x32_bf16 v[188:191], a[24:27], v[96:99], v[188:191]
  ds_write_b128 v6, v[180:183] offset:3072
  v_mfma_f32_16x16x32_bf16 v[188:191], a[28:31], v[100:103], v[188:191]
  ds_read_b128 v[128:131], v7 offset:0
  v_add_f32 v134, v134, v154
  v_mfma_f32_16x16x32_bf16 v[188:191], a[32:35], v[104:107], v[188:191]
  ds_read_b128 v[148:151], v7 offset:5120
  v_add_f32 v135, v135, v155
  ds_write_b128 v6, v[184:187] offset:4096
  buffer_load_dwordx4 a[20:23], v3, s[4:7], s70 offen offset:1024
  v_mfma_f32_16x16x32_bf16 v[188:191], a[36:39], v[108:111], v[188:191]
  v_fmac_f32 v132, v28, v192
  v_fmac_f32 v133, v28, v193
  v_fmac_f32 v134, v28, v194
  v_fmac_f32 v135, v28, v195
  s_waitcnt lgkmcnt(10)
  v_add_f32 v136, v136, v156
  v_add_f32 v137, v137, v157
  v_mfma_f32_16x16x32_bf16 v[192:195], a[40:43], v[92:95], v[132:135]
  v_add_f32 v138, v138, v158
  v_add_f32 v139, v139, v159
  v_mfma_f32_16x16x32_bf16 v[192:195], a[44:47], v[96:99], v[192:195]
  v_fmac_f32 v136, v28, v196
  v_fmac_f32 v137, v28, v197
  v_mfma_f32_16x16x32_bf16 v[192:195], a[48:51], v[100:103], v[192:195]
  buffer_load_dwordx4 a[24:27], v3, s[4:7], s70 offen offset:2048
  v_mfma_f32_16x16x32_bf16 v[192:195], a[52:55], v[104:107], v[192:195]
  v_fmac_f32 v138, v28, v198
  v_fmac_f32 v139, v28, v199
  v_mfma_f32_16x16x32_bf16 v[192:195], a[56:59], v[108:111], v[192:195]
  s_waitcnt lgkmcnt(7)
  v_add_f32 v140, v140, v160
  v_add_f32 v141, v141, v161
  v_mfma_f32_16x16x32_bf16 v[196:199], a[60:63], v[92:95], v[136:139]
  s_waitcnt vmcnt(11)
  v_bitop3_b32 v27, v240, v244, v14 bitop3:0x2a
  v_cmp_ne_u32 vcc, 0, v27
  v_mfma_f32_16x16x32_bf16 v[196:199], a[64:67], v[96:99], v[196:199]
  s_cbranch_vccz L_ok_148
L_retry_147:
  s_sub_u32 s69, s69, 1
  s_cbranch_scc1 L_retry_147_to
  buffer_load_dwordx4 v[240:243], v124, s[4:7], s65 offen sc1
  buffer_load_dwordx4 v[244:247], v124, s[4:7], s66 offen sc1
  s_waitcnt vmcnt(0)
  v_bitop3_b32 v27, v240, v244, v14 bitop3:0x2a
  v_cmp_ne_u32 vcc, 0, v27
  s_nop 1
  s_cbranch_vccnz L_retry_147
L_ok_148:
  v_lshlrev_b32 v228, 16, v240
  v_lshlrev_b32 v236, 16, v244
  buffer_load_dwordx4 a[28:31], v3, s[4:7], s70 offen offset:3072
  v_and_b32 v229, 0xffff0000, v240
  v_and_b32 v237, 0xffff0000, v244
  v_lshlrev_b32 v230, 16, v241
  v_and_b32 v231, 0xffff0000, v241
  v_lshlrev_b32 v238, 16, v245
  v_and_b32 v239, 0xffff0000, v245
  v_sub_u32 v228, v228, v127
  v_sub_u32 v236, v236, v127
  v_add_f32 v229, v229, v237
  v_add_f32 v230, v230, v238
  v_add_f32 v231, v231, v239
  v_add_f32 v228, v228, v236
  v_lshlrev_b32 v232, 16, v242
  v_and_b32 v233, 0xffff0000, v242
  v_lshlrev_b32 v234, 16, v243
  v_and_b32 v235, 0xffff0000, v243
  v_and_b32 v237, 0xffff0000, v246
  v_lshlrev_b32 v238, 16, v247
  v_and_b32 v239, 0xffff0000, v247
  s_mov_b32 s70, 118784
  buffer_load_dwordx4 a[32:35], v3, s[4:7], s70 offen offset:0
  v_lshlrev_b32 v236, 16, v246
  v_add_f32 v233, v233, v237
  v_add_f32 v234, v234, v238
  v_add_f32 v235, v235, v239
  v_add_f32 v232, v232, v236
  v_permlane32_swap_b32 v229, v233
  v_permlane32_swap_b32 v230, v234
  v_permlane32_swap_b32 v231, v235
  v_permlane32_swap_b32 v228, v232
  v_add_f32 v229, v229, v233
  v_add_f32 v230, v230, v234
  v_add_f32 v231, v231, v235
  v_add_f32 v228, v228, v232
  v_cmp_eq_u32 vcc, 0, v0
  buffer_load_dwordx4 a[36:39], v3, s[4:7], s70 offen offset:1024
  v_permlane16_swap_b32 v229, v231
  v_permlane16_swap_b32 v228, v230
  v_add_f32 v229, v229, v231
  v_add_f32 v228, v228, v230
  v_cndmask_b32 v127, 0, 1, vcc
  v_add_f32_dpp v231, v229, v229 row_ror:4 row_mask:0xf bank_mask:0xf
  v_add_f32_dpp v230, v228, v228 row_ror:4 row_mask:0xf bank_mask:0xf
  v_mfma_f32_16x16x32_bf16 v[196:199], a[68:71], v[100:103], v[196:199]
  v_add_f32_dpp v229, v231, v231 row_ror:8 row_mask:0xf bank_mask:0xf
  v_add_f32_dpp v228, v230, v230 row_ror:8 row_mask:0xf bank_mask:0xf
  v_cvt_pk_bf16_f32 v126, v228, v229
  v_or_b32 v126, v127, v126
  buffer_store_dword v126, v125, s[4:7], s63 offen sc1
  v_mfma_f32_16x16x32_bf16 v[196:199], a[72:75], v[104:107], v[196:199]
  s_waitcnt lgkmcnt(0)
  s_barrier
  v_mfma_f32_16x16x32_bf16 v[196:199], a[76:79], v[108:111], v[196:199]
  v_add_f32 v142, v142, v162
  buffer_load_dwordx4 a[40:43], v3, s[4:7], s70 offen offset:2048
  v_add_f32 v143, v143, v163
  v_fmac_f32 v140, v28, v200
  v_fmac_f32 v141, v28, v201
  v_fmac_f32 v142, v28, v202
  v_fmac_f32 v143, v28, v203
  ds_read_b128 v[172:175], v7 offset:11264
  v_add_f32 v128, v128, v148
  v_mfma_f32_16x16x32_bf16 v[200:203], a[80:83], v[92:95], v[140:143]
  ds_read_b128 v[168:171], v7 offset:10240
  v_add_f32 v129, v129, v149
  v_add_f32 v130, v130, v150
  v_add_f32 v131, v131, v151
  ds_read_b128 v[148:151], v8 offset:0
  v_mfma_f32_16x16x32_bf16 v[200:203], a[84:87], v[96:99], v[200:203]
  buffer_load_dwordx4 a[44:47], v3, s[4:7], s70 offen offset:3072
  ds_read_b128 v[152:155], v8 offset:192
  v_mfma_f32_16x16x32_bf16 v[200:203], a[88:91], v[100:103], v[200:203]
  v_add_f32 v144, v144, v164
  ds_read_b128 v[176:179], v7 offset:12288
  v_mfma_f32_16x16x32_bf16 v[200:203], a[92:95], v[104:107], v[200:203]
  v_add_f32 v145, v145, v165
  ds_read_b128 v[156:159], v8 offset:384
  v_mfma_f32_16x16x32_bf16 v[200:203], a[96:99], v[108:111], v[200:203]
  v_add_f32 v146, v146, v166
  ds_read_b128 v[180:183], v7 offset:13312
  v_add_f32 v147, v147, v167
  v_fmac_f32 v144, v28, v204
  v_fmac_f32 v145, v28, v205
  s_mov_b32 s70, 122880
  buffer_load_dwordx4 a[48:51], v3, s[4:7], s70 offen offset:0
  ds_read_b128 v[160:163], v8 offset:576
  v_fmac_f32 v146, v28, v206
  v_fmac_f32 v147, v28, v207
  v_add_f32 v188, v188, v128
  ds_read_b128 v[184:187], v7 offset:14336
  v_mfma_f32_16x16x32_bf16 v[204:207], a[100:103], v[92:95], v[144:147]
  v_add_f32 v189, v189, v129
  ds_read_b128 v[164:167], v8 offset:768
  v_mfma_f32_16x16x32_bf16 v[204:207], a[104:107], v[96:99], v[204:207]
  v_add_f32 v190, v190, v130
  v_add_f32 v191, v191, v131
  v_mfma_f32_16x16x32_bf16 v[204:207], a[108:111], v[100:103], v[204:207]
  buffer_load_dwordx4 a[52:55], v3, s[4:7], s70 offen offset:1024
  v_mfma_f32_16x16x32_bf16 v[204:207], a[112:115], v[104:107], v[204:207]
  s_waitcnt lgkmcnt(8)
  v_add_f32 v188, v188, v168
  v_add_f32 v189, v189, v169
  v_mfma_f32_16x16x32_bf16 v[204:207], a[116:119], v[108:111], v[204:207]
  v_add_f32 v190, v190, v170
  v_add_f32 v191, v191, v171
  v_pk_add_f32 v[192:193], v[192:193], v[172:173]
  v_pk_add_f32 v[194:195], v[194:195], v[174:175]
  v_cvt_pk_bf16_f32 v128, v188, v189
  v_cvt_pk_bf16_f32 v129, v190, v191
  buffer_load_dwordx4 a[56:59], v3, s[4:7], s70 offen offset:2048
  v_cvt_pk_bf16_f32 v130, v192, v193
  v_cvt_pk_bf16_f32 v131, v194, v195
  v_cmp_gt_u32 vcc, 32, v0
  ds_read_b128 v[72:75], v8 offset:224
  s_waitcnt lgkmcnt(8)
  v_mfma_f32_16x16x32_bf16 v[168:171], v[148:151], v[128:131], 0
  v_cndmask_b32 v42, v46, v45, vcc
  v_add_u32 v45, 32, v45
  s_waitcnt lgkmcnt(7)
  v_mfma_f32_16x16x32_bf16 v[172:175], v[152:155], v[128:131], 0
  v_add_u32 v46, 640, v46
  v_cndmask_b32 v43, v46, v45, vcc
  s_waitcnt lgkmcnt(6)
  v_pk_add_f32 v[196:197], v[196:197], v[176:177]
  v_pk_add_f32 v[198:199], v[198:199], v[178:179]
  buffer_load_dwordx4 a[60:63], v3, s[4:7], s70 offen offset:3072
  s_waitcnt lgkmcnt(5)
  v_mfma_f32_16x16x32_bf16 v[176:179], v[156:159], v[128:131], 0
  ds_read_b128 v[76:79], v8 offset:416
  v_cvt_pk_bf16_f32 v132, v196, v197
  s_waitcnt lgkmcnt(5)
  v_pk_add_f32 v[200:201], v[200:201], v[180:181]
  v_pk_add_f32 v[202:203], v[202:203], v[182:183]
  ds_read_b128 v[80:83], v8 offset:608
  s_waitcnt lgkmcnt(5)
  v_mfma_f32_16x16x32_bf16 v[180:183], v[160:163], v[128:131], 0
  v_cvt_pk_bf16_f32 v133, v198, v199
  v_cvt_pk_bf16_f32 v134, v200, v201
  s_waitcnt lgkmcnt(4)
  v_pk_add_f32 v[204:205], v[204:205], v[184:185]
  v_pk_add_f32 v[206:207], v[206:207], v[186:187]
  s_mov_b32 s70, 126976
  buffer_load_dwordx4 a[64:67], v3, s[4:7], s70 offen offset:0
  s_waitcnt lgkmcnt(3)
  v_mfma_f32_16x16x32_bf16 v[184:187], v[164:167], v[128:131], 0
  v_cvt_pk_bf16_f32 v135, v202, v203
  ds_read_b128 v[84:87], v8 offset:800
  v_mov_b32 v138, 0
  v_mfma_f32_16x16x32_bf16 v[168:171], v[48:51], v[132:135], v[168:171]
  v_cvt_pk_bf16_f32 v136, v204, v205
  v_mfma_f32_16x16x32_bf16 v[172:175], v[52:55], v[132:135], v[172:175]
  v_cvt_pk_bf16_f32 v137, v206, v207
  v_mfma_f32_16x16x32_bf16 v[176:179], v[56:59], v[132:135], v[176:179]
  buffer_load_dwordx4 a[68:71], v3, s[4:7], s70 offen offset:1024
  v_mfma_f32_16x16x32_bf16 v[180:183], v[60:63], v[132:135], v[180:183]
  v_mov_b32 v139, 0
  v_mfma_f32_16x16x32_bf16 v[184:187], v[64:67], v[132:135], v[184:187]
  s_nop 0
  v_mfma_f32_16x16x32_bf16 v[168:171], v[68:71], v[136:139], v[168:171]
  s_waitcnt lgkmcnt(3)
  v_mfma_f32_16x16x32_bf16 v[172:175], v[72:75], v[136:139], v[172:175]
  buffer_load_dwordx4 a[72:75], v3, s[4:7], s70 offen offset:2048
  s_waitcnt lgkmcnt(2)
  v_mfma_f32_16x16x32_bf16 v[176:179], v[76:79], v[136:139], v[176:179]
  s_waitcnt lgkmcnt(1)
  v_mfma_f32_16x16x32_bf16 v[180:183], v[80:83], v[136:139], v[180:183]
  s_waitcnt lgkmcnt(0)
  v_mfma_f32_16x16x32_bf16 v[184:187], v[84:87], v[136:139], v[184:187]
  v_max3_f32 v248, v168, v169, v170
  buffer_load_dwordx4 a[76:79], v3, s[4:7], s70 offen offset:3072
  v_min3_f32 v250, v168, v169, v170
  v_max3_f32 v248, v248, v171, v172
  v_max3_f32 v248, v248, v173, v174
  v_min3_f32 v250, v250, v171, v172
  v_max3_f32 v248, v248, v175, v176
  v_max3_f32 v248, v248, v177, v178
  v_max3_f32 v248, v248, v179, v180
  v_max3_f32 v248, v248, v181, v182
  v_max3_f32 v248, v248, v183, v184
  v_max3_f32 v248, v248, v185, v186
  v_min3_f32 v250, v250, v173, v174
  s_mov_b32 s70, 131072
  buffer_load_dwordx4 a[80:83], v3, s[4:7], s70 offen offset:0
  v_max_f32 v248, v248, v187
  v_min3_f32 v250, v250, v175, v176
  v_mul_f32 v248, v252, v248
  v_pk_fma_f32 v[188:189], v[168:169], v[252:253], v[248:249] op_sel_hi:[1,0,0] neg_lo:[0,0,1] neg_hi:[0,0,1]
  v_pk_fma_f32 v[190:191], v[170:171], v[252:253], v[248:249] op_sel_hi:[1,0,0] neg_lo:[0,0,1] neg_hi:[0,0,1]
  v_min3_f32 v250, v250, v177, v178
  v_pk_fma_f32 v[192:193], v[172:173], v[252:253], v[248:249] op_sel_hi:[1,0,0] neg_lo:[0,0,1] neg_hi:[0,0,1]
  v_exp_f32 v188, v188
  v_exp_f32 v189, v189
  v_exp_f32 v190, v190
  v_exp_f32 v191, v191
  buffer_load_dwordx4 a[84:87], v3, s[4:7], s70 offen offset:1024
  v_min3_f32 v250, v250, v179, v180
  v_pk_fma_f32 v[194:195], v[174:175], v[252:253], v[248:249] op_sel_hi:[1,0,0] neg_lo:[0,0,1] neg_hi:[0,0,1]
  v_pk_fma_f32 v[196:197], v[176:177], v[252:253], v[248:249] op_sel_hi:[1,0,0] neg_lo:[0,0,1] neg_hi:[0,0,1]
  v_pk_fma_f32 v[198:199], v[178:179], v[252:253], v[248:249] op_sel_hi:[1,0,0] neg_lo:[0,0,1] neg_hi:[0,0,1]
  v_pk_fma_f32 v[200:201], v[180:181], v[252:253], v[248:249] op_sel_hi:[1,0,0] neg_lo:[0,0,1] neg_hi:[0,0,1]
  v_pk_fma_f32 v[202:203], v[182:183], v[252:253], v[248:249] op_sel_hi:[1,0,0] neg_lo:[0,0,1] neg_hi:[0,0,1]
  v_pk_fma_f32 v[204:205], v[184:185], v[252:253], v[248:249] op_sel_hi:[1,0,0] neg_lo:[0,0,1] neg_hi:[0,0,1]
  v_pk_fma_f32 v[206:207], v[186:187], v[252:253], v[248:249] op_sel_hi:[1,0,0] neg_lo:[0,0,1] neg_hi:[0,0,1]
  v_exp_f32 v192, v192
  v_exp_f32 v193, v193
  v_min3_f32 v250, v250, v181, v182
  v_pk_add_f32 v[248:249], v[188:189], v[190:191]
  buffer_load_dwordx4 a[88:91], v3, s[4:7], s70 offen offset:2048
  v_exp_f32 v194, v194
  v_exp_f32 v195, v195
  v_min3_f32 v250, v250, v183, v184
  v_pk_add_f32 v[248:249], v[248:249], v[192:193]
  v_exp_f32 v196, v196
  v_exp_f32 v197, v197
  v_min3_f32 v250, v250, v185, v186
  v_pk_add_f32 v[248:249], v[248:249], v[194:195]
  v_exp_f32 v198, v198
  v_exp_f32 v199, v199
  buffer_load_dwordx4 a[92:95], v3, s[4:7], s70 offen offset:3072
  v_min_f32 v250, v250, v187
  v_pk_add_f32 v[248:249], v[248:249], v[196:197]
  v_exp_f32 v200, v200
  v_exp_f32 v201, v201
  v_mul_f32 v250, v252, v250
  v_pk_add_f32 v[248:249], v[248:249], v[198:199]
  v_pk_fma_f32 v[168:169], v[168:169], v[252:253], v[250:251] op_sel_hi:[1,0,0] neg_lo:[1,0,0] neg_hi:[1,0,0]
  v_pk_fma_f32 v[170:171], v[170:171], v[252:253], v[250:251] op_sel_hi:[1,0,0] neg_lo:[1,0,0] neg_hi:[1,0,0]
  v_exp_f32 v202, v202
  v_exp_f32 v203, v203
  v_pk_add_f32 v[248:249], v[248:249], v[200:201]
  s_mov_b32 s70, 135168
  buffer_load_dwordx4 a[96:99], v3, s[4:7], s70 offen offset:0
  v_pk_fma_f32 v[172:173], v[172:173], v[252:253], v[250:251] op_sel_hi:[1,0,0] neg_lo:[1,0,0] neg_hi:[1,0,0]
  v_exp_f32 v168, v168
  v_exp_f32 v169, v169
  v_exp_f32 v170, v170
  v_exp_f32 v171, v171
  v_exp_f32 v204, v204
  v_exp_f32 v205, v205
  v_pk_fma_f32 v[174:175], v[174:175], v[252:253], v[250:251] op_sel_hi:[1,0,0] neg_lo:[1,0,0] neg_hi:[1,0,0]
  v_pk_fma_f32 v[176:177], v[176:177], v[252:253], v[250:251] op_sel_hi:[1,0,0] neg_lo:[1,0,0] neg_hi:[1,0,0]
  buffer_load_dwordx4 a[100:103], v3, s[4:7], s70 offen offset:1024
  v_pk_fma_f32 v[178:179], v[178:179], v[252:253], v[250:251] op_sel_hi:[1,0,0] neg_lo:[1,0,0] neg_hi:[1,0,0]
  v_pk_fma_f32 v[180:181], v[180:181], v[252:253], v[250:251] op_sel_hi:[1,0,0] neg_lo:[1,0,0] neg_hi:[1,0,0]
  v_pk_fma_f32 v[182:183], v[182:183], v[252:253], v[250:251] op_sel_hi:[1,0,0] neg_lo:[1,0,0] neg_hi:[1,0,0]
  v_pk_fma_f32 v[184:185], v[184:185], v[252:253], v[250:251] op_sel_hi:[1,0,0] neg_lo:[1,0,0] neg_hi:[1,0,0]
  v_pk_fma_f32 v[186:187], v[186:187], v[252:253], v[250:251] op_sel_hi:[1,0,0] neg_lo:[1,0,0] neg_hi:[1,0,0]
  v_pk_add_f32 v[248:249], v[248:249], v[202:203]
  v_exp_f32 v172, v172
  v_exp_f32 v173, v173
  v_exp_f32 v206, v206
  v_exp_f32 v207, v207
  buffer_load_dwordx4 a[104:107], v3, s[4:7], s70 offen offset:2048
  v_pk_add_f32 v[250:251], v[168:169], v[170:171]
  v_pk_add_f32 v[248:249], v[248:249], v[204:205]
  v_exp_f32 v174, v174
  v_exp_f32 v175, v175
  v_pk_add_f32 v[250:251], v[250:251], v[172:173]
  v_pk_add_f32 v[248:249], v[248:249], v[206:207]
  v_exp_f32 v176, v176
  v_exp_f32 v177, v177
  v_pk_add_f32 v[250:251], v[250:251], v[174:175]
  v_add_f32 v248, v248, v249
  v_exp_f32 v178, v178
  buffer_load_dwordx4 v[32:35], v40, s[4:7], s64 offen offset:0 sc1
  v_exp_f32 v179, v179
  v_pk_add_f32 v[250:251], v[250:251], v[176:177]
  v_rcp_f32 v248, v248
  v_exp_f32 v180, v180
  v_exp_f32 v181, v181
  v_pk_add_f32 v[250:251], v[250:251], v[178:179]
  v_exp_f32 v182, v182
  v_exp_f32 v183, v183
  v_pk_mul_f32 v[188:189], v[188:189], v[248:249] op_sel_hi:[1,0]
  v_pk_mul_f32 v[190:191], v[190:191], v[248:249] op_sel_hi:[1,0]
  buffer_load_dwordx4 v[36:39], v40, s[4:7], s64 offen offset:2048 sc1
  v_pk_mul_f32 v[192:193], v[192:193], v[248:249] op_sel_hi:[1,0]
  v_pk_mul_f32 v[194:195], v[194:195], v[248:249] op_sel_hi:[1,0]
  v_pk_add_f32 v[250:251], v[250:251], v[180:181]
  v_exp_f32 v184, v184
  v_exp_f32 v185, v185
  v_cvt_pk_bf16_f32 v228, v188, v189
  v_cvt_pk_bf16_f32 v229, v190, v191
  v_cvt_pk_bf16_f32 v230, v192, v193
  v_cvt_pk_bf16_f32 v231, v194, v195
  v_pk_add_f32 v[250:251], v[250:251], v[182:183]
  v_exp_f32 v186, v186
  buffer_load_dwordx4 a[108:111], v3, s[4:7], s70 offen offset:3072
  v_exp_f32 v187, v187
  v_pk_add_f32 v[250:251], v[250:251], v[184:185]
  v_pk_mul_f32 v[196:197], v[196:197], v[248:249] op_sel_hi:[1,0]
  v_pk_mul_f32 v[198:199], v[198:199], v[248:249] op_sel_hi:[1,0]
  v_pk_mul_f32 v[200:201], v[200:201], v[248:249] op_sel_hi:[1,0]
  v_pk_mul_f32 v[202:203], v[202:203], v[248:249] op_sel_hi:[1,0]
  v_pk_add_f32 v[250:251], v[250:251], v[186:187]
  v_cvt_pk_bf16_f32 v232, v196, v197
  v_cvt_pk_bf16_f32 v233, v198, v199
  v_cvt_pk_bf16_f32 v234, v200, v201
  v_cvt_pk_bf16_f32 v235, v202, v203
  v_add_f32 v250, v250, v251
  s_mov_b32 s70, 139264
  buffer_load_dwordx4 a[112:115], v3, s[4:7], s70 offen offset:0
  v_rcp_f32 v250, v250
  v_pk_mul_f32 v[204:205], v[204:205], v[248:249] op_sel_hi:[1,0]
  v_pk_mul_f32 v[206:207], v[206:207], v[248:249] op_sel_hi:[1,0]
  v_pk_mul_f32 v[168:169], v[168:169], v[250:251] op_sel_hi:[1,0]
  v_pk_mul_f32 v[170:171], v[170:171], v[250:251] op_sel_hi:[1,0]
  v_cvt_pk_bf16_f32 v236, v204, v205
  v_cvt_pk_bf16_f32 v237, v206, v207
  v_cvt_pk_bf16_f32 v238, v168, v169
  v_cvt_pk_bf16_f32 v239, v170, v171
  v_pk_mul_f32 v[172:173], v[172:173], v[250:251] op_sel_hi:[1,0]
  v_pk_mul_f32 v[174:175], v[174:175], v[250:251] op_sel_hi:[1,0]
  v_pk_mul_f32 v[176:177], v[176:177], v[250:251] op_sel_hi:[1,0]
  buffer_load_dwordx4 a[116:119], v3, s[4:7], s70 offen offset:1024
  v_pk_mul_f32 v[178:179], v[178:179], v[250:251] op_sel_hi:[1,0]
  v_cvt_pk_bf16_f32 v240, v172, v173
  v_cvt_pk_bf16_f32 v241, v174, v175
  v_cvt_pk_bf16_f32 v242, v176, v177
  v_cvt_pk_bf16_f32 v243, v178, v179
  v_pk_mul_f32 v[180:181], v[180:181], v[250:251] op_sel_hi:[1,0]
  v_pk_mul_f32 v[182:183], v[182:183], v[250:251] op_sel_hi:[1,0]
  v_pk_mul_f32 v[184:185], v[184:185], v[250:251] op_sel_hi:[1,0]
  v_pk_mul_f32 v[186:187], v[186:187], v[250:251] op_sel_hi:[1,0]
  v_cvt_pk_bf16_f32 v244, v180, v181
  v_cvt_pk_bf16_f32 v245, v182, v183
  v_cvt_pk_bf16_f32 v246, v184, v185
  v_cvt_pk_bf16_f32 v247, v186, v187
  s_add_u32 m0, s72, 0
  s_mov_b32 s2, 211968
  buffer_load_dwordx4 v3, s[4:7], s2 offen lds
  v_add_u32 v249, s91, v1
  v_add_u32 v251, s72, v1
  s_add_u32 m0, s72, 1024
  s_mov_b32 s2, 212992
  buffer_load_dwordx4 v3, s[4:7], s2 offen lds
  s_add_u32 m0, s72, 2048
  s_mov_b32 s2, 214016
  buffer_load_dwordx4 v3, s[4:7], s2 offen lds
  s_add_u32 m0, s72, 3072
  s_mov_b32 s2, 215040
  buffer_load_dwordx4 v3, s[4:7], s2 offen lds
  s_add_u32 m0, s72, 4096
  s_mov_b32 s2, 216064
  buffer_load_dwordx4 v3, s[4:7], s2 offen lds
  s_add_u32 m0, s72, 5120
  s_mov_b32 s2, 217088
  buffer_load_dwordx4 v3, s[4:7], s2 offen lds
  s_add_u32 m0, s72, 6144
  s_mov_b32 s2, 218112
  buffer_load_dwordx4 v3, s[4:7], s2 offen lds
  s_add_u32 m0, s72, 7168
  s_mov_b32 s2, 219136
  buffer_load_dwordx4 v3, s[4:7], s2 offen lds
  s_add_u32 m0, s72, 8192
  s_mov_b32 s2, 220160
  buffer_load_dwordx4 v3, s[4:7], s2 offen lds
  s_waitcnt vmcnt(12)
  v_bitop3_b32 v27, v32, v36, v14 bitop3:0x2a
  v_cmp_ne_u32 vcc, 0, v27
  s_nop 0
  s_cbranch_vccz L_ok_150
L_retry_149:
  s_sub_u32 s69, s69, 1
  s_cbranch_scc1 L_retry_149_to
  buffer_load_dwordx4 v[32:35], v40, s[4:7], s64 offen offset:0 sc1
  buffer_load_dwordx4 v[36:39], v40, s[4:7], s64 offen offset:2048 sc1
  s_waitcnt vmcnt(0)
  v_bitop3_b32 v27, v32, v36, v14 bitop3:0x2a
  v_cmp_ne_u32 vcc, 0, v27
  s_nop 1
  s_cbranch_vccnz L_retry_149
L_ok_150:
  ds_write_b64 v41, v[32:33]
  ds_write_b64 v41, v[34:35] offset:32
  ds_write_b64 v42, v[36:37]
  ds_write_b64 v43, v[38:39]
  s_waitcnt lgkmcnt(0)
  s_barrier
  ds_read_b128 v[48:51], v9 offset:1600
  ds_read_b128 v[52:55], v9 offset:1616
  ds_read_b128 v[56:59], v9 offset:1632
  ds_read_b128 v[60:63], v9 offset:1648
  ds_read_b128 v[64:67], v9 offset:1664
  ds_read_b128 v[68:71], v9 offset:0
  ds_read_b128 v[72:75], v9 offset:16
  ds_read_b128 v[76:79], v9 offset:32
  ds_read_b128 v[80:83], v9 offset:48
  ds_read_b128 v[84:87], v9 offset:64
  s_waitcnt lgkmcnt(9)
  v_mfma_f32_16x16x32_bf16 v[188:191], v[48:51], v[228:231], 0
  ds_read_b128 v[88:91], v9 offset:320
  s_waitcnt lgkmcnt(9)
  v_mfma_f32_16x16x32_bf16 v[188:191], v[52:55], v[232:235], v[188:191]
  ds_read_b128 v[92:95], v9 offset:336
  s_waitcnt lgkmcnt(9)
  v_mfma_f32_16x16x32_bf16 v[188:191], v[56:59], v[236:239], v[188:191]
  ds_read_b128 v[96:99], v9 offset:352
  s_waitcnt lgkmcnt(9)
  v_mfma_f32_16x16x32_bf16 v[188:191], v[60:63], v[240:243], v[188:191]
  ds_read_b128 v[100:103], v9 offset:368
  s_waitcnt lgkmcnt(9)
  v_mfma_f32_16x16x32_bf16 v[188:191], v[64:67], v[244:247], v[188:191]
  ds_read_b128 v[104:107], v9 offset:384
  s_waitcnt lgkmcnt(9)
  v_mfma_f32_16x16x32_bf16 v[168:171], v[68:71], v[228:231], 0
  ds_read_b128 v[108:111], v9 offset:640
  s_waitcnt lgkmcnt(9)
  v_mfma_f32_16x16x32_bf16 v[168:171], v[72:75], v[232:235], v[168:171]
  ds_read_b128 v[48:51], v9 offset:656
  s_waitcnt lgkmcnt(9)
  v_mfma_f32_16x16x32_bf16 v[168:171], v[76:79], v[236:239], v[168:171]
  ds_read_b128 v[52:55], v9 offset:672
  s_waitcnt lgkmcnt(9)
  v_mfma_f32_16x16x32_bf16 v[168:171], v[80:83], v[240:243], v[168:171]
  ds_read_b128 v[56:59], v9 offset:688
  v_add_f32 v248, 0x358637bd, v188
  s_waitcnt lgkmcnt(9)
  v_mfma_f32_16x16x32_bf16 v[168:171], v[84:87], v[244:247], v[168:171]
  ds_read_b128 v[60:63], v9 offset:704
  v_rcp_f32 v248, v248
  s_waitcnt lgkmcnt(9)
  v_mfma_f32_16x16x32_bf16 v[172:175], v[88:91], v[228:231], 0
  ds_read_b128 v[64:67], v9 offset:960
  s_waitcnt lgkmcnt(9)
  v_mfma_f32_16x16x32_bf16 v[172:175], v[92:95], v[232:235], v[172:175]
  ds_read_b128 v[68:71], v9 offset:976
  s_waitcnt lgkmcnt(9)
  v_mfma_f32_16x16x32_bf16 v[172:175], v[96:99], v[236:239], v[172:175]
  ds_read_b128 v[72:75], v9 offset:992
  v_mul_f32 v168, v168, v248
  s_waitcnt lgkmcnt(9)
  v_mfma_f32_16x16x32_bf16 v[172:175], v[100:103], v[240:243], v[172:175]
  ds_read_b128 v[76:79], v9 offset:1008
  v_mul_f32 v169, v169, v248
  s_waitcnt lgkmcnt(9)
  v_mfma_f32_16x16x32_bf16 v[172:175], v[104:107], v[244:247], v[172:175]
  ds_read_b128 v[80:83], v9 offset:1024
  v_mul_f32 v170, v170, v248
  s_waitcnt lgkmcnt(9)
  v_mfma_f32_16x16x32_bf16 v[176:179], v[108:111], v[228:231], 0
  v_cvt_pk_bf16_f32 v148, v168, v169
  s_waitcnt lgkmcnt(8)
  v_mfma_f32_16x16x32_bf16 v[176:179], v[48:51], v[232:235], v[176:179]
  v_mul_f32 v171, v171, v248
  v_perm_b32 v148, v148, v168, s67
  s_waitcnt lgkmcnt(7)
  v_mfma_f32_16x16x32_bf16 v[176:179], v[52:55], v[236:239], v[176:179]
  v_mul_f32 v172, v172, v248
  v_mul_f32 v173, v173, v248
  v_mul_f32 v174, v174, v248
  v_mul_f32 v175, v175, v248
  v_cvt_pk_bf16_f32 v149, v170, v171
  v_cvt_pk_bf16_f32 v150, v172, v173
  v_cvt_pk_bf16_f32 v151, v174, v175
  v_or_b32 v148, 1, v148
  s_cmp_eq_u32 s71, 0
  s_cbranch_scc1 L_slow_151
  buffer_store_dwordx4 v[148:151], v1, s[4:7], s48 offen offset:1024
L_back_152:
  s_waitcnt lgkmcnt(6)
  v_mfma_f32_16x16x32_bf16 v[176:179], v[56:59], v[240:243], v[176:179]
  ds_read_b128 v[84:87], v9 offset:1280
  s_waitcnt lgkmcnt(6)
  v_mfma_f32_16x16x32_bf16 v[176:179], v[60:63], v[244:247], v[176:179]
  ds_read_b128 v[88:91], v9 offset:1296
  s_waitcnt lgkmcnt(6)
  v_mfma_f32_16x16x32_bf16 v[180:183], v[64:67], v[228:231], 0
  ds_read_b128 v[92:95], v9 offset:1312
  s_waitcnt lgkmcnt(6)
  v_mfma_f32_16x16x32_bf16 v[180:183], v[68:71], v[232:235], v[180:183]
  ds_read_b128 v[96:99], v9 offset:1328
  s_waitcnt lgkmcnt(6)
  v_mfma_f32_16x16x32_bf16 v[180:183], v[72:75], v[236:239], v[180:183]
  ds_read_b128 v[100:103], v9 offset:1344
  s_waitcnt lgkmcnt(6)
  v_mfma_f32_16x16x32_bf16 v[180:183], v[76:79], v[240:243], v[180:183]
  v_mul_f32 v176, v176, v248
  v_mul_f32 v177, v177, v248
  s_waitcnt lgkmcnt(5)
  v_mfma_f32_16x16x32_bf16 v[180:183], v[80:83], v[244:247], v[180:183]
  v_cvt_pk_bf16_f32 v152, v176, v177
  v_mul_f32 v178, v178, v248
  v_mul_f32 v179, v179, v248
  v_perm_b32 v152, v152, v176, s67
  v_cvt_pk_bf16_f32 v153, v178, v179
  v_or_b32 v152, 1, v152
  s_nop 1
  v_mul_f32 v180, v180, v248
  v_mul_f32 v181, v181, v248
  v_mul_f32 v182, v182, v248
  v_mul_f32 v183, v183, v248
  v_cvt_pk_bf16_f32 v154, v180, v181
  v_cvt_pk_bf16_f32 v155, v182, v183
  s_cmp_eq_u32 s71, 0
  s_cbranch_scc1 L_slow_153
  buffer_store_dwordx4 v[152:155], v1, s[4:7], s48 offen offset:2048
L_back_154:
  s_waitcnt lgkmcnt(4)
  v_mfma_f32_16x16x32_bf16 v[184:187], v[84:87], v[228:231], 0
  s_waitcnt lgkmcnt(3)
  v_mfma_f32_16x16x32_bf16 v[184:187], v[88:91], v[232:235], v[184:187]
  s_waitcnt lgkmcnt(2)
  v_mfma_f32_16x16x32_bf16 v[184:187], v[92:95], v[236:239], v[184:187]
  s_waitcnt lgkmcnt(1)
  v_mfma_f32_16x16x32_bf16 v[184:187], v[96:99], v[240:243], v[184:187]
  s_waitcnt lgkmcnt(0)
  v_mfma_f32_16x16x32_bf16 v[184:187], v[100:103], v[244:247], v[184:187]
  s_nop 7
  v_mul_f32 v184, v184, v248
  buffer_load_dwordx4 v[32:35], v1, s[4:7], s16 offen offset:0 sc1
  v_mul_f32 v185, v185, v248
  v_mul_f32 v186, v186, v248
  buffer_load_dwordx4 v[44:47], v1, s[4:7], s16 offen offset:3072 sc1
  v_mul_f32 v187, v187, v248
  v_cvt_pk_bf16_f32 v156, v184, v185
  v_cvt_pk_bf16_f32 v157, v186, v187
  s_nop 0
  v_permlane32_swap_b32 v156, v158
  v_or_b32 v156, 1, v156
  v_permlane32_swap_b32 v157, v159
  s_cmp_eq_u32 s71, 0
  s_cbranch_scc1 L_slow_155
  buffer_store_dwordx4 v[156:159], v254, s[4:7], s48 offen
L_back_156:
  buffer_load_dwordx4 v[36:39], v1, s[4:7], s16 offen offset:1024 sc1
  buffer_load_dwordx4 v[48:51], v1, s[4:7], s24 offen offset:0 sc1
  s_waitcnt vmcnt(3)
  v_bitop3_b32 v27, v32, v44, v14 bitop3:0x2a
  v_cmp_ne_u32 vcc, 0, v27
  s_nop 0
  s_cbranch_vccz L_ok_158
L_retry_157:
  s_sub_u32 s69, s69, 1
  s_cbranch_scc1 L_retry_157_to
  buffer_load_dwordx4 v[32:35], v1, s[4:7], s16 offen offset:0 sc1
  buffer_load_dwordx4 v[44:47], v1, s[4:7], s16 offen offset:3072 sc1
  s_waitcnt vmcnt(0)
  v_bitop3_b32 v27, v32, v44, v14 bitop3:0x2a
  v_cmp_ne_u32 vcc, 0, v27
  s_nop 1
  s_cbranch_vccnz L_retry_157
  v_bitop3_b32 v27, v36, v48, v14 bitop3:0x2a
  v_cmp_ne_u32 vcc, 0, v27
  s_nop 1
  s_cbranch_vccz L_ok_158
  buffer_load_dwordx4 v[36:39], v1, s[4:7], s16 offen offset:1024 sc1
  buffer_load_dwordx4 v[48:51], v1, s[4:7], s24 offen offset:0 sc1
L_ok_158:
  v_mfma_f32_16x16x32_bf16 v[128:131], a[120:123], v[32:35], 0
  buffer_load_dwordx4 v[40:43], v1, s[4:7], s16 offen offset:2048 sc1
  v_mfma_f32_16x16x32_bf16 v[132:135], a[140:143], v[32:35], 0
  v_mfma_f32_16x16x32_bf16 v[136:139], a[160:163], v[32:35], 0
  v_mfma_f32_16x16x32_bf16 v[140:143], a[180:183], v[32:35], 0
  v_mfma_f32_16x16x32_bf16 v[144:147], a[200:203], v[32:35], 0
  buffer_load_dwordx4 v[52:55], v1, s[4:7], s17 offen offset:0 sc1
  v_mfma_f32_16x16x32_bf16 v[128:131], a[132:135], v[44:47], v[128:131]
  v_mfma_f32_16x16x32_bf16 v[132:135], a[152:155], v[44:47], v[132:135]
  v_mfma_f32_16x16x32_bf16 v[136:139], a[172:175], v[44:47], v[136:139]
  v_mfma_f32_16x16x32_bf16 v[140:143], a[192:195], v[44:47], v[140:143]
  buffer_load_dwordx4 v[64:67], v1, s[4:7], s17 offen offset:3072 sc1
  v_mfma_f32_16x16x32_bf16 v[144:147], a[212:215], v[44:47], v[144:147]
  s_waitcnt vmcnt(3)
  v_bitop3_b32 v27, v36, v48, v14 bitop3:0x2a
  v_cmp_ne_u32 vcc, 0, v27
  s_nop 0
  s_cbranch_vccz L_ok_160
L_retry_159:
  s_sub_u32 s69, s69, 1
  s_cbranch_scc1 L_retry_159_to
  buffer_load_dwordx4 v[36:39], v1, s[4:7], s16 offen offset:1024 sc1
  buffer_load_dwordx4 v[48:51], v1, s[4:7], s24 offen offset:0 sc1
  s_waitcnt vmcnt(0)
  v_bitop3_b32 v27, v36, v48, v14 bitop3:0x2a
  v_cmp_ne_u32 vcc, 0, v27
  s_nop 1
  s_cbranch_vccnz L_retry_159
  v_bitop3_b32 v27, v40, v52, v64 bitop3:0x80
  v_bitop3_b32 v27, v27, v27, v14 bitop3:0x2a
  v_cmp_ne_u32 vcc, 0, v27
  s_nop 1
  s_cbranch_vccz L_ok_160
  buffer_load_dwordx4 v[40:43], v1, s[4:7], s16 offen offset:2048 sc1
  buffer_load_dwordx4 v[52:55], v1, s[4:7], s17 offen offset:0 sc1
  buffer_load_dwordx4 v[64:67], v1, s[4:7], s17 offen offset:3072 sc1
L_ok_160:
  v_mfma_f32_16x16x32_bf16 v[128:131], a[124:127], v[36:39], v[128:131]
  buffer_load_dwordx4 v[56:59], v1, s[4:7], s17 offen offset:1024 sc1
  v_mfma_f32_16x16x32_bf16 v[132:135], a[144:147], v[36:39], v[132:135]
  v_mfma_f32_16x16x32_bf16 v[136:139], a[164:167], v[36:39], v[136:139]
  v_mfma_f32_16x16x32_bf16 v[140:143], a[184:187], v[36:39], v[140:143]
  v_mfma_f32_16x16x32_bf16 v[144:147], a[204:207], v[36:39], v[144:147]
  buffer_load_dwordx4 v[68:71], v1, s[4:7], s25 offen offset:0 sc1
  v_mfma_f32_16x16x32_bf16 v[128:131], a[136:139], v[48:51], v[128:131]
  v_mfma_f32_16x16x32_bf16 v[132:135], a[156:159], v[48:51], v[132:135]
  v_mfma_f32_16x16x32_bf16 v[136:139], a[176:179], v[48:51], v[136:139]
  v_mfma_f32_16x16x32_bf16 v[140:143], a[196:199], v[48:51], v[140:143]
  buffer_load_dwordx4 v[60:63], v1, s[4:7], s17 offen offset:2048 sc1
  v_mfma_f32_16x16x32_bf16 v[144:147], a[216:219], v[48:51], v[144:147]
  s_waitcnt vmcnt(5)
  v_bitop3_b32 v27, v40, v40, v14 bitop3:0x2a
  buffer_load_dwordx4 v[72:75], v1, s[4:7], s18 offen offset:0 sc1
  v_cmp_ne_u32 vcc, 0, v27
  s_nop 0
  s_cbranch_vccz L_ok_162
L_retry_161:
  s_sub_u32 s69, s69, 1
  s_cbranch_scc1 L_retry_161_to
  buffer_load_dwordx4 v[40:43], v1, s[4:7], s16 offen offset:2048 sc1
  s_waitcnt vmcnt(0)
  v_bitop3_b32 v27, v40, v40, v14 bitop3:0x2a
  v_cmp_ne_u32 vcc, 0, v27
  s_nop 1
  s_cbranch_vccnz L_retry_161
  v_bitop3_b32 v27, v52, v64, v56 bitop3:0x80
  v_bitop3_b32 v27, v27, v68, v60 bitop3:0x80
  v_bitop3_b32 v27, v27, v72, v14 bitop3:0x2a
  v_cmp_ne_u32 vcc, 0, v27
  s_nop 1
  s_cbranch_vccz L_ok_162
  buffer_load_dwordx4 v[52:55], v1, s[4:7], s17 offen offset:0 sc1
  buffer_load_dwordx4 v[64:67], v1, s[4:7], s17 offen offset:3072 sc1
  buffer_load_dwordx4 v[56:59], v1, s[4:7], s17 offen offset:1024 sc1
  buffer_load_dwordx4 v[68:71], v1, s[4:7], s25 offen offset:0 sc1
  buffer_load_dwordx4 v[60:63], v1, s[4:7], s17 offen offset:2048 sc1
  buffer_load_dwordx4 v[72:75], v1, s[4:7], s18 offen offset:0 sc1
L_ok_162:
  v_mfma_f32_16x16x32_bf16 v[128:131], a[128:131], v[40:43], v[128:131]
  v_mfma_f32_16x16x32_bf16 v[132:135], a[148:151], v[40:43], v[132:135]
  v_mfma_f32_16x16x32_bf16 v[136:139], a[168:171], v[40:43], v[136:139]
  buffer_load_dwordx4 v[84:87], v1, s[4:7], s18 offen offset:3072 sc1
  v_mfma_f32_16x16x32_bf16 v[140:143], a[188:191], v[40:43], v[140:143]
  v_mfma_f32_16x16x32_bf16 v[144:147], a[208:211], v[40:43], v[144:147]
  s_nop 2
  ds_write_b128 v4, v[128:131] offset:0
  s_waitcnt vmcnt(5)
  v_bitop3_b32 v27, v52, v64, v14 bitop3:0x2a
  buffer_load_dwordx4 v[76:79], v1, s[4:7], s18 offen offset:1024 sc1
  v_cmp_ne_u32 vcc, 0, v27
  s_nop 0
  s_cbranch_vccz L_ok_164
L_retry_163:
  s_sub_u32 s69, s69, 1
  s_cbranch_scc1 L_retry_163_to
  buffer_load_dwordx4 v[52:55], v1, s[4:7], s17 offen offset:0 sc1
  buffer_load_dwordx4 v[64:67], v1, s[4:7], s17 offen offset:3072 sc1
  s_waitcnt vmcnt(0)
  v_bitop3_b32 v27, v52, v64, v14 bitop3:0x2a
  v_cmp_ne_u32 vcc, 0, v27
  s_nop 1
  s_cbranch_vccnz L_retry_163
  v_bitop3_b32 v27, v56, v68, v60 bitop3:0x80
  v_bitop3_b32 v27, v27, v72, v84 bitop3:0x80
  v_bitop3_b32 v27, v27, v76, v14 bitop3:0x2a
  v_cmp_ne_u32 vcc, 0, v27
  s_nop 1
  s_cbranch_vccz L_ok_164
  buffer_load_dwordx4 v[56:59], v1, s[4:7], s17 offen offset:1024 sc1
  buffer_load_dwordx4 v[68:71], v1, s[4:7], s25 offen offset:0 sc1
  buffer_load_dwordx4 v[60:63], v1, s[4:7], s17 offen offset:2048 sc1
  buffer_load_dwordx4 v[72:75], v1, s[4:7], s18 offen offset:0 sc1
  buffer_load_dwordx4 v[84:87], v1, s[4:7], s18 offen offset:3072 sc1
  buffer_load_dwordx4 v[76:79], v1, s[4:7], s18 offen offset:1024 sc1
L_ok_164:
  v_mfma_f32_16x16x32_bf16 v[148:151], a[120:123], v[52:55], 0
  ds_write_b128 v4, v[132:135] offset:1024
  v_mfma_f32_16x16x32_bf16 v[152:155], a[140:143], v[52:55], 0
  v_mfma_f32_16x16x32_bf16 v[156:159], a[160:163], v[52:55], 0
  buffer_load_dwordx4 v[88:91], v1, s[4:7], s26 offen offset:0 sc1
  v_mfma_f32_16x16x32_bf16 v[160:163], a[180:183], v[52:55], 0
  ds_write_b128 v4, v[136:139] offset:2048
  v_mfma_f32_16x16x32_bf16 v[164:167], a[200:203], v[52:55], 0
  v_mfma_f32_16x16x32_bf16 v[148:151], a[132:135], v[64:67], v[148:151]
  v_mfma_f32_16x16x32_bf16 v[152:155], a[152:155], v[64:67], v[152:155]
  buffer_load_dwordx4 v[80:83], v1, s[4:7], s18 offen offset:2048 sc1
  v_mfma_f32_16x16x32_bf16 v[156:159], a[172:175], v[64:67], v[156:159]
  ds_write_b128 v4, v[140:143] offset:3072
  v_mfma_f32_16x16x32_bf16 v[160:163], a[192:195], v[64:67], v[160:163]
  v_mfma_f32_16x16x32_bf16 v[164:167], a[212:215], v[64:67], v[164:167]
  s_waitcnt vmcnt(5)
  v_bitop3_b32 v27, v56, v68, v60 bitop3:0x80
  v_bitop3_b32 v27, v27, v27, v14 bitop3:0x2a
  buffer_load_dwordx4 v[92:95], v1, s[4:7], s19 offen offset:0 sc1
  v_cmp_ne_u32 vcc, 0, v27
  ds_write_b128 v4, v[144:147] offset:4096
  s_cbranch_vccz L_ok_166
L_retry_165:
  s_sub_u32 s69, s69, 1
  s_cbranch_scc1 L_retry_165_to
  buffer_load_dwordx4 v[56:59], v1, s[4:7], s17 offen offset:1024 sc1
  buffer_load_dwordx4 v[68:71], v1, s[4:7], s25 offen offset:0 sc1
  buffer_load_dwordx4 v[60:63], v1, s[4:7], s17 offen offset:2048 sc1
  s_waitcnt vmcnt(0)
  v_bitop3_b32 v27, v56, v68, v60 bitop3:0x80
  v_bitop3_b32 v27, v27, v27, v14 bitop3:0x2a
  v_cmp_ne_u32 vcc, 0, v27
  s_nop 1
  s_cbranch_vccnz L_retry_165
  v_bitop3_b32 v27, v72, v84, v76 bitop3:0x80
  v_bitop3_b32 v27, v27, v88, v80 bitop3:0x80
  v_bitop3_b32 v27, v27, v92, v14 bitop3:0x2a
  v_cmp_ne_u32 vcc, 0, v27
  s_nop 1
  s_cbranch_vccz L_ok_166
  buffer_load_dwordx4 v[72:75], v1, s[4:7], s18 offen offset:0 sc1
  buffer_load_dwordx4 v[84:87], v1, s[4:7], s18 offen offset:3072 sc1
  buffer_load_dwordx4 v[76:79], v1, s[4:7], s18 offen offset:1024 sc1
  buffer_load_dwordx4 v[88:91], v1, s[4:7], s26 offen offset:0 sc1
  buffer_load_dwordx4 v[80:83], v1, s[4:7], s18 offen offset:2048 sc1
  buffer_load_dwordx4 v[92:95], v1, s[4:7], s19 offen offset:0 sc1
L_ok_166:
  v_mfma_f32_16x16x32_bf16 v[148:151], a[124:127], v[56:59], v[148:151]
  v_mfma_f32_16x16x32_bf16 v[148:151], a[136:139], v[68:71], v[148:151]
  v_mfma_f32_16x16x32_bf16 v[148:151], a[128:131], v[60:63], v[148:151]
  buffer_load_dwordx4 v[104:107], v1, s[4:7], s19 offen offset:3072 sc1
  v_mfma_f32_16x16x32_bf16 v[152:155], a[144:147], v[56:59], v[152:155]
  v_mfma_f32_16x16x32_bf16 v[152:155], a[156:159], v[68:71], v[152:155]
  v_mfma_f32_16x16x32_bf16 v[152:155], a[148:151], v[60:63], v[152:155]
  v_mfma_f32_16x16x32_bf16 v[156:159], a[164:167], v[56:59], v[156:159]
  v_mfma_f32_16x16x32_bf16 v[156:159], a[176:179], v[68:71], v[156:159]
  buffer_load_dwordx4 v[96:99], v1, s[4:7], s19 offen offset:1024 sc1
  v_mfma_f32_16x16x32_bf16 v[156:159], a[168:171], v[60:63], v[156:159]
  ds_write_b128 v5, v[148:151] offset:0
  v_mfma_f32_16x16x32_bf16 v[160:163], a[184:187], v[56:59], v[160:163]
  s_waitcnt vmcnt(5)
  v_bitop3_b32 v27, v72, v84, v76 bitop3:0x80
  v_mfma_f32_16x16x32_bf16 v[160:163], a[196:199], v[68:71], v[160:163]
  v_mfma_f32_16x16x32_bf16 v[160:163], a[188:191], v[60:63], v[160:163]
  buffer_load_dwordx4 v[108:111], v1, s[4:7], s27 offen offset:0 sc1
  v_mfma_f32_16x16x32_bf16 v[164:167], a[204:207], v[56:59], v[164:167]
  ds_write_b128 v5, v[152:155] offset:1024
  v_mfma_f32_16x16x32_bf16 v[164:167], a[216:219], v[68:71], v[164:167]
  v_mfma_f32_16x16x32_bf16 v[164:167], a[208:211], v[60:63], v[164:167]
  ds_write_b128 v5, v[156:159] offset:2048
  buffer_load_dwordx4 v[100:103], v1, s[4:7], s19 offen offset:2048 sc1
  s_waitcnt vmcnt(5)
  v_bitop3_b32 v27, v27, v88, v80 bitop3:0x80
  v_bitop3_b32 v27, v27, v27, v14 bitop3:0x2a
  v_cmp_ne_u32 vcc, 0, v27
  ds_write_b128 v5, v[160:163] offset:3072
  s_cbranch_vccnz L_retry_167
L_ok_168:
  v_mfma_f32_16x16x32_bf16 v[168:171], a[120:123], v[72:75], 0
  s_mov_b32 s81, 65536
  buffer_load_dword a254, v2, s[96:99], s81 offen
  v_mfma_f32_16x16x32_bf16 v[168:171], a[132:135], v[84:87], v[168:171]
  ds_write_b128 v5, v[164:167] offset:4096
  v_mfma_f32_16x16x32_bf16 v[168:171], a[124:127], v[76:79], v[168:171]
  v_mfma_f32_16x16x32_bf16 v[168:171], a[136:139], v[88:91], v[168:171]
  v_mfma_f32_16x16x32_bf16 v[168:171], a[128:131], v[80:83], v[168:171]
  v_mfma_f32_16x16x32_bf16 v[172:175], a[140:143], v[72:75], 0
  v_mfma_f32_16x16x32_bf16 v[172:175], a[152:155], v[84:87], v[172:175]
  v_mfma_f32_16x16x32_bf16 v[172:175], a[144:147], v[76:79], v[172:175]
  v_mfma_f32_16x16x32_bf16 v[172:175], a[156:159], v[88:91], v[172:175]
  v_mfma_f32_16x16x32_bf16 v[172:175], a[148:151], v[80:83], v[172:175]
  v_mfma_f32_16x16x32_bf16 v[176:179], a[160:163], v[72:75], 0
  v_mfma_f32_16x16x32_bf16 v[176:179], a[172:175], v[84:87], v[176:179]
  s_waitcnt lgkmcnt(0)
  s_barrier
  v_mfma_f32_16x16x32_bf16 v[176:179], a[164:167], v[76:79], v[176:179]
  ds_write_b128 v6, v[168:171] offset:0
  v_mfma_f32_16x16x32_bf16 v[176:179], a[176:179], v[88:91], v[176:179]
  ds_read_b128 v[132:135], v7 offset:1024
  v_mfma_f32_16x16x32_bf16 v[176:179], a[168:171], v[80:83], v[176:179]
  ds_read_b128 v[152:155], v7 offset:6144
  v_mfma_f32_16x16x32_bf16 v[180:183], a[180:183], v[72:75], 0
  ds_write_b128 v6, v[172:175] offset:1024
  v_mfma_f32_16x16x32_bf16 v[180:183], a[192:195], v[84:87], v[180:183]
  ds_read_b128 v[136:139], v7 offset:2048
  v_mfma_f32_16x16x32_bf16 v[180:183], a[184:187], v[76:79], v[180:183]
  ds_read_b128 v[156:159], v7 offset:7168
  v_mfma_f32_16x16x32_bf16 v[180:183], a[196:199], v[88:91], v[180:183]
  ds_write_b128 v6, v[176:179] offset:2048
  v_mfma_f32_16x16x32_bf16 v[180:183], a[188:191], v[80:83], v[180:183]
  ds_read_b128 v[140:143], v7 offset:3072
  v_mfma_f32_16x16x32_bf16 v[184:187], a[200:203], v[72:75], 0
  ds_read_b128 v[160:163], v7 offset:8192
  v_mfma_f32_16x16x32_bf16 v[184:187], a[212:215], v[84:87], v[184:187]
  ds_read_b128 v[144:147], v7 offset:4096
  v_mfma_f32_16x16x32_bf16 v[184:187], a[204:207], v[76:79], v[184:187]
  ds_read_b128 v[164:167], v7 offset:9216
  s_waitcnt lgkmcnt(8)
  v_add_f32 v132, v132, v152
  v_mfma_f32_16x16x32_bf16 v[184:187], a[216:219], v[88:91], v[184:187]
  ds_write_b128 v6, v[180:183] offset:3072
  v_mfma_f32_16x16x32_bf16 v[184:187], a[208:211], v[80:83], v[184:187]
  ds_read_b128 v[128:131], v7 offset:0
  s_waitcnt vmcnt(3)
  v_bitop3_b32 v27, v92, v104, v96 bitop3:0x80
  s_waitcnt vmcnt(1)
  v_bitop3_b32 v27, v27, v108, v100 bitop3:0x80
  v_bitop3_b32 v27, v27, v27, v14 bitop3:0x2a
  ds_read_b128 v[148:151], v7 offset:5120
  v_cmp_ne_u32 vcc, 0, v27
  v_add_f32 v133, v133, v153
  s_cbranch_vccnz L_retry_169
L_ok_170:
  ds_write_b128 v6, v[184:187] offset:4096
  v_mfma_f32_16x16x32_bf16 v[188:191], a[120:123], v[92:95], v[208:211]
  buffer_load_dwordx4 a[120:123], v3, s[4:7], s70 offen offset:2048
  v_mfma_f32_16x16x32_bf16 v[188:191], a[132:135], v[104:107], v[188:191]
  v_add_f32 v134, v134, v154
  v_add_f32 v135, v135, v155
  v_mfma_f32_16x16x32_bf16 v[188:191], a[124:127], v[96:99], v[188:191]
  v_add_f32 v132, v132, v212
  v_add_f32 v133, v133, v213
  v_mfma_f32_16x16x32_bf16 v[188:191], a[136:139], v[108:111], v[188:191]
  v_add_f32 v134, v134, v214
  v_add_f32 v135, v135, v215
  v_mfma_f32_16x16x32_bf16 v[188:191], a[128:131], v[100:103], v[188:191]
  s_waitcnt lgkmcnt(9)
  v_add_f32 v136, v136, v156
  buffer_load_dwordx4 a[124:127], v3, s[4:7], s70 offen offset:3072
  v_mfma_f32_16x16x32_bf16 v[192:195], a[140:143], v[92:95], v[132:135]
  v_add_f32 v137, v137, v157
  v_add_f32 v138, v138, v158
  v_mfma_f32_16x16x32_bf16 v[192:195], a[152:155], v[104:107], v[192:195]
  v_add_f32 v139, v139, v159
  v_add_f32 v136, v136, v216
  v_mfma_f32_16x16x32_bf16 v[192:195], a[144:147], v[96:99], v[192:195]
  v_add_f32 v137, v137, v217
  v_add_f32 v138, v138, v218
  v_mfma_f32_16x16x32_bf16 v[192:195], a[156:159], v[108:111], v[192:195]
  v_add_f32 v139, v139, v219
  s_waitcnt lgkmcnt(1)
  v_add_f32 v128, v128, v148
  v_mfma_f32_16x16x32_bf16 v[192:195], a[148:151], v[100:103], v[192:195]
  s_mov_b32 s70, 143360
  buffer_load_dwordx4 a[128:131], v3, s[4:7], s70 offen offset:0
  s_waitcnt lgkmcnt(0)
  s_barrier
  ds_read_b128 v[172:175], v7 offset:11264
  v_mfma_f32_16x16x32_bf16 v[196:199], a[160:163], v[92:95], v[136:139]
  v_add_f32 v129, v129, v149
  ds_read_b128 v[168:171], v7 offset:10240
  v_mfma_f32_16x16x32_bf16 v[196:199], a[172:175], v[104:107], v[196:199]
  v_add_f32 v188, v188, v128
  buffer_load_dwordx4 a[132:135], v3, s[4:7], s70 offen offset:1024
  v_mfma_f32_16x16x32_bf16 v[196:199], a[164:167], v[96:99], v[196:199]
  v_add_f32 v189, v189, v129
  v_add_f32 v130, v130, v150
  v_add_f32 v131, v131, v151
  v_add_f32 v190, v190, v130
  v_add_f32 v191, v191, v131
  ds_read_b128 v[176:179], v7 offset:12288
  v_mfma_f32_16x16x32_bf16 v[196:199], a[176:179], v[108:111], v[196:199]
  v_add_f32 v140, v140, v160
  ds_read_b128 v[180:183], v7 offset:13312
  v_mfma_f32_16x16x32_bf16 v[196:199], a[168:171], v[100:103], v[196:199]
  v_add_f32 v141, v141, v161
  v_add_f32 v142, v142, v162
  buffer_load_dwordx4 a[136:139], v3, s[4:7], s70 offen offset:2048
  v_add_f32 v143, v143, v163
  v_add_f32 v140, v140, v220
  v_add_f32 v141, v141, v221
  v_add_f32 v142, v142, v222
  v_add_f32 v143, v143, v223
  ds_read_b128 v[184:187], v7 offset:14336
  v_add_f32 v144, v144, v164
  v_mfma_f32_16x16x32_bf16 v[200:203], a[180:183], v[92:95], v[140:143]
  v_add_f32 v145, v145, v165
  v_add_f32 v146, v146, v166
  s_waitcnt lgkmcnt(4)
  v_pk_add_f32 v[192:193], v[192:193], v[172:173]
  v_pk_add_f32 v[194:195], v[194:195], v[174:175]
  buffer_load_dwordx4 a[140:143], v3, s[4:7], s70 offen offset:3072
  s_waitcnt lgkmcnt(3)
  v_add_f32 v188, v188, v168
  v_add_f32 v189, v189, v169
  v_cvt_pk_bf16_f32 v148, v188, v189
  v_add_f32 v190, v190, v170
  v_add_f32 v191, v191, v171
  v_cvt_pk_bf16_f32 v150, v192, v193
  v_cvt_pk_bf16_f32 v151, v194, v195
  v_bitop3_b32 v148, v148, v14, v14 bitop3:0x30
  v_cvt_pk_bf16_f32 v149, v190, v191
  s_cmp_eq_u32 s71, 0
  s_cbranch_scc1 L_slow_171
  buffer_store_dwordx4 v[148:151], v1, s[4:7], s49 offen offset:1024
L_back_172:
  v_pk_add_f32 v[116:117], v[188:189], v[190:191]
  v_pk_mul_f32 v[118:119], v[188:189], v[188:189]
  v_pk_fma_f32 v[118:119], v[190:191], v[190:191], v[118:119]
  v_pk_add_f32 v[116:117], v[116:117], v[192:193]
  v_pk_fma_f32 v[118:119], v[192:193], v[192:193], v[118:119]
  v_add_f32 v147, v147, v167
  v_mfma_f32_16x16x32_bf16 v[200:203], a[192:195], v[104:107], v[200:203]
  v_add_f32 v144, v144, v224
  v_add_f32 v145, v145, v225
  v_mfma_f32_16x16x32_bf16 v[200:203], a[184:187], v[96:99], v[200:203]
  v_add_f32 v146, v146, v226
  v_add_f32 v147, v147, v227
  v_mfma_f32_16x16x32_bf16 v[200:203], a[196:199], v[108:111], v[200:203]
  v_mfma_f32_16x16x32_bf16 v[200:203], a[188:191], v[100:103], v[200:203]
  v_mfma_f32_16x16x32_bf16 v[204:207], a[200:203], v[92:95], v[144:147]
  v_mfma_f32_16x16x32_bf16 v[204:207], a[212:215], v[104:107], v[204:207]
  v_mfma_f32_16x16x32_bf16 v[204:207], a[204:207], v[96:99], v[204:207]
  v_mfma_f32_16x16x32_bf16 v[204:207], a[216:219], v[108:111], v[204:207]
  v_mfma_f32_16x16x32_bf16 v[204:207], a[208:211], v[100:103], v[204:207]
  s_waitcnt lgkmcnt(2)
  v_pk_add_f32 v[196:197], v[196:197], v[176:177]
  v_pk_add_f32 v[198:199], v[198:199], v[178:179]
  s_waitcnt lgkmcnt(1)
  v_pk_add_f32 v[200:201], v[200:201], v[180:181]
  v_pk_add_f32 v[202:203], v[202:203], v[182:183]
  v_cvt_pk_bf16_f32 v152, v196, v197
  v_cvt_pk_bf16_f32 v153, v198, v199
  v_cvt_pk_bf16_f32 v154, v200, v201
  v_cvt_pk_bf16_f32 v155, v202, v203
  v_bitop3_b32 v152, v152, v14, v14 bitop3:0x30
  s_cmp_eq_u32 s71, 0
  s_cbranch_scc1 L_slow_173
  buffer_store_dwordx4 v[152:155], v1, s[4:7], s49 offen offset:2048
L_back_174:
  s_waitcnt lgkmcnt(0)
  v_pk_add_f32 v[204:205], v[204:205], v[184:185]
  v_pk_add_f32 v[206:207], v[206:207], v[186:187]
  v_cvt_pk_bf16_f32 v156, v204, v205
  v_cvt_pk_bf16_f32 v157, v206, v207
  v_pk_add_f32 v[116:117], v[116:117], v[194:195]
  v_pk_fma_f32 v[118:119], v[194:195], v[194:195], v[118:119]
  v_pk_add_f32 v[116:117], v[116:117], v[196:197]
  v_pk_fma_f32 v[118:119], v[196:197], v[196:197], v[118:119]
  v_pk_add_f32 v[116:117], v[116:117], v[198:199]
  v_permlane32_swap_b32 v156, v158
  v_permlane32_swap_b32 v157, v159
  v_bitop3_b32 v156, v156, v14, v14 bitop3:0x30
  s_cmp_eq_u32 s71, 0
  s_cbranch_scc1 L_slow_175
  buffer_store_dwordx4 v[156:159], v254, s[4:7], s49 offen
L_back_176:
  v_pk_fma_f32 v[118:119], v[198:199], v[198:199], v[118:119]
  v_pk_add_f32 v[116:117], v[116:117], v[200:201]
  v_pk_fma_f32 v[118:119], v[200:201], v[200:201], v[118:119]
  v_pk_add_f32 v[116:117], v[116:117], v[202:203]
  v_pk_fma_f32 v[118:119], v[202:203], v[202:203], v[118:119]
  v_pk_add_f32 v[116:117], v[116:117], v[204:205]
  v_pk_fma_f32 v[118:119], v[204:205], v[204:205], v[118:119]
  v_pk_add_f32 v[116:117], v[116:117], v[206:207]
  v_pk_fma_f32 v[118:119], v[206:207], v[206:207], v[118:119]
  buffer_load_dwordx4 v[32:35], v1, s[4:7], s20 offen offset:0 sc1
  v_add_f32 v116, v116, v117
  v_add_f32 v118, v118, v119
  v_mov_b64 v[208:209], v[188:189]
  v_mov_b64 v[210:211], v[190:191]
  v_mov_b64 v[212:213], v[192:193]
  v_mov_b64 v[214:215], v[194:195]
  v_mov_b64 v[216:217], v[196:197]
  v_mov_b64 v[218:219], v[198:199]
  v_mov_b64 v[220:221], v[200:201]
  v_mov_b64 v[222:223], v[202:203]
  v_mov_b64 v[224:225], v[204:205]
  v_mov_b64 v[226:227], v[206:207]
  v_permlane16_swap_b32 v116, v118
  buffer_load_dwordx4 v[44:47], v1, s[4:7], s20 offen offset:3072 sc1
  v_add_f32 v116, v116, v118
  v_mov_b32 v117, v116
  ds_read_b128 v[188:191], v12 offset:960
  s_nop 0
  v_permlane32_swap_b32 v116, v117
  v_add_f32 v116, v116, v117
  v_and_b32 v116, -2, v116
  s_cmp_eq_u32 s71, 0
  s_cbranch_scc1 L_slow_177
  buffer_store_dword v116, v26, s[4:7], s58 offen
L_back_178:
  ds_read_b128 v[192:195], v12 offset:976
  ds_read_b128 v[196:199], v12 offset:992
  ds_read_b128 v[200:203], v12 offset:1008
  ds_read_b128 v[204:207], v12 offset:1024
  buffer_load_dwordx4 v[36:39], v1, s[4:7], s20 offen offset:1024 sc1
  buffer_load_dwordx4 v[48:51], v1, s[4:7], s28 offen offset:0 sc1
  buffer_load_dwordx4 v[40:43], v1, s[4:7], s20 offen offset:2048 sc1
  buffer_load_dwordx4 v[52:55], v1, s[4:7], s21 offen offset:0 sc1
  buffer_load_dwordx4 v[64:67], v1, s[4:7], s21 offen offset:3072 sc1
  buffer_load_dwordx4 v[56:59], v1, s[4:7], s21 offen offset:1024 sc1
  s_waitcnt vmcnt(7)
  v_bitop3_b32 v27, v32, v44, v14 bitop3:0xa8
  v_cmp_ne_u32 vcc, 0, v27
  s_nop 0
  s_cbranch_vccz L_ok_180
L_retry_179:
  s_sub_u32 s69, s69, 1
  s_cbranch_scc1 L_retry_179_to
  buffer_load_dwordx4 v[32:35], v1, s[4:7], s20 offen offset:0 sc1
  buffer_load_dwordx4 v[44:47], v1, s[4:7], s20 offen offset:3072 sc1
  s_waitcnt vmcnt(0)
  v_bitop3_b32 v27, v32, v44, v14 bitop3:0xa8
  v_cmp_ne_u32 vcc, 0, v27
  s_nop 1
  s_cbranch_vccnz L_retry_179
  v_bitop3_b32 v27, v36, v48, v40 bitop3:0xfe
  v_bitop3_b32 v27, v27, v52, v64 bitop3:0xfe
  v_bitop3_b32 v27, v27, v56, v14 bitop3:0xa8
  v_cmp_ne_u32 vcc, 0, v27
  s_nop 1
  s_cbranch_vccz L_ok_180
  buffer_load_dwordx4 v[36:39], v1, s[4:7], s20 offen offset:1024 sc1
  buffer_load_dwordx4 v[48:51], v1, s[4:7], s28 offen offset:0 sc1
  buffer_load_dwordx4 v[40:43], v1, s[4:7], s20 offen offset:2048 sc1
  buffer_load_dwordx4 v[52:55], v1, s[4:7], s21 offen offset:0 sc1
  buffer_load_dwordx4 v[64:67], v1, s[4:7], s21 offen offset:3072 sc1
  buffer_load_dwordx4 v[56:59], v1, s[4:7], s21 offen offset:1024 sc1
L_ok_180:
  v_mfma_f32_16x16x32_bf16 v[128:131], a[220:223], v[32:35], 0
  v_mfma_f32_16x16x32_bf16 v[132:135], a[240:243], v[32:35], 0
  v_mfma_f32_16x16x32_bf16 v[136:139], a[8:11], v[32:35], 0
  buffer_load_dwordx4 v[68:71], v1, s[4:7], s29 offen offset:0 sc1
  v_mfma_f32_16x16x32_bf16 v[140:143], a[28:31], v[32:35], 0
  v_mfma_f32_16x16x32_bf16 v[144:147], a[48:51], v[32:35], 0
  v_mfma_f32_16x16x32_bf16 v[128:131], a[232:235], v[44:47], v[128:131]
  v_mfma_f32_16x16x32_bf16 v[132:135], a[0:3], v[44:47], v[132:135]
  v_mfma_f32_16x16x32_bf16 v[136:139], a[20:23], v[44:47], v[136:139]
  buffer_load_dwordx4 v[60:63], v1, s[4:7], s21 offen offset:2048 sc1
  v_mfma_f32_16x16x32_bf16 v[140:143], a[40:43], v[44:47], v[140:143]
  s_waitcnt vmcnt(6)
  v_bitop3_b32 v27, v36, v48, v14 bitop3:0xa8
  v_mfma_f32_16x16x32_bf16 v[144:147], a[60:63], v[44:47], v[144:147]
  v_cmp_ne_u32 vcc, 0, v27
  s_nop 0
  s_cbranch_vccz L_ok_182
L_retry_181:
  s_sub_u32 s69, s69, 1
  s_cbranch_scc1 L_retry_181_to
  buffer_load_dwordx4 v[36:39], v1, s[4:7], s20 offen offset:1024 sc1
  buffer_load_dwordx4 v[48:51], v1, s[4:7], s28 offen offset:0 sc1
  s_waitcnt vmcnt(0)
  v_bitop3_b32 v27, v36, v48, v14 bitop3:0xa8
  v_cmp_ne_u32 vcc, 0, v27
  s_nop 1
  s_cbranch_vccnz L_retry_181
  v_bitop3_b32 v27, v40, v52, v64 bitop3:0xfe
  v_bitop3_b32 v27, v27, v56, v68 bitop3:0xfe
  v_bitop3_b32 v27, v27, v60, v14 bitop3:0xa8
  v_cmp_ne_u32 vcc, 0, v27
  s_nop 1
  s_cbranch_vccz L_ok_182
  buffer_load_dwordx4 v[40:43], v1, s[4:7], s20 offen offset:2048 sc1
  buffer_load_dwordx4 v[52:55], v1, s[4:7], s21 offen offset:0 sc1
  buffer_load_dwordx4 v[64:67], v1, s[4:7], s21 offen offset:3072 sc1
  buffer_load_dwordx4 v[56:59], v1, s[4:7], s21 offen offset:1024 sc1
  buffer_load_dwordx4 v[68:71], v1, s[4:7], s29 offen offset:0 sc1
  buffer_load_dwordx4 v[60:63], v1, s[4:7], s21 offen offset:2048 sc1
L_ok_182:
  v_mfma_f32_16x16x32_bf16 v[128:131], a[224:227], v[36:39], v[128:131]
  v_mfma_f32_16x16x32_bf16 v[132:135], a[244:247], v[36:39], v[132:135]
  buffer_load_dwordx4 v[72:75], v1, s[4:7], s22 offen offset:0 sc1
  v_mfma_f32_16x16x32_bf16 v[136:139], a[12:15], v[36:39], v[136:139]
  s_waitcnt vmcnt(6)
  v_bitop3_b32 v27, v40, v40, v14 bitop3:0xa8
  v_mfma_f32_16x16x32_bf16 v[140:143], a[32:35], v[36:39], v[140:143]
  v_cmp_ne_u32 vcc, 0, v27
  v_mfma_f32_16x16x32_bf16 v[144:147], a[52:55], v[36:39], v[144:147]
  s_cbranch_vccz L_ok_184
L_retry_183:
  s_sub_u32 s69, s69, 1
  s_cbranch_scc1 L_retry_183_to
  buffer_load_dwordx4 v[40:43], v1, s[4:7], s20 offen offset:2048 sc1
  s_waitcnt vmcnt(0)
  v_bitop3_b32 v27, v40, v40, v14 bitop3:0xa8
  v_cmp_ne_u32 vcc, 0, v27
  s_nop 1
  s_cbranch_vccnz L_retry_183
  v_bitop3_b32 v27, v52, v64, v56 bitop3:0xfe
  v_bitop3_b32 v27, v27, v68, v60 bitop3:0xfe
  v_bitop3_b32 v27, v27, v72, v14 bitop3:0xa8
  v_cmp_ne_u32 vcc, 0, v27
  s_nop 1
  s_cbranch_vccz L_ok_184
  buffer_load_dwordx4 v[52:55], v1, s[4:7], s21 offen offset:0 sc1
  buffer_load_dwordx4 v[64:67], v1, s[4:7], s21 offen offset:3072 sc1
  buffer_load_dwordx4 v[56:59], v1, s[4:7], s21 offen offset:1024 sc1
  buffer_load_dwordx4 v[68:71], v1, s[4:7], s29 offen offset:0 sc1
  buffer_load_dwordx4 v[60:63], v1, s[4:7], s21 offen offset:2048 sc1
  buffer_load_dwordx4 v[72:75], v1, s[4:7], s22 offen offset:0 sc1
L_ok_184:
  v_mfma_f32_16x16x32_bf16 v[128:131], a[236:239], v[48:51], v[128:131]
  buffer_load_dwordx4 v[84:87], v1, s[4:7], s22 offen offset:3072 sc1
  v_mfma_f32_16x16x32_bf16 v[132:135], a[4:7], v[48:51], v[132:135]
  v_mfma_f32_16x16x32_bf16 v[136:139], a[24:27], v[48:51], v[136:139]
  v_mfma_f32_16x16x32_bf16 v[140:143], a[44:47], v[48:51], v[140:143]
  v_mfma_f32_16x16x32_bf16 v[144:147], a[64:67], v[48:51], v[144:147]
  s_waitcnt vmcnt(5)
  v_bitop3_b32 v27, v52, v64, v14 bitop3:0xa8
  v_mfma_f32_16x16x32_bf16 v[128:131], a[228:231], v[40:43], v[128:131]
  buffer_load_dwordx4 v[76:79], v1, s[4:7], s22 offen offset:1024 sc1
  v_mfma_f32_16x16x32_bf16 v[132:135], a[248:251], v[40:43], v[132:135]
  v_cmp_ne_u32 vcc, 0, v27
  v_mfma_f32_16x16x32_bf16 v[136:139], a[16:19], v[40:43], v[136:139]
  s_cbranch_vccz L_ok_186
L_retry_185:
  s_sub_u32 s69, s69, 1
  s_cbranch_scc1 L_retry_185_to
  buffer_load_dwordx4 v[52:55], v1, s[4:7], s21 offen offset:0 sc1
  buffer_load_dwordx4 v[64:67], v1, s[4:7], s21 offen offset:3072 sc1
  s_waitcnt vmcnt(0)
  v_bitop3_b32 v27, v52, v64, v14 bitop3:0xa8
  v_cmp_ne_u32 vcc, 0, v27
  s_nop 1
  s_cbranch_vccnz L_retry_185
  v_bitop3_b32 v27, v56, v68, v60 bitop3:0xfe
  v_bitop3_b32 v27, v27, v72, v84 bitop3:0xfe
  v_bitop3_b32 v27, v27, v76, v14 bitop3:0xa8
  v_cmp_ne_u32 vcc, 0, v27
  s_nop 1
  s_cbranch_vccz L_ok_186
  buffer_load_dwordx4 v[56:59], v1, s[4:7], s21 offen offset:1024 sc1
  buffer_load_dwordx4 v[68:71], v1, s[4:7], s29 offen offset:0 sc1
  buffer_load_dwordx4 v[60:63], v1, s[4:7], s21 offen offset:2048 sc1
  buffer_load_dwordx4 v[72:75], v1, s[4:7], s22 offen offset:0 sc1
  buffer_load_dwordx4 v[84:87], v1, s[4:7], s22 offen offset:3072 sc1
  buffer_load_dwordx4 v[76:79], v1, s[4:7], s22 offen offset:1024 sc1
L_ok_186:
  v_mfma_f32_16x16x32_bf16 v[140:143], a[36:39], v[40:43], v[140:143]
  v_mfma_f32_16x16x32_bf16 v[144:147], a[56:59], v[40:43], v[144:147]
  buffer_load_dwordx4 v[88:91], v1, s[4:7], s30 offen offset:0 sc1
  v_mfma_f32_16x16x32_bf16 v[148:151], a[220:223], v[52:55], 0
  ds_write_b128 v4, v[128:131] offset:0
  v_mfma_f32_16x16x32_bf16 v[152:155], a[240:243], v[52:55], 0
  v_mfma_f32_16x16x32_bf16 v[156:159], a[8:11], v[52:55], 0
  v_mfma_f32_16x16x32_bf16 v[160:163], a[28:31], v[52:55], 0
  buffer_load_dwordx4 v[80:83], v1, s[4:7], s22 offen offset:2048 sc1
  v_mfma_f32_16x16x32_bf16 v[164:167], a[48:51], v[52:55], 0
  ds_write_b128 v4, v[132:135] offset:1024
  v_mfma_f32_16x16x32_bf16 v[148:151], a[232:235], v[64:67], v[148:151]
  v_mfma_f32_16x16x32_bf16 v[152:155], a[0:3], v[64:67], v[152:155]
  s_waitcnt vmcnt(5)
  v_bitop3_b32 v27, v56, v68, v60 bitop3:0xfe
  v_mfma_f32_16x16x32_bf16 v[156:159], a[20:23], v[64:67], v[156:159]
  buffer_load_dwordx2 v[112:113], v15, s[4:7], s55 offen offset:0 sc1
  v_mfma_f32_16x16x32_bf16 v[160:163], a[40:43], v[64:67], v[160:163]
  v_bitop3_b32 v27, v27, v27, v14 bitop3:0xa8
  v_mfma_f32_16x16x32_bf16 v[164:167], a[60:63], v[64:67], v[164:167]
  v_cmp_ne_u32 vcc, 0, v27
  ds_write_b128 v4, v[136:139] offset:2048
  s_cbranch_vccz L_ok_188
L_retry_187:
  s_sub_u32 s69, s69, 1
  s_cbranch_scc1 L_retry_187_to
  buffer_load_dwordx4 v[56:59], v1, s[4:7], s21 offen offset:1024 sc1
  buffer_load_dwordx4 v[68:71], v1, s[4:7], s29 offen offset:0 sc1
  buffer_load_dwordx4 v[60:63], v1, s[4:7], s21 offen offset:2048 sc1
  s_waitcnt vmcnt(0)
  v_bitop3_b32 v27, v56, v68, v60 bitop3:0xfe
  v_bitop3_b32 v27, v27, v27, v14 bitop3:0xa8
  v_cmp_ne_u32 vcc, 0, v27
  s_nop 1
  s_cbranch_vccnz L_retry_187
  v_bitop3_b32 v27, v72, v84, v76 bitop3:0xfe
  v_bitop3_b32 v27, v27, v88, v80 bitop3:0xfe
  v_bitop3_b32 v27, v27, v112, v14 bitop3:0xa8
  v_cmp_ne_u32 vcc, 0, v27
  s_nop 1
  s_cbranch_vccz L_ok_188
  buffer_load_dwordx4 v[72:75], v1, s[4:7], s22 offen offset:0 sc1
  buffer_load_dwordx4 v[84:87], v1, s[4:7], s22 offen offset:3072 sc1
  buffer_load_dwordx4 v[76:79], v1, s[4:7], s22 offen offset:1024 sc1
  buffer_load_dwordx4 v[88:91], v1, s[4:7], s30 offen offset:0 sc1
  buffer_load_dwordx4 v[80:83], v1, s[4:7], s22 offen offset:2048 sc1
  buffer_load_dwordx2 v[112:113], v15, s[4:7], s55 offen offset:0 sc1
L_ok_188:
  v_mfma_f32_16x16x32_bf16 v[148:151], a[224:227], v[56:59], v[148:151]
  buffer_load_dwordx2 v[114:115], v15, s[4:7], s55 offen offset:512 sc1
  v_mfma_f32_16x16x32_bf16 v[148:151], a[236:239], v[68:71], v[148:151]
  ds_write_b128 v4, v[140:143] offset:3072
  v_mfma_f32_16x16x32_bf16 v[148:151], a[228:231], v[60:63], v[148:151]
  v_mfma_f32_16x16x32_bf16 v[152:155], a[244:247], v[56:59], v[152:155]
  v_mfma_f32_16x16x32_bf16 v[152:155], a[4:7], v[68:71], v[152:155]
  buffer_load_dwordx4 v[92:95], v1, s[4:7], s23 offen offset:0 sc1
  v_mfma_f32_16x16x32_bf16 v[152:155], a[248:251], v[60:63], v[152:155]
  ds_write_b128 v4, v[144:147] offset:4096
  v_mfma_f32_16x16x32_bf16 v[156:159], a[12:15], v[56:59], v[156:159]
  v_mfma_f32_16x16x32_bf16 v[156:159], a[24:27], v[68:71], v[156:159]
  s_waitcnt vmcnt(5)
  v_bitop3_b32 v27, v72, v84, v76 bitop3:0xfe
  v_mfma_f32_16x16x32_bf16 v[156:159], a[16:19], v[60:63], v[156:159]
  buffer_load_dwordx4 v[104:107], v1, s[4:7], s23 offen offset:3072 sc1
  v_mfma_f32_16x16x32_bf16 v[160:163], a[32:35], v[56:59], v[160:163]
  ds_write_b128 v5, v[148:151] offset:0
  v_mfma_f32_16x16x32_bf16 v[160:163], a[44:47], v[68:71], v[160:163]
  v_mfma_f32_16x16x32_bf16 v[160:163], a[36:39], v[60:63], v[160:163]
  v_mfma_f32_16x16x32_bf16 v[164:167], a[52:55], v[56:59], v[164:167]
  buffer_load_dwordx4 v[96:99], v1, s[4:7], s23 offen offset:1024 sc1
  v_mfma_f32_16x16x32_bf16 v[164:167], a[64:67], v[68:71], v[164:167]
  ds_write_b128 v5, v[152:155] offset:1024
  v_mfma_f32_16x16x32_bf16 v[164:167], a[56:59], v[60:63], v[164:167]
  s_waitcnt vmcnt(5)
  v_bitop3_b32 v27, v27, v88, v80 bitop3:0xfe
  v_bitop3_b32 v27, v27, v27, v14 bitop3:0xa8
  v_cmp_ne_u32 vcc, 0, v27
  s_nop 0
  s_cbranch_vccnz L_retry_189
L_ok_190:
  v_mfma_f32_16x16x32_bf16 v[168:171], a[220:223], v[72:75], 0
  buffer_load_dwordx4 v[108:111], v1, s[4:7], s31 offen offset:0 sc1
  v_mfma_f32_16x16x32_bf16 v[168:171], a[232:235], v[84:87], v[168:171]
  ds_write_b128 v5, v[156:159] offset:2048
  v_mfma_f32_16x16x32_bf16 v[168:171], a[224:227], v[76:79], v[168:171]
  v_mfma_f32_16x16x32_bf16 v[168:171], a[236:239], v[88:91], v[168:171]
  v_mfma_f32_16x16x32_bf16 v[168:171], a[228:231], v[80:83], v[168:171]
  buffer_load_dwordx4 v[100:103], v1, s[4:7], s23 offen offset:2048 sc1
  v_mfma_f32_16x16x32_bf16 v[172:175], a[240:243], v[72:75], 0
  ds_write_b128 v5, v[160:163] offset:3072
  v_mfma_f32_16x16x32_bf16 v[172:175], a[0:3], v[84:87], v[172:175]
  v_mfma_f32_16x16x32_bf16 v[172:175], a[244:247], v[76:79], v[172:175]
  v_mfma_f32_16x16x32_bf16 v[172:175], a[4:7], v[88:91], v[172:175]
  s_mov_b32 s70, 147456
  buffer_load_dwordx4 a[144:147], v3, s[4:7], s70 offen offset:0
  v_mfma_f32_16x16x32_bf16 v[172:175], a[248:251], v[80:83], v[172:175]
  ds_write_b128 v5, v[164:167] offset:4096
  v_mfma_f32_16x16x32_bf16 v[176:179], a[8:11], v[72:75], 0
  v_mfma_f32_16x16x32_bf16 v[176:179], a[20:23], v[84:87], v[176:179]
  v_mfma_f32_16x16x32_bf16 v[176:179], a[12:15], v[76:79], v[176:179]
  buffer_load_dwordx4 a[148:151], v3, s[4:7], s70 offen offset:1024
  v_mfma_f32_16x16x32_bf16 v[176:179], a[24:27], v[88:91], v[176:179]
  v_mfma_f32_16x16x32_bf16 v[176:179], a[16:19], v[80:83], v[176:179]
  v_mfma_f32_16x16x32_bf16 v[180:183], a[28:31], v[72:75], 0
  v_mfma_f32_16x16x32_bf16 v[180:183], a[40:43], v[84:87], v[180:183]
  v_mfma_f32_16x16x32_bf16 v[180:183], a[32:35], v[76:79], v[180:183]
  buffer_load_dwordx4 a[152:155], v3, s[4:7], s70 offen offset:2048
  v_mfma_f32_16x16x32_bf16 v[180:183], a[44:47], v[88:91], v[180:183]
  v_mfma_f32_16x16x32_bf16 v[180:183], a[36:39], v[80:83], v[180:183]
  s_waitcnt lgkmcnt(0)
  s_barrier
  v_mfma_f32_16x16x32_bf16 v[184:187], a[48:51], v[72:75], 0
  buffer_load_dwordx4 a[156:159], v3, s[4:7], s70 offen offset:3072
  v_mfma_f32_16x16x32_bf16 v[184:187], a[60:63], v[84:87], v[184:187]
  ds_write_b128 v6, v[168:171] offset:0
  v_mfma_f32_16x16x32_bf16 v[184:187], a[52:55], v[76:79], v[184:187]
  ds_read_b128 v[132:135], v7 offset:1024
  v_mfma_f32_16x16x32_bf16 v[184:187], a[64:67], v[88:91], v[184:187]
  ds_read_b128 v[152:155], v7 offset:6144
  v_mfma_f32_16x16x32_bf16 v[184:187], a[56:59], v[80:83], v[184:187]
  s_mov_b32 s70, 151552
  buffer_load_dwordx4 a[160:163], v3, s[4:7], s70 offen offset:0
  ds_write_b128 v6, v[172:175] offset:1024
  ds_read_b128 v[136:139], v7 offset:2048
  ds_read_b128 v[156:159], v7 offset:7168
  ds_write_b128 v6, v[176:179] offset:2048
  buffer_load_dwordx4 a[164:167], v3, s[4:7], s70 offen offset:1024
  ds_read_b128 v[140:143], v7 offset:3072
  ds_read_b128 v[160:163], v7 offset:8192
  ds_write_b128 v6, v[180:183] offset:3072
  ds_read_b128 v[144:147], v7 offset:4096
  s_waitcnt lgkmcnt(8)
  v_add_f32 v132, v132, v152
  s_waitcnt vmcnt(11)
  v_bitop3_b32 v27, v112, v114, v14 bitop3:0xa8
  v_cmp_ne_u32 vcc, 0, v27
  buffer_load_dwordx4 a[168:171], v3, s[4:7], s70 offen offset:2048
  ds_read_b128 v[164:167], v7 offset:9216
  s_cbranch_vccz L_ok_192
L_retry_191:
  s_sub_u32 s69, s69, 1
  s_cbranch_scc1 L_retry_191_to
  buffer_load_dwordx2 v[112:113], v15, s[4:7], s55 offen offset:0 sc1
  buffer_load_dwordx2 v[114:115], v15, s[4:7], s55 offen offset:512 sc1
  s_waitcnt vmcnt(0)
  v_bitop3_b32 v27, v112, v114, v14 bitop3:0xa8
  v_cmp_ne_u32 vcc, 0, v27
  s_nop 1
  s_cbranch_vccnz L_retry_191
  v_bitop3_b32 v27, v92, v104, v96 bitop3:0xfe
  v_bitop3_b32 v27, v27, v108, v100 bitop3:0xfe
  v_bitop3_b32 v27, v27, v27, v14 bitop3:0xa8
  v_cmp_ne_u32 vcc, 0, v27
  s_nop 1
  s_cbranch_vccz L_ok_192
  buffer_load_dwordx4 v[92:95], v1, s[4:7], s23 offen offset:0 sc1
  buffer_load_dwordx4 v[104:107], v1, s[4:7], s23 offen offset:3072 sc1
  buffer_load_dwordx4 v[96:99], v1, s[4:7], s23 offen offset:1024 sc1
  buffer_load_dwordx4 v[108:111], v1, s[4:7], s31 offen offset:0 sc1
  buffer_load_dwordx4 v[100:103], v1, s[4:7], s23 offen offset:2048 sc1
  buffer_load_dword a253, v26, s[4:7], s76 offen
  buffer_load_dword a253, v26, s[4:7], s76 offen
  buffer_load_dword a253, v26, s[4:7], s76 offen
  buffer_load_dword a253, v26, s[4:7], s76 offen
  buffer_load_dword a253, v26, s[4:7], s76 offen
  buffer_load_dword a253, v26, s[4:7], s76 offen
  buffer_load_dword a253, v26, s[4:7], s76 offen
L_ok_192:
  ds_write_b128 v6, v[184:187] offset:4096
  ds_read_b128 v[128:131], v7 offset:0
  v_add_f32 v112, v112, v114
  v_mov_b32 v114, v112
  v_add_f32 v133, v133, v153
  ds_read_b128 v[148:151], v7 offset:5120
  v_permlane16_swap_b32 v112, v114
  v_add_f32 v112, v112, v114
  buffer_load_dwordx4 a[172:175], v3, s[4:7], s70 offen offset:3072
  v_mov_b32 v114, v112
  v_add_f32 v134, v134, v154
  v_add_f32 v135, v135, v155
  v_permlane32_swap_b32 v112, v114
  v_add_f32 v112, v112, v114
  v_mul_f32 v28, 0xbacccccd, v112
  v_mul_f32 v188, v28, v188
  v_mul_f32 v189, v28, v189
  v_mul_f32 v190, v28, v190
  v_mul_f32 v191, v28, v191
  v_fmac_f32 v132, v28, v192
  v_fmac_f32 v133, v28, v193
  v_fmac_f32 v134, v28, v194
  v_fmac_f32 v135, v28, v195
  v_add_f32 v113, v113, v115
  s_mov_b32 s70, 155648
  buffer_load_dwordx4 a[176:179], v3, s[4:7], s70 offen offset:0
  v_mov_b32 v115, v113
  s_waitcnt lgkmcnt(9)
  v_add_f32 v136, v136, v156
  v_add_f32 v137, v137, v157
  v_permlane16_swap_b32 v113, v115
  v_add_f32 v113, v113, v115
  v_mov_b32 v115, v113
  v_add_f32 v138, v138, v158
  v_add_f32 v139, v139, v159
  v_permlane32_swap_b32 v113, v115
  v_add_f32 v113, v113, v115
  v_mul_f32 v113, 0x3acccccd, v113
  s_waitcnt vmcnt(11)
  v_bitop3_b32 v27, v92, v104, v96 bitop3:0xfe
  v_fmac_f32 v136, v28, v196
  buffer_load_dwordx4 a[180:183], v3, s[4:7], s70 offen offset:1024
  v_fmac_f32 v137, v28, v197
  v_fmac_f32 v138, v28, v198
  v_fmac_f32 v139, v28, v199
  v_fma_f32 v29, -v28, v28, v113
  v_max_f32 v29, 0, v29
  v_add_f32 v31, 0x3727c5ac, v29
  v_rsq_f32 v30, v31
  s_waitcnt lgkmcnt(0)
  v_add_f32 v128, v128, v148
  v_mul_f32 v120, v30, v30
  v_fma_f32 v120, v120, v29, v121
  v_rsq_f32 v120, v120
  v_add_f32 v129, v129, v149
  v_mul_f32 v120, v120, v30
  buffer_load_dwordx4 a[184:187], v3, s[4:7], s70 offen offset:2048
  v_add_f32 v130, v130, v150
  v_add_f32 v131, v131, v151
  v_mul_f32 v250, v120, v120
  v_mul_f32 v250, v250, v120
  v_mul_f32 v248, s79, v120
  v_mul_f32 v250, s80, v250
  v_add_f32 v140, v140, v160
  v_add_f32 v141, v141, v161
  v_add_f32 v142, v142, v162
  v_add_f32 v143, v143, v163
  v_fmac_f32 v140, v28, v200
  v_fmac_f32 v141, v28, v201
  v_fmac_f32 v142, v28, v202
  v_fmac_f32 v143, v28, v203
  s_waitcnt vmcnt(11)
  v_bitop3_b32 v27, v27, v108, v100 bitop3:0xfe
  v_bitop3_b32 v27, v27, v27, v14 bitop3:0xa8
  buffer_load_dwordx4 a[188:191], v3, s[4:7], s70 offen offset:3072
  v_cmp_ne_u32 vcc, 0, v27
  v_rcp_f32 v252, v120
  s_cbranch_vccnz L_retry_193
L_ok_194:
  v_pk_add_f32 v[228:229], v[208:209], v[28:29] op_sel_hi:[1,0]
  v_pk_add_f32 v[230:231], v[210:211], v[28:29] op_sel_hi:[1,0]
  v_pk_add_f32 v[232:233], v[212:213], v[28:29] op_sel_hi:[1,0]
  v_pk_add_f32 v[234:235], v[214:215], v[28:29] op_sel_hi:[1,0]
  v_pk_add_f32 v[236:237], v[216:217], v[28:29] op_sel_hi:[1,0]
  v_pk_add_f32 v[238:239], v[218:219], v[28:29] op_sel_hi:[1,0]
  v_pk_add_f32 v[240:241], v[220:221], v[28:29] op_sel_hi:[1,0]
  v_pk_add_f32 v[242:243], v[222:223], v[28:29] op_sel_hi:[1,0]
  v_pk_add_f32 v[244:245], v[224:225], v[28:29] op_sel_hi:[1,0]
  v_pk_add_f32 v[246:247], v[226:227], v[28:29] op_sel_hi:[1,0]
  s_mov_b32 s70, 159744
  buffer_load_dwordx4 a[192:195], v3, s[4:7], s70 offen offset:0
  v_pk_mul_f32 v[228:229], v[228:229], v[30:31] op_sel_hi:[1,0]
  v_pk_mul_f32 v[230:231], v[230:231], v[30:31] op_sel_hi:[1,0]
  v_pk_mul_f32 v[232:233], v[232:233], v[30:31] op_sel_hi:[1,0]
  v_pk_mul_f32 v[234:235], v[234:235], v[30:31] op_sel_hi:[1,0]
  v_pk_mul_f32 v[236:237], v[236:237], v[30:31] op_sel_hi:[1,0]
  v_pk_mul_f32 v[238:239], v[238:239], v[30:31] op_sel_hi:[1,0]
  v_pk_mul_f32 v[240:241], v[240:241], v[30:31] op_sel_hi:[1,0]
  v_pk_mul_f32 v[242:243], v[242:243], v[30:31] op_sel_hi:[1,0]
  v_pk_mul_f32 v[244:245], v[244:245], v[30:31] op_sel_hi:[1,0]
  v_pk_mul_f32 v[246:247], v[246:247], v[30:31] op_sel_hi:[1,0]
  v_add_f32 v144, v144, v164
  v_mfma_f32_16x16x32_bf16 v[188:191], a[220:223], v[92:95], v[188:191]
  buffer_load_dwordx4 a[196:199], v3, s[4:7], s70 offen offset:1024
  v_mfma_f32_16x16x32_bf16 v[188:191], a[232:235], v[104:107], v[188:191]
  s_barrier
  v_mfma_f32_16x16x32_bf16 v[188:191], a[224:227], v[96:99], v[188:191]
  ds_read_b128 v[172:175], v7 offset:11264
  v_add_f32 v145, v145, v165
  v_mfma_f32_16x16x32_bf16 v[188:191], a[236:239], v[108:111], v[188:191]
  buffer_load_dwordx4 a[200:203], v3, s[4:7], s70 offen offset:2048
  ds_read_b128 v[168:171], v7 offset:10240
  v_mfma_f32_16x16x32_bf16 v[188:191], a[228:231], v[100:103], v[188:191]
  v_add_f32 v146, v146, v166
  ds_read_b128 v[176:179], v7 offset:12288
  v_mfma_f32_16x16x32_bf16 v[192:195], a[240:243], v[92:95], v[132:135]
  v_add_f32 v147, v147, v167
  ds_read_b128 v[180:183], v7 offset:13312
  v_mfma_f32_16x16x32_bf16 v[192:195], a[0:3], v[104:107], v[192:195]
  v_fmac_f32 v144, v28, v204
  ds_read_b128 v[184:187], v7 offset:14336
  v_mfma_f32_16x16x32_bf16 v[192:195], a[244:247], v[96:99], v[192:195]
  v_add_f32 v188, v188, v128
  buffer_load_dwordx4 a[204:207], v3, s[4:7], s70 offen offset:3072
  v_mfma_f32_16x16x32_bf16 v[192:195], a[4:7], v[108:111], v[192:195]
  v_add_f32 v189, v189, v129
  v_add_f32 v190, v190, v130
  v_mfma_f32_16x16x32_bf16 v[192:195], a[248:251], v[100:103], v[192:195]
  v_add_f32 v191, v191, v131
  v_fmac_f32 v145, v28, v205
  v_mfma_f32_16x16x32_bf16 v[196:199], a[8:11], v[92:95], v[136:139]
  v_fmac_f32 v146, v28, v206
  v_fmac_f32 v147, v28, v207
  v_mfma_f32_16x16x32_bf16 v[196:199], a[20:23], v[104:107], v[196:199]
  v_mfma_f32_16x16x32_bf16 v[196:199], a[12:15], v[96:99], v[196:199]
  s_mov_b32 s70, 163840
  buffer_load_dwordx4 a[208:211], v3, s[4:7], s70 offen offset:0
  s_waitcnt lgkmcnt(4)
  v_pk_add_f32 v[192:193], v[192:193], v[172:173]
  v_pk_add_f32 v[194:195], v[194:195], v[174:175]
  s_waitcnt lgkmcnt(3)
  v_add_f32 v188, v188, v168
  v_add_f32 v189, v189, v169
  v_add_f32 v190, v190, v170
  v_add_f32 v191, v191, v171
  v_pk_mul_f32 v[128:129], v[188:189], v[188:189]
  v_pk_fma_f32 v[128:129], v[128:129], v[250:251], v[248:249] op_sel_hi:[1,0,0]
  v_pk_mul_f32 v[128:129], v[128:129], v[188:189]
  v_pk_mul_f32 v[130:131], v[190:191], v[190:191]
  v_pk_fma_f32 v[130:131], v[130:131], v[250:251], v[248:249] op_sel_hi:[1,0,0]
  v_pk_mul_f32 v[130:131], v[130:131], v[190:191]
  v_pk_mul_f32 v[132:133], v[192:193], v[192:193]
  v_pk_fma_f32 v[132:133], v[132:133], v[250:251], v[248:249] op_sel_hi:[1,0,0]
  v_pk_mul_f32 v[132:133], v[132:133], v[192:193]
  v_pk_mul_f32 v[134:135], v[194:195], v[194:195]
  v_pk_fma_f32 v[134:135], v[134:135], v[250:251], v[248:249] op_sel_hi:[1,0,0]
  v_pk_mul_f32 v[134:135], v[134:135], v[194:195]
  buffer_load_dwordx4 a[212:215], v3, s[4:7], s70 offen offset:1024
  v_mfma_f32_16x16x32_bf16 v[196:199], a[24:27], v[108:111], v[196:199]
  v_exp_f32 v128, v128
  v_mfma_f32_16x16x32_bf16 v[196:199], a[16:19], v[100:103], v[196:199]
  v_exp_f32 v129, v129
  v_mfma_f32_16x16x32_bf16 v[200:203], a[28:31], v[92:95], v[140:143]
  v_exp_f32 v130, v130
  v_mfma_f32_16x16x32_bf16 v[200:203], a[40:43], v[104:107], v[200:203]
  v_exp_f32 v131, v131
  v_exp_f32 v132, v132
  v_exp_f32 v133, v133
  buffer_load_dwordx4 a[216:219], v3, s[4:7], s70 offen offset:2048
  v_exp_f32 v134, v134
  v_exp_f32 v135, v135
  v_pk_fma_f32 v[128:129], v[128:129], v[252:253], v[252:253] op_sel_hi:[1,0,0]
  v_pk_fma_f32 v[130:131], v[130:131], v[252:253], v[252:253] op_sel_hi:[1,0,0]
  v_pk_fma_f32 v[132:133], v[132:133], v[252:253], v[252:253] op_sel_hi:[1,0,0]
  v_pk_fma_f32 v[134:135], v[134:135], v[252:253], v[252:253] op_sel_hi:[1,0,0]
  v_mfma_f32_16x16x32_bf16 v[200:203], a[32:35], v[96:99], v[200:203]
  v_rcp_f32 v128, v128
  v_mfma_f32_16x16x32_bf16 v[200:203], a[44:47], v[108:111], v[200:203]
  buffer_load_dwordx4 a[220:223], v3, s[4:7], s70 offen offset:3072
  v_rcp_f32 v129, v129
  v_rcp_f32 v130, v130
  v_rcp_f32 v131, v131
  v_rcp_f32 v132, v132
  v_rcp_f32 v133, v133
  v_rcp_f32 v134, v134
  v_rcp_f32 v135, v135
  v_pk_mul_f32 v[188:189], v[188:189], v[128:129]
  v_pk_mul_f32 v[190:191], v[190:191], v[130:131]
  v_pk_mul_f32 v[192:193], v[192:193], v[132:133]
  v_pk_mul_f32 v[194:195], v[194:195], v[134:135]
  s_mov_b32 s70, 167936
  buffer_load_dwordx4 a[224:227], v3, s[4:7], s70 offen offset:0
  v_mfma_f32_16x16x32_bf16 v[200:203], a[36:39], v[100:103], v[200:203]
  v_cvt_pk_bf16_f32 v148, v188, v189
  v_add_u32 v188, 0x10000, v188
  v_perm_b32 v148, v148, v188, s67
  v_cvt_pk_bf16_f32 v149, v190, v191
  v_cvt_pk_bf16_f32 v150, v192, v193
  v_cvt_pk_bf16_f32 v151, v194, v195
  v_and_b32 v148, -2, v148
  s_cmp_eq_u32 s71, 0
  s_cbranch_scc1 L_slow_195
  buffer_store_dwordx4 v[148:151], v1, s[4:7], s48 offen offset:1024
L_back_196:
  s_cmp_eq_u32 s73, 1
  s_cbranch_scc1 L_nohalo_197
  buffer_store_dwordx4 v[148:151], v24, s[4:7], s50 offen offset:1024 sc1
  s_nop 1
L_nohalo_197:
  s_waitcnt lgkmcnt(2)
  v_pk_add_f32 v[196:197], v[196:197], v[176:177]
  v_pk_add_f32 v[198:199], v[198:199], v[178:179]
  s_waitcnt lgkmcnt(1)
  v_pk_add_f32 v[200:201], v[200:201], v[180:181]
  v_pk_add_f32 v[202:203], v[202:203], v[182:183]
  v_pk_mul_f32 v[136:137], v[196:197], v[196:197]
  v_pk_fma_f32 v[136:137], v[136:137], v[250:251], v[248:249] op_sel_hi:[1,0,0]
  v_pk_mul_f32 v[136:137], v[136:137], v[196:197]
  v_pk_mul_f32 v[138:139], v[198:199], v[198:199]
  v_pk_fma_f32 v[138:139], v[138:139], v[250:251], v[248:249] op_sel_hi:[1,0,0]
  v_pk_mul_f32 v[138:139], v[138:139], v[198:199]
  v_pk_mul_f32 v[140:141], v[200:201], v[200:201]
  v_pk_fma_f32 v[140:141], v[140:141], v[250:251], v[248:249] op_sel_hi:[1,0,0]
  v_pk_mul_f32 v[140:141], v[140:141], v[200:201]
  v_pk_mul_f32 v[142:143], v[202:203], v[202:203]
  v_pk_fma_f32 v[142:143], v[142:143], v[250:251], v[248:249] op_sel_hi:[1,0,0]
  v_pk_mul_f32 v[142:143], v[142:143], v[202:203]
  v_exp_f32 v136, v136
  v_exp_f32 v137, v137
  v_exp_f32 v138, v138
  v_exp_f32 v139, v139
  v_exp_f32 v140, v140
  v_exp_f32 v141, v141
  v_exp_f32 v142, v142
  v_exp_f32 v143, v143
  v_pk_fma_f32 v[136:137], v[136:137], v[252:253], v[252:253] op_sel_hi:[1,0,0]
  v_pk_fma_f32 v[138:139], v[138:139], v[252:253], v[252:253] op_sel_hi:[1,0,0]
  v_pk_fma_f32 v[140:141], v[140:141], v[252:253], v[252:253] op_sel_hi:[1,0,0]
  v_pk_fma_f32 v[142:143], v[142:143], v[252:253], v[252:253] op_sel_hi:[1,0,0]
  v_rcp_f32 v136, v136
  v_rcp_f32 v137, v137
  v_rcp_f32 v138, v138
  v_rcp_f32 v139, v139
  v_rcp_f32 v140, v140
  v_rcp_f32 v141, v141
  v_rcp_f32 v142, v142
  v_rcp_f32 v143, v143
  v_pk_mul_f32 v[196:197], v[196:197], v[136:137]
  v_pk_mul_f32 v[198:199], v[198:199], v[138:139]
  v_pk_mul_f32 v[200:201], v[200:201], v[140:141]
  v_pk_mul_f32 v[202:203], v[202:203], v[142:143]
  v_mfma_f32_16x16x32_bf16 v[204:207], a[48:51], v[92:95], v[144:147]
  v_cvt_pk_bf16_f32 v152, v196, v197
  v_mfma_f32_16x16x32_bf16 v[204:207], a[60:63], v[104:107], v[204:207]
  v_add_u32 v196, 0x10000, v196
  v_perm_b32 v152, v152, v196, s67
  v_mfma_f32_16x16x32_bf16 v[204:207], a[52:55], v[96:99], v[204:207]
  v_cvt_pk_bf16_f32 v153, v198, v199
  v_cvt_pk_bf16_f32 v154, v200, v201
  v_cvt_pk_bf16_f32 v155, v202, v203
  v_and_b32 v152, -2, v152
  s_cmp_eq_u32 s71, 0
  s_cbranch_scc1 L_slow_198
  buffer_store_dwordx4 v[152:155], v1, s[4:7], s48 offen offset:2048
L_back_199:
  s_cmp_eq_u32 s73, 1
  s_cbranch_scc1 L_nohalo_200
  buffer_store_dwordx4 v[152:155], v24, s[4:7], s50 offen offset:2048 sc1
  s_nop 1
L_nohalo_200:
  v_mfma_f32_16x16x32_bf16 v[204:207], a[64:67], v[108:111], v[204:207]
  v_mfma_f32_16x16x32_bf16 v[204:207], a[56:59], v[100:103], v[204:207]
  buffer_load_dwordx4 v[32:35], v16, s[4:7], s32 offen offset:0 sc1
  s_waitcnt lgkmcnt(0)
  s_nop 5
  v_pk_add_f32 v[204:205], v[204:205], v[184:185]
  v_pk_add_f32 v[206:207], v[206:207], v[186:187]
  v_pk_mul_f32 v[144:145], v[204:205], v[204:205]
  v_pk_fma_f32 v[144:145], v[144:145], v[250:251], v[248:249] op_sel_hi:[1,0,0]
  v_pk_mul_f32 v[144:145], v[144:145], v[204:205]
  v_pk_mul_f32 v[146:147], v[206:207], v[206:207]
  v_pk_fma_f32 v[146:147], v[146:147], v[250:251], v[248:249] op_sel_hi:[1,0,0]
  v_pk_mul_f32 v[146:147], v[146:147], v[206:207]
  buffer_load_dwordx4 v[44:47], v16, s[4:7], s32 offen offset:3072 sc1
  v_exp_f32 v144, v144
  v_exp_f32 v145, v145
  v_exp_f32 v146, v146
  v_exp_f32 v147, v147
  v_pk_fma_f32 v[144:145], v[144:145], v[252:253], v[252:253] op_sel_hi:[1,0,0]
  v_pk_fma_f32 v[146:147], v[146:147], v[252:253], v[252:253] op_sel_hi:[1,0,0]
  v_rcp_f32 v144, v144
  v_rcp_f32 v145, v145
  v_rcp_f32 v146, v146
  v_rcp_f32 v147, v147
  v_pk_mul_f32 v[204:205], v[204:205], v[144:145]
  v_pk_mul_f32 v[206:207], v[206:207], v[146:147]
  v_cvt_pk_bf16_f32 v156, v204, v205
  v_cvt_pk_bf16_f32 v157, v206, v207
  s_nop 0
  v_permlane32_swap_b32 v156, v158
  v_and_b32 v156, -2, v156
  v_permlane32_swap_b32 v157, v159
  s_cmp_eq_u32 s71, 0
  s_cbranch_scc1 L_slow_201
  buffer_store_dwordx4 v[156:159], v254, s[4:7], s48 offen
L_back_202:
  s_cmp_eq_u32 s73, 1
  s_cbranch_scc1 L_nohalo_203
  buffer_store_dwordx4 v[156:159], v23, s[4:7], s50 offen sc1
  s_nop 1
L_nohalo_203:
  buffer_load_dwordx4 v[36:39], v16, s[4:7], s32 offen offset:1024 sc1
  buffer_load_dwordx4 v[48:51], v16, s[4:7], s33 offen offset:0 sc1
  s_waitcnt vmcnt(3)
  v_bitop3_b32 v27, v32, v44, 1 bitop3:0xa8
  v_cmp_ne_u32 vcc, 0, v27
  s_nop 0
  s_cbranch_vccz L_ok_205
L_retry_204:
  s_sub_u32 s69, s69, 1
  s_cbranch_scc1 L_retry_204_to
  buffer_load_dwordx4 v[32:35], v16, s[4:7], s32 offen offset:0 sc1
  buffer_load_dwordx4 v[44:47], v16, s[4:7], s32 offen offset:3072 sc1
  s_waitcnt vmcnt(0)
  v_bitop3_b32 v27, v32, v44, 1 bitop3:0xa8
  v_cmp_ne_u32 vcc, 0, v27
  s_nop 1
  s_cbranch_vccnz L_retry_204
  v_bitop3_b32 v27, v36, v48, 1 bitop3:0xa8
  v_cmp_ne_u32 vcc, 0, v27
  s_nop 1
  s_cbranch_vccz L_ok_205
  buffer_load_dwordx4 v[36:39], v16, s[4:7], s32 offen offset:1024 sc1
  buffer_load_dwordx4 v[48:51], v16, s[4:7], s33 offen offset:0 sc1
L_ok_205:
  v_mfma_f32_16x16x32_bf16 v[128:131], a[68:71], v[32:35], 0
  v_mfma_f32_16x16x32_bf16 v[132:135], a[88:91], v[32:35], 0
  v_mfma_f32_16x16x32_bf16 v[136:139], a[108:111], v[32:35], 0
  buffer_load_dwordx4 v[40:43], v16, s[4:7], s32 offen offset:2048 sc1
  v_mfma_f32_16x16x32_bf16 v[140:143], a[128:131], v[32:35], 0
  v_mfma_f32_16x16x32_bf16 v[144:147], a[148:151], v[32:35], 0
  v_mfma_f32_16x16x32_bf16 v[128:131], a[80:83], v[44:47], v[128:131]
  v_mfma_f32_16x16x32_bf16 v[132:135], a[100:103], v[44:47], v[132:135]
  buffer_load_dwordx4 v[52:55], v17, s[4:7], s32 offen offset:0 sc1
  v_mfma_f32_16x16x32_bf16 v[136:139], a[120:123], v[44:47], v[136:139]
  v_mfma_f32_16x16x32_bf16 v[140:143], a[140:143], v[44:47], v[140:143]
  v_mfma_f32_16x16x32_bf16 v[144:147], a[160:163], v[44:47], v[144:147]
  buffer_load_dwordx4 v[64:67], v17, s[4:7], s32 offen offset:3072 sc1
  s_waitcnt vmcnt(3)
  v_bitop3_b32 v27, v36, v48, 1 bitop3:0xa8
  v_cmp_ne_u32 vcc, 0, v27
  s_nop 0
  s_cbranch_vccz L_ok_207
L_retry_206:
  s_sub_u32 s69, s69, 1
  s_cbranch_scc1 L_retry_206_to
  buffer_load_dwordx4 v[36:39], v16, s[4:7], s32 offen offset:1024 sc1
  buffer_load_dwordx4 v[48:51], v16, s[4:7], s33 offen offset:0 sc1
  s_waitcnt vmcnt(0)
  v_bitop3_b32 v27, v36, v48, 1 bitop3:0xa8
  v_cmp_ne_u32 vcc, 0, v27
  s_nop 1
  s_cbranch_vccnz L_retry_206
  v_bitop3_b32 v27, v40, v52, v64 bitop3:0xfe
  v_bitop3_b32 v27, v27, v27, 1 bitop3:0xa8
  v_cmp_ne_u32 vcc, 0, v27
  s_nop 1
  s_cbranch_vccz L_ok_207
  buffer_load_dwordx4 v[40:43], v16, s[4:7], s32 offen offset:2048 sc1
  buffer_load_dwordx4 v[52:55], v17, s[4:7], s32 offen offset:0 sc1
  buffer_load_dwordx4 v[64:67], v17, s[4:7], s32 offen offset:3072 sc1
L_ok_207:
  v_mfma_f32_16x16x32_bf16 v[128:131], a[72:75], v[36:39], v[128:131]
  buffer_load_dwordx4 v[56:59], v17, s[4:7], s32 offen offset:1024 sc1
  v_mfma_f32_16x16x32_bf16 v[132:135], a[92:95], v[36:39], v[132:135]
  v_mfma_f32_16x16x32_bf16 v[136:139], a[112:115], v[36:39], v[136:139]
  v_mfma_f32_16x16x32_bf16 v[140:143], a[132:135], v[36:39], v[140:143]
  v_mfma_f32_16x16x32_bf16 v[144:147], a[152:155], v[36:39], v[144:147]
  buffer_load_dwordx4 v[68:71], v17, s[4:7], s33 offen offset:0 sc1
  v_mfma_f32_16x16x32_bf16 v[128:131], a[84:87], v[48:51], v[128:131]
  v_mfma_f32_16x16x32_bf16 v[132:135], a[104:107], v[48:51], v[132:135]
  v_mfma_f32_16x16x32_bf16 v[136:139], a[124:127], v[48:51], v[136:139]
  v_mfma_f32_16x16x32_bf16 v[140:143], a[144:147], v[48:51], v[140:143]
  buffer_load_dwordx4 v[60:63], v17, s[4:7], s32 offen offset:2048 sc1
  v_mfma_f32_16x16x32_bf16 v[144:147], a[164:167], v[48:51], v[144:147]
  s_waitcnt vmcnt(5)
  v_bitop3_b32 v27, v40, v40, 1 bitop3:0xa8
  buffer_load_dwordx4 v[72:75], v18, s[4:7], s32 offen offset:0 sc1
  v_cmp_ne_u32 vcc, 0, v27
  s_nop 0
  s_cbranch_vccz L_ok_209
L_retry_208:
  s_sub_u32 s69, s69, 1
  s_cbranch_scc1 L_retry_208_to
  buffer_load_dwordx4 v[40:43], v16, s[4:7], s32 offen offset:2048 sc1
  s_waitcnt vmcnt(0)
  v_bitop3_b32 v27, v40, v40, 1 bitop3:0xa8
  v_cmp_ne_u32 vcc, 0, v27
  s_nop 1
  s_cbranch_vccnz L_retry_208
  v_bitop3_b32 v27, v52, v64, v56 bitop3:0xfe
  v_bitop3_b32 v27, v27, v68, v60 bitop3:0xfe
  v_bitop3_b32 v27, v27, v72, 1 bitop3:0xa8
  v_cmp_ne_u32 vcc, 0, v27
  s_nop 1
  s_cbranch_vccz L_ok_209
  buffer_load_dwordx4 v[52:55], v17, s[4:7], s32 offen offset:0 sc1
  buffer_load_dwordx4 v[64:67], v17, s[4:7], s32 offen offset:3072 sc1
  buffer_load_dwordx4 v[56:59], v17, s[4:7], s32 offen offset:1024 sc1
  buffer_load_dwordx4 v[68:71], v17, s[4:7], s33 offen offset:0 sc1
  buffer_load_dwordx4 v[60:63], v17, s[4:7], s32 offen offset:2048 sc1
  buffer_load_dwordx4 v[72:75], v18, s[4:7], s32 offen offset:0 sc1
L_ok_209:
  v_mfma_f32_16x16x32_bf16 v[128:131], a[76:79], v[40:43], v[128:131]
  v_mfma_f32_16x16x32_bf16 v[132:135], a[96:99], v[40:43], v[132:135]
  v_mfma_f32_16x16x32_bf16 v[136:139], a[116:119], v[40:43], v[136:139]
  buffer_load_dwordx4 v[84:87], v18, s[4:7], s32 offen offset:3072 sc1
  v_mfma_f32_16x16x32_bf16 v[140:143], a[136:139], v[40:43], v[140:143]
  v_mfma_f32_16x16x32_bf16 v[144:147], a[156:159], v[40:43], v[144:147]
  s_nop 2
  ds_write_b128 v4, v[128:131] offset:0
  s_waitcnt vmcnt(5)
  v_bitop3_b32 v27, v52, v64, 1 bitop3:0xa8
  buffer_load_dwordx4 v[76:79], v18, s[4:7], s32 offen offset:1024 sc1
  v_cmp_ne_u32 vcc, 0, v27
  s_nop 0
  s_cbranch_vccz L_ok_211
L_retry_210:
  s_sub_u32 s69, s69, 1
  s_cbranch_scc1 L_retry_210_to
  buffer_load_dwordx4 v[52:55], v17, s[4:7], s32 offen offset:0 sc1
  buffer_load_dwordx4 v[64:67], v17, s[4:7], s32 offen offset:3072 sc1
  s_waitcnt vmcnt(0)
  v_bitop3_b32 v27, v52, v64, 1 bitop3:0xa8
  v_cmp_ne_u32 vcc, 0, v27
  s_nop 1
  s_cbranch_vccnz L_retry_210
  v_bitop3_b32 v27, v56, v68, v60 bitop3:0xfe
  v_bitop3_b32 v27, v27, v72, v84 bitop3:0xfe
  v_bitop3_b32 v27, v27, v76, 1 bitop3:0xa8
  v_cmp_ne_u32 vcc, 0, v27
  s_nop 1
  s_cbranch_vccz L_ok_211
  buffer_load_dwordx4 v[56:59], v17, s[4:7], s32 offen offset:1024 sc1
  buffer_load_dwordx4 v[68:71], v17, s[4:7], s33 offen offset:0 sc1
  buffer_load_dwordx4 v[60:63], v17, s[4:7], s32 offen offset:2048 sc1
  buffer_load_dwordx4 v[72:75], v18, s[4:7], s32 offen offset:0 sc1
  buffer_load_dwordx4 v[84:87], v18, s[4:7], s32 offen offset:3072 sc1
  buffer_load_dwordx4 v[76:79], v18, s[4:7], s32 offen offset:1024 sc1
L_ok_211:
  v_mfma_f32_16x16x32_bf16 v[148:151], a[68:71], v[52:55], 0
  ds_write_b128 v4, v[132:135] offset:1024
  v_mfma_f32_16x16x32_bf16 v[152:155], a[88:91], v[52:55], 0
  v_mfma_f32_16x16x32_bf16 v[156:159], a[108:111], v[52:55], 0
  buffer_load_dwordx4 v[88:91], v18, s[4:7], s33 offen offset:0 sc1
  v_mfma_f32_16x16x32_bf16 v[160:163], a[128:131], v[52:55], 0
  ds_write_b128 v4, v[136:139] offset:2048
  v_mfma_f32_16x16x32_bf16 v[164:167], a[148:151], v[52:55], 0
  v_mfma_f32_16x16x32_bf16 v[148:151], a[80:83], v[64:67], v[148:151]
  v_mfma_f32_16x16x32_bf16 v[152:155], a[100:103], v[64:67], v[152:155]
  buffer_load_dwordx4 v[80:83], v18, s[4:7], s32 offen offset:2048 sc1
  v_mfma_f32_16x16x32_bf16 v[156:159], a[120:123], v[64:67], v[156:159]
  ds_write_b128 v4, v[140:143] offset:3072
  v_mfma_f32_16x16x32_bf16 v[160:163], a[140:143], v[64:67], v[160:163]
  v_mfma_f32_16x16x32_bf16 v[164:167], a[160:163], v[64:67], v[164:167]
  s_waitcnt vmcnt(5)
  v_bitop3_b32 v27, v56, v68, v60 bitop3:0xfe
  v_bitop3_b32 v27, v27, v27, 1 bitop3:0xa8
  buffer_load_dwordx4 v[92:95], v19, s[4:7], s32 offen offset:0 sc1
  v_cmp_ne_u32 vcc, 0, v27
  ds_write_b128 v4, v[144:147] offset:4096
  s_cbranch_vccz L_ok_213
L_retry_212:
  s_sub_u32 s69, s69, 1
  s_cbranch_scc1 L_retry_212_to
  buffer_load_dwordx4 v[56:59], v17, s[4:7], s32 offen offset:1024 sc1
  buffer_load_dwordx4 v[68:71], v17, s[4:7], s33 offen offset:0 sc1
  buffer_load_dwordx4 v[60:63], v17, s[4:7], s32 offen offset:2048 sc1
  s_waitcnt vmcnt(0)
  v_bitop3_b32 v27, v56, v68, v60 bitop3:0xfe
  v_bitop3_b32 v27, v27, v27, 1 bitop3:0xa8
  v_cmp_ne_u32 vcc, 0, v27
  s_nop 1
  s_cbranch_vccnz L_retry_212
  v_bitop3_b32 v27, v72, v84, v76 bitop3:0xfe
  v_bitop3_b32 v27, v27, v88, v80 bitop3:0xfe
  v_bitop3_b32 v27, v27, v92, 1 bitop3:0xa8
  v_cmp_ne_u32 vcc, 0, v27
  s_nop 1
  s_cbranch_vccz L_ok_213
  buffer_load_dwordx4 v[72:75], v18, s[4:7], s32 offen offset:0 sc1
  buffer_load_dwordx4 v[84:87], v18, s[4:7], s32 offen offset:3072 sc1
  buffer_load_dwordx4 v[76:79], v18, s[4:7], s32 offen offset:1024 sc1
  buffer_load_dwordx4 v[88:91], v18, s[4:7], s33 offen offset:0 sc1
  buffer_load_dwordx4 v[80:83], v18, s[4:7], s32 offen offset:2048 sc1
  buffer_load_dwordx4 v[92:95], v19, s[4:7], s32 offen offset:0 sc1
L_ok_213:
  v_mfma_f32_16x16x32_bf16 v[148:151], a[72:75], v[56:59], v[148:151]
  v_mfma_f32_16x16x32_bf16 v[148:151], a[84:87], v[68:71], v[148:151]
  v_mfma_f32_16x16x32_bf16 v[148:151], a[76:79], v[60:63], v[148:151]
  buffer_load_dwordx4 v[104:107], v19, s[4:7], s32 offen offset:3072 sc1
  v_mfma_f32_16x16x32_bf16 v[152:155], a[92:95], v[56:59], v[152:155]
  v_mfma_f32_16x16x32_bf16 v[152:155], a[104:107], v[68:71], v[152:155]
  v_mfma_f32_16x16x32_bf16 v[152:155], a[96:99], v[60:63], v[152:155]
  v_mfma_f32_16x16x32_bf16 v[156:159], a[112:115], v[56:59], v[156:159]
  v_mfma_f32_16x16x32_bf16 v[156:159], a[124:127], v[68:71], v[156:159]
  buffer_load_dwordx4 v[96:99], v19, s[4:7], s32 offen offset:1024 sc1
  v_mfma_f32_16x16x32_bf16 v[156:159], a[116:119], v[60:63], v[156:159]
  ds_write_b128 v5, v[148:151] offset:0
  v_mfma_f32_16x16x32_bf16 v[160:163], a[132:135], v[56:59], v[160:163]
  s_waitcnt vmcnt(5)
  v_bitop3_b32 v27, v72, v84, v76 bitop3:0xfe
  v_mfma_f32_16x16x32_bf16 v[160:163], a[144:147], v[68:71], v[160:163]
  v_mfma_f32_16x16x32_bf16 v[160:163], a[136:139], v[60:63], v[160:163]
  buffer_load_dwordx4 v[108:111], v19, s[4:7], s33 offen offset:0 sc1
  v_mfma_f32_16x16x32_bf16 v[164:167], a[152:155], v[56:59], v[164:167]
  ds_write_b128 v5, v[152:155] offset:1024
  v_mfma_f32_16x16x32_bf16 v[164:167], a[164:167], v[68:71], v[164:167]
  v_mfma_f32_16x16x32_bf16 v[164:167], a[156:159], v[60:63], v[164:167]
  ds_write_b128 v5, v[156:159] offset:2048
  buffer_load_dwordx4 v[100:103], v19, s[4:7], s32 offen offset:2048 sc1
  s_waitcnt vmcnt(5)
  v_bitop3_b32 v27, v27, v88, v80 bitop3:0xfe
  v_bitop3_b32 v27, v27, v27, 1 bitop3:0xa8
  v_cmp_ne_u32 vcc, 0, v27
  ds_write_b128 v5, v[160:163] offset:3072
  s_cbranch_vccz L_ok_215
L_retry_214:
  s_sub_u32 s69, s69, 1
  s_cbranch_scc1 L_retry_214_to
  buffer_load_dwordx4 v[72:75], v18, s[4:7], s32 offen offset:0 sc1
  buffer_load_dwordx4 v[84:87], v18, s[4:7], s32 offen offset:3072 sc1
  buffer_load_dwordx4 v[76:79], v18, s[4:7], s32 offen offset:1024 sc1
  buffer_load_dwordx4 v[88:91], v18, s[4:7], s33 offen offset:0 sc1
  buffer_load_dwordx4 v[80:83], v18, s[4:7], s32 offen offset:2048 sc1
  s_waitcnt vmcnt(0)
  v_bitop3_b32 v27, v72, v84, v76 bitop3:0xfe
  v_bitop3_b32 v27, v27, v88, v80 bitop3:0xfe
  v_bitop3_b32 v27, v27, v27, 1 bitop3:0xa8
  v_cmp_ne_u32 vcc, 0, v27
  s_nop 1
  s_cbranch_vccnz L_retry_214
  v_bitop3_b32 v27, v92, v104, v96 bitop3:0xfe
  v_bitop3_b32 v27, v27, v108, v100 bitop3:0xfe
  v_bitop3_b32 v27, v27, v27, 1 bitop3:0xa8
  v_cmp_ne_u32 vcc, 0, v27
  s_nop 1
  s_cbranch_vccz L_ok_215
  buffer_load_dwordx4 v[92:95], v19, s[4:7], s32 offen offset:0 sc1
  buffer_load_dwordx4 v[104:107], v19, s[4:7], s32 offen offset:3072 sc1
  buffer_load_dwordx4 v[96:99], v19, s[4:7], s32 offen offset:1024 sc1
  buffer_load_dwordx4 v[108:111], v19, s[4:7], s33 offen offset:0 sc1
  buffer_load_dwordx4 v[100:103], v19, s[4:7], s32 offen offset:2048 sc1
L_ok_215:
  v_mfma_f32_16x16x32_bf16 v[168:171], a[68:71], v[72:75], 0
  buffer_load_dwordx4 a[228:231], v3, s[4:7], s70 offen offset:1024
  v_mfma_f32_16x16x32_bf16 v[168:171], a[80:83], v[84:87], v[168:171]
  ds_write_b128 v5, v[164:167] offset:4096
  v_mfma_f32_16x16x32_bf16 v[168:171], a[72:75], v[76:79], v[168:171]
  v_mfma_f32_16x16x32_bf16 v[168:171], a[84:87], v[88:91], v[168:171]
  v_mfma_f32_16x16x32_bf16 v[168:171], a[76:79], v[80:83], v[168:171]
  buffer_load_dwordx4 a[232:235], v3, s[4:7], s70 offen offset:2048
  v_mfma_f32_16x16x32_bf16 v[172:175], a[88:91], v[72:75], 0
  v_mfma_f32_16x16x32_bf16 v[172:175], a[100:103], v[84:87], v[172:175]
  v_mfma_f32_16x16x32_bf16 v[172:175], a[92:95], v[76:79], v[172:175]
  v_mfma_f32_16x16x32_bf16 v[172:175], a[104:107], v[88:91], v[172:175]
  v_mfma_f32_16x16x32_bf16 v[172:175], a[96:99], v[80:83], v[172:175]
  buffer_load_dwordx4 a[236:239], v3, s[4:7], s70 offen offset:3072
  v_mfma_f32_16x16x32_bf16 v[176:179], a[108:111], v[72:75], 0
  v_mfma_f32_16x16x32_bf16 v[176:179], a[120:123], v[84:87], v[176:179]
  s_waitcnt lgkmcnt(0)
  s_barrier
  v_mfma_f32_16x16x32_bf16 v[176:179], a[112:115], v[76:79], v[176:179]
  s_mov_b32 s70, 172032
  buffer_load_dwordx4 a[240:243], v3, s[4:7], s70 offen offset:0
  v_mfma_f32_16x16x32_bf16 v[176:179], a[124:127], v[88:91], v[176:179]
  ds_read_b128 v[132:135], v7 offset:1024
  v_mfma_f32_16x16x32_bf16 v[176:179], a[116:119], v[80:83], v[176:179]
  ds_read_b128 v[152:155], v7 offset:6144
  v_mfma_f32_16x16x32_bf16 v[180:183], a[128:131], v[72:75], 0
  ds_write_b128 v6, v[168:171] offset:0
  v_mfma_f32_16x16x32_bf16 v[180:183], a[140:143], v[84:87], v[180:183]
  buffer_load_dwordx4 a[244:247], v3, s[4:7], s70 offen offset:1024
  v_mfma_f32_16x16x32_bf16 v[180:183], a[132:135], v[76:79], v[180:183]
  s_waitcnt vmcnt(7)
  v_bitop3_b32 v27, v92, v104, v96 bitop3:0xfe
  v_mfma_f32_16x16x32_bf16 v[180:183], a[144:147], v[88:91], v[180:183]
  ds_write_b128 v6, v[172:175] offset:1024
  v_mfma_f32_16x16x32_bf16 v[180:183], a[136:139], v[80:83], v[180:183]
  s_waitcnt vmcnt(5)
  v_bitop3_b32 v27, v27, v108, v100 bitop3:0xfe
  v_mfma_f32_16x16x32_bf16 v[184:187], a[148:151], v[72:75], 0
  buffer_load_dwordx4 a[248:251], v3, s[4:7], s70 offen offset:2048
  v_mfma_f32_16x16x32_bf16 v[184:187], a[160:163], v[84:87], v[184:187]
  ds_write_b128 v6, v[176:179] offset:2048
  v_mfma_f32_16x16x32_bf16 v[184:187], a[152:155], v[76:79], v[184:187]
  ds_read_b128 v[136:139], v7 offset:2048
  s_waitcnt lgkmcnt(4)
  v_add_f32 v132, v132, v152
  v_mfma_f32_16x16x32_bf16 v[184:187], a[164:167], v[88:91], v[184:187]
  ds_read_b128 v[156:159], v7 offset:7168
  v_add_f32 v133, v133, v153
  v_mfma_f32_16x16x32_bf16 v[184:187], a[156:159], v[80:83], v[184:187]
  buffer_load_dwordx4 a[0:3], v3, s[4:7], s70 offen offset:3072
  ds_write_b128 v6, v[180:183] offset:3072
  ds_read_b128 v[140:143], v7 offset:3072
  v_bitop3_b32 v27, v27, v27, 1 bitop3:0xa8
  v_cmp_ne_u32 vcc, 0, v27
  v_add_f32 v134, v134, v154
  ds_read_b128 v[160:163], v7 offset:8192
  s_cbranch_vccz L_ok_217
L_retry_216:
  s_sub_u32 s69, s69, 1
  s_cbranch_scc1 L_retry_216_to
  buffer_load_dwordx4 v[92:95], v19, s[4:7], s32 offen offset:0 sc1
  buffer_load_dwordx4 v[104:107], v19, s[4:7], s32 offen offset:3072 sc1
  buffer_load_dwordx4 v[96:99], v19, s[4:7], s32 offen offset:1024 sc1
  buffer_load_dwordx4 v[108:111], v19, s[4:7], s33 offen offset:0 sc1
  buffer_load_dwordx4 v[100:103], v19, s[4:7], s32 offen offset:2048 sc1
  s_waitcnt vmcnt(0)
  v_bitop3_b32 v27, v92, v104, v96 bitop3:0xfe
  v_bitop3_b32 v27, v27, v108, v100 bitop3:0xfe
  v_bitop3_b32 v27, v27, v27, 1 bitop3:0xa8
  v_cmp_ne_u32 vcc, 0, v27
  s_nop 1
  s_cbranch_vccnz L_retry_216
L_ok_217:
  v_mfma_f32_16x16x32_bf16 v[188:191], a[68:71], v[92:95], v[228:231]
  ds_write_b128 v6, v[184:187] offset:4096
  s_mov_b32 s70, 176128
  buffer_load_dwordx4 a[4:7], v3, s[4:7], s70 offen offset:0
  ds_read_b128 v[144:147], v7 offset:4096
  v_mfma_f32_16x16x32_bf16 v[188:191], a[80:83], v[104:107], v[188:191]
  v_add_f32 v135, v135, v155
  ds_read_b128 v[164:167], v7 offset:9216
  v_mfma_f32_16x16x32_bf16 v[188:191], a[72:75], v[96:99], v[188:191]
  v_add_f32 v132, v132, v232
  ds_read_b128 v[128:131], v7 offset:0
  v_mfma_f32_16x16x32_bf16 v[188:191], a[84:87], v[108:111], v[188:191]
  v_add_f32 v133, v133, v233
  ds_read_b128 v[148:151], v7 offset:5120
  v_mfma_f32_16x16x32_bf16 v[188:191], a[76:79], v[100:103], v[188:191]
  buffer_load_dwordx4 a[8:11], v3, s[4:7], s70 offen offset:1024
  v_add_f32 v134, v134, v234
  v_add_f32 v135, v135, v235
  s_waitcnt lgkmcnt(8)
  v_add_f32 v136, v136, v156
  v_add_f32 v137, v137, v157
  v_mfma_f32_16x16x32_bf16 v[192:195], a[88:91], v[92:95], v[132:135]
  v_add_f32 v138, v138, v158
  v_add_f32 v139, v139, v159
  v_mfma_f32_16x16x32_bf16 v[192:195], a[100:103], v[104:107], v[192:195]
  v_add_f32 v136, v136, v236
  v_add_f32 v137, v137, v237
  v_mfma_f32_16x16x32_bf16 v[192:195], a[92:95], v[96:99], v[192:195]
  v_add_f32 v138, v138, v238
  v_add_f32 v139, v139, v239
  v_mfma_f32_16x16x32_bf16 v[192:195], a[104:107], v[108:111], v[192:195]
  buffer_load_dwordx4 a[12:15], v3, s[4:7], s70 offen offset:2048
  v_mfma_f32_16x16x32_bf16 v[192:195], a[96:99], v[100:103], v[192:195]
  s_waitcnt lgkmcnt(5)
  v_add_f32 v140, v140, v160
  v_add_f32 v141, v141, v161
  v_mfma_f32_16x16x32_bf16 v[196:199], a[108:111], v[92:95], v[136:139]
  v_add_f32 v142, v142, v162
  v_add_f32 v143, v143, v163
  v_mfma_f32_16x16x32_bf16 v[196:199], a[120:123], v[104:107], v[196:199]
  v_add_f32 v140, v140, v240
  v_add_f32 v141, v141, v241
  v_mfma_f32_16x16x32_bf16 v[196:199], a[112:115], v[96:99], v[196:199]
  s_waitcnt lgkmcnt(0)
  s_barrier
  s_mov_b32 s81, 73728
  buffer_load_dword a254, v2, s[96:99], s81 offen
  ds_read_b128 v[172:175], v7 offset:11264
  v_mfma_f32_16x16x32_bf16 v[196:199], a[124:127], v[108:111], v[196:199]
  v_add_f32 v142, v142, v242
  ds_read_b128 v[168:171], v7 offset:10240
  v_mfma_f32_16x16x32_bf16 v[196:199], a[116:119], v[100:103], v[196:199]
  v_add_f32 v143, v143, v243
  ds_read_b128 v[176:179], v7 offset:12288
  v_add_f32 v128, v128, v148
  v_mfma_f32_16x16x32_bf16 v[200:203], a[128:131], v[92:95], v[140:143]
  ds_read_b128 v[180:183], v7 offset:13312
  v_add_f32 v129, v129, v149
  v_mfma_f32_16x16x32_bf16 v[200:203], a[140:143], v[104:107], v[200:203]
  buffer_load_dwordx4 a[16:19], v3, s[4:7], s70 offen offset:3072
  v_mfma_f32_16x16x32_bf16 v[200:203], a[132:135], v[96:99], v[200:203]
  ds_read_b128 v[184:187], v7 offset:14336
  v_add_f32 v130, v130, v150
  v_mfma_f32_16x16x32_bf16 v[200:203], a[144:147], v[108:111], v[200:203]
  v_add_f32 v131, v131, v151
  v_add_f32 v188, v188, v128
  v_add_f32 v189, v189, v129
  v_add_f32 v190, v190, v130
  v_add_f32 v191, v191, v131
  v_mfma_f32_16x16x32_bf16 v[200:203], a[136:139], v[100:103], v[200:203]
  v_add_f32 v144, v144, v164
  v_add_f32 v145, v145, v165
  s_mov_b32 s70, 180224
  buffer_load_dwordx4 a[20:23], v3, s[4:7], s70 offen offset:0
  v_add_f32 v146, v146, v166
  v_add_f32 v147, v147, v167
  s_waitcnt lgkmcnt(4)
  v_pk_add_f32 v[192:193], v[192:193], v[172:173]
  v_pk_add_f32 v[194:195], v[194:195], v[174:175]
  v_cvt_pk_bf16_f32 v150, v192, v193
  v_cvt_pk_bf16_f32 v151, v194, v195
  s_waitcnt lgkmcnt(3)
  v_add_f32 v188, v188, v168
  v_add_f32 v189, v189, v169
  v_add_f32 v190, v190, v170
  v_add_f32 v191, v191, v171
  v_cvt_pk_bf16_f32 v148, v188, v189
  v_cvt_pk_bf16_f32 v149, v190, v191
  buffer_load_dwordx4 a[24:27], v3, s[4:7], s70 offen offset:1024
  v_or_b32 v148, v14, v148
  v_add_f32 v144, v144, v244
  v_add_f32 v145, v145, v245
  v_add_f32 v146, v146, v246
  v_add_f32 v147, v147, v247
  v_pk_add_f32 v[116:117], v[188:189], v[190:191]
  v_pk_mul_f32 v[118:119], v[188:189], v[188:189]
  v_pk_fma_f32 v[118:119], v[190:191], v[190:191], v[118:119]
  v_pk_add_f32 v[116:117], v[116:117], v[192:193]
  v_pk_fma_f32 v[118:119], v[192:193], v[192:193], v[118:119]
  s_cmp_eq_u32 s71, 0
  s_cbranch_scc1 L_slow_218
  buffer_store_dwordx4 v[148:151], v1, s[4:7], s49 offen offset:1024
L_back_219:
  v_mfma_f32_16x16x32_bf16 v[204:207], a[148:151], v[92:95], v[144:147]
  ds_read_b128 v[228:231], v13 offset:32
  v_mfma_f32_16x16x32_bf16 v[204:207], a[160:163], v[104:107], v[204:207]
  ds_read_b128 v[232:235], v13 offset:48
  v_mfma_f32_16x16x32_bf16 v[204:207], a[152:155], v[96:99], v[204:207]
  s_waitcnt lgkmcnt(2)
  s_barrier
  v_mfma_f32_16x16x32_bf16 v[204:207], a[164:167], v[108:111], v[204:207]
  ds_read_b128 v[236:239], v13 offset:64
  v_mfma_f32_16x16x32_bf16 v[204:207], a[156:159], v[100:103], v[204:207]
  ds_read_b128 v[240:243], v13 offset:80
  v_pk_add_f32 v[196:197], v[196:197], v[176:177]
  v_pk_add_f32 v[198:199], v[198:199], v[178:179]
  v_pk_add_f32 v[116:117], v[116:117], v[194:195]
  v_pk_fma_f32 v[118:119], v[194:195], v[194:195], v[118:119]
  v_pk_add_f32 v[116:117], v[116:117], v[196:197]
  v_pk_fma_f32 v[118:119], v[196:197], v[196:197], v[118:119]
  v_pk_add_f32 v[116:117], v[116:117], v[198:199]
  v_pk_add_f32 v[200:201], v[200:201], v[180:181]
  v_pk_add_f32 v[202:203], v[202:203], v[182:183]
  v_pk_fma_f32 v[118:119], v[198:199], v[198:199], v[118:119]
  v_pk_add_f32 v[116:117], v[116:117], v[200:201]
  v_pk_fma_f32 v[118:119], v[200:201], v[200:201], v[118:119]
  v_pk_add_f32 v[116:117], v[116:117], v[202:203]
  v_pk_fma_f32 v[118:119], v[202:203], v[202:203], v[118:119]
  v_cvt_pk_bf16_f32 v152, v196, v197
  v_pk_add_f32 v[204:205], v[204:205], v[184:185]
  v_pk_add_f32 v[206:207], v[206:207], v[186:187]
  v_cvt_pk_bf16_f32 v153, v198, v199
  v_cvt_pk_bf16_f32 v154, v200, v201
  v_cvt_pk_bf16_f32 v155, v202, v203
  v_or_b32 v152, v14, v152
  s_cmp_eq_u32 s71, 0
  s_cbranch_scc1 L_slow_220
  buffer_store_dwordx4 v[152:155], v1, s[4:7], s49 offen offset:2048
L_back_221:
  v_pk_add_f32 v[116:117], v[116:117], v[204:205]
  v_pk_fma_f32 v[118:119], v[204:205], v[204:205], v[118:119]
  v_pk_add_f32 v[116:117], v[116:117], v[206:207]
  v_pk_fma_f32 v[118:119], v[206:207], v[206:207], v[118:119]
  v_add_f32 v116, v116, v117
  v_add_f32 v118, v118, v119
  v_cvt_pk_bf16_f32 v156, v204, v205
  v_cvt_pk_bf16_f32 v157, v206, v207
  v_permlane16_swap_b32 v116, v118
  v_add_f32 v116, v116, v118
  v_mov_b32 v117, v116
  v_permlane32_swap_b32 v156, v158
  v_permlane32_swap_b32 v157, v159
  v_permlane32_swap_b32 v116, v117
  v_add_f32 v116, v116, v117
  v_or_b32 v116, 1, v116
  s_cmp_eq_u32 s71, 0
  s_cbranch_scc1 L_slow_224
  buffer_store_dword v116, v26, s[4:7], s59 offen
L_back_225:
  v_or_b32 v156, v14, v156
  s_cmp_eq_u32 s71, 0
  s_cbranch_scc1 L_slow_222
  buffer_store_dwordx4 v[156:159], v254, s[4:7], s49 offen
L_back_223:
  v_pk_add_f32 v[208:209], v[208:209], v[188:189]
  v_pk_add_f32 v[210:211], v[210:211], v[190:191]
  v_pk_add_f32 v[212:213], v[212:213], v[192:193]
  v_pk_add_f32 v[214:215], v[214:215], v[194:195]
  v_pk_add_f32 v[216:217], v[216:217], v[196:197]
  v_pk_add_f32 v[218:219], v[218:219], v[198:199]
  v_pk_add_f32 v[220:221], v[220:221], v[200:201]
  v_pk_add_f32 v[222:223], v[222:223], v[202:203]
  v_pk_add_f32 v[224:225], v[224:225], v[204:205]
  v_pk_add_f32 v[226:227], v[226:227], v[206:207]
  buffer_load_dwordx4 v[32:35], v1, s[4:7], s20 offen offset:0 sc1
  ds_read_b128 v[200:203], v13 offset:0
  ds_read_b128 v[204:207], v13 offset:16
  ds_read_b128 a[96:99], v249 offset:0
  ds_read_b128 a[100:103], v249 offset:1024
  buffer_load_dwordx4 v[44:47], v1, s[4:7], s20 offen offset:3072 sc1
  ds_read_b128 a[104:107], v249 offset:2048
  ds_read_b128 a[108:111], v249 offset:3072
  ds_read_b128 a[112:115], v249 offset:4096
  ds_read_b128 a[116:119], v249 offset:5120
  ds_read_b128 a[120:123], v249 offset:6144
  buffer_load_dwordx4 v[36:39], v1, s[4:7], s20 offen offset:1024 sc1
  ds_read_b128 a[124:127], v249 offset:7168
  ds_read_b128 a[128:131], v249 offset:8192
  ds_read_b128 a[132:135], v249 offset:9216
  ds_read_b128 a[136:139], v249 offset:10240
  buffer_load_dwordx4 v[48:51], v1, s[4:7], s28 offen offset:0 sc1
  ds_read_b128 a[140:143], v249 offset:11264
  ds_read_b128 a[144:147], v251 offset:0
  ds_read_b128 a[148:151], v251 offset:1024
  ds_read_b128 a[152:155], v251 offset:2048
  ds_read_b128 a[156:159], v251 offset:3072
  buffer_load_dwordx4 v[40:43], v1, s[4:7], s20 offen offset:2048 sc1
  ds_read_b128 a[160:163], v251 offset:4096
  ds_read_b128 a[164:167], v251 offset:5120
  buffer_load_dwordx4 v[52:55], v1, s[4:7], s21 offen offset:0 sc1
  buffer_load_dwordx4 v[64:67], v1, s[4:7], s21 offen offset:3072 sc1
  buffer_load_dwordx4 v[56:59], v1, s[4:7], s21 offen offset:1024 sc1
  s_waitcnt vmcnt(6)
  v_bitop3_b32 v27, v32, v44, v14 bitop3:0x2a
  v_cmp_ne_u32 vcc, 0, v27
  s_nop 0
  s_cbranch_vccz L_ok_227
L_retry_226:
  s_sub_u32 s69, s69, 1
  s_cbranch_scc1 L_retry_226_to
  buffer_load_dwordx4 v[32:35], v1, s[4:7], s20 offen offset:0 sc1
  buffer_load_dwordx4 v[44:47], v1, s[4:7], s20 offen offset:3072 sc1
  s_waitcnt vmcnt(0)
  v_bitop3_b32 v27, v32, v44, v14 bitop3:0x2a
  v_cmp_ne_u32 vcc, 0, v27
  s_nop 1
  s_cbranch_vccnz L_retry_226
  v_bitop3_b32 v27, v36, v48, v40 bitop3:0x80
  v_bitop3_b32 v27, v27, v52, v64 bitop3:0x80
  v_bitop3_b32 v27, v27, v56, v14 bitop3:0x2a
  v_cmp_ne_u32 vcc, 0, v27
  s_nop 1
  s_cbranch_vccz L_ok_227
  buffer_load_dwordx4 v[36:39], v1, s[4:7], s20 offen offset:1024 sc1
  buffer_load_dwordx4 v[48:51], v1, s[4:7], s28 offen offset:0 sc1
  buffer_load_dwordx4 v[40:43], v1, s[4:7], s20 offen offset:2048 sc1
  buffer_load_dwordx4 v[52:55], v1, s[4:7], s21 offen offset:0 sc1
  buffer_load_dwordx4 v[64:67], v1, s[4:7], s21 offen offset:3072 sc1
  buffer_load_dwordx4 v[56:59], v1, s[4:7], s21 offen offset:1024 sc1
L_ok_227:
  v_mfma_f32_16x16x32_bf16 v[128:131], a[168:171], v[32:35], 0
  v_mfma_f32_16x16x32_bf16 v[132:135], a[188:191], v[32:35], 0
  v_mfma_f32_16x16x32_bf16 v[152:155], a[208:211], v[32:35], 0
  buffer_load_dwordx4 v[68:71], v1, s[4:7], s29 offen offset:0 sc1
  v_mfma_f32_16x16x32_bf16 v[156:159], a[228:231], v[32:35], 0
  v_mfma_f32_16x16x32_bf16 v[128:131], a[180:183], v[44:47], v[128:131]
  v_mfma_f32_16x16x32_bf16 v[132:135], a[200:203], v[44:47], v[132:135]
  v_mfma_f32_16x16x32_bf16 v[152:155], a[220:223], v[44:47], v[152:155]
  buffer_load_dwordx4 v[60:63], v1, s[4:7], s21 offen offset:2048 sc1
  v_mfma_f32_16x16x32_bf16 v[156:159], a[240:243], v[44:47], v[156:159]
  s_waitcnt vmcnt(6)
  v_bitop3_b32 v27, v36, v48, v14 bitop3:0x2a
  v_cmp_ne_u32 vcc, 0, v27
  s_nop 0
  s_cbranch_vccz L_ok_229
L_retry_228:
  s_sub_u32 s69, s69, 1
  s_cbranch_scc1 L_retry_228_to
  buffer_load_dwordx4 v[36:39], v1, s[4:7], s20 offen offset:1024 sc1
  buffer_load_dwordx4 v[48:51], v1, s[4:7], s28 offen offset:0 sc1
  s_waitcnt vmcnt(0)
  v_bitop3_b32 v27, v36, v48, v14 bitop3:0x2a
  v_cmp_ne_u32 vcc, 0, v27
  s_nop 1
  s_cbranch_vccnz L_retry_228
  v_bitop3_b32 v27, v40, v52, v64 bitop3:0x80
  v_bitop3_b32 v27, v27, v56, v68 bitop3:0x80
  v_bitop3_b32 v27, v27, v60, v14 bitop3:0x2a
  v_cmp_ne_u32 vcc, 0, v27
  s_nop 1
  s_cbranch_vccz L_ok_229
  buffer_load_dwordx4 v[40:43], v1, s[4:7], s20 offen offset:2048 sc1
  buffer_load_dwordx4 v[52:55], v1, s[4:7], s21 offen offset:0 sc1
  buffer_load_dwordx4 v[64:67], v1, s[4:7], s21 offen offset:3072 sc1
  buffer_load_dwordx4 v[56:59], v1, s[4:7], s21 offen offset:1024 sc1
  buffer_load_dwordx4 v[68:71], v1, s[4:7], s29 offen offset:0 sc1
  buffer_load_dwordx4 v[60:63], v1, s[4:7], s21 offen offset:2048 sc1
L_ok_229:
  v_mfma_f32_16x16x32_bf16 v[128:131], a[172:175], v[36:39], v[128:131]
  v_mfma_f32_16x16x32_bf16 v[132:135], a[192:195], v[36:39], v[132:135]
  v_mfma_f32_16x16x32_bf16 v[152:155], a[212:215], v[36:39], v[152:155]
  buffer_load_dwordx4 v[72:75], v1, s[4:7], s22 offen offset:0 sc1
  v_mfma_f32_16x16x32_bf16 v[156:159], a[232:235], v[36:39], v[156:159]
  s_waitcnt vmcnt(6)
  v_bitop3_b32 v27, v40, v40, v14 bitop3:0x2a
  v_mfma_f32_16x16x32_bf16 v[128:131], a[184:187], v[48:51], v[128:131]
  v_cmp_ne_u32 vcc, 0, v27
  v_mfma_f32_16x16x32_bf16 v[132:135], a[204:207], v[48:51], v[132:135]
  s_cbranch_vccz L_ok_231
L_retry_230:
  s_sub_u32 s69, s69, 1
  s_cbranch_scc1 L_retry_230_to
  buffer_load_dwordx4 v[40:43], v1, s[4:7], s20 offen offset:2048 sc1
  s_waitcnt vmcnt(0)
  v_bitop3_b32 v27, v40, v40, v14 bitop3:0x2a
  v_cmp_ne_u32 vcc, 0, v27
  s_nop 1
  s_cbranch_vccnz L_retry_230
  v_bitop3_b32 v27, v52, v64, v56 bitop3:0x80
  v_bitop3_b32 v27, v27, v68, v60 bitop3:0x80
  v_bitop3_b32 v27, v27, v72, v14 bitop3:0x2a
  v_cmp_ne_u32 vcc, 0, v27
  s_nop 1
  s_cbranch_vccz L_ok_231
  buffer_load_dwordx4 v[52:55], v1, s[4:7], s21 offen offset:0 sc1
  buffer_load_dwordx4 v[64:67], v1, s[4:7], s21 offen offset:3072 sc1
  buffer_load_dwordx4 v[56:59], v1, s[4:7], s21 offen offset:1024 sc1
  buffer_load_dwordx4 v[68:71], v1, s[4:7], s29 offen offset:0 sc1
  buffer_load_dwordx4 v[60:63], v1, s[4:7], s21 offen offset:2048 sc1
  buffer_load_dwordx4 v[72:75], v1, s[4:7], s22 offen offset:0 sc1
L_ok_231:
  v_mfma_f32_16x16x32_bf16 v[152:155], a[224:227], v[48:51], v[152:155]
  buffer_load_dwordx4 v[84:87], v1, s[4:7], s22 offen offset:3072 sc1
  v_mfma_f32_16x16x32_bf16 v[156:159], a[244:247], v[48:51], v[156:159]
  v_mfma_f32_16x16x32_bf16 v[128:131], a[176:179], v[40:43], v[128:131]
  v_mfma_f32_16x16x32_bf16 v[132:135], a[196:199], v[40:43], v[132:135]
  v_mfma_f32_16x16x32_bf16 v[152:155], a[216:219], v[40:43], v[152:155]
  buffer_load_dwordx4 v[76:79], v1, s[4:7], s22 offen offset:1024 sc1
  s_waitcnt vmcnt(6)
  v_bitop3_b32 v27, v52, v64, v14 bitop3:0x2a
  v_mfma_f32_16x16x32_bf16 v[156:159], a[236:239], v[40:43], v[156:159]
  v_cmp_ne_u32 vcc, 0, v27
  s_nop 0
  s_cbranch_vccz L_ok_233
L_retry_232:
  s_sub_u32 s69, s69, 1
  s_cbranch_scc1 L_retry_232_to
  buffer_load_dwordx4 v[52:55], v1, s[4:7], s21 offen offset:0 sc1
  buffer_load_dwordx4 v[64:67], v1, s[4:7], s21 offen offset:3072 sc1
  s_waitcnt vmcnt(0)
  v_bitop3_b32 v27, v52, v64, v14 bitop3:0x2a
  v_cmp_ne_u32 vcc, 0, v27
  s_nop 1
  s_cbranch_vccnz L_retry_232
  v_bitop3_b32 v27, v56, v68, v60 bitop3:0x80
  v_bitop3_b32 v27, v27, v72, v84 bitop3:0x80
  v_bitop3_b32 v27, v27, v76, v14 bitop3:0x2a
  v_cmp_ne_u32 vcc, 0, v27
  s_nop 1
  s_cbranch_vccz L_ok_233
  buffer_load_dwordx4 v[56:59], v1, s[4:7], s21 offen offset:1024 sc1
  buffer_load_dwordx4 v[68:71], v1, s[4:7], s29 offen offset:0 sc1
  buffer_load_dwordx4 v[60:63], v1, s[4:7], s21 offen offset:2048 sc1
  buffer_load_dwordx4 v[72:75], v1, s[4:7], s22 offen offset:0 sc1
  buffer_load_dwordx4 v[84:87], v1, s[4:7], s22 offen offset:3072 sc1
  buffer_load_dwordx4 v[76:79], v1, s[4:7], s22 offen offset:1024 sc1
L_ok_233:
  v_mfma_f32_16x16x32_bf16 v[136:139], a[168:171], v[52:55], 0
  ds_write_b128 v4, v[128:131] offset:0
  v_mfma_f32_16x16x32_bf16 v[140:143], a[188:191], v[52:55], 0
  buffer_load_dwordx4 v[88:91], v1, s[4:7], s30 offen offset:0 sc1
  v_mfma_f32_16x16x32_bf16 v[160:163], a[208:211], v[52:55], 0
  v_mfma_f32_16x16x32_bf16 v[164:167], a[228:231], v[52:55], 0
  ds_write_b128 v4, v[132:135] offset:1024
  v_mfma_f32_16x16x32_bf16 v[136:139], a[180:183], v[64:67], v[136:139]
  v_mfma_f32_16x16x32_bf16 v[140:143], a[200:203], v[64:67], v[140:143]
  buffer_load_dwordx4 v[80:83], v1, s[4:7], s22 offen offset:2048 sc1
  v_mfma_f32_16x16x32_bf16 v[160:163], a[220:223], v[64:67], v[160:163]
  ds_write_b128 v4, v[152:155] offset:2048
  v_mfma_f32_16x16x32_bf16 v[164:167], a[240:243], v[64:67], v[164:167]
  s_waitcnt vmcnt(5)
  v_bitop3_b32 v27, v56, v68, v60 bitop3:0x80
  buffer_load_dwordx2 v[112:113], v15, s[4:7], s56 offen offset:0 sc1
  v_bitop3_b32 v27, v27, v27, v14 bitop3:0x2a
  v_cmp_ne_u32 vcc, 0, v27
  ds_write_b128 v4, v[156:159] offset:3072
  s_cbranch_vccz L_ok_235
L_retry_234:
  s_sub_u32 s69, s69, 1
  s_cbranch_scc1 L_retry_234_to
  buffer_load_dwordx4 v[56:59], v1, s[4:7], s21 offen offset:1024 sc1
  buffer_load_dwordx4 v[68:71], v1, s[4:7], s29 offen offset:0 sc1
  buffer_load_dwordx4 v[60:63], v1, s[4:7], s21 offen offset:2048 sc1
  s_waitcnt vmcnt(0)
  v_bitop3_b32 v27, v56, v68, v60 bitop3:0x80
  v_bitop3_b32 v27, v27, v27, v14 bitop3:0x2a
  v_cmp_ne_u32 vcc, 0, v27
  s_nop 1
  s_cbranch_vccnz L_retry_234
  v_bitop3_b32 v27, v72, v84, v76 bitop3:0x80
  v_bitop3_b32 v27, v27, v88, v80 bitop3:0x80
  v_bitop3_b32 v27, v27, v112, v14 bitop3:0x2a
  v_cmp_ne_u32 vcc, 0, v27
  s_nop 1
  s_cbranch_vccz L_ok_235
  buffer_load_dwordx4 v[72:75], v1, s[4:7], s22 offen offset:0 sc1
  buffer_load_dwordx4 v[84:87], v1, s[4:7], s22 offen offset:3072 sc1
  buffer_load_dwordx4 v[76:79], v1, s[4:7], s22 offen offset:1024 sc1
  buffer_load_dwordx4 v[88:91], v1, s[4:7], s30 offen offset:0 sc1
  buffer_load_dwordx4 v[80:83], v1, s[4:7], s22 offen offset:2048 sc1
  buffer_load_dwordx2 v[112:113], v15, s[4:7], s56 offen offset:0 sc1
L_ok_235:
  v_mfma_f32_16x16x32_bf16 v[136:139], a[172:175], v[56:59], v[136:139]
  v_mfma_f32_16x16x32_bf16 v[136:139], a[184:187], v[68:71], v[136:139]
  buffer_load_dwordx2 v[114:115], v15, s[4:7], s56 offen offset:512 sc1
  v_mfma_f32_16x16x32_bf16 v[136:139], a[176:179], v[60:63], v[136:139]
  v_mfma_f32_16x16x32_bf16 v[140:143], a[192:195], v[56:59], v[140:143]
  v_mfma_f32_16x16x32_bf16 v[140:143], a[204:207], v[68:71], v[140:143]
  v_mfma_f32_16x16x32_bf16 v[140:143], a[196:199], v[60:63], v[140:143]
  buffer_load_dwordx4 v[92:95], v1, s[4:7], s23 offen offset:0 sc1
  v_mfma_f32_16x16x32_bf16 v[160:163], a[212:215], v[56:59], v[160:163]
  v_mfma_f32_16x16x32_bf16 v[160:163], a[224:227], v[68:71], v[160:163]
  v_mfma_f32_16x16x32_bf16 v[160:163], a[216:219], v[60:63], v[160:163]
  v_mfma_f32_16x16x32_bf16 v[164:167], a[232:235], v[56:59], v[164:167]
  ds_write_b128 v5, v[136:139] offset:0
  buffer_load_dwordx4 v[104:107], v1, s[4:7], s23 offen offset:3072 sc1
  v_mfma_f32_16x16x32_bf16 v[164:167], a[244:247], v[68:71], v[164:167]
  s_waitcnt vmcnt(6)
  v_bitop3_b32 v27, v72, v84, v76 bitop3:0x80
  v_mfma_f32_16x16x32_bf16 v[164:167], a[236:239], v[60:63], v[164:167]
  ds_write_b128 v5, v[140:143] offset:1024
  buffer_load_dwordx4 v[96:99], v1, s[4:7], s23 offen offset:1024 sc1
  ds_write_b128 v5, v[160:163] offset:2048
  s_waitcnt vmcnt(5)
  v_bitop3_b32 v27, v27, v88, v80 bitop3:0x80
  v_bitop3_b32 v27, v27, v27, v14 bitop3:0x2a
  v_cmp_ne_u32 vcc, 0, v27
  buffer_load_dwordx4 v[108:111], v1, s[4:7], s31 offen offset:0 sc1
  s_cbranch_vccnz L_retry_236
L_ok_237:
  v_mfma_f32_16x16x32_bf16 v[144:147], a[168:171], v[72:75], 0
  ds_write_b128 v5, v[164:167] offset:3072
  v_mfma_f32_16x16x32_bf16 v[144:147], a[180:183], v[84:87], v[144:147]
  v_mfma_f32_16x16x32_bf16 v[144:147], a[172:175], v[76:79], v[144:147]
  buffer_load_dwordx4 v[100:103], v1, s[4:7], s23 offen offset:2048 sc1
  v_mfma_f32_16x16x32_bf16 v[144:147], a[184:187], v[88:91], v[144:147]
  v_mfma_f32_16x16x32_bf16 v[144:147], a[176:179], v[80:83], v[144:147]
  v_mfma_f32_16x16x32_bf16 v[148:151], a[188:191], v[72:75], 0
  v_mfma_f32_16x16x32_bf16 v[148:151], a[200:203], v[84:87], v[148:151]
  buffer_load_dwordx4 a[28:31], v3, s[4:7], s70 offen offset:2048
  v_mfma_f32_16x16x32_bf16 v[148:151], a[192:195], v[76:79], v[148:151]
  v_mfma_f32_16x16x32_bf16 v[148:151], a[204:207], v[88:91], v[148:151]
  v_mfma_f32_16x16x32_bf16 v[148:151], a[196:199], v[80:83], v[148:151]
  v_mfma_f32_16x16x32_bf16 v[168:171], a[208:211], v[72:75], 0
  buffer_load_dwordx4 a[32:35], v3, s[4:7], s70 offen offset:3072
  v_mfma_f32_16x16x32_bf16 v[168:171], a[220:223], v[84:87], v[168:171]
  ds_write_b128 v6, v[144:147] offset:0
  v_mfma_f32_16x16x32_bf16 v[168:171], a[212:215], v[76:79], v[168:171]
  v_mfma_f32_16x16x32_bf16 v[168:171], a[224:227], v[88:91], v[168:171]
  v_mfma_f32_16x16x32_bf16 v[168:171], a[216:219], v[80:83], v[168:171]
  s_mov_b32 s70, 184320
  buffer_load_dwordx4 a[36:39], v3, s[4:7], s70 offen offset:0
  v_mfma_f32_16x16x32_bf16 v[172:175], a[228:231], v[72:75], 0
  ds_write_b128 v6, v[148:151] offset:1024
  v_mfma_f32_16x16x32_bf16 v[172:175], a[240:243], v[84:87], v[172:175]
  v_mfma_f32_16x16x32_bf16 v[172:175], a[232:235], v[76:79], v[172:175]
  v_mfma_f32_16x16x32_bf16 v[172:175], a[244:247], v[88:91], v[172:175]
  buffer_load_dwordx4 a[40:43], v3, s[4:7], s70 offen offset:1024
  v_mfma_f32_16x16x32_bf16 v[172:175], a[236:239], v[80:83], v[172:175]
  ds_write_b128 v6, v[168:171] offset:2048
  buffer_load_dwordx4 a[44:47], v3, s[4:7], s70 offen offset:2048
  s_nop 5
  ds_write_b128 v6, v[172:175] offset:3072
  buffer_load_dwordx4 a[48:51], v3, s[4:7], s70 offen offset:3072
  s_mov_b32 s70, 188416
  buffer_load_dwordx4 a[52:55], v3, s[4:7], s70 offen offset:0
  s_waitcnt vmcnt(12)
  v_bitop3_b32 v27, v112, v114, v14 bitop3:0x2a
  v_cmp_ne_u32 vcc, 0, v27
  s_nop 0
  s_cbranch_vccz L_ok_239
L_retry_238:
  s_sub_u32 s69, s69, 1
  s_cbranch_scc1 L_retry_238_to
  buffer_load_dwordx2 v[112:113], v15, s[4:7], s56 offen offset:0 sc1
  buffer_load_dwordx2 v[114:115], v15, s[4:7], s56 offen offset:512 sc1
  s_waitcnt vmcnt(0)
  v_bitop3_b32 v27, v112, v114, v14 bitop3:0x2a
  v_cmp_ne_u32 vcc, 0, v27
  s_nop 1
  s_cbranch_vccnz L_retry_238
  v_bitop3_b32 v27, v92, v104, v96 bitop3:0x80
  v_bitop3_b32 v27, v27, v108, v100 bitop3:0x80
  v_bitop3_b32 v27, v27, v27, v14 bitop3:0x2a
  v_cmp_ne_u32 vcc, 0, v27
  s_nop 1
  s_cbranch_vccz L_ok_239
  buffer_load_dwordx4 v[92:95], v1, s[4:7], s23 offen offset:0 sc1
  buffer_load_dwordx4 v[104:107], v1, s[4:7], s23 offen offset:3072 sc1
  buffer_load_dwordx4 v[96:99], v1, s[4:7], s23 offen offset:1024 sc1
  buffer_load_dwordx4 v[108:111], v1, s[4:7], s31 offen offset:0 sc1
  buffer_load_dwordx4 v[100:103], v1, s[4:7], s23 offen offset:2048 sc1
  buffer_load_dword a253, v26, s[4:7], s76 offen
  buffer_load_dword a253, v26, s[4:7], s76 offen
  buffer_load_dword a253, v26, s[4:7], s76 offen
  buffer_load_dword a253, v26, s[4:7], s76 offen
  buffer_load_dword a253, v26, s[4:7], s76 offen
  buffer_load_dword a253, v26, s[4:7], s76 offen
  buffer_load_dword a253, v26, s[4:7], s76 offen
L_ok_239:
  v_add_f32 v112, v112, v114
  buffer_load_dwordx4 a[56:59], v3, s[4:7], s70 offen offset:1024
  v_mov_b32 v114, v112
  v_add_f32 v113, v113, v115
  v_mov_b32 v115, v113
  v_permlane16_swap_b32 v112, v114
  v_add_f32 v112, v112, v114
  v_mov_b32 v114, v112
  v_permlane16_swap_b32 v113, v115
  v_add_f32 v113, v113, v115
  v_permlane32_swap_b32 v112, v114
  v_add_f32 v112, v112, v114
  v_mul_f32 v28, 0xbacccccd, v112
  s_waitcnt lgkmcnt(15)
  v_mul_f32 v200, v28, v200
  v_mul_f32 v201, v28, v201
  buffer_load_dwordx4 a[60:63], v3, s[4:7], s70 offen offset:2048
  v_mul_f32 v202, v28, v202
  v_mul_f32 v203, v28, v203
  v_mul_f32 v204, v28, v204
  v_mul_f32 v205, v28, v205
  v_mul_f32 v206, v28, v206
  v_mul_f32 v207, v28, v207
  v_mul_f32 v228, v28, v228
  v_mul_f32 v229, v28, v229
  v_mul_f32 v230, v28, v230
  v_mul_f32 v231, v28, v231
  v_mul_f32 v232, v28, v232
  v_mul_f32 v233, v28, v233
  v_mul_f32 v234, v28, v234
  v_mul_f32 v235, v28, v235
  v_mov_b32 v115, v113
  v_mul_f32 v236, v28, v236
  buffer_load_dwordx4 a[64:67], v3, s[4:7], s70 offen offset:3072
  v_permlane32_swap_b32 v113, v115
  v_add_f32 v113, v113, v115
  v_mul_f32 v113, 0x3acccccd, v113
  v_fma_f32 v29, -v28, v28, v113
  v_max_f32 v29, 0, v29
  v_add_f32 v31, 0x3727c5ac, v29
  v_rsq_f32 v30, v31
  v_rcp_f32 v252, v30
  s_waitcnt vmcnt(12)
  v_bitop3_b32 v27, v92, v104, v96 bitop3:0x80
  v_mul_f32 v250, v30, v30
  v_mul_f32 v250, v250, v30
  v_mul_f32 v248, s79, v30
  s_mov_b32 s70, 192512
  buffer_load_dwordx4 a[68:71], v3, s[4:7], s70 offen offset:0
  v_mul_f32 v250, s80, v250
  v_mul_f32 v237, v28, v237
  v_mul_f32 v238, v28, v238
  v_mul_f32 v239, v28, v239
  v_mul_f32 v240, v28, v240
  v_mul_f32 v241, v28, v241
  v_mul_f32 v242, v28, v242
  v_mul_f32 v243, v28, v243
  buffer_load_dwordx4 a[72:75], v3, s[4:7], s70 offen offset:1024
  s_waitcnt vmcnt(12)
  v_bitop3_b32 v27, v27, v108, v100 bitop3:0x80
  v_bitop3_b32 v27, v27, v27, v14 bitop3:0x2a
  v_cmp_ne_u32 vcc, 0, v27
  s_nop 0
  s_cbranch_vccnz L_retry_240
L_ok_241:
  v_mfma_f32_16x16x32_bf16 v[200:203], a[168:171], v[92:95], v[200:203]
  buffer_load_dwordx4 a[76:79], v3, s[4:7], s70 offen offset:2048
  v_mfma_f32_16x16x32_bf16 v[200:203], a[180:183], v[104:107], v[200:203]
  s_waitcnt lgkmcnt(0)
  s_barrier
  v_mfma_f32_16x16x32_bf16 v[200:203], a[172:175], v[96:99], v[200:203]
  ds_read_b128 v[128:131], v7 offset:0
  v_mfma_f32_16x16x32_bf16 v[200:203], a[184:187], v[108:111], v[200:203]
  buffer_load_dwordx4 a[80:83], v3, s[4:7], s70 offen offset:3072
  v_mfma_f32_16x16x32_bf16 v[200:203], a[176:179], v[100:103], v[200:203]
  ds_read_b128 v[136:139], v7 offset:5120
  v_mfma_f32_16x16x32_bf16 v[204:207], a[188:191], v[92:95], v[204:207]
  ds_read_b128 v[144:147], v7 offset:10240
  v_mfma_f32_16x16x32_bf16 v[204:207], a[200:203], v[104:107], v[204:207]
  ds_read_b128 v[132:135], v7 offset:1024
  v_mfma_f32_16x16x32_bf16 v[204:207], a[192:195], v[96:99], v[204:207]
  ds_read_b128 v[140:143], v7 offset:6144
  s_mov_b32 s70, 196608
  buffer_load_dwordx4 a[84:87], v3, s[4:7], s70 offen offset:0
  v_mfma_f32_16x16x32_bf16 v[204:207], a[204:207], v[108:111], v[204:207]
  ds_read_b128 v[148:151], v7 offset:11264
  v_mfma_f32_16x16x32_bf16 v[204:207], a[196:199], v[100:103], v[204:207]
  ds_read_b128 v[152:155], v7 offset:2048
  v_mfma_f32_16x16x32_bf16 v[228:231], a[208:211], v[92:95], v[228:231]
  ds_read_b128 v[160:163], v7 offset:7168
  v_mfma_f32_16x16x32_bf16 v[228:231], a[220:223], v[104:107], v[228:231]
  ds_read_b128 v[168:171], v7 offset:12288
  buffer_load_dwordx4 a[88:91], v3, s[4:7], s70 offen offset:1024
  v_mfma_f32_16x16x32_bf16 v[228:231], a[212:215], v[96:99], v[228:231]
  ds_read_b128 v[156:159], v7 offset:3072
  v_mfma_f32_16x16x32_bf16 v[228:231], a[224:227], v[108:111], v[228:231]
  ds_read_b128 v[164:167], v7 offset:8192
  s_waitcnt lgkmcnt(9)
  v_add_f32 v128, v128, v136
  v_mfma_f32_16x16x32_bf16 v[228:231], a[216:219], v[100:103], v[228:231]
  v_add_f32 v129, v129, v137
  v_add_f32 v130, v130, v138
  v_mfma_f32_16x16x32_bf16 v[232:235], a[228:231], v[92:95], v[232:235]
  v_add_f32 v131, v131, v139
  s_waitcnt lgkmcnt(8)
  v_add_f32 v200, v200, v144
  v_mfma_f32_16x16x32_bf16 v[232:235], a[240:243], v[104:107], v[232:235]
  buffer_load_dwordx4 a[92:95], v3, s[4:7], s70 offen offset:2048
  v_mfma_f32_16x16x32_bf16 v[232:235], a[232:235], v[96:99], v[232:235]
  v_add_f32 v201, v201, v145
  v_add_f32 v202, v202, v146
  v_mfma_f32_16x16x32_bf16 v[232:235], a[244:247], v[108:111], v[232:235]
  v_add_f32 v203, v203, v147
  s_waitcnt lgkmcnt(6)
  v_add_f32 v132, v132, v140
  v_mfma_f32_16x16x32_bf16 v[232:235], a[236:239], v[100:103], v[232:235]
  v_add_f32 v133, v133, v141
  v_add_f32 v134, v134, v142
  v_mfma_f32_16x16x32_bf16 v[176:179], a[248:251], v[32:35], 0
  v_add_f32 v135, v135, v143
  s_mov_b32 s70, 221184
  buffer_load_dwordx4 a[180:183], v3, s[4:7], s70 offen offset:0
  v_mfma_f32_16x16x32_bf16 v[176:179], a[0:3], v[36:39], v[176:179]
  s_waitcnt lgkmcnt(5)
  v_add_f32 v204, v204, v148
  v_add_f32 v205, v205, v149
  v_mfma_f32_16x16x32_bf16 v[176:179], a[4:7], v[40:43], v[176:179]
  v_add_f32 v206, v206, v150
  v_add_f32 v207, v207, v151
  v_mfma_f32_16x16x32_bf16 v[176:179], a[8:11], v[44:47], v[176:179]
  v_add_f32 v200, v200, v128
  v_add_f32 v201, v201, v129
  v_mfma_f32_16x16x32_bf16 v[176:179], a[12:15], v[48:51], v[176:179]
  v_add_f32 v202, v202, v130
  buffer_load_dwordx4 a[184:187], v3, s[4:7], s70 offen offset:1024
  v_mfma_f32_16x16x32_bf16 v[180:183], a[16:19], v[32:35], 0
  v_add_f32 v203, v203, v131
  v_add_f32 v204, v204, v132
  v_mfma_f32_16x16x32_bf16 v[180:183], a[20:23], v[36:39], v[180:183]
  v_add_f32 v205, v205, v133
  v_add_f32 v206, v206, v134
  v_mfma_f32_16x16x32_bf16 v[180:183], a[24:27], v[40:43], v[180:183]
  v_add_f32 v207, v207, v135
  v_pk_mul_f32 v[144:145], v[200:201], v[200:201]
  v_pk_fma_f32 v[144:145], v[144:145], v[250:251], v[248:249] op_sel_hi:[1,0,0]
  v_pk_mul_f32 v[144:145], v[144:145], v[200:201]
  v_pk_mul_f32 v[146:147], v[202:203], v[202:203]
  v_pk_fma_f32 v[146:147], v[146:147], v[250:251], v[248:249] op_sel_hi:[1,0,0]
  v_pk_mul_f32 v[146:147], v[146:147], v[202:203]
  v_pk_mul_f32 v[148:149], v[204:205], v[204:205]
  v_pk_fma_f32 v[148:149], v[148:149], v[250:251], v[248:249] op_sel_hi:[1,0,0]
  v_pk_mul_f32 v[148:149], v[148:149], v[204:205]
  v_pk_mul_f32 v[150:151], v[206:207], v[206:207]
  v_pk_fma_f32 v[150:151], v[150:151], v[250:251], v[248:249] op_sel_hi:[1,0,0]
  v_pk_mul_f32 v[150:151], v[150:151], v[206:207]
  buffer_load_dwordx4 a[188:191], v3, s[4:7], s70 offen offset:2048
  s_waitcnt vmcnt(19)
  v_mfma_f32_16x16x32_bf16 v[180:183], a[28:31], v[44:47], v[180:183]
  ds_read_b128 v[172:175], v7 offset:13312
  s_waitcnt lgkmcnt(4)
  v_add_f32 v152, v152, v160
  s_waitcnt vmcnt(18)
  v_mfma_f32_16x16x32_bf16 v[180:183], a[32:35], v[48:51], v[180:183]
  v_exp_f32 v144, v144
  v_mfma_f32_16x16x32_bf16 v[184:187], a[248:251], v[52:55], 0
  v_exp_f32 v145, v145
  v_mfma_f32_16x16x32_bf16 v[184:187], a[0:3], v[56:59], v[184:187]
  v_exp_f32 v146, v146
  v_mfma_f32_16x16x32_bf16 v[184:187], a[4:7], v[60:63], v[184:187]
  buffer_load_dwordx4 a[192:195], v3, s[4:7], s70 offen offset:3072
  v_mfma_f32_16x16x32_bf16 v[184:187], a[8:11], v[64:67], v[184:187]
  v_exp_f32 v147, v147
  v_mfma_f32_16x16x32_bf16 v[184:187], a[12:15], v[68:71], v[184:187]
  v_exp_f32 v148, v148
  v_mfma_f32_16x16x32_bf16 v[188:191], a[16:19], v[52:55], 0
  v_exp_f32 v149, v149
  v_mfma_f32_16x16x32_bf16 v[188:191], a[20:23], v[56:59], v[188:191]
  v_exp_f32 v150, v150
  v_mfma_f32_16x16x32_bf16 v[188:191], a[24:27], v[60:63], v[188:191]
  s_mov_b32 s70, 225280
  buffer_load_dwordx4 a[196:199], v3, s[4:7], s70 offen offset:0
  v_mfma_f32_16x16x32_bf16 v[188:191], a[28:31], v[64:67], v[188:191]
  v_exp_f32 v151, v151
  v_mfma_f32_16x16x32_bf16 v[188:191], a[32:35], v[68:71], v[188:191]
  v_fma_f32 v144, v144, v252, v252
  v_mfma_f32_16x16x32_bf16 v[192:195], a[248:251], v[72:75], 0
  v_fma_f32 v145, v145, v252, v252
  v_mfma_f32_16x16x32_bf16 v[192:195], a[0:3], v[76:79], v[192:195]
  v_fma_f32 v146, v146, v252, v252
  v_mfma_f32_16x16x32_bf16 v[192:195], a[4:7], v[80:83], v[192:195]
  buffer_load_dwordx4 a[200:203], v3, s[4:7], s70 offen offset:1024
  v_mfma_f32_16x16x32_bf16 v[192:195], a[8:11], v[84:87], v[192:195]
  v_fma_f32 v147, v147, v252, v252
  v_mfma_f32_16x16x32_bf16 v[192:195], a[12:15], v[88:91], v[192:195]
  v_fma_f32 v148, v148, v252, v252
  v_fma_f32 v149, v149, v252, v252
  v_fma_f32 v150, v150, v252, v252
  v_fma_f32 v151, v151, v252, v252
  v_rcp_f32 v144, v144
  v_rcp_f32 v145, v145
  v_rcp_f32 v146, v146
  v_rcp_f32 v147, v147
  buffer_load_dwordx4 a[204:207], v3, s[4:7], s70 offen offset:2048
  v_rcp_f32 v148, v148
  v_rcp_f32 v149, v149
  v_rcp_f32 v150, v150
  v_rcp_f32 v151, v151
  v_mul_f32 v200, v200, v144
  v_mul_f32 v201, v201, v145
  v_mfma_f32_16x16x32_bf16 v[196:199], a[16:19], v[72:75], 0
  v_mul_f32 v202, v202, v146
  v_mul_f32 v203, v203, v147
  v_mul_f32 v204, v204, v148
  v_mul_f32 v205, v205, v149
  v_mul_f32 v206, v206, v150
  v_mul_f32 v207, v207, v151
  v_cvt_pk_bf16_f32 v244, v200, v201
  buffer_load_dwordx4 a[208:211], v3, s[4:7], s70 offen offset:3072
  v_cvt_pk_bf16_f32 v245, v202, v203
  v_cvt_pk_bf16_f32 v246, v204, v205
  v_cvt_pk_bf16_f32 v247, v206, v207
  v_or_b32 v244, v14, v244
  v_mfma_f32_16x16x32_bf16 v[196:199], a[20:23], v[76:79], v[196:199]
  buffer_store_dwordx4 v[244:247], v1, s[4:7], s52 offen offset:0 sc1
  v_mfma_f32_16x16x32_bf16 v[196:199], a[24:27], v[80:83], v[196:199]
  v_add_f32 v153, v153, v161
  v_add_f32 v154, v154, v162
  v_mfma_f32_16x16x32_bf16 v[196:199], a[28:31], v[84:87], v[196:199]
  v_add_f32 v155, v155, v163
  s_waitcnt lgkmcnt(1)
  v_add_f32 v156, v156, v164
  v_mfma_f32_16x16x32_bf16 v[196:199], a[32:35], v[88:91], v[196:199]
  v_add_f32 v157, v157, v165
  v_add_f32 v158, v158, v166
  v_mfma_f32_16x16x32_bf16 v[236:239], a[248:251], v[92:95], v[236:239]
  s_mov_b32 s70, 229376
  buffer_load_dwordx4 a[212:215], v3, s[4:7], s70 offen offset:0
  v_add_f32 v159, v159, v167
  v_add_f32 v228, v228, v168
  v_add_f32 v229, v229, v169
  v_add_f32 v230, v230, v170
  v_add_f32 v231, v231, v171
  s_waitcnt lgkmcnt(0)
  v_add_f32 v232, v232, v172
  v_add_f32 v233, v233, v173
  v_add_f32 v234, v234, v174
  v_add_f32 v235, v235, v175
  v_add_f32 v228, v228, v152
  v_add_f32 v229, v229, v153
  v_add_f32 v230, v230, v154
  v_add_f32 v231, v231, v155
  v_add_f32 v232, v232, v156
  v_add_f32 v233, v233, v157
  v_add_f32 v234, v234, v158
  v_add_f32 v235, v235, v159
  v_pk_mul_f32 v[168:169], v[228:229], v[228:229]
  v_pk_fma_f32 v[168:169], v[168:169], v[250:251], v[248:249] op_sel_hi:[1,0,0]
  v_pk_mul_f32 v[168:169], v[168:169], v[228:229]
  v_pk_mul_f32 v[170:171], v[230:231], v[230:231]
  v_pk_fma_f32 v[170:171], v[170:171], v[250:251], v[248:249] op_sel_hi:[1,0,0]
  v_pk_mul_f32 v[170:171], v[170:171], v[230:231]
  v_pk_mul_f32 v[172:173], v[232:233], v[232:233]
  v_pk_fma_f32 v[172:173], v[172:173], v[250:251], v[248:249] op_sel_hi:[1,0,0]
  v_pk_mul_f32 v[172:173], v[172:173], v[232:233]
  v_pk_mul_f32 v[174:175], v[234:235], v[234:235]
  v_pk_fma_f32 v[174:175], v[174:175], v[250:251], v[248:249] op_sel_hi:[1,0,0]
  v_pk_mul_f32 v[174:175], v[174:175], v[234:235]
  buffer_load_dwordx4 a[216:219], v3, s[4:7], s70 offen offset:1024
  v_mfma_f32_16x16x32_bf16 v[236:239], a[0:3], v[96:99], v[236:239]
  v_exp_f32 v168, v168
  v_mfma_f32_16x16x32_bf16 v[236:239], a[4:7], v[100:103], v[236:239]
  v_exp_f32 v169, v169
  v_mfma_f32_16x16x32_bf16 v[236:239], a[8:11], v[104:107], v[236:239]
  v_exp_f32 v170, v170
  v_mfma_f32_16x16x32_bf16 v[236:239], a[12:15], v[108:111], v[236:239]
  v_exp_f32 v171, v171
  v_exp_f32 v172, v172
  v_exp_f32 v173, v173
  buffer_load_dwordx4 a[220:223], v3, s[4:7], s70 offen offset:2048
  v_exp_f32 v174, v174
  v_exp_f32 v175, v175
  v_fma_f32 v168, v168, v252, v252
  v_fma_f32 v169, v169, v252, v252
  v_fma_f32 v170, v170, v252, v252
  v_fma_f32 v171, v171, v252, v252
  v_fma_f32 v172, v172, v252, v252
  v_fma_f32 v173, v173, v252, v252
  v_fma_f32 v174, v174, v252, v252
  v_fma_f32 v175, v175, v252, v252
  v_mfma_f32_16x16x32_bf16 v[240:243], a[16:19], v[92:95], v[240:243]
  buffer_load_dwordx4 a[224:227], v3, s[4:7], s70 offen offset:3072
  v_rcp_f32 v168, v168
  v_rcp_f32 v169, v169
  v_rcp_f32 v170, v170
  v_rcp_f32 v171, v171
  v_rcp_f32 v172, v172
  v_rcp_f32 v173, v173
  v_rcp_f32 v174, v174
  v_rcp_f32 v175, v175
  v_mul_f32 v228, v228, v168
  v_mul_f32 v229, v229, v169
  v_mul_f32 v230, v230, v170
  s_mov_b32 s70, 233472
  buffer_load_dwordx4 a[228:231], v3, s[4:7], s70 offen offset:0
  v_mul_f32 v231, v231, v171
  v_mul_f32 v232, v232, v172
  v_mul_f32 v233, v233, v173
  v_mul_f32 v234, v234, v174
  v_mul_f32 v235, v235, v175
  v_cvt_pk_bf16_f32 v244, v228, v229
  v_cvt_pk_bf16_f32 v245, v230, v231
  v_cvt_pk_bf16_f32 v246, v232, v233
  v_cvt_pk_bf16_f32 v247, v234, v235
  v_mfma_f32_16x16x32_bf16 v[240:243], a[20:23], v[96:99], v[240:243]
  v_or_b32 v244, v14, v244
  buffer_store_dwordx4 v[244:247], v1, s[4:7], s52 offen offset:1024 sc1
  v_mfma_f32_16x16x32_bf16 v[240:243], a[24:27], v[100:103], v[240:243]
  ds_read_b128 v[200:203], v13 offset:96
  v_mfma_f32_16x16x32_bf16 v[240:243], a[28:31], v[104:107], v[240:243]
  ds_read_b128 v[204:207], v13 offset:112
  v_mfma_f32_16x16x32_bf16 v[240:243], a[32:35], v[108:111], v[240:243]
  s_barrier
  buffer_load_dwordx4 a[232:235], v3, s[4:7], s70 offen offset:1024
  s_waitcnt vmcnt(30)
  v_mfma_f32_16x16x32_bf16 v[128:131], a[36:39], v[32:35], 0
  ds_write_b128 v4, v[176:179] offset:0
  s_waitcnt vmcnt(29)
  v_mfma_f32_16x16x32_bf16 v[128:131], a[40:43], v[36:39], v[128:131]
  ds_read_b128 v[228:231], v13 offset:128
  s_waitcnt vmcnt(28)
  v_mfma_f32_16x16x32_bf16 v[128:131], a[44:47], v[40:43], v[128:131]
  ds_read_b128 v[232:235], v13 offset:144
  s_waitcnt vmcnt(27)
  v_mfma_f32_16x16x32_bf16 v[128:131], a[48:51], v[44:47], v[128:131]
  buffer_load_dwordx4 a[236:239], v3, s[4:7], s70 offen offset:2048
  s_waitcnt vmcnt(27)
  v_mfma_f32_16x16x32_bf16 v[128:131], a[52:55], v[48:51], v[128:131]
  ds_write_b128 v4, v[180:183] offset:1024
  s_waitcnt vmcnt(26)
  v_mfma_f32_16x16x32_bf16 v[132:135], a[56:59], v[32:35], 0
  s_waitcnt lgkmcnt(5)
  v_mul_f32 v200, v28, v200
  v_mul_f32 v201, v28, v201
  s_waitcnt vmcnt(25)
  v_mfma_f32_16x16x32_bf16 v[132:135], a[60:63], v[36:39], v[132:135]
  v_mul_f32 v202, v28, v202
  v_mul_f32 v203, v28, v203
  s_waitcnt vmcnt(24)
  v_mfma_f32_16x16x32_bf16 v[132:135], a[64:67], v[40:43], v[132:135]
  buffer_load_dwordx4 a[240:243], v3, s[4:7], s70 offen offset:3072
  s_waitcnt vmcnt(24)
  v_mfma_f32_16x16x32_bf16 v[132:135], a[68:71], v[44:47], v[132:135]
  s_waitcnt lgkmcnt(4)
  v_mul_f32 v204, v28, v204
  v_mul_f32 v205, v28, v205
  s_waitcnt vmcnt(23)
  v_mfma_f32_16x16x32_bf16 v[132:135], a[72:75], v[48:51], v[132:135]
  v_mul_f32 v206, v28, v206
  v_mul_f32 v207, v28, v207
  v_mfma_f32_16x16x32_bf16 v[136:139], a[36:39], v[52:55], 0
  ds_write_b128 v5, v[184:187] offset:0
  v_mfma_f32_16x16x32_bf16 v[136:139], a[40:43], v[56:59], v[136:139]
  s_mov_b32 s70, 237568
  buffer_load_dwordx4 a[244:247], v3, s[4:7], s70 offen offset:0
  v_mfma_f32_16x16x32_bf16 v[136:139], a[44:47], v[60:63], v[136:139]
  s_waitcnt lgkmcnt(3)
  v_mul_f32 v228, v28, v228
  v_mul_f32 v229, v28, v229
  v_mfma_f32_16x16x32_bf16 v[136:139], a[48:51], v[64:67], v[136:139]
  ds_write_b128 v5, v[188:191] offset:1024
  v_mfma_f32_16x16x32_bf16 v[136:139], a[52:55], v[68:71], v[136:139]
  v_mul_f32 v230, v28, v230
  v_mul_f32 v231, v28, v231
  v_mfma_f32_16x16x32_bf16 v[140:143], a[56:59], v[52:55], 0
  buffer_load_dwordx4 a[248:251], v3, s[4:7], s70 offen offset:1024
  v_mfma_f32_16x16x32_bf16 v[140:143], a[60:63], v[56:59], v[140:143]
  ds_write_b128 v6, v[192:195] offset:0
  v_mfma_f32_16x16x32_bf16 v[140:143], a[64:67], v[60:63], v[140:143]
  s_waitcnt lgkmcnt(4)
  v_mul_f32 v232, v28, v232
  v_mul_f32 v233, v28, v233
  v_mfma_f32_16x16x32_bf16 v[140:143], a[68:71], v[64:67], v[140:143]
  v_mul_f32 v234, v28, v234
  v_mul_f32 v235, v28, v235
  v_mfma_f32_16x16x32_bf16 v[140:143], a[72:75], v[68:71], v[140:143]
  buffer_load_dwordx4 a[0:3], v3, s[4:7], s70 offen offset:2048
  v_mfma_f32_16x16x32_bf16 v[144:147], a[36:39], v[72:75], 0
  ds_write_b128 v6, v[196:199] offset:1024
  v_mfma_f32_16x16x32_bf16 v[144:147], a[40:43], v[76:79], v[144:147]
  ds_read_b128 a[168:171], v251 offset:6144
  v_mfma_f32_16x16x32_bf16 v[144:147], a[44:47], v[80:83], v[144:147]
  ds_read_b128 a[172:175], v251 offset:7168
  v_mfma_f32_16x16x32_bf16 v[144:147], a[48:51], v[84:87], v[144:147]
  buffer_load_dwordx4 a[4:7], v3, s[4:7], s70 offen offset:3072
  v_mfma_f32_16x16x32_bf16 v[144:147], a[52:55], v[88:91], v[144:147]
  ds_write_b128 v4, v[128:131] offset:2048
  v_mfma_f32_16x16x32_bf16 v[148:151], a[56:59], v[72:75], 0
  ds_read_b128 a[176:179], v251 offset:8192
  v_mfma_f32_16x16x32_bf16 v[148:151], a[60:63], v[76:79], v[148:151]
  v_mfma_f32_16x16x32_bf16 v[148:151], a[64:67], v[80:83], v[148:151]
  buffer_load_dwordx4 v[112:115], v1, s[4:7], s36 offen offset:0 sc1
  v_mfma_f32_16x16x32_bf16 v[148:151], a[68:71], v[84:87], v[148:151]
  ds_write_b128 v4, v[132:135] offset:3072
  v_mfma_f32_16x16x32_bf16 v[148:151], a[72:75], v[88:91], v[148:151]
  s_waitcnt lgkmcnt(5)
  s_barrier
  v_mfma_f32_16x16x32_bf16 v[200:203], a[36:39], v[92:95], v[200:203]
  s_mov_b32 s70, 241664
  buffer_load_dwordx4 a[8:11], v3, s[4:7], s70 offen offset:0
  v_mfma_f32_16x16x32_bf16 v[200:203], a[40:43], v[96:99], v[200:203]
  ds_write_b128 v5, v[136:139] offset:2048
  v_mfma_f32_16x16x32_bf16 v[200:203], a[44:47], v[100:103], v[200:203]
  ds_read_b128 v[176:179], v7 offset:0
  v_mfma_f32_16x16x32_bf16 v[200:203], a[48:51], v[104:107], v[200:203]
  ds_read_b128 v[184:187], v7 offset:5120
  v_mfma_f32_16x16x32_bf16 v[200:203], a[52:55], v[108:111], v[200:203]
  buffer_load_dwordx4 a[12:15], v3, s[4:7], s70 offen offset:1024
  v_mfma_f32_16x16x32_bf16 v[204:207], a[56:59], v[92:95], v[204:207]
  ds_write_b128 v5, v[140:143] offset:3072
  v_mfma_f32_16x16x32_bf16 v[204:207], a[60:63], v[96:99], v[204:207]
  ds_read_b128 v[192:195], v7 offset:10240
  v_mfma_f32_16x16x32_bf16 v[204:207], a[64:67], v[100:103], v[204:207]
  ds_read_b128 v[180:183], v7 offset:1024
  v_mfma_f32_16x16x32_bf16 v[204:207], a[68:71], v[104:107], v[204:207]
  buffer_load_dwordx4 a[16:19], v3, s[4:7], s70 offen offset:2048
  v_mfma_f32_16x16x32_bf16 v[204:207], a[72:75], v[108:111], v[204:207]
  ds_write_b128 v6, v[144:147] offset:2048
  s_waitcnt vmcnt(30)
  v_mfma_f32_16x16x32_bf16 v[152:155], a[76:79], v[32:35], 0
  ds_read_b128 v[188:191], v7 offset:6144
  s_waitcnt vmcnt(29)
  v_mfma_f32_16x16x32_bf16 v[152:155], a[80:83], v[36:39], v[152:155]
  ds_read_b128 v[196:199], v7 offset:11264
  s_waitcnt lgkmcnt(6)
  v_add_f32 v176, v176, v184
  s_waitcnt vmcnt(28)
  v_mfma_f32_16x16x32_bf16 v[152:155], a[84:87], v[40:43], v[152:155]
  buffer_load_dwordx4 a[20:23], v3, s[4:7], s70 offen offset:3072
  s_waitcnt vmcnt(28)
  v_mfma_f32_16x16x32_bf16 v[152:155], a[88:91], v[44:47], v[152:155]
  ds_write_b128 v6, v[148:151] offset:3072
  s_waitcnt vmcnt(27)
  v_mfma_f32_16x16x32_bf16 v[152:155], a[92:95], v[48:51], v[152:155]
  v_add_f32 v177, v177, v185
  v_add_f32 v178, v178, v186
  v_mfma_f32_16x16x32_bf16 v[156:159], a[96:99], v[32:35], 0
  v_add_f32 v179, v179, v187
  s_waitcnt lgkmcnt(5)
  v_add_f32 v236, v236, v192
  v_mfma_f32_16x16x32_bf16 v[156:159], a[100:103], v[36:39], v[156:159]
  s_mov_b32 s70, 245760
  buffer_load_dwordx4 a[24:27], v3, s[4:7], s70 offen offset:0
  v_mfma_f32_16x16x32_bf16 v[156:159], a[104:107], v[40:43], v[156:159]
  v_add_f32 v237, v237, v193
  v_add_f32 v238, v238, v194
  v_mfma_f32_16x16x32_bf16 v[156:159], a[108:111], v[44:47], v[156:159]
  v_add_f32 v239, v239, v195
  v_add_f32 v236, v236, v176
  v_mfma_f32_16x16x32_bf16 v[156:159], a[112:115], v[48:51], v[156:159]
  s_waitcnt lgkmcnt(2)
  v_add_f32 v180, v180, v188
  v_add_f32 v181, v181, v189
  v_mfma_f32_16x16x32_bf16 v[160:163], a[76:79], v[52:55], 0
  v_add_f32 v182, v182, v190
  buffer_load_dwordx4 v[116:119], v1, s[4:7], s36 offen offset:1024 sc1
  v_mfma_f32_16x16x32_bf16 v[160:163], a[80:83], v[56:59], v[160:163]
  v_add_f32 v183, v183, v191
  s_waitcnt lgkmcnt(1)
  v_add_f32 v240, v240, v196
  v_mfma_f32_16x16x32_bf16 v[160:163], a[84:87], v[60:63], v[160:163]
  v_add_f32 v241, v241, v197
  v_add_f32 v242, v242, v198
  v_mfma_f32_16x16x32_bf16 v[160:163], a[88:91], v[64:67], v[160:163]
  s_waitcnt lgkmcnt(0)
  s_barrier
  v_mfma_f32_16x16x32_bf16 v[160:163], a[92:95], v[68:71], v[160:163]
  buffer_load_dwordx4 v[120:123], v1, s[4:7], s37 offen offset:2048 sc1
  v_mfma_f32_16x16x32_bf16 v[164:167], a[96:99], v[52:55], 0
  v_add_f32 v243, v243, v199
  v_add_f32 v237, v237, v177
  v_mfma_f32_16x16x32_bf16 v[164:167], a[100:103], v[56:59], v[164:167]
  v_add_f32 v238, v238, v178
  v_add_f32 v239, v239, v179
  v_mfma_f32_16x16x32_bf16 v[164:167], a[104:107], v[60:63], v[164:167]
  v_add_f32 v240, v240, v180
  v_add_f32 v241, v241, v181
  v_mfma_f32_16x16x32_bf16 v[164:167], a[108:111], v[64:67], v[164:167]
  v_add_f32 v242, v242, v182
  v_add_f32 v243, v243, v183
  v_pk_mul_f32 v[192:193], v[236:237], v[236:237]
  v_pk_fma_f32 v[192:193], v[192:193], v[250:251], v[248:249] op_sel_hi:[1,0,0]
  v_pk_mul_f32 v[192:193], v[192:193], v[236:237]
  v_pk_mul_f32 v[194:195], v[238:239], v[238:239]
  v_pk_fma_f32 v[194:195], v[194:195], v[250:251], v[248:249] op_sel_hi:[1,0,0]
  v_pk_mul_f32 v[194:195], v[194:195], v[238:239]
  v_pk_mul_f32 v[196:197], v[240:241], v[240:241]
  v_pk_fma_f32 v[196:197], v[196:197], v[250:251], v[248:249] op_sel_hi:[1,0,0]
  v_pk_mul_f32 v[196:197], v[196:197], v[240:241]
  v_pk_mul_f32 v[198:199], v[242:243], v[242:243]
  v_pk_fma_f32 v[198:199], v[198:199], v[250:251], v[248:249] op_sel_hi:[1,0,0]
  v_pk_mul_f32 v[198:199], v[198:199], v[242:243]
  buffer_load_dwordx4 v[124:127], v1, s[4:7], s37 offen offset:3072 sc1
  v_mfma_f32_16x16x32_bf16 v[164:167], a[112:115], v[68:71], v[164:167]
  ds_read_b128 v[128:131], v7 offset:2048
  v_mfma_f32_16x16x32_bf16 v[168:171], a[76:79], v[72:75], 0
  ds_read_b128 v[136:139], v7 offset:7168
  v_mfma_f32_16x16x32_bf16 v[168:171], a[80:83], v[76:79], v[168:171]
  ds_read_b128 v[144:147], v7 offset:12288
  v_mfma_f32_16x16x32_bf16 v[168:171], a[84:87], v[80:83], v[168:171]
  ds_read_b128 v[132:135], v7 offset:3072
  v_mfma_f32_16x16x32_bf16 v[168:171], a[88:91], v[84:87], v[168:171]
  buffer_load_dwordx4 a[28:31], v3, s[4:7], s70 offen offset:1024
  ds_read_b128 v[140:143], v7 offset:8192
  v_exp_f32 v192, v192
  v_exp_f32 v193, v193
  ds_read_b128 v[148:151], v7 offset:13312
  v_exp_f32 v194, v194
  v_exp_f32 v195, v195
  v_exp_f32 v196, v196
  v_exp_f32 v197, v197
  v_exp_f32 v198, v198
  v_exp_f32 v199, v199
  v_mfma_f32_16x16x32_bf16 v[168:171], a[92:95], v[88:91], v[168:171]
  buffer_load_dwordx4 a[32:35], v3, s[4:7], s70 offen offset:2048
  v_fma_f32 v192, v192, v252, v252
  v_fma_f32 v193, v193, v252, v252
  v_fma_f32 v194, v194, v252, v252
  v_fma_f32 v195, v195, v252, v252
  v_fma_f32 v196, v196, v252, v252
  v_fma_f32 v197, v197, v252, v252
  v_fma_f32 v198, v198, v252, v252
  v_fma_f32 v199, v199, v252, v252
  v_rcp_f32 v192, v192
  v_rcp_f32 v193, v193
  v_rcp_f32 v194, v194
  v_rcp_f32 v195, v195
  v_rcp_f32 v196, v196
  buffer_load_dwordx4 a[36:39], v3, s[4:7], s70 offen offset:3072
  v_rcp_f32 v197, v197
  v_rcp_f32 v198, v198
  v_rcp_f32 v199, v199
  v_mul_f32 v236, v236, v192
  v_mul_f32 v237, v237, v193
  v_mfma_f32_16x16x32_bf16 v[172:175], a[96:99], v[72:75], 0
  v_mul_f32 v238, v238, v194
  v_mul_f32 v239, v239, v195
  v_mul_f32 v240, v240, v196
  v_mul_f32 v241, v241, v197
  v_mul_f32 v242, v242, v198
  v_mul_f32 v243, v243, v199
  v_cvt_pk_bf16_f32 v244, v236, v237
  v_cvt_pk_bf16_f32 v245, v238, v239
  s_mov_b32 s70, 249856
  buffer_load_dwordx4 a[40:43], v3, s[4:7], s70 offen offset:0
  v_cvt_pk_bf16_f32 v246, v240, v241
  v_cvt_pk_bf16_f32 v247, v242, v243
  v_or_b32 v244, v14, v244
  v_mfma_f32_16x16x32_bf16 v[172:175], a[100:103], v[76:79], v[172:175]
  buffer_store_dwordx4 v[244:247], v1, s[4:7], s52 offen offset:2048 sc1
  v_mfma_f32_16x16x32_bf16 v[172:175], a[104:107], v[80:83], v[172:175]
  s_waitcnt lgkmcnt(4)
  v_add_f32 v128, v128, v136
  v_add_f32 v129, v129, v137
  v_mfma_f32_16x16x32_bf16 v[172:175], a[108:111], v[84:87], v[172:175]
  v_add_f32 v130, v130, v138
  v_add_f32 v131, v131, v139
  v_mfma_f32_16x16x32_bf16 v[172:175], a[112:115], v[88:91], v[172:175]
  s_waitcnt lgkmcnt(3)
  v_add_f32 v200, v200, v144
  v_add_f32 v201, v201, v145
  v_mfma_f32_16x16x32_bf16 v[228:231], a[76:79], v[92:95], v[228:231]
  buffer_load_dwordx4 a[44:47], v3, s[4:7], s70 offen offset:1024
  v_add_f32 v202, v202, v146
  v_add_f32 v203, v203, v147
  s_waitcnt lgkmcnt(1)
  v_add_f32 v132, v132, v140
  v_add_f32 v133, v133, v141
  v_add_f32 v134, v134, v142
  v_add_f32 v135, v135, v143
  s_waitcnt lgkmcnt(0)
  v_add_f32 v204, v204, v148
  v_add_f32 v205, v205, v149
  v_add_f32 v206, v206, v150
  v_add_f32 v207, v207, v151
  v_add_f32 v200, v200, v128
  v_add_f32 v201, v201, v129
  v_add_f32 v202, v202, v130
  v_add_f32 v203, v203, v131
  v_add_f32 v204, v204, v132
  v_add_f32 v205, v205, v133
  v_add_f32 v206, v206, v134
  v_add_f32 v207, v207, v135
  v_pk_mul_f32 v[144:145], v[200:201], v[200:201]
  v_pk_fma_f32 v[144:145], v[144:145], v[250:251], v[248:249] op_sel_hi:[1,0,0]
  v_pk_mul_f32 v[144:145], v[144:145], v[200:201]
  v_pk_mul_f32 v[146:147], v[202:203], v[202:203]
  v_pk_fma_f32 v[146:147], v[146:147], v[250:251], v[248:249] op_sel_hi:[1,0,0]
  v_pk_mul_f32 v[146:147], v[146:147], v[202:203]
  v_pk_mul_f32 v[148:149], v[204:205], v[204:205]
  v_pk_fma_f32 v[148:149], v[148:149], v[250:251], v[248:249] op_sel_hi:[1,0,0]
  v_pk_mul_f32 v[148:149], v[148:149], v[204:205]
  v_pk_mul_f32 v[150:151], v[206:207], v[206:207]
  v_pk_fma_f32 v[150:151], v[150:151], v[250:251], v[248:249] op_sel_hi:[1,0,0]
  v_pk_mul_f32 v[150:151], v[150:151], v[206:207]
  buffer_load_dwordx4 a[48:51], v3, s[4:7], s70 offen offset:2048
  v_mfma_f32_16x16x32_bf16 v[228:231], a[80:83], v[96:99], v[228:231]
  v_exp_f32 v144, v144
  v_mfma_f32_16x16x32_bf16 v[228:231], a[84:87], v[100:103], v[228:231]
  v_exp_f32 v145, v145
  v_mfma_f32_16x16x32_bf16 v[228:231], a[88:91], v[104:107], v[228:231]
  v_exp_f32 v146, v146
  v_mfma_f32_16x16x32_bf16 v[228:231], a[92:95], v[108:111], v[228:231]
  v_exp_f32 v147, v147
  v_exp_f32 v148, v148
  v_exp_f32 v149, v149
  buffer_load_dwordx4 a[52:55], v3, s[4:7], s70 offen offset:3072
  v_exp_f32 v150, v150
  v_exp_f32 v151, v151
  v_fma_f32 v144, v144, v252, v252
  v_fma_f32 v145, v145, v252, v252
  v_fma_f32 v146, v146, v252, v252
  v_fma_f32 v147, v147, v252, v252
  v_fma_f32 v148, v148, v252, v252
  v_fma_f32 v149, v149, v252, v252
  v_fma_f32 v150, v150, v252, v252
  v_fma_f32 v151, v151, v252, v252
  v_mfma_f32_16x16x32_bf16 v[232:235], a[96:99], v[92:95], v[232:235]
  s_mov_b32 s70, 253952
  buffer_load_dwordx4 a[56:59], v3, s[4:7], s70 offen offset:0
  v_rcp_f32 v144, v144
  v_rcp_f32 v145, v145
  v_rcp_f32 v146, v146
  v_rcp_f32 v147, v147
  v_rcp_f32 v148, v148
  v_rcp_f32 v149, v149
  v_rcp_f32 v150, v150
  v_rcp_f32 v151, v151
  v_mul_f32 v200, v200, v144
  v_mul_f32 v201, v201, v145
  buffer_load_dwordx4 a[60:63], v3, s[4:7], s70 offen offset:1024
  v_mul_f32 v202, v202, v146
  v_mul_f32 v203, v203, v147
  v_mul_f32 v204, v204, v148
  v_mul_f32 v205, v205, v149
  v_mul_f32 v206, v206, v150
  v_mul_f32 v207, v207, v151
  v_cvt_pk_bf16_f32 v244, v200, v201
  v_cvt_pk_bf16_f32 v245, v202, v203
  v_cvt_pk_bf16_f32 v246, v204, v205
  v_cvt_pk_bf16_f32 v247, v206, v207
  v_mfma_f32_16x16x32_bf16 v[232:235], a[100:103], v[96:99], v[232:235]
  v_or_b32 v244, v14, v244
  buffer_store_dwordx4 v[244:247], v1, s[4:7], s52 offen offset:3072 sc1
  v_mfma_f32_16x16x32_bf16 v[232:235], a[104:107], v[100:103], v[232:235]
  ds_read_b128 v[236:239], v13 offset:160
  v_mfma_f32_16x16x32_bf16 v[232:235], a[108:111], v[104:107], v[232:235]
  ds_read_b128 v[240:243], v13 offset:176
  v_mfma_f32_16x16x32_bf16 v[232:235], a[112:115], v[108:111], v[232:235]
  ds_write_b128 v4, v[152:155] offset:0
  v_mfma_f32_16x16x32_bf16 v[176:179], a[116:119], v[32:35], 0
  buffer_load_dwordx4 a[64:67], v3, s[4:7], s70 offen offset:2048
  v_mfma_f32_16x16x32_bf16 v[176:179], a[120:123], v[36:39], v[176:179]
  s_waitcnt vmcnt(13)
  v_bitop3_b32 v27, v112, v116, v120 bitop3:0x80
  v_mfma_f32_16x16x32_bf16 v[176:179], a[124:127], v[40:43], v[176:179]
  ds_write_b128 v4, v[156:159] offset:1024
  v_mfma_f32_16x16x32_bf16 v[176:179], a[128:131], v[44:47], v[176:179]
  s_waitcnt vmcnt(12)
  v_bitop3_b32 v27, v27, v124, v14 bitop3:0x2a
  v_mfma_f32_16x16x32_bf16 v[176:179], a[132:135], v[48:51], v[176:179]
  buffer_load_dwordx4 a[68:71], v3, s[4:7], s70 offen offset:3072
  v_mfma_f32_16x16x32_bf16 v[180:183], a[136:139], v[32:35], 0
  ds_write_b128 v5, v[160:163] offset:0
  v_mfma_f32_16x16x32_bf16 v[180:183], a[140:143], v[36:39], v[180:183]
  s_waitcnt lgkmcnt(4)
  v_mul_f32 v236, v28, v236
  v_mul_f32 v237, v28, v237
  v_mfma_f32_16x16x32_bf16 v[180:183], a[144:147], v[40:43], v[180:183]
  v_mul_f32 v238, v28, v238
  v_mul_f32 v239, v28, v239
  buffer_load_dwordx4 v[32:35], v1, s[4:7], s39 offen offset:0 sc1
  v_mfma_f32_16x16x32_bf16 v[180:183], a[148:151], v[44:47], v[180:183]
  s_waitcnt lgkmcnt(3)
  v_mul_f32 v240, v28, v240
  v_mul_f32 v241, v28, v241
  v_mfma_f32_16x16x32_bf16 v[180:183], a[152:155], v[48:51], v[180:183]
  v_mul_f32 v242, v28, v242
  v_mul_f32 v243, v28, v243
  v_mfma_f32_16x16x32_bf16 v[184:187], a[116:119], v[52:55], 0
  ds_write_b128 v5, v[164:167] offset:1024
  v_mfma_f32_16x16x32_bf16 v[184:187], a[120:123], v[56:59], v[184:187]
  buffer_load_dwordx4 v[36:39], v1, s[4:7], s39 offen offset:1024 sc1
  v_mfma_f32_16x16x32_bf16 v[184:187], a[124:127], v[60:63], v[184:187]
  v_cmp_ne_u32 vcc, 0, v27
  v_mfma_f32_16x16x32_bf16 v[184:187], a[128:131], v[64:67], v[184:187]
  ds_write_b128 v6, v[168:171] offset:0
  v_mfma_f32_16x16x32_bf16 v[184:187], a[132:135], v[68:71], v[184:187]
  s_cbranch_vccnz L_retry_242
L_ok_243:
  v_mfma_f32_16x16x32_bf16 v[188:191], a[136:139], v[52:55], 0
  buffer_load_dwordx4 v[40:43], v1, s[4:7], s40 offen offset:2048 sc1
  v_mfma_f32_16x16x32_bf16 v[188:191], a[140:143], v[56:59], v[188:191]
  ds_write_b128 v6, v[172:175] offset:1024
  v_mfma_f32_16x16x32_bf16 v[188:191], a[144:147], v[60:63], v[188:191]
  v_mfma_f32_16x16x32_bf16 v[188:191], a[148:151], v[64:67], v[188:191]
  v_mfma_f32_16x16x32_bf16 v[188:191], a[152:155], v[68:71], v[188:191]
  buffer_load_dwordx4 v[44:47], v1, s[4:7], s40 offen offset:3072 sc1
  v_mfma_f32_16x16x32_bf16 v[192:195], a[116:119], v[72:75], 0
  v_mfma_f32_16x16x32_bf16 v[192:195], a[120:123], v[76:79], v[192:195]
  v_mfma_f32_16x16x32_bf16 v[192:195], a[124:127], v[80:83], v[192:195]
  v_mfma_f32_16x16x32_bf16 v[192:195], a[128:131], v[84:87], v[192:195]
  buffer_load_dwordx4 v[48:51], v1, s[4:7], s42 offen offset:0 sc1
  v_mfma_f32_16x16x32_bf16 v[192:195], a[132:135], v[88:91], v[192:195]
  v_mfma_f32_16x16x32_bf16 v[196:199], a[136:139], v[72:75], 0
  v_mfma_f32_16x16x32_bf16 v[196:199], a[140:143], v[76:79], v[196:199]
  s_waitcnt lgkmcnt(0)
  s_barrier
  buffer_load_dwordx4 v[52:55], v1, s[4:7], s42 offen offset:1024 sc1
  v_mfma_f32_16x16x32_bf16 v[196:199], a[144:147], v[80:83], v[196:199]
  ds_read_b128 v[152:155], v7 offset:0
  v_mfma_f32_16x16x32_bf16 v[196:199], a[148:151], v[84:87], v[196:199]
  ds_read_b128 v[160:163], v7 offset:5120
  v_mfma_f32_16x16x32_bf16 v[196:199], a[152:155], v[88:91], v[196:199]
  ds_read_b128 v[168:171], v7 offset:10240
  v_mfma_f32_16x16x32_bf16 v[236:239], a[116:119], v[92:95], v[236:239]
  ds_read_b128 v[156:159], v7 offset:1024
  buffer_load_dwordx4 v[56:59], v1, s[4:7], s43 offen offset:2048 sc1
  v_mfma_f32_16x16x32_bf16 v[236:239], a[120:123], v[96:99], v[236:239]
  ds_read_b128 v[164:167], v7 offset:6144
  v_mfma_f32_16x16x32_bf16 v[236:239], a[124:127], v[100:103], v[236:239]
  ds_read_b128 v[172:175], v7 offset:11264
  v_mfma_f32_16x16x32_bf16 v[236:239], a[128:131], v[104:107], v[236:239]
  ds_write_b128 v4, v[176:179] offset:2048
  v_mfma_f32_16x16x32_bf16 v[236:239], a[132:135], v[108:111], v[236:239]
  buffer_load_dwordx4 v[60:63], v1, s[4:7], s43 offen offset:3072 sc1
  v_mfma_f32_16x16x32_bf16 v[240:243], a[136:139], v[92:95], v[240:243]
  v_mfma_f32_16x16x32_bf16 v[240:243], a[140:143], v[96:99], v[240:243]
  ds_write_b128 v4, v[180:183] offset:3072
  v_mfma_f32_16x16x32_bf16 v[240:243], a[144:147], v[100:103], v[240:243]
  s_waitcnt lgkmcnt(6)
  v_add_f32 v152, v152, v160
  v_add_f32 v153, v153, v161
  v_mfma_f32_16x16x32_bf16 v[240:243], a[148:151], v[104:107], v[240:243]
  buffer_load_dwordx4 v[64:67], v1, s[4:7], s45 offen offset:0 sc1
  v_mfma_f32_16x16x32_bf16 v[240:243], a[152:155], v[108:111], v[240:243]
  ds_write_b128 v5, v[184:187] offset:2048
  v_mfma_f32_16x16x32_bf16 v[128:131], a[156:159], v[112:115], 0
  v_add_f32 v154, v154, v162
  v_add_f32 v155, v155, v163
  v_mfma_f32_16x16x32_bf16 v[128:131], a[160:163], v[116:119], v[128:131]
  s_waitcnt lgkmcnt(6)
  v_add_f32 v228, v228, v168
  v_add_f32 v229, v229, v169
  v_mfma_f32_16x16x32_bf16 v[128:131], a[164:167], v[120:123], v[128:131]
  buffer_load_dwordx4 v[68:71], v1, s[4:7], s45 offen offset:1024 sc1
  v_mfma_f32_16x16x32_bf16 v[128:131], a[168:171], v[124:127], v[128:131]
  ds_write_b128 v5, v[188:191] offset:3072
  v_mfma_f32_16x16x32_bf16 v[132:135], a[172:175], v[112:115], 0
  v_add_f32 v230, v230, v170
  v_add_f32 v231, v231, v171
  v_mfma_f32_16x16x32_bf16 v[132:135], a[176:179], v[116:119], v[132:135]
  s_waitcnt lgkmcnt(5)
  v_add_f32 v156, v156, v164
  v_add_f32 v157, v157, v165
  v_mfma_f32_16x16x32_bf16 v[132:135], a[180:183], v[120:123], v[132:135]
  buffer_load_dwordx4 v[72:75], v1, s[4:7], s46 offen offset:2048 sc1
  v_mfma_f32_16x16x32_bf16 v[132:135], a[184:187], v[124:127], v[132:135]
  ds_write_b128 v6, v[192:195] offset:2048
  v_mfma_f32_16x16x32_bf16 v[136:139], a[188:191], v[112:115], 0
  v_add_f32 v158, v158, v166
  v_add_f32 v159, v159, v167
  v_mfma_f32_16x16x32_bf16 v[136:139], a[192:195], v[116:119], v[136:139]
  s_waitcnt lgkmcnt(5)
  v_add_f32 v232, v232, v172
  v_add_f32 v233, v233, v173
  ds_write_b128 v6, v[196:199] offset:3072
  buffer_load_dwordx4 v[76:79], v1, s[4:7], s46 offen offset:3072 sc1
  v_mfma_f32_16x16x32_bf16 v[136:139], a[196:199], v[120:123], v[136:139]
  v_add_f32 v234, v234, v174
  v_add_f32 v235, v235, v175
  v_mfma_f32_16x16x32_bf16 v[136:139], a[200:203], v[124:127], v[136:139]
  v_add_f32 v228, v228, v152
  v_add_f32 v229, v229, v153
  v_mfma_f32_16x16x32_bf16 v[140:143], a[204:207], v[112:115], 0
  v_add_f32 v230, v230, v154
  v_add_f32 v231, v231, v155
  v_mfma_f32_16x16x32_bf16 v[140:143], a[208:211], v[116:119], v[140:143]
  v_add_f32 v232, v232, v156
  v_add_f32 v233, v233, v157
  v_mfma_f32_16x16x32_bf16 v[140:143], a[212:215], v[120:123], v[140:143]
  buffer_load_dwordx4 v[80:83], v1, s[4:7], s36 offen offset:2048 sc1
  v_mfma_f32_16x16x32_bf16 v[140:143], a[216:219], v[124:127], v[140:143]
  v_add_f32 v234, v234, v158
  v_add_f32 v235, v235, v159
  v_pk_mul_f32 v[168:169], v[228:229], v[228:229]
  v_pk_fma_f32 v[168:169], v[168:169], v[250:251], v[248:249] op_sel_hi:[1,0,0]
  v_pk_mul_f32 v[168:169], v[168:169], v[228:229]
  v_pk_mul_f32 v[170:171], v[230:231], v[230:231]
  v_pk_fma_f32 v[170:171], v[170:171], v[250:251], v[248:249] op_sel_hi:[1,0,0]
  v_pk_mul_f32 v[170:171], v[170:171], v[230:231]
  v_pk_mul_f32 v[172:173], v[232:233], v[232:233]
  v_pk_fma_f32 v[172:173], v[172:173], v[250:251], v[248:249] op_sel_hi:[1,0,0]
  v_pk_mul_f32 v[172:173], v[172:173], v[232:233]
  v_pk_mul_f32 v[174:175], v[234:235], v[234:235]
  v_pk_fma_f32 v[174:175], v[174:175], v[250:251], v[248:249] op_sel_hi:[1,0,0]
  v_pk_mul_f32 v[174:175], v[174:175], v[234:235]
  buffer_load_dwordx4 v[84:87], v1, s[4:7], s36 offen offset:3072 sc1
  v_mfma_f32_16x16x32_bf16 v[144:147], a[220:223], v[112:115], 0
  s_waitcnt lgkmcnt(0)
  s_barrier
  v_mfma_f32_16x16x32_bf16 v[144:147], a[224:227], v[116:119], v[144:147]
  s_waitcnt vmcnt(11)
  v_bitop3_b32 v27, v32, v36, v40 bitop3:0x80
  v_mfma_f32_16x16x32_bf16 v[144:147], a[228:231], v[120:123], v[144:147]
  v_exp_f32 v168, v168
  v_mfma_f32_16x16x32_bf16 v[144:147], a[232:235], v[124:127], v[144:147]
  buffer_load_dwordx4 v[88:91], v1, s[4:7], s38 offen offset:0 sc1
  v_exp_f32 v169, v169
  v_exp_f32 v170, v170
  v_exp_f32 v171, v171
  v_exp_f32 v172, v172
  v_exp_f32 v173, v173
  s_waitcnt vmcnt(11)
  v_bitop3_b32 v27, v27, v44, v14 bitop3:0x2a
  v_cmp_ne_u32 vcc, 0, v27
  v_exp_f32 v174, v174
  s_cbranch_vccnz L_retry_244
L_ok_245:
  v_mfma_f32_16x16x32_bf16 v[148:151], a[156:159], v[32:35], 0
  buffer_load_dwordx4 v[92:95], v1, s[4:7], s38 offen offset:1024 sc1
  v_exp_f32 v175, v175
  ds_read_b128 v[176:179], v7 offset:2048
  v_fma_f32 v168, v168, v252, v252
  v_fma_f32 v169, v169, v252, v252
  v_mfma_f32_16x16x32_bf16 v[148:151], a[160:163], v[36:39], v[148:151]
  ds_read_b128 v[184:187], v7 offset:7168
  v_fma_f32 v170, v170, v252, v252
  v_fma_f32 v171, v171, v252, v252
  v_fma_f32 v172, v172, v252, v252
  ds_read_b128 v[192:195], v7 offset:12288
  v_fma_f32 v173, v173, v252, v252
  v_fma_f32 v174, v174, v252, v252
  v_fma_f32 v175, v175, v252, v252
  ds_read_b128 v[180:183], v7 offset:3072
  v_rcp_f32 v168, v168
  buffer_load_dwordx4 v[96:99], v1, s[4:7], s39 offen offset:2048 sc1
  ds_read_b128 v[188:191], v7 offset:8192
  v_rcp_f32 v169, v169
  v_rcp_f32 v170, v170
  ds_read_b128 v[196:199], v7 offset:13312
  v_rcp_f32 v171, v171
  v_rcp_f32 v172, v172
  v_rcp_f32 v173, v173
  v_rcp_f32 v174, v174
  v_rcp_f32 v175, v175
  v_mul_f32 v228, v228, v168
  v_mul_f32 v229, v229, v169
  v_mul_f32 v230, v230, v170
  buffer_load_dwordx4 v[100:103], v1, s[4:7], s39 offen offset:3072 sc1
  v_mul_f32 v231, v231, v171
  v_mul_f32 v232, v232, v172
  v_mul_f32 v233, v233, v173
  v_mul_f32 v234, v234, v174
  v_mul_f32 v235, v235, v175
  v_cvt_pk_bf16_f32 v244, v228, v229
  v_mfma_f32_16x16x32_bf16 v[148:151], a[164:167], v[40:43], v[148:151]
  v_cvt_pk_bf16_f32 v245, v230, v231
  v_cvt_pk_bf16_f32 v246, v232, v233
  v_cvt_pk_bf16_f32 v247, v234, v235
  v_or_b32 v244, v14, v244
  buffer_store_dwordx4 v[244:247], v1, s[4:7], s53 offen offset:0 sc1
  v_mfma_f32_16x16x32_bf16 v[148:151], a[168:171], v[44:47], v[148:151]
  s_waitcnt lgkmcnt(4)
  v_add_f32 v176, v176, v184
  v_add_f32 v177, v177, v185
  v_mfma_f32_16x16x32_bf16 v[152:155], a[172:175], v[32:35], 0
  s_waitcnt lgkmcnt(3)
  v_add_f32 v236, v236, v192
  v_add_f32 v237, v237, v193
  v_mfma_f32_16x16x32_bf16 v[152:155], a[176:179], v[36:39], v[152:155]
  v_add_f32 v178, v178, v186
  v_add_f32 v179, v179, v187
  v_mfma_f32_16x16x32_bf16 v[152:155], a[180:183], v[40:43], v[152:155]
  buffer_load_dwordx4 v[104:107], v1, s[4:7], s41 offen offset:0 sc1
  v_mfma_f32_16x16x32_bf16 v[152:155], a[184:187], v[44:47], v[152:155]
  v_add_f32 v238, v238, v194
  v_add_f32 v239, v239, v195
  v_mfma_f32_16x16x32_bf16 v[156:159], a[188:191], v[32:35], 0
  s_waitcnt lgkmcnt(1)
  v_add_f32 v180, v180, v188
  v_add_f32 v181, v181, v189
  v_mfma_f32_16x16x32_bf16 v[156:159], a[192:195], v[36:39], v[156:159]
  v_add_f32 v182, v182, v190
  v_add_f32 v183, v183, v191
  s_waitcnt lgkmcnt(0)
  v_add_f32 v240, v240, v196
  v_add_f32 v241, v241, v197
  v_add_f32 v242, v242, v198
  v_add_f32 v243, v243, v199
  v_add_f32 v236, v236, v176
  v_add_f32 v237, v237, v177
  v_mfma_f32_16x16x32_bf16 v[156:159], a[196:199], v[40:43], v[156:159]
  buffer_load_dwordx4 v[108:111], v1, s[4:7], s41 offen offset:1024 sc1
  v_add_f32 v238, v238, v178
  v_add_f32 v239, v239, v179
  v_add_f32 v240, v240, v180
  v_add_f32 v241, v241, v181
  v_add_f32 v242, v242, v182
  v_add_f32 v243, v243, v183
  v_mul_f32 v192, v236, v236
  v_mul_f32 v193, v237, v237
  v_mul_f32 v194, v238, v238
  v_mul_f32 v195, v239, v239
  v_mul_f32 v196, v240, v240
  v_mul_f32 v197, v241, v241
  v_mul_f32 v198, v242, v242
  v_mul_f32 v199, v243, v243
  v_fma_f32 v192, v192, v250, v248
  v_fma_f32 v193, v193, v250, v248
  v_fma_f32 v194, v194, v250, v248
  v_fma_f32 v195, v195, v250, v248
  buffer_load_dwordx4 v[112:115], v1, s[4:7], s42 offen offset:2048 sc1
  v_fma_f32 v196, v196, v250, v248
  v_fma_f32 v197, v197, v250, v248
  v_fma_f32 v198, v198, v250, v248
  v_fma_f32 v199, v199, v250, v248
  v_mul_f32 v192, v192, v236
  v_mul_f32 v193, v193, v237
  v_mul_f32 v194, v194, v238
  v_mul_f32 v195, v195, v239
  v_mul_f32 v196, v196, v240
  v_mul_f32 v197, v197, v241
  v_mul_f32 v198, v198, v242
  v_mul_f32 v199, v199, v243
  v_exp_f32 v192, v192
  v_exp_f32 v193, v193
  v_mfma_f32_16x16x32_bf16 v[156:159], a[200:203], v[44:47], v[156:159]
  buffer_load_dwordx4 v[116:119], v1, s[4:7], s42 offen offset:3072 sc1
  v_exp_f32 v194, v194
  v_exp_f32 v195, v195
  v_exp_f32 v196, v196
  v_exp_f32 v197, v197
  v_exp_f32 v198, v198
  v_exp_f32 v199, v199
  v_fma_f32 v192, v192, v252, v252
  v_fma_f32 v193, v193, v252, v252
  v_fma_f32 v194, v194, v252, v252
  v_fma_f32 v195, v195, v252, v252
  v_fma_f32 v196, v196, v252, v252
  v_fma_f32 v197, v197, v252, v252
  buffer_load_dwordx4 v[120:123], v1, s[4:7], s44 offen offset:0 sc1
  v_fma_f32 v198, v198, v252, v252
  v_fma_f32 v199, v199, v252, v252
  v_rcp_f32 v192, v192
  v_rcp_f32 v193, v193
  v_rcp_f32 v194, v194
  v_rcp_f32 v195, v195
  v_rcp_f32 v196, v196
  v_rcp_f32 v197, v197
  v_rcp_f32 v198, v198
  v_rcp_f32 v199, v199
  v_mfma_f32_16x16x32_bf16 v[160:163], a[204:207], v[32:35], 0
  buffer_load_dwordx4 v[124:127], v1, s[4:7], s44 offen offset:1024 sc1
  v_mul_f32 v236, v236, v192
  v_mul_f32 v237, v237, v193
  v_mul_f32 v238, v238, v194
  v_mul_f32 v239, v239, v195
  v_mul_f32 v240, v240, v196
  v_mul_f32 v241, v241, v197
  v_mul_f32 v242, v242, v198
  v_mul_f32 v243, v243, v199
  v_cvt_pk_bf16_f32 v244, v236, v237
  v_cvt_pk_bf16_f32 v245, v238, v239
  v_cvt_pk_bf16_f32 v246, v240, v241
  v_cvt_pk_bf16_f32 v247, v242, v243
  v_or_b32 v244, v14, v244
  buffer_store_dwordx4 v[244:247], v1, s[4:7], s53 offen offset:1024 sc1
  v_mfma_f32_16x16x32_bf16 v[160:163], a[208:211], v[36:39], v[160:163]
  s_waitcnt vmcnt(19)
  v_bitop3_b32 v27, v48, v52, v56 bitop3:0x80
  v_mfma_f32_16x16x32_bf16 v[160:163], a[212:215], v[40:43], v[160:163]
  s_waitcnt vmcnt(18)
  v_bitop3_b32 v27, v27, v60, v14 bitop3:0x2a
  v_mfma_f32_16x16x32_bf16 v[160:163], a[216:219], v[44:47], v[160:163]
  v_cmp_ne_u32 vcc, 0, v27
  v_mfma_f32_16x16x32_bf16 v[164:167], a[220:223], v[32:35], 0
  buffer_load_dwordx4 v[32:35], v1, s[4:7], s45 offen offset:2048 sc1
  v_mfma_f32_16x16x32_bf16 v[164:167], a[224:227], v[36:39], v[164:167]
  s_cbranch_vccnz L_retry_246
L_ok_247:
  v_mfma_f32_16x16x32_bf16 v[164:167], a[228:231], v[40:43], v[164:167]
  s_waitcnt vmcnt(16)
  v_bitop3_b32 v27, v64, v68, v72 bitop3:0x80
  v_mfma_f32_16x16x32_bf16 v[164:167], a[232:235], v[44:47], v[164:167]
  s_waitcnt vmcnt(15)
  v_bitop3_b32 v27, v27, v76, v14 bitop3:0x2a
  v_mfma_f32_16x16x32_bf16 v[168:171], a[156:159], v[48:51], 0
  v_cmp_ne_u32 vcc, 0, v27
  v_mfma_f32_16x16x32_bf16 v[168:171], a[160:163], v[52:55], v[168:171]
  buffer_load_dwordx4 v[36:39], v1, s[4:7], s45 offen offset:3072 sc1
  v_mfma_f32_16x16x32_bf16 v[168:171], a[164:167], v[56:59], v[168:171]
  s_cbranch_vccnz L_retry_248
L_ok_249:
  v_mfma_f32_16x16x32_bf16 v[168:171], a[168:171], v[60:63], v[168:171]
  s_waitcnt vmcnt(13)
  v_bitop3_b32 v27, v80, v84, v88 bitop3:0x80
  v_mfma_f32_16x16x32_bf16 v[172:175], a[172:175], v[48:51], 0
  s_waitcnt vmcnt(12)
  v_bitop3_b32 v27, v27, v92, v14 bitop3:0x2a
  v_mfma_f32_16x16x32_bf16 v[172:175], a[176:179], v[52:55], v[172:175]
  v_cmp_ne_u32 vcc, 0, v27
  v_mfma_f32_16x16x32_bf16 v[172:175], a[180:183], v[56:59], v[172:175]
  buffer_load_dwordx4 v[40:43], v1, s[4:7], s47 offen offset:0 sc1
  v_mfma_f32_16x16x32_bf16 v[172:175], a[184:187], v[60:63], v[172:175]
  s_cbranch_vccnz L_retry_250
L_ok_251:
  v_mfma_f32_16x16x32_bf16 v[176:179], a[188:191], v[48:51], 0
  s_barrier
  v_mfma_f32_16x16x32_bf16 v[176:179], a[192:195], v[52:55], v[176:179]
  buffer_load_dwordx4 v[44:47], v1, s[4:7], s47 offen offset:1024 sc1
  v_mfma_f32_16x16x32_bf16 v[176:179], a[196:199], v[56:59], v[176:179]
  v_mfma_f32_16x16x32_bf16 v[176:179], a[200:203], v[60:63], v[176:179]
  v_mfma_f32_16x16x32_bf16 v[180:183], a[204:207], v[48:51], 0
  v_mfma_f32_16x16x32_bf16 v[180:183], a[208:211], v[52:55], v[180:183]
  v_mfma_f32_16x16x32_bf16 v[180:183], a[212:215], v[56:59], v[180:183]
  s_mov_b32 s70, 258048
  buffer_load_dwordx4 a[72:75], v3, s[4:7], s70 offen offset:0
  v_mfma_f32_16x16x32_bf16 v[180:183], a[216:219], v[60:63], v[180:183]
  v_mfma_f32_16x16x32_bf16 v[184:187], a[220:223], v[48:51], 0
  s_waitcnt vmcnt(11)
  v_bitop3_b32 v27, v96, v100, v104 bitop3:0x80
  v_mfma_f32_16x16x32_bf16 v[184:187], a[224:227], v[52:55], v[184:187]
  v_mfma_f32_16x16x32_bf16 v[184:187], a[228:231], v[56:59], v[184:187]
  v_mfma_f32_16x16x32_bf16 v[184:187], a[232:235], v[60:63], v[184:187]
  buffer_load_dwordx4 a[76:79], v3, s[4:7], s70 offen offset:1024
  v_mfma_f32_16x16x32_bf16 v[188:191], a[156:159], v[64:67], v[208:211]
  v_mfma_f32_16x16x32_bf16 v[188:191], a[160:163], v[68:71], v[188:191]
  v_mfma_f32_16x16x32_bf16 v[188:191], a[164:167], v[72:75], v[188:191]
  s_waitcnt vmcnt(11)
  v_bitop3_b32 v27, v27, v108, v14 bitop3:0x2a
  v_mfma_f32_16x16x32_bf16 v[188:191], a[168:171], v[76:79], v[188:191]
  v_cmp_ne_u32 vcc, 0, v27
  buffer_load_dwordx4 v[48:51], v1, s[4:7], s37 offen offset:0 sc1
  v_mfma_f32_16x16x32_bf16 v[192:195], a[172:175], v[64:67], v[212:215]
  s_cbranch_vccnz L_retry_252
L_ok_253:
  v_mfma_f32_16x16x32_bf16 v[192:195], a[176:179], v[68:71], v[192:195]
  v_mfma_f32_16x16x32_bf16 v[192:195], a[180:183], v[72:75], v[192:195]
  v_mfma_f32_16x16x32_bf16 v[192:195], a[184:187], v[76:79], v[192:195]
  v_mfma_f32_16x16x32_bf16 v[196:199], a[188:191], v[64:67], v[216:219]
  buffer_load_dwordx4 a[80:83], v3, s[4:7], s70 offen offset:2048
  v_mfma_f32_16x16x32_bf16 v[196:199], a[192:195], v[68:71], v[196:199]
  v_mfma_f32_16x16x32_bf16 v[196:199], a[196:199], v[72:75], v[196:199]
  v_mfma_f32_16x16x32_bf16 v[196:199], a[200:203], v[76:79], v[196:199]
  v_mfma_f32_16x16x32_bf16 v[200:203], a[204:207], v[64:67], v[220:223]
  v_mfma_f32_16x16x32_bf16 v[200:203], a[208:211], v[68:71], v[200:203]
  buffer_load_dwordx4 a[84:87], v3, s[4:7], s70 offen offset:3072
  v_mfma_f32_16x16x32_bf16 v[200:203], a[212:215], v[72:75], v[200:203]
  v_mfma_f32_16x16x32_bf16 v[200:203], a[216:219], v[76:79], v[200:203]
  v_mfma_f32_16x16x32_bf16 v[204:207], a[220:223], v[64:67], v[224:227]
  v_mfma_f32_16x16x32_bf16 v[204:207], a[224:227], v[68:71], v[204:207]
  s_waitcnt vmcnt(11)
  v_bitop3_b32 v27, v112, v116, v120 bitop3:0x80
  v_mfma_f32_16x16x32_bf16 v[204:207], a[228:231], v[72:75], v[204:207]
  s_mov_b32 s70, 262144
  buffer_load_dwordx4 a[88:91], v3, s[4:7], s70 offen offset:0
  v_mfma_f32_16x16x32_bf16 v[204:207], a[232:235], v[76:79], v[204:207]
  v_mfma_f32_16x16x32_bf16 v[128:131], a[236:239], v[80:83], v[128:131]
  v_mfma_f32_16x16x32_bf16 v[128:131], a[240:243], v[84:87], v[128:131]
  v_mfma_f32_16x16x32_bf16 v[128:131], a[244:247], v[88:91], v[128:131]
  s_waitcnt vmcnt(11)
  v_bitop3_b32 v27, v27, v124, v14 bitop3:0x2a
  v_mfma_f32_16x16x32_bf16 v[128:131], a[248:251], v[92:95], v[128:131]
  buffer_load_dwordx4 a[92:95], v3, s[4:7], s70 offen offset:1024
  v_mfma_f32_16x16x32_bf16 v[132:135], a[0:3], v[80:83], v[132:135]
  v_cmp_ne_u32 vcc, 0, v27
  v_mfma_f32_16x16x32_bf16 v[132:135], a[4:7], v[84:87], v[132:135]
  s_cbranch_vccnz L_retry_254
L_ok_255:
  v_mfma_f32_16x16x32_bf16 v[132:135], a[8:11], v[88:91], v[132:135]
  v_mfma_f32_16x16x32_bf16 v[132:135], a[12:15], v[92:95], v[132:135]
  v_mfma_f32_16x16x32_bf16 v[136:139], a[16:19], v[80:83], v[136:139]
  buffer_load_dwordx4 a[96:99], v3, s[4:7], s70 offen offset:2048
  v_mfma_f32_16x16x32_bf16 v[136:139], a[20:23], v[84:87], v[136:139]
  v_mfma_f32_16x16x32_bf16 v[136:139], a[24:27], v[88:91], v[136:139]
  v_mfma_f32_16x16x32_bf16 v[136:139], a[28:31], v[92:95], v[136:139]
  v_mfma_f32_16x16x32_bf16 v[140:143], a[32:35], v[80:83], v[140:143]
  v_mfma_f32_16x16x32_bf16 v[140:143], a[36:39], v[84:87], v[140:143]
  buffer_load_dwordx4 a[100:103], v3, s[4:7], s70 offen offset:3072
  v_mfma_f32_16x16x32_bf16 v[140:143], a[40:43], v[88:91], v[140:143]
  v_mfma_f32_16x16x32_bf16 v[140:143], a[44:47], v[92:95], v[140:143]
  v_mfma_f32_16x16x32_bf16 v[144:147], a[48:51], v[80:83], v[144:147]
  v_mfma_f32_16x16x32_bf16 v[144:147], a[52:55], v[84:87], v[144:147]
  buffer_load_dwordx4 v[52:55], v1, s[4:7], s37 offen offset:1024 sc1
  v_mfma_f32_16x16x32_bf16 v[144:147], a[56:59], v[88:91], v[144:147]
  v_mfma_f32_16x16x32_bf16 v[144:147], a[60:63], v[92:95], v[144:147]
  v_mfma_f32_16x16x32_bf16 v[148:151], a[236:239], v[96:99], v[148:151]
  v_mfma_f32_16x16x32_bf16 v[148:151], a[240:243], v[100:103], v[148:151]
  s_waitcnt vmcnt(11)
  v_bitop3_b32 v27, v32, v36, v40 bitop3:0x80
  v_mfma_f32_16x16x32_bf16 v[148:151], a[244:247], v[104:107], v[148:151]
  buffer_load_dwordx4 v[56:59], v1, s[4:7], s38 offen offset:2048 sc1
  v_mfma_f32_16x16x32_bf16 v[148:151], a[248:251], v[108:111], v[148:151]
  v_mfma_f32_16x16x32_bf16 v[152:155], a[0:3], v[96:99], v[152:155]
  v_mfma_f32_16x16x32_bf16 v[152:155], a[4:7], v[100:103], v[152:155]
  s_waitcnt vmcnt(11)
  v_bitop3_b32 v27, v27, v44, v14 bitop3:0x2a
  v_mfma_f32_16x16x32_bf16 v[152:155], a[8:11], v[104:107], v[152:155]
  v_cmp_ne_u32 vcc, 0, v27
  buffer_load_dwordx4 v[60:63], v1, s[4:7], s38 offen offset:3072 sc1
  v_mfma_f32_16x16x32_bf16 v[152:155], a[12:15], v[108:111], v[152:155]
  s_cbranch_vccnz L_retry_256
L_ok_257:
  v_mfma_f32_16x16x32_bf16 v[156:159], a[16:19], v[96:99], v[156:159]
  v_mfma_f32_16x16x32_bf16 v[156:159], a[20:23], v[100:103], v[156:159]
  v_mfma_f32_16x16x32_bf16 v[156:159], a[24:27], v[104:107], v[156:159]
  v_mfma_f32_16x16x32_bf16 v[156:159], a[28:31], v[108:111], v[156:159]
  s_mov_b32 s70, 266240
  buffer_load_dwordx4 a[104:107], v3, s[4:7], s70 offen offset:0
  v_mfma_f32_16x16x32_bf16 v[160:163], a[32:35], v[96:99], v[160:163]
  v_mfma_f32_16x16x32_bf16 v[160:163], a[36:39], v[100:103], v[160:163]
  v_mfma_f32_16x16x32_bf16 v[160:163], a[40:43], v[104:107], v[160:163]
  v_mfma_f32_16x16x32_bf16 v[160:163], a[44:47], v[108:111], v[160:163]
  buffer_load_dwordx4 a[108:111], v3, s[4:7], s70 offen offset:1024
  v_mfma_f32_16x16x32_bf16 v[164:167], a[48:51], v[96:99], v[164:167]
  v_mfma_f32_16x16x32_bf16 v[164:167], a[52:55], v[100:103], v[164:167]
  v_mfma_f32_16x16x32_bf16 v[164:167], a[56:59], v[104:107], v[164:167]
  v_mfma_f32_16x16x32_bf16 v[164:167], a[60:63], v[108:111], v[164:167]
  buffer_load_dwordx4 a[112:115], v3, s[4:7], s70 offen offset:2048
  v_mfma_f32_16x16x32_bf16 v[168:171], a[236:239], v[112:115], v[168:171]
  v_mfma_f32_16x16x32_bf16 v[168:171], a[240:243], v[116:119], v[168:171]
  v_mfma_f32_16x16x32_bf16 v[168:171], a[244:247], v[120:123], v[168:171]
  v_mfma_f32_16x16x32_bf16 v[168:171], a[248:251], v[124:127], v[168:171]
  buffer_load_dwordx4 a[116:119], v3, s[4:7], s70 offen offset:3072
  v_mfma_f32_16x16x32_bf16 v[172:175], a[0:3], v[112:115], v[172:175]
  v_mfma_f32_16x16x32_bf16 v[172:175], a[4:7], v[116:119], v[172:175]
  v_mfma_f32_16x16x32_bf16 v[172:175], a[8:11], v[120:123], v[172:175]
  v_mfma_f32_16x16x32_bf16 v[172:175], a[12:15], v[124:127], v[172:175]
  s_mov_b32 s70, 270336
  buffer_load_dwordx4 a[120:123], v3, s[4:7], s70 offen offset:0
  v_mfma_f32_16x16x32_bf16 v[176:179], a[16:19], v[112:115], v[176:179]
  v_mfma_f32_16x16x32_bf16 v[176:179], a[20:23], v[116:119], v[176:179]
  v_mfma_f32_16x16x32_bf16 v[176:179], a[24:27], v[120:123], v[176:179]
  v_mfma_f32_16x16x32_bf16 v[176:179], a[28:31], v[124:127], v[176:179]
  buffer_load_dwordx4 a[124:127], v3, s[4:7], s70 offen offset:1024
  v_mfma_f32_16x16x32_bf16 v[180:183], a[32:35], v[112:115], v[180:183]
  v_mfma_f32_16x16x32_bf16 v[180:183], a[36:39], v[116:119], v[180:183]
  v_mfma_f32_16x16x32_bf16 v[180:183], a[40:43], v[120:123], v[180:183]
  v_mfma_f32_16x16x32_bf16 v[180:183], a[44:47], v[124:127], v[180:183]
  buffer_load_dwordx4 a[128:131], v3, s[4:7], s70 offen offset:2048
  v_mfma_f32_16x16x32_bf16 v[184:187], a[48:51], v[112:115], v[184:187]
  v_mfma_f32_16x16x32_bf16 v[184:187], a[52:55], v[116:119], v[184:187]
  v_mfma_f32_16x16x32_bf16 v[184:187], a[56:59], v[120:123], v[184:187]
  v_mfma_f32_16x16x32_bf16 v[184:187], a[60:63], v[124:127], v[184:187]
  buffer_load_dwordx4 a[132:135], v3, s[4:7], s70 offen offset:3072
  v_mfma_f32_16x16x32_bf16 v[188:191], a[236:239], v[32:35], v[188:191]
  v_mfma_f32_16x16x32_bf16 v[188:191], a[240:243], v[36:39], v[188:191]
  v_mfma_f32_16x16x32_bf16 v[188:191], a[244:247], v[40:43], v[188:191]
  v_mfma_f32_16x16x32_bf16 v[188:191], a[248:251], v[44:47], v[188:191]
  buffer_load_dwordx4 v[64:67], v1, s[4:7], s40 offen offset:0 sc1
  v_mfma_f32_16x16x32_bf16 v[192:195], a[0:3], v[32:35], v[192:195]
  v_mfma_f32_16x16x32_bf16 v[192:195], a[4:7], v[36:39], v[192:195]
  v_mfma_f32_16x16x32_bf16 v[192:195], a[8:11], v[40:43], v[192:195]
  v_mfma_f32_16x16x32_bf16 v[192:195], a[12:15], v[44:47], v[192:195]
  s_mov_b32 s70, 274432
  buffer_load_dwordx4 a[136:139], v3, s[4:7], s70 offen offset:0
  v_mfma_f32_16x16x32_bf16 v[196:199], a[16:19], v[32:35], v[196:199]
  v_mfma_f32_16x16x32_bf16 v[196:199], a[20:23], v[36:39], v[196:199]
  v_mfma_f32_16x16x32_bf16 v[196:199], a[24:27], v[40:43], v[196:199]
  v_mfma_f32_16x16x32_bf16 v[196:199], a[28:31], v[44:47], v[196:199]
  buffer_load_dwordx4 v[68:71], v1, s[4:7], s40 offen offset:1024 sc1
  v_mfma_f32_16x16x32_bf16 v[200:203], a[32:35], v[32:35], v[200:203]
  v_mfma_f32_16x16x32_bf16 v[200:203], a[36:39], v[36:39], v[200:203]
  v_mfma_f32_16x16x32_bf16 v[200:203], a[40:43], v[40:43], v[200:203]
  v_mfma_f32_16x16x32_bf16 v[200:203], a[44:47], v[44:47], v[200:203]
  buffer_load_dwordx4 v[72:75], v1, s[4:7], s41 offen offset:2048 sc1
  v_mfma_f32_16x16x32_bf16 v[204:207], a[48:51], v[32:35], v[204:207]
  s_waitcnt vmcnt(13)
  v_bitop3_b32 v27, v48, v52, v56 bitop3:0x80
  v_mfma_f32_16x16x32_bf16 v[204:207], a[52:55], v[36:39], v[204:207]
  v_mfma_f32_16x16x32_bf16 v[204:207], a[56:59], v[40:43], v[204:207]
  v_mfma_f32_16x16x32_bf16 v[204:207], a[60:63], v[44:47], v[204:207]
  buffer_load_dwordx4 a[140:143], v3, s[4:7], s70 offen offset:1024
  s_waitcnt vmcnt(13)
  v_bitop3_b32 v27, v27, v60, v14 bitop3:0x2a
  v_cmp_ne_u32 vcc, 0, v27
  s_nop 0
  s_cbranch_vccnz L_retry_258
L_ok_259:
  v_mfma_f32_16x16x32_bf16 v[128:131], a[64:67], v[48:51], v[128:131]
  v_mfma_f32_16x16x32_bf16 v[128:131], a[68:71], v[52:55], v[128:131]
  v_mfma_f32_16x16x32_bf16 v[128:131], a[72:75], v[56:59], v[128:131]
  buffer_load_dwordx4 v[76:79], v1, s[4:7], s41 offen offset:3072 sc1
  v_mfma_f32_16x16x32_bf16 v[128:131], a[76:79], v[60:63], v[128:131]
  v_mfma_f32_16x16x32_bf16 v[132:135], a[80:83], v[48:51], v[132:135]
  v_mfma_f32_16x16x32_bf16 v[132:135], a[84:87], v[52:55], v[132:135]
  v_mfma_f32_16x16x32_bf16 v[132:135], a[88:91], v[56:59], v[132:135]
  buffer_load_dwordx4 v[80:83], v1, s[4:7], s43 offen offset:0 sc1
  v_mfma_f32_16x16x32_bf16 v[132:135], a[92:95], v[60:63], v[132:135]
  v_mfma_f32_16x16x32_bf16 v[136:139], a[96:99], v[48:51], v[136:139]
  v_mfma_f32_16x16x32_bf16 v[136:139], a[100:103], v[52:55], v[136:139]
  s_waitcnt vmcnt(14)
  v_mfma_f32_16x16x32_bf16 v[136:139], a[104:107], v[56:59], v[136:139]
  ds_write_b128 v4, v[128:131] offset:0
  buffer_load_dwordx4 v[84:87], v1, s[4:7], s43 offen offset:1024 sc1
  s_waitcnt vmcnt(14)
  v_mfma_f32_16x16x32_bf16 v[136:139], a[108:111], v[60:63], v[136:139]
  s_waitcnt vmcnt(13)
  v_mfma_f32_16x16x32_bf16 v[140:143], a[112:115], v[48:51], v[140:143]
  ds_write_b128 v4, v[132:135] offset:1024
  s_waitcnt vmcnt(12)
  v_mfma_f32_16x16x32_bf16 v[140:143], a[116:119], v[52:55], v[140:143]
  buffer_load_dwordx4 v[88:91], v1, s[4:7], s44 offen offset:2048 sc1
  s_nop 1
  ds_write_b128 v4, v[136:139] offset:2048
  s_waitcnt vmcnt(12)
  v_mfma_f32_16x16x32_bf16 v[140:143], a[120:123], v[56:59], v[140:143]
  buffer_load_dwordx4 v[92:95], v1, s[4:7], s44 offen offset:3072 sc1
  s_waitcnt vmcnt(12)
  v_mfma_f32_16x16x32_bf16 v[140:143], a[124:127], v[60:63], v[140:143]
  buffer_load_dwordx4 v[96:99], v1, s[4:7], s46 offen offset:0 sc1
  s_waitcnt vmcnt(12)
  v_mfma_f32_16x16x32_bf16 v[144:147], a[128:131], v[48:51], v[144:147]
  buffer_load_dwordx4 v[100:103], v1, s[4:7], s46 offen offset:1024 sc1
  s_nop 3
  ds_write_b128 v4, v[140:143] offset:3072
  s_waitcnt vmcnt(12)
  v_mfma_f32_16x16x32_bf16 v[144:147], a[132:135], v[52:55], v[144:147]
  buffer_load_dwordx4 v[104:107], v1, s[4:7], s47 offen offset:2048 sc1
  buffer_load_dwordx4 v[108:111], v1, s[4:7], s47 offen offset:3072 sc1
  s_waitcnt vmcnt(12)
  v_mfma_f32_16x16x32_bf16 v[144:147], a[136:139], v[56:59], v[144:147]
  s_waitcnt vmcnt(10)
  v_bitop3_b32 v27, v64, v68, v72 bitop3:0x80
  s_waitcnt vmcnt(9)
  v_mfma_f32_16x16x32_bf16 v[144:147], a[140:143], v[60:63], v[144:147]
  s_waitcnt vmcnt(8)
  v_bitop3_b32 v27, v27, v76, v14 bitop3:0x2a
  v_cmp_ne_u32 vcc, 0, v27
  s_nop 0
  s_cbranch_vccnz L_retry_260
L_ok_261:
  v_mfma_f32_16x16x32_bf16 v[148:151], a[64:67], v[64:67], v[148:151]
  v_mfma_f32_16x16x32_bf16 v[148:151], a[68:71], v[68:71], v[148:151]
  v_mfma_f32_16x16x32_bf16 v[148:151], a[72:75], v[72:75], v[148:151]
  v_mfma_f32_16x16x32_bf16 v[148:151], a[76:79], v[76:79], v[148:151]
  v_mfma_f32_16x16x32_bf16 v[152:155], a[80:83], v[64:67], v[152:155]
  ds_write_b128 v4, v[144:147] offset:4096
  v_mfma_f32_16x16x32_bf16 v[152:155], a[84:87], v[68:71], v[152:155]
  v_mfma_f32_16x16x32_bf16 v[152:155], a[88:91], v[72:75], v[152:155]
  v_mfma_f32_16x16x32_bf16 v[152:155], a[92:95], v[76:79], v[152:155]
  v_mfma_f32_16x16x32_bf16 v[156:159], a[96:99], v[64:67], v[156:159]
  v_mfma_f32_16x16x32_bf16 v[156:159], a[100:103], v[68:71], v[156:159]
  v_mfma_f32_16x16x32_bf16 v[156:159], a[104:107], v[72:75], v[156:159]
  ds_write_b128 v5, v[148:151] offset:0
  v_mfma_f32_16x16x32_bf16 v[156:159], a[108:111], v[76:79], v[156:159]
  s_waitcnt vmcnt(5)
  v_bitop3_b32 v27, v80, v84, v88 bitop3:0x80
  v_mfma_f32_16x16x32_bf16 v[160:163], a[112:115], v[64:67], v[160:163]
  v_mfma_f32_16x16x32_bf16 v[160:163], a[116:119], v[68:71], v[160:163]
  ds_write_b128 v5, v[152:155] offset:1024
  v_mfma_f32_16x16x32_bf16 v[160:163], a[120:123], v[72:75], v[160:163]
  s_waitcnt vmcnt(4)
  v_bitop3_b32 v27, v27, v92, v14 bitop3:0x2a
  v_mfma_f32_16x16x32_bf16 v[160:163], a[124:127], v[76:79], v[160:163]
  v_cmp_ne_u32 vcc, 0, v27
  v_mfma_f32_16x16x32_bf16 v[164:167], a[128:131], v[64:67], v[164:167]
  s_cbranch_vccnz L_retry_262
L_ok_263:
  v_mfma_f32_16x16x32_bf16 v[164:167], a[132:135], v[68:71], v[164:167]
  ds_write_b128 v5, v[156:159] offset:2048
  v_mfma_f32_16x16x32_bf16 v[164:167], a[136:139], v[72:75], v[164:167]
  v_mfma_f32_16x16x32_bf16 v[164:167], a[140:143], v[76:79], v[164:167]
  v_mfma_f32_16x16x32_bf16 v[168:171], a[64:67], v[80:83], v[168:171]
  ds_write_b128 v5, v[160:163] offset:3072
  v_mfma_f32_16x16x32_bf16 v[168:171], a[68:71], v[84:87], v[168:171]
  v_mfma_f32_16x16x32_bf16 v[168:171], a[72:75], v[88:91], v[168:171]
  v_mfma_f32_16x16x32_bf16 v[168:171], a[76:79], v[92:95], v[168:171]
  v_mfma_f32_16x16x32_bf16 v[172:175], a[80:83], v[80:83], v[172:175]
  v_mfma_f32_16x16x32_bf16 v[172:175], a[84:87], v[84:87], v[172:175]
  s_waitcnt vmcnt(1)
  v_bitop3_b32 v27, v96, v100, v104 bitop3:0x80
  v_mfma_f32_16x16x32_bf16 v[172:175], a[88:91], v[88:91], v[172:175]
  ds_write_b128 v5, v[164:167] offset:4096
  v_mfma_f32_16x16x32_bf16 v[172:175], a[92:95], v[92:95], v[172:175]
  v_mfma_f32_16x16x32_bf16 v[176:179], a[96:99], v[80:83], v[176:179]
  v_mfma_f32_16x16x32_bf16 v[176:179], a[100:103], v[84:87], v[176:179]
  s_waitcnt vmcnt(0)
  v_bitop3_b32 v27, v27, v108, v14 bitop3:0x2a
  v_mfma_f32_16x16x32_bf16 v[176:179], a[104:107], v[88:91], v[176:179]
  v_cmp_ne_u32 vcc, 0, v27
  v_mfma_f32_16x16x32_bf16 v[176:179], a[108:111], v[92:95], v[176:179]
  s_cbranch_vccnz L_retry_264
L_ok_265:
  v_mfma_f32_16x16x32_bf16 v[180:183], a[112:115], v[80:83], v[180:183]
  ds_write_b128 v6, v[168:171] offset:0
  v_mfma_f32_16x16x32_bf16 v[180:183], a[116:119], v[84:87], v[180:183]
  v_mfma_f32_16x16x32_bf16 v[180:183], a[120:123], v[88:91], v[180:183]
  v_mfma_f32_16x16x32_bf16 v[180:183], a[124:127], v[92:95], v[180:183]
  ds_write_b128 v6, v[172:175] offset:1024
  v_mfma_f32_16x16x32_bf16 v[184:187], a[128:131], v[80:83], v[184:187]
  s_waitcnt lgkmcnt(2)
  s_barrier
  v_mfma_f32_16x16x32_bf16 v[184:187], a[132:135], v[84:87], v[184:187]
  ds_write_b128 v6, v[176:179] offset:2048
  v_mfma_f32_16x16x32_bf16 v[184:187], a[136:139], v[88:91], v[184:187]
  ds_read_b128 v[132:135], v7 offset:1024
  v_mfma_f32_16x16x32_bf16 v[184:187], a[140:143], v[92:95], v[184:187]
  ds_read_b128 v[152:155], v7 offset:6144
  v_mfma_f32_16x16x32_bf16 v[188:191], a[64:67], v[96:99], v[188:191]
  ds_write_b128 v6, v[180:183] offset:3072
  v_mfma_f32_16x16x32_bf16 v[188:191], a[68:71], v[100:103], v[188:191]
  ds_read_b128 v[136:139], v7 offset:2048
  v_mfma_f32_16x16x32_bf16 v[188:191], a[72:75], v[104:107], v[188:191]
  ds_read_b128 v[156:159], v7 offset:7168
  v_mfma_f32_16x16x32_bf16 v[188:191], a[76:79], v[108:111], v[188:191]
  ds_write_b128 v6, v[184:187] offset:4096
  ds_read_b128 v[140:143], v7 offset:3072
  v_mfma_f32_16x16x32_bf16 v[192:195], a[80:83], v[96:99], v[192:195]
  ds_read_b128 v[160:163], v7 offset:8192
  v_mfma_f32_16x16x32_bf16 v[192:195], a[84:87], v[100:103], v[192:195]
  ds_read_b128 v[144:147], v7 offset:4096
  v_mfma_f32_16x16x32_bf16 v[192:195], a[88:91], v[104:107], v[192:195]
  ds_read_b128 v[164:167], v7 offset:9216
  v_mfma_f32_16x16x32_bf16 v[192:195], a[92:95], v[108:111], v[192:195]
  s_waitcnt lgkmcnt(8)
  v_add_f32 v132, v132, v152
  ds_read_b128 v[128:131], v7 offset:0
  v_mfma_f32_16x16x32_bf16 v[196:199], a[96:99], v[96:99], v[196:199]
  v_add_f32 v133, v133, v153
  ds_read_b128 v[148:151], v7 offset:5120
  v_mfma_f32_16x16x32_bf16 v[196:199], a[100:103], v[100:103], v[196:199]
  v_add_f32 v134, v134, v154
  v_add_f32 v135, v135, v155
  v_mfma_f32_16x16x32_bf16 v[196:199], a[104:107], v[104:107], v[196:199]
  v_add_f32 v192, v192, v132
  v_add_f32 v193, v193, v133
  v_mfma_f32_16x16x32_bf16 v[196:199], a[108:111], v[108:111], v[196:199]
  s_waitcnt lgkmcnt(7)
  v_add_f32 v136, v136, v156
  v_add_f32 v137, v137, v157
  v_mfma_f32_16x16x32_bf16 v[200:203], a[112:115], v[96:99], v[200:203]
  v_add_f32 v138, v138, v158
  v_add_f32 v139, v139, v159
  v_mfma_f32_16x16x32_bf16 v[200:203], a[116:119], v[100:103], v[200:203]
  v_add_f32 v194, v194, v134
  v_add_f32 v195, v195, v135
  v_mfma_f32_16x16x32_bf16 v[200:203], a[120:123], v[104:107], v[200:203]
  s_waitcnt lgkmcnt(4)
  v_add_f32 v140, v140, v160
  v_add_f32 v141, v141, v161
  v_mfma_f32_16x16x32_bf16 v[200:203], a[124:127], v[108:111], v[200:203]
  v_add_f32 v142, v142, v162
  v_add_f32 v143, v143, v163
  v_mfma_f32_16x16x32_bf16 v[204:207], a[128:131], v[96:99], v[204:207]
  s_waitcnt lgkmcnt(2)
  v_add_f32 v144, v144, v164
  v_add_f32 v145, v145, v165
  v_mfma_f32_16x16x32_bf16 v[204:207], a[132:135], v[100:103], v[204:207]
  v_add_f32 v146, v146, v166
  v_add_f32 v147, v147, v167
  v_mfma_f32_16x16x32_bf16 v[204:207], a[136:139], v[104:107], v[204:207]
  s_waitcnt lgkmcnt(0)
  s_barrier
  ds_read_b128 v[172:175], v7 offset:11264
  v_mfma_f32_16x16x32_bf16 v[204:207], a[140:143], v[108:111], v[204:207]
  v_add_f32 v196, v196, v136
  ds_read_b128 v[176:179], v7 offset:12288
  v_add_f32 v197, v197, v137
  v_add_f32 v198, v198, v138
  v_add_f32 v199, v199, v139
  ds_read_b128 v[180:183], v7 offset:13312
  v_add_f32 v200, v200, v140
  v_add_f32 v201, v201, v141
  v_add_f32 v202, v202, v142
  ds_read_b128 v[184:187], v7 offset:14336
  v_add_f32 v203, v203, v143
  v_add_f32 v204, v204, v144
  v_add_f32 v205, v205, v145
  ds_read_b128 v[168:171], v7 offset:10240
  v_add_f32 v206, v206, v146
  v_add_f32 v207, v207, v147
  v_add_f32 v128, v128, v148
  v_add_f32 v129, v129, v149
  v_add_f32 v130, v130, v150
  v_add_f32 v131, v131, v151
  v_add_f32 v188, v188, v128
  v_add_f32 v189, v189, v129
  v_add_f32 v190, v190, v130
  v_add_f32 v191, v191, v131
  s_waitcnt lgkmcnt(4)
  v_pk_add_f32 v[192:193], v[192:193], v[172:173]
  v_pk_add_f32 v[194:195], v[194:195], v[174:175]
  s_waitcnt lgkmcnt(3)
  v_pk_add_f32 v[196:197], v[196:197], v[176:177]
  v_pk_add_f32 v[198:199], v[198:199], v[178:179]
  s_waitcnt lgkmcnt(2)
  v_pk_add_f32 v[200:201], v[200:201], v[180:181]
  v_pk_add_f32 v[202:203], v[202:203], v[182:183]
  s_waitcnt lgkmcnt(1)
  v_pk_add_f32 v[204:205], v[204:205], v[184:185]
  v_pk_add_f32 v[206:207], v[206:207], v[186:187]
  v_cvt_pk_bf16_f32 v130, v192, v193
  v_cvt_pk_bf16_f32 v131, v194, v195
  s_waitcnt lgkmcnt(0)
  v_add_f32 v188, v188, v168
  v_add_f32 v189, v189, v169
  v_add_f32 v190, v190, v170
  v_add_f32 v191, v191, v171
  v_cvt_pk_bf16_f32 v132, v196, v197
  v_cvt_pk_bf16_f32 v133, v198, v199
  v_cvt_pk_bf16_f32 v134, v200, v201
  v_cvt_pk_bf16_f32 v135, v202, v203
  buffer_store_dwordx4 v[132:135], v255, s[8:11], 0 offen offset:16 nt
  v_cvt_pk_bf16_f32 v136, v204, v205
  v_cvt_pk_bf16_f32 v137, v206, v207
  v_cvt_pk_bf16_f32 v128, v188, v189
  v_cvt_pk_bf16_f32 v129, v190, v191
  buffer_store_dwordx2 v[136:137], v255, s[8:11], 0 offen offset:32 nt
  buffer_store_dwordx4 v[128:131], v255, s[8:11], 0 offen nt
  s_or_b32 s84, s12, s15
  s_cbranch_scc1 L_main_exit
  v_mov_b32 v27, s68
  v_mov_b32 v2, 0
  s_mov_b32 s84, 9027584
  buffer_store_dword v27, v2, s[4:7], s84 offen sc1
L_main_exit:
  s_endpgm
L_start_1_to:
  s_mov_b32 s69, 0
  s_branch L_start_1_d
L_slow_8:
  s_nop 3
  buffer_store_dwordx4 v[148:151], v1, s[4:7], s49 offen offset:1024 sc1
  s_branch L_back_9
L_slow_10:
  s_nop 3
  buffer_store_dwordx4 v[152:155], v1, s[4:7], s49 offen offset:2048 sc1
  s_branch L_back_11
L_slow_12:
  s_nop 3
  buffer_store_dwordx4 v[156:159], v254, s[4:7], s49 offen sc1
  s_branch L_back_13
L_slow_28:
  s_nop 3
  buffer_store_dwordx4 v[148:151], v1, s[4:7], s48 offen offset:1024 sc1
  s_branch L_back_29
L_slow_30:
  s_nop 3
  buffer_store_dwordx4 v[152:155], v1, s[4:7], s48 offen offset:2048 sc1
  s_branch L_back_31
L_slow_32:
  s_nop 3
  buffer_store_dwordx4 v[156:159], v254, s[4:7], s48 offen sc1
  s_branch L_back_33
L_slow_34:
  s_nop 3
  buffer_store_dword v116, v26, s[4:7], s58 offen sc1
  s_branch L_back_35
L_slow_52:
  s_nop 3
  buffer_store_dwordx4 v[148:151], v1, s[4:7], s49 offen offset:1024 sc1
  s_branch L_back_53
L_slow_55:
  s_nop 3
  buffer_store_dwordx4 v[152:155], v1, s[4:7], s49 offen offset:2048 sc1
  s_branch L_back_56
L_slow_58:
  s_nop 3
  buffer_store_dwordx4 v[156:159], v254, s[4:7], s49 offen sc1
  s_branch L_back_59
L_slow_75:
  s_nop 3
  buffer_store_dwordx4 v[148:151], v1, s[4:7], s48 offen offset:1024 sc1
  s_branch L_back_76
L_slow_77:
  s_nop 3
  buffer_store_dwordx4 v[152:155], v1, s[4:7], s48 offen offset:2048 sc1
  s_branch L_back_78
L_slow_79:
  s_nop 3
  buffer_store_dwordx4 v[156:159], v254, s[4:7], s48 offen sc1
  s_branch L_back_80
L_slow_81:
  s_nop 3
  buffer_store_dword v116, v26, s[4:7], s59 offen sc1
  s_branch L_back_82
L_slow_123:
  s_nop 3
  buffer_store_dwordx4 v[148:151], v1, s[4:7], s49 offen offset:1024 sc1
  s_branch L_back_124
L_slow_125:
  s_nop 3
  buffer_store_dwordx4 v[152:155], v1, s[4:7], s49 offen offset:2048 sc1
  s_branch L_back_126
L_slow_127:
  s_nop 3
  buffer_store_dwordx4 v[156:159], v254, s[4:7], s49 offen sc1
  s_branch L_back_128
L_slow_129:
  s_nop 3
  buffer_store_dword v116, v26, s[4:7], s57 offen sc1
  s_branch L_back_130
L_slow_151:
  s_nop 3
  buffer_store_dwordx4 v[148:151], v1, s[4:7], s48 offen offset:1024 sc1
  s_branch L_back_152
L_slow_153:
  s_nop 3
  buffer_store_dwordx4 v[152:155], v1, s[4:7], s48 offen offset:2048 sc1
  s_branch L_back_154
L_slow_155:
  s_nop 3
  buffer_store_dwordx4 v[156:159], v254, s[4:7], s48 offen sc1
  s_branch L_back_156
L_slow_171:
  s_nop 3
  buffer_store_dwordx4 v[148:151], v1, s[4:7], s49 offen offset:1024 sc1
  s_branch L_back_172
L_slow_173:
  s_nop 3
  buffer_store_dwordx4 v[152:155], v1, s[4:7], s49 offen offset:2048 sc1
  s_branch L_back_174
L_slow_175:
  s_nop 3
  buffer_store_dwordx4 v[156:159], v254, s[4:7], s49 offen sc1
  s_branch L_back_176
L_slow_177:
  s_nop 3
  buffer_store_dword v116, v26, s[4:7], s58 offen sc1
  s_branch L_back_178
L_slow_195:
  s_nop 3
  buffer_store_dwordx4 v[148:151], v1, s[4:7], s48 offen offset:1024 sc1
  s_branch L_back_196
L_slow_198:
  s_nop 3
  buffer_store_dwordx4 v[152:155], v1, s[4:7], s48 offen offset:2048 sc1
  s_branch L_back_199
L_slow_201:
  s_nop 3
  buffer_store_dwordx4 v[156:159], v254, s[4:7], s48 offen sc1
  s_branch L_back_202
L_slow_218:
  s_nop 3
  buffer_store_dwordx4 v[148:151], v1, s[4:7], s49 offen offset:1024 sc1
  s_branch L_back_219
L_slow_220:
  s_nop 3
  buffer_store_dwordx4 v[152:155], v1, s[4:7], s49 offen offset:2048 sc1
  s_branch L_back_221
L_slow_222:
  s_nop 3
  buffer_store_dwordx4 v[156:159], v254, s[4:7], s49 offen sc1
  s_branch L_back_223
L_slow_224:
  s_nop 3
  buffer_store_dword v116, v26, s[4:7], s59 offen sc1
  s_branch L_back_225
L_retry_4_to:
  s_mov_b32 s69, 0
  s_waitcnt vmcnt(0)
  s_branch L_ok_5
L_retry_6_to:
  s_mov_b32 s69, 0
  s_waitcnt vmcnt(0)
  s_branch L_ok_7
L_retry_14_to:
  s_mov_b32 s69, 0
  s_waitcnt vmcnt(0)
  s_branch L_ok_15
L_retry_16_to:
  s_mov_b32 s69, 0
  s_waitcnt vmcnt(0)
  s_branch L_ok_17
L_retry_18_to:
  s_mov_b32 s69, 0
  s_waitcnt vmcnt(0)
  s_branch L_ok_19
L_retry_20_to:
  s_mov_b32 s69, 0
  s_waitcnt vmcnt(0)
  s_branch L_ok_21
L_retry_22_to:
  s_mov_b32 s69, 0
  s_waitcnt vmcnt(0)
  s_branch L_ok_23
L_retry_36_to:
  s_mov_b32 s69, 0
  s_waitcnt vmcnt(0)
  s_branch L_ok_37
L_retry_38_to:
  s_mov_b32 s69, 0
  s_waitcnt vmcnt(0)
  s_branch L_ok_39
L_retry_40_to:
  s_mov_b32 s69, 0
  s_waitcnt vmcnt(0)
  s_branch L_ok_41
L_retry_42_to:
  s_mov_b32 s69, 0
  s_waitcnt vmcnt(0)
  s_branch L_ok_43
L_retry_44_to:
  s_mov_b32 s69, 0
  s_waitcnt vmcnt(0)
  s_branch L_ok_45
L_retry_48_to:
  s_mov_b32 s69, 0
  s_waitcnt vmcnt(0)
  s_branch L_ok_49
L_retry_61_to:
  s_mov_b32 s69, 0
  s_waitcnt vmcnt(0)
  s_branch L_ok_62
L_retry_63_to:
  s_mov_b32 s69, 0
  s_waitcnt vmcnt(0)
  s_branch L_ok_64
L_retry_65_to:
  s_mov_b32 s69, 0
  s_waitcnt vmcnt(0)
  s_branch L_ok_66
L_retry_67_to:
  s_mov_b32 s69, 0
  s_waitcnt vmcnt(0)
  s_branch L_ok_68
L_retry_69_to:
  s_mov_b32 s69, 0
  s_waitcnt vmcnt(0)
  s_branch L_ok_70
L_retry_71_to:
  s_mov_b32 s69, 0
  s_waitcnt vmcnt(0)
  s_branch L_ok_72
L_retry_73_to:
  s_mov_b32 s69, 0
  s_waitcnt vmcnt(0)
  s_branch L_ok_74
L_retry_83_to:
  s_mov_b32 s69, 0
  s_waitcnt vmcnt(0)
  s_branch L_ok_84
L_retry_85_to:
  s_mov_b32 s69, 0
  s_waitcnt vmcnt(0)
  s_branch L_ok_86
L_retry_87_to:
  s_mov_b32 s69, 0
  s_waitcnt vmcnt(0)
  s_branch L_ok_88
L_retry_89_to:
  s_mov_b32 s69, 0
  s_waitcnt vmcnt(0)
  s_branch L_ok_90
L_retry_91_to:
  s_mov_b32 s69, 0
  s_waitcnt vmcnt(0)
  s_branch L_ok_92
L_retry_95_to:
  s_mov_b32 s69, 0
  s_waitcnt vmcnt(0)
  s_branch L_ok_96
L_retry_131_to:
  s_mov_b32 s69, 0
  s_waitcnt vmcnt(0)
  s_branch L_ok_132
L_retry_133_to:
  s_mov_b32 s69, 0
  s_waitcnt vmcnt(0)
  s_branch L_ok_134
L_retry_135_to:
  s_mov_b32 s69, 0
  s_waitcnt vmcnt(0)
  s_branch L_ok_136
L_retry_137_to:
  s_mov_b32 s69, 0
  s_waitcnt vmcnt(0)
  s_branch L_ok_138
L_retry_139_to:
  s_mov_b32 s69, 0
  s_waitcnt vmcnt(0)
  s_branch L_ok_140
L_retry_143_to:
  s_mov_b32 s69, 0
  s_waitcnt vmcnt(0)
  s_branch L_ok_144
L_retry_147_to:
  s_mov_b32 s69, 0
  s_waitcnt vmcnt(0)
  s_branch L_ok_148
L_retry_149_to:
  s_mov_b32 s69, 0
  s_waitcnt vmcnt(0)
  s_branch L_ok_150
L_retry_157_to:
  s_mov_b32 s69, 0
  s_waitcnt vmcnt(0)
  s_branch L_ok_158
L_retry_159_to:
  s_mov_b32 s69, 0
  s_waitcnt vmcnt(0)
  s_branch L_ok_160
L_retry_161_to:
  s_mov_b32 s69, 0
  s_waitcnt vmcnt(0)
  s_branch L_ok_162
L_retry_163_to:
  s_mov_b32 s69, 0
  s_waitcnt vmcnt(0)
  s_branch L_ok_164
L_retry_165_to:
  s_mov_b32 s69, 0
  s_waitcnt vmcnt(0)
  s_branch L_ok_166
L_retry_179_to:
  s_mov_b32 s69, 0
  s_waitcnt vmcnt(0)
  s_branch L_ok_180
L_retry_181_to:
  s_mov_b32 s69, 0
  s_waitcnt vmcnt(0)
  s_branch L_ok_182
L_retry_183_to:
  s_mov_b32 s69, 0
  s_waitcnt vmcnt(0)
  s_branch L_ok_184
L_retry_185_to:
  s_mov_b32 s69, 0
  s_waitcnt vmcnt(0)
  s_branch L_ok_186
L_retry_187_to:
  s_mov_b32 s69, 0
  s_waitcnt vmcnt(0)
  s_branch L_ok_188
L_retry_191_to:
  s_mov_b32 s69, 0
  s_waitcnt vmcnt(0)
  s_branch L_ok_192
L_retry_204_to:
  s_mov_b32 s69, 0
  s_waitcnt vmcnt(0)
  s_branch L_ok_205
L_retry_206_to:
  s_mov_b32 s69, 0
  s_waitcnt vmcnt(0)
  s_branch L_ok_207
L_retry_208_to:
  s_mov_b32 s69, 0
  s_waitcnt vmcnt(0)
  s_branch L_ok_209
L_retry_210_to:
  s_mov_b32 s69, 0
  s_waitcnt vmcnt(0)
  s_branch L_ok_211
L_retry_212_to:
  s_mov_b32 s69, 0
  s_waitcnt vmcnt(0)
  s_branch L_ok_213
L_retry_214_to:
  s_mov_b32 s69, 0
  s_waitcnt vmcnt(0)
  s_branch L_ok_215
L_retry_216_to:
  s_mov_b32 s69, 0
  s_waitcnt vmcnt(0)
  s_branch L_ok_217
L_retry_226_to:
  s_mov_b32 s69, 0
  s_waitcnt vmcnt(0)
  s_branch L_ok_227
L_retry_228_to:
  s_mov_b32 s69, 0
  s_waitcnt vmcnt(0)
  s_branch L_ok_229
L_retry_230_to:
  s_mov_b32 s69, 0
  s_waitcnt vmcnt(0)
  s_branch L_ok_231
L_retry_232_to:
  s_mov_b32 s69, 0
  s_waitcnt vmcnt(0)
  s_branch L_ok_233
L_retry_234_to:
  s_mov_b32 s69, 0
  s_waitcnt vmcnt(0)
  s_branch L_ok_235
L_retry_238_to:
  s_mov_b32 s69, 0
  s_waitcnt vmcnt(0)
  s_branch L_ok_239
L_retry_2:
  s_sub_u32 s69, s69, 1
  s_cbranch_scc1 L_retry_2_to
  buffer_load_dwordx2 v[120:121], v122, s[4:7], s76 offen sc1
  s_waitcnt vmcnt(0)
  v_cmp_ne_u32 vcc, s68, v120
  s_nop 1
  s_cbranch_vccnz L_retry_2
  s_branch L_ok_3
L_retry_2_to:
  s_mov_b32 s69, 0
  s_waitcnt vmcnt(0)
  s_branch L_ok_3
L_retry_24:
  s_sub_u32 s69, s69, 1
  s_cbranch_scc1 L_retry_24_to
  buffer_load_dwordx4 v[72:75], v1, s[4:7], s22 offen offset:0 sc1
  buffer_load_dwordx4 v[84:87], v1, s[4:7], s22 offen offset:3072 sc1
  buffer_load_dwordx4 v[76:79], v1, s[4:7], s22 offen offset:1024 sc1
  buffer_load_dwordx4 v[88:91], v1, s[4:7], s30 offen offset:0 sc1
  buffer_load_dwordx4 v[80:83], v1, s[4:7], s22 offen offset:2048 sc1
  s_waitcnt vmcnt(0)
  v_bitop3_b32 v27, v72, v84, v76 bitop3:0x80
  v_bitop3_b32 v27, v27, v88, v80 bitop3:0x80
  v_bitop3_b32 v27, v27, v27, v14 bitop3:0x2a
  v_cmp_ne_u32 vcc, 0, v27
  s_nop 1
  s_cbranch_vccnz L_retry_24
  v_bitop3_b32 v27, v92, v104, v96 bitop3:0x80
  v_bitop3_b32 v27, v27, v108, v100 bitop3:0x80
  v_bitop3_b32 v27, v27, v27, v14 bitop3:0x2a
  v_cmp_ne_u32 vcc, 0, v27
  s_nop 1
  s_cbranch_vccz L_ok_25
  buffer_load_dwordx4 v[92:95], v1, s[4:7], s23 offen offset:0 sc1
  buffer_load_dwordx4 v[104:107], v1, s[4:7], s23 offen offset:3072 sc1
  buffer_load_dwordx4 v[96:99], v1, s[4:7], s23 offen offset:1024 sc1
  buffer_load_dwordx4 v[108:111], v1, s[4:7], s31 offen offset:0 sc1
  buffer_load_dwordx4 v[100:103], v1, s[4:7], s23 offen offset:2048 sc1
  buffer_load_dword a253, v26, s[4:7], s76 offen
  buffer_load_dword a253, v26, s[4:7], s76 offen
  buffer_load_dword a253, v26, s[4:7], s76 offen
  buffer_load_dword a253, v26, s[4:7], s76 offen
  buffer_load_dword a253, v26, s[4:7], s76 offen
  s_branch L_ok_25
L_retry_24_to:
  s_mov_b32 s69, 0
  s_waitcnt vmcnt(0)
  s_branch L_ok_25
L_retry_26:
  s_sub_u32 s69, s69, 1
  s_cbranch_scc1 L_retry_26_to
  buffer_load_dwordx4 v[92:95], v1, s[4:7], s23 offen offset:0 sc1
  buffer_load_dwordx4 v[104:107], v1, s[4:7], s23 offen offset:3072 sc1
  buffer_load_dwordx4 v[96:99], v1, s[4:7], s23 offen offset:1024 sc1
  buffer_load_dwordx4 v[108:111], v1, s[4:7], s31 offen offset:0 sc1
  buffer_load_dwordx4 v[100:103], v1, s[4:7], s23 offen offset:2048 sc1
  s_waitcnt vmcnt(0)
  v_bitop3_b32 v27, v92, v104, v96 bitop3:0x80
  v_bitop3_b32 v27, v27, v108, v100 bitop3:0x80
  v_bitop3_b32 v27, v27, v27, v14 bitop3:0x2a
  v_cmp_ne_u32 vcc, 0, v27
  s_nop 1
  s_cbranch_vccnz L_retry_26
  s_branch L_ok_27
L_retry_26_to:
  s_mov_b32 s69, 0
  s_waitcnt vmcnt(0)
  s_branch L_ok_27
L_retry_46:
  s_sub_u32 s69, s69, 1
  s_cbranch_scc1 L_retry_46_to
  buffer_load_dwordx4 v[72:75], v1, s[4:7], s18 offen offset:0 sc1
  buffer_load_dwordx4 v[84:87], v1, s[4:7], s18 offen offset:3072 sc1
  buffer_load_dwordx4 v[76:79], v1, s[4:7], s18 offen offset:1024 sc1
  buffer_load_dwordx4 v[88:91], v1, s[4:7], s26 offen offset:0 sc1
  buffer_load_dwordx4 v[80:83], v1, s[4:7], s18 offen offset:2048 sc1
  s_waitcnt vmcnt(0)
  v_bitop3_b32 v27, v72, v84, v76 bitop3:0x80
  v_bitop3_b32 v27, v27, v88, v80 bitop3:0x80
  v_bitop3_b32 v27, v27, v27, v14 bitop3:0x2a
  v_cmp_ne_u32 vcc, 0, v27
  s_nop 1
  s_cbranch_vccnz L_retry_46
  v_bitop3_b32 v27, v112, v114, v92 bitop3:0x80
  v_bitop3_b32 v27, v27, v104, v96 bitop3:0x80
  v_bitop3_b32 v27, v27, v27, v14 bitop3:0x2a
  v_cmp_ne_u32 vcc, 0, v27
  s_nop 1
  s_cbranch_vccz L_ok_47
  buffer_load_dwordx2 v[112:113], v15, s[4:7], s55 offen offset:0 sc1
  buffer_load_dwordx2 v[114:115], v15, s[4:7], s55 offen offset:512 sc1
  buffer_load_dwordx4 v[92:95], v1, s[4:7], s19 offen offset:0 sc1
  buffer_load_dwordx4 v[104:107], v1, s[4:7], s19 offen offset:3072 sc1
  buffer_load_dwordx4 v[96:99], v1, s[4:7], s19 offen offset:1024 sc1
  s_branch L_ok_47
L_retry_46_to:
  s_mov_b32 s69, 0
  s_waitcnt vmcnt(0)
  s_branch L_ok_47
L_retry_50:
  s_sub_u32 s69, s69, 1
  s_cbranch_scc1 L_retry_50_to
  buffer_load_dwordx4 v[92:95], v1, s[4:7], s19 offen offset:0 sc1
  buffer_load_dwordx4 v[104:107], v1, s[4:7], s19 offen offset:3072 sc1
  buffer_load_dwordx4 v[96:99], v1, s[4:7], s19 offen offset:1024 sc1
  buffer_load_dwordx4 v[108:111], v1, s[4:7], s27 offen offset:0 sc1
  buffer_load_dwordx4 v[100:103], v1, s[4:7], s19 offen offset:2048 sc1
  s_waitcnt vmcnt(0)
  v_bitop3_b32 v27, v92, v104, v96 bitop3:0x80
  v_bitop3_b32 v27, v27, v108, v100 bitop3:0x80
  v_bitop3_b32 v27, v27, v27, v14 bitop3:0x2a
  v_cmp_ne_u32 vcc, 0, v27
  s_nop 1
  s_cbranch_vccnz L_retry_50
  s_branch L_ok_51
L_retry_50_to:
  s_mov_b32 s69, 0
  s_waitcnt vmcnt(0)
  s_branch L_ok_51
L_retry_93:
  s_sub_u32 s69, s69, 1
  s_cbranch_scc1 L_retry_93_to
  buffer_load_dwordx4 v[72:75], v1, s[4:7], s18 offen offset:0 sc1
  buffer_load_dwordx4 v[84:87], v1, s[4:7], s18 offen offset:3072 sc1
  buffer_load_dwordx4 v[76:79], v1, s[4:7], s18 offen offset:1024 sc1
  buffer_load_dwordx4 v[88:91], v1, s[4:7], s26 offen offset:0 sc1
  buffer_load_dwordx4 v[80:83], v1, s[4:7], s18 offen offset:2048 sc1
  s_waitcnt vmcnt(0)
  v_bitop3_b32 v27, v72, v84, v76 bitop3:0xfe
  v_bitop3_b32 v27, v27, v88, v80 bitop3:0xfe
  v_bitop3_b32 v27, v27, v27, v14 bitop3:0xa8
  v_cmp_ne_u32 vcc, 0, v27
  s_nop 1
  s_cbranch_vccnz L_retry_93
  v_bitop3_b32 v27, v112, v114, v92 bitop3:0xfe
  v_bitop3_b32 v27, v27, v104, v96 bitop3:0xfe
  v_bitop3_b32 v27, v27, v108, v14 bitop3:0xa8
  v_cmp_ne_u32 vcc, 0, v27
  s_nop 1
  s_cbranch_vccz L_ok_94
  buffer_load_dwordx2 v[112:113], v15, s[4:7], s56 offen offset:0 sc1
  buffer_load_dwordx2 v[114:115], v15, s[4:7], s56 offen offset:512 sc1
  buffer_load_dwordx4 v[92:95], v1, s[4:7], s19 offen offset:0 sc1
  buffer_load_dwordx4 v[104:107], v1, s[4:7], s19 offen offset:3072 sc1
  buffer_load_dwordx4 v[96:99], v1, s[4:7], s19 offen offset:1024 sc1
  buffer_load_dwordx4 v[108:111], v1, s[4:7], s27 offen offset:0 sc1
  s_branch L_ok_94
L_retry_93_to:
  s_mov_b32 s69, 0
  s_waitcnt vmcnt(0)
  s_branch L_ok_94
L_retry_97:
  s_sub_u32 s69, s69, 1
  s_cbranch_scc1 L_retry_97_to
  buffer_load_dwordx4 v[92:95], v1, s[4:7], s19 offen offset:0 sc1
  buffer_load_dwordx4 v[104:107], v1, s[4:7], s19 offen offset:3072 sc1
  buffer_load_dwordx4 v[96:99], v1, s[4:7], s19 offen offset:1024 sc1
  buffer_load_dwordx4 v[108:111], v1, s[4:7], s27 offen offset:0 sc1
  buffer_load_dwordx4 v[100:103], v1, s[4:7], s19 offen offset:2048 sc1
  s_waitcnt vmcnt(0)
  v_bitop3_b32 v27, v92, v104, v96 bitop3:0xfe
  v_bitop3_b32 v27, v27, v108, v100 bitop3:0xfe
  v_bitop3_b32 v27, v27, v27, v14 bitop3:0xa8
  v_cmp_ne_u32 vcc, 0, v27
  s_nop 1
  s_cbranch_vccnz L_retry_97
  s_branch L_ok_98
L_retry_97_to:
  s_mov_b32 s69, 0
  s_waitcnt vmcnt(0)
  s_branch L_ok_98
L_retry_99:
  s_sub_u32 s69, s69, 1
  s_cbranch_scc1 L_retry_99_to
  buffer_load_dwordx4 v[112:115], v1, s[4:7], s36 offen offset:0 sc1
  buffer_load_dwordx4 v[116:119], v1, s[4:7], s36 offen offset:1024 sc1
  buffer_load_dwordx4 v[120:123], v1, s[4:7], s37 offen offset:2048 sc1
  buffer_load_dwordx4 v[124:127], v1, s[4:7], s37 offen offset:3072 sc1
  s_waitcnt vmcnt(0)
  v_bitop3_b32 v27, v112, v116, v120 bitop3:0xfe
  v_bitop3_b32 v27, v27, v124, v14 bitop3:0xa8
  v_cmp_ne_u32 vcc, 0, v27
  s_nop 1
  s_cbranch_vccnz L_retry_99
  v_bitop3_b32 v27, v32, v36, v14 bitop3:0xa8
  v_cmp_ne_u32 vcc, 0, v27
  s_nop 1
  s_cbranch_vccz L_ok_100
  buffer_load_dwordx4 v[32:35], v1, s[4:7], s39 offen offset:0 sc1
  buffer_load_dwordx4 v[36:39], v1, s[4:7], s39 offen offset:1024 sc1
  s_branch L_ok_100
L_retry_99_to:
  s_mov_b32 s69, 0
  s_waitcnt vmcnt(0)
  s_branch L_ok_100
L_retry_101:
  s_sub_u32 s69, s69, 1
  s_cbranch_scc1 L_retry_101_to
  buffer_load_dwordx4 v[32:35], v1, s[4:7], s39 offen offset:0 sc1
  buffer_load_dwordx4 v[36:39], v1, s[4:7], s39 offen offset:1024 sc1
  buffer_load_dwordx4 v[40:43], v1, s[4:7], s40 offen offset:2048 sc1
  buffer_load_dwordx4 v[44:47], v1, s[4:7], s40 offen offset:3072 sc1
  s_waitcnt vmcnt(0)
  v_bitop3_b32 v27, v32, v36, v40 bitop3:0xfe
  v_bitop3_b32 v27, v27, v44, v14 bitop3:0xa8
  v_cmp_ne_u32 vcc, 0, v27
  s_nop 1
  s_cbranch_vccnz L_retry_101
  v_bitop3_b32 v27, v48, v52, v56 bitop3:0xfe
  v_bitop3_b32 v27, v27, v60, v64 bitop3:0xfe
  v_bitop3_b32 v27, v27, v68, v72 bitop3:0xfe
  v_bitop3_b32 v27, v27, v76, v80 bitop3:0xfe
  v_bitop3_b32 v27, v27, v84, v88 bitop3:0xfe
  v_bitop3_b32 v27, v27, v27, v14 bitop3:0xa8
  v_cmp_ne_u32 vcc, 0, v27
  s_nop 1
  s_cbranch_vccz L_ok_102
  buffer_load_dwordx4 v[48:51], v1, s[4:7], s42 offen offset:0 sc1
  buffer_load_dwordx4 v[52:55], v1, s[4:7], s42 offen offset:1024 sc1
  buffer_load_dwordx4 v[56:59], v1, s[4:7], s43 offen offset:2048 sc1
  buffer_load_dwordx4 v[60:63], v1, s[4:7], s43 offen offset:3072 sc1
  buffer_load_dwordx4 v[64:67], v1, s[4:7], s45 offen offset:0 sc1
  buffer_load_dwordx4 v[68:71], v1, s[4:7], s45 offen offset:1024 sc1
  buffer_load_dwordx4 v[72:75], v1, s[4:7], s46 offen offset:2048 sc1
  buffer_load_dwordx4 v[76:79], v1, s[4:7], s46 offen offset:3072 sc1
  buffer_load_dwordx4 v[80:83], v1, s[4:7], s36 offen offset:2048 sc1
  buffer_load_dwordx4 v[84:87], v1, s[4:7], s36 offen offset:3072 sc1
  buffer_load_dwordx4 v[88:91], v1, s[4:7], s38 offen offset:0 sc1
  s_branch L_ok_102
L_retry_101_to:
  s_mov_b32 s69, 0
  s_waitcnt vmcnt(0)
  s_branch L_ok_102
L_retry_103:
  s_sub_u32 s69, s69, 1
  s_cbranch_scc1 L_retry_103_to
  buffer_load_dwordx4 v[48:51], v1, s[4:7], s42 offen offset:0 sc1
  buffer_load_dwordx4 v[52:55], v1, s[4:7], s42 offen offset:1024 sc1
  buffer_load_dwordx4 v[56:59], v1, s[4:7], s43 offen offset:2048 sc1
  buffer_load_dwordx4 v[60:63], v1, s[4:7], s43 offen offset:3072 sc1
  s_waitcnt vmcnt(0)
  v_bitop3_b32 v27, v48, v52, v56 bitop3:0xfe
  v_bitop3_b32 v27, v27, v60, v14 bitop3:0xa8
  v_cmp_ne_u32 vcc, 0, v27
  s_nop 1
  s_cbranch_vccnz L_retry_103
  s_branch L_ok_104
L_retry_103_to:
  s_mov_b32 s69, 0
  s_waitcnt vmcnt(0)
  s_branch L_ok_104
L_retry_105:
  s_sub_u32 s69, s69, 1
  s_cbranch_scc1 L_retry_105_to
  buffer_load_dwordx4 v[64:67], v1, s[4:7], s45 offen offset:0 sc1
  buffer_load_dwordx4 v[68:71], v1, s[4:7], s45 offen offset:1024 sc1
  buffer_load_dwordx4 v[72:75], v1, s[4:7], s46 offen offset:2048 sc1
  buffer_load_dwordx4 v[76:79], v1, s[4:7], s46 offen offset:3072 sc1
  s_waitcnt vmcnt(0)
  v_bitop3_b32 v27, v64, v68, v72 bitop3:0xfe
  v_bitop3_b32 v27, v27, v76, v14 bitop3:0xa8
  v_cmp_ne_u32 vcc, 0, v27
  s_nop 1
  s_cbranch_vccnz L_retry_105
  v_bitop3_b32 v27, v80, v84, v88 bitop3:0xfe
  v_bitop3_b32 v27, v27, v92, v96 bitop3:0xfe
  v_bitop3_b32 v27, v27, v100, v104 bitop3:0xfe
  v_bitop3_b32 v27, v27, v108, v112 bitop3:0xfe
  v_bitop3_b32 v27, v27, v116, v120 bitop3:0xfe
  v_bitop3_b32 v27, v27, v124, v32 bitop3:0xfe
  v_bitop3_b32 v27, v27, v36, v14 bitop3:0xa8
  v_cmp_ne_u32 vcc, 0, v27
  s_nop 1
  s_cbranch_vccz L_ok_106
  buffer_load_dwordx4 v[80:83], v1, s[4:7], s36 offen offset:2048 sc1
  buffer_load_dwordx4 v[84:87], v1, s[4:7], s36 offen offset:3072 sc1
  buffer_load_dwordx4 v[88:91], v1, s[4:7], s38 offen offset:0 sc1
  buffer_load_dwordx4 v[92:95], v1, s[4:7], s38 offen offset:1024 sc1
  buffer_load_dwordx4 v[96:99], v1, s[4:7], s39 offen offset:2048 sc1
  buffer_load_dwordx4 v[100:103], v1, s[4:7], s39 offen offset:3072 sc1
  buffer_load_dword a253, v26, s[4:7], s76 offen
  buffer_load_dwordx4 v[104:107], v1, s[4:7], s41 offen offset:0 sc1
  buffer_load_dwordx4 v[108:111], v1, s[4:7], s41 offen offset:1024 sc1
  buffer_load_dwordx4 v[112:115], v1, s[4:7], s42 offen offset:2048 sc1
  buffer_load_dwordx4 v[116:119], v1, s[4:7], s42 offen offset:3072 sc1
  buffer_load_dwordx4 v[120:123], v1, s[4:7], s44 offen offset:0 sc1
  buffer_load_dwordx4 v[124:127], v1, s[4:7], s44 offen offset:1024 sc1
  buffer_load_dword a253, v26, s[4:7], s76 offen
  buffer_load_dwordx4 v[32:35], v1, s[4:7], s45 offen offset:2048 sc1
  buffer_load_dwordx4 v[36:39], v1, s[4:7], s45 offen offset:3072 sc1
  s_branch L_ok_106
L_retry_105_to:
  s_mov_b32 s69, 0
  s_waitcnt vmcnt(0)
  s_branch L_ok_106
L_retry_107:
  s_sub_u32 s69, s69, 1
  s_cbranch_scc1 L_retry_107_to
  buffer_load_dwordx4 v[80:83], v1, s[4:7], s36 offen offset:2048 sc1
  buffer_load_dwordx4 v[84:87], v1, s[4:7], s36 offen offset:3072 sc1
  buffer_load_dwordx4 v[88:91], v1, s[4:7], s38 offen offset:0 sc1
  buffer_load_dwordx4 v[92:95], v1, s[4:7], s38 offen offset:1024 sc1
  s_waitcnt vmcnt(0)
  v_bitop3_b32 v27, v80, v84, v88 bitop3:0xfe
  v_bitop3_b32 v27, v27, v92, v14 bitop3:0xa8
  v_cmp_ne_u32 vcc, 0, v27
  s_nop 1
  s_cbranch_vccnz L_retry_107
  v_bitop3_b32 v27, v96, v100, v104 bitop3:0xfe
  v_bitop3_b32 v27, v27, v108, v112 bitop3:0xfe
  v_bitop3_b32 v27, v27, v116, v120 bitop3:0xfe
  v_bitop3_b32 v27, v27, v124, v32 bitop3:0xfe
  v_bitop3_b32 v27, v27, v36, v40 bitop3:0xfe
  v_bitop3_b32 v27, v27, v27, v14 bitop3:0xa8
  v_cmp_ne_u32 vcc, 0, v27
  s_nop 1
  s_cbranch_vccz L_ok_108
  buffer_load_dwordx4 v[96:99], v1, s[4:7], s39 offen offset:2048 sc1
  buffer_load_dwordx4 v[100:103], v1, s[4:7], s39 offen offset:3072 sc1
  buffer_load_dword a253, v26, s[4:7], s76 offen
  buffer_load_dwordx4 v[104:107], v1, s[4:7], s41 offen offset:0 sc1
  buffer_load_dwordx4 v[108:111], v1, s[4:7], s41 offen offset:1024 sc1
  buffer_load_dwordx4 v[112:115], v1, s[4:7], s42 offen offset:2048 sc1
  buffer_load_dwordx4 v[116:119], v1, s[4:7], s42 offen offset:3072 sc1
  buffer_load_dwordx4 v[120:123], v1, s[4:7], s44 offen offset:0 sc1
  buffer_load_dwordx4 v[124:127], v1, s[4:7], s44 offen offset:1024 sc1
  buffer_load_dword a253, v26, s[4:7], s76 offen
  buffer_load_dwordx4 v[32:35], v1, s[4:7], s45 offen offset:2048 sc1
  buffer_load_dwordx4 v[36:39], v1, s[4:7], s45 offen offset:3072 sc1
  buffer_load_dwordx4 v[40:43], v1, s[4:7], s47 offen offset:0 sc1
  s_branch L_ok_108
L_retry_107_to:
  s_mov_b32 s69, 0
  s_waitcnt vmcnt(0)
  s_branch L_ok_108
L_retry_109:
  s_sub_u32 s69, s69, 1
  s_cbranch_scc1 L_retry_109_to
  buffer_load_dwordx4 v[96:99], v1, s[4:7], s39 offen offset:2048 sc1
  buffer_load_dwordx4 v[100:103], v1, s[4:7], s39 offen offset:3072 sc1
  buffer_load_dwordx4 v[104:107], v1, s[4:7], s41 offen offset:0 sc1
  buffer_load_dwordx4 v[108:111], v1, s[4:7], s41 offen offset:1024 sc1
  s_waitcnt vmcnt(0)
  v_bitop3_b32 v27, v96, v100, v104 bitop3:0xfe
  v_bitop3_b32 v27, v27, v108, v14 bitop3:0xa8
  v_cmp_ne_u32 vcc, 0, v27
  s_nop 1
  s_cbranch_vccnz L_retry_109
  v_bitop3_b32 v27, v112, v116, v120 bitop3:0xfe
  v_bitop3_b32 v27, v27, v124, v32 bitop3:0xfe
  v_bitop3_b32 v27, v27, v36, v40 bitop3:0xfe
  v_bitop3_b32 v27, v27, v44, v14 bitop3:0xa8
  v_cmp_ne_u32 vcc, 0, v27
  s_nop 1
  s_cbranch_vccz L_ok_110
  buffer_load_dwordx4 v[112:115], v1, s[4:7], s42 offen offset:2048 sc1
  buffer_load_dwordx4 v[116:119], v1, s[4:7], s42 offen offset:3072 sc1
  buffer_load_dwordx4 v[120:123], v1, s[4:7], s44 offen offset:0 sc1
  buffer_load_dwordx4 v[124:127], v1, s[4:7], s44 offen offset:1024 sc1
  buffer_load_dword a253, v26, s[4:7], s76 offen
  buffer_load_dwordx4 v[32:35], v1, s[4:7], s45 offen offset:2048 sc1
  buffer_load_dwordx4 v[36:39], v1, s[4:7], s45 offen offset:3072 sc1
  buffer_load_dwordx4 v[40:43], v1, s[4:7], s47 offen offset:0 sc1
  buffer_load_dwordx4 v[44:47], v1, s[4:7], s47 offen offset:1024 sc1
  buffer_load_dword a253, v26, s[4:7], s76 offen
  buffer_load_dword a253, v26, s[4:7], s76 offen
  s_branch L_ok_110
L_retry_109_to:
  s_mov_b32 s69, 0
  s_waitcnt vmcnt(0)
  s_branch L_ok_110
L_retry_111:
  s_sub_u32 s69, s69, 1
  s_cbranch_scc1 L_retry_111_to
  buffer_load_dwordx4 v[112:115], v1, s[4:7], s42 offen offset:2048 sc1
  buffer_load_dwordx4 v[116:119], v1, s[4:7], s42 offen offset:3072 sc1
  buffer_load_dwordx4 v[120:123], v1, s[4:7], s44 offen offset:0 sc1
  buffer_load_dwordx4 v[124:127], v1, s[4:7], s44 offen offset:1024 sc1
  s_waitcnt vmcnt(0)
  v_bitop3_b32 v27, v112, v116, v120 bitop3:0xfe
  v_bitop3_b32 v27, v27, v124, v14 bitop3:0xa8
  v_cmp_ne_u32 vcc, 0, v27
  s_nop 1
  s_cbranch_vccnz L_retry_111
  v_bitop3_b32 v27, v32, v36, v40 bitop3:0xfe
  v_bitop3_b32 v27, v27, v44, v48 bitop3:0xfe
  v_bitop3_b32 v27, v27, v27, v14 bitop3:0xa8
  v_cmp_ne_u32 vcc, 0, v27
  s_nop 1
  s_cbranch_vccz L_ok_112
  buffer_load_dwordx4 v[32:35], v1, s[4:7], s45 offen offset:2048 sc1
  buffer_load_dwordx4 v[36:39], v1, s[4:7], s45 offen offset:3072 sc1
  buffer_load_dwordx4 v[40:43], v1, s[4:7], s47 offen offset:0 sc1
  buffer_load_dwordx4 v[44:47], v1, s[4:7], s47 offen offset:1024 sc1
  buffer_load_dword a253, v26, s[4:7], s76 offen
  buffer_load_dword a253, v26, s[4:7], s76 offen
  buffer_load_dwordx4 v[48:51], v1, s[4:7], s37 offen offset:0 sc1
  buffer_load_dword a253, v26, s[4:7], s76 offen
  buffer_load_dword a253, v26, s[4:7], s76 offen
  buffer_load_dword a253, v26, s[4:7], s76 offen
  buffer_load_dword a253, v26, s[4:7], s76 offen
  s_branch L_ok_112
L_retry_111_to:
  s_mov_b32 s69, 0
  s_waitcnt vmcnt(0)
  s_branch L_ok_112
L_retry_113:
  s_sub_u32 s69, s69, 1
  s_cbranch_scc1 L_retry_113_to
  buffer_load_dwordx4 v[32:35], v1, s[4:7], s45 offen offset:2048 sc1
  buffer_load_dwordx4 v[36:39], v1, s[4:7], s45 offen offset:3072 sc1
  buffer_load_dwordx4 v[40:43], v1, s[4:7], s47 offen offset:0 sc1
  buffer_load_dwordx4 v[44:47], v1, s[4:7], s47 offen offset:1024 sc1
  s_waitcnt vmcnt(0)
  v_bitop3_b32 v27, v32, v36, v40 bitop3:0xfe
  v_bitop3_b32 v27, v27, v44, v14 bitop3:0xa8
  v_cmp_ne_u32 vcc, 0, v27
  s_nop 1
  s_cbranch_vccnz L_retry_113
  v_bitop3_b32 v27, v48, v52, v56 bitop3:0xfe
  v_bitop3_b32 v27, v27, v60, v14 bitop3:0xa8
  v_cmp_ne_u32 vcc, 0, v27
  s_nop 1
  s_cbranch_vccz L_ok_114
  buffer_load_dwordx4 v[48:51], v1, s[4:7], s37 offen offset:0 sc1
  buffer_load_dword a253, v26, s[4:7], s76 offen
  buffer_load_dword a253, v26, s[4:7], s76 offen
  buffer_load_dword a253, v26, s[4:7], s76 offen
  buffer_load_dword a253, v26, s[4:7], s76 offen
  buffer_load_dword a253, v26, s[4:7], s76 offen
  buffer_load_dword a253, v26, s[4:7], s76 offen
  buffer_load_dwordx4 v[52:55], v1, s[4:7], s37 offen offset:1024 sc1
  buffer_load_dwordx4 v[56:59], v1, s[4:7], s38 offen offset:2048 sc1
  buffer_load_dwordx4 v[60:63], v1, s[4:7], s38 offen offset:3072 sc1
  s_branch L_ok_114
L_retry_113_to:
  s_mov_b32 s69, 0
  s_waitcnt vmcnt(0)
  s_branch L_ok_114
L_retry_115:
  s_sub_u32 s69, s69, 1
  s_cbranch_scc1 L_retry_115_to
  buffer_load_dwordx4 v[48:51], v1, s[4:7], s37 offen offset:0 sc1
  buffer_load_dwordx4 v[52:55], v1, s[4:7], s37 offen offset:1024 sc1
  buffer_load_dwordx4 v[56:59], v1, s[4:7], s38 offen offset:2048 sc1
  buffer_load_dwordx4 v[60:63], v1, s[4:7], s38 offen offset:3072 sc1
  s_waitcnt vmcnt(0)
  v_bitop3_b32 v27, v48, v52, v56 bitop3:0xfe
  v_bitop3_b32 v27, v27, v60, v14 bitop3:0xa8
  v_cmp_ne_u32 vcc, 0, v27
  s_nop 1
  s_cbranch_vccnz L_retry_115
  v_bitop3_b32 v27, v64, v68, v72 bitop3:0xfe
  v_bitop3_b32 v27, v27, v27, v14 bitop3:0xa8
  v_cmp_ne_u32 vcc, 0, v27
  s_nop 1
  s_cbranch_vccz L_ok_116
  buffer_load_dwordx4 v[64:67], v1, s[4:7], s40 offen offset:0 sc1
  buffer_load_dword a253, v26, s[4:7], s76 offen
  buffer_load_dwordx4 v[68:71], v1, s[4:7], s40 offen offset:1024 sc1
  buffer_load_dwordx4 v[72:75], v1, s[4:7], s41 offen offset:2048 sc1
  buffer_load_dword a253, v26, s[4:7], s76 offen
  s_branch L_ok_116
L_retry_115_to:
  s_mov_b32 s69, 0
  s_waitcnt vmcnt(0)
  s_branch L_ok_116
L_retry_117:
  s_sub_u32 s69, s69, 1
  s_cbranch_scc1 L_retry_117_to
  buffer_load_dwordx4 v[64:67], v1, s[4:7], s40 offen offset:0 sc1
  buffer_load_dwordx4 v[68:71], v1, s[4:7], s40 offen offset:1024 sc1
  buffer_load_dwordx4 v[72:75], v1, s[4:7], s41 offen offset:2048 sc1
  buffer_load_dwordx4 v[76:79], v1, s[4:7], s41 offen offset:3072 sc1
  s_waitcnt vmcnt(0)
  v_bitop3_b32 v27, v64, v68, v72 bitop3:0xfe
  v_bitop3_b32 v27, v27, v76, v14 bitop3:0xa8
  v_cmp_ne_u32 vcc, 0, v27
  s_nop 1
  s_cbranch_vccnz L_retry_117
  v_bitop3_b32 v27, v80, v84, v88 bitop3:0xfe
  v_bitop3_b32 v27, v27, v92, v96 bitop3:0xfe
  v_bitop3_b32 v27, v27, v100, v104 bitop3:0xfe
  v_bitop3_b32 v27, v27, v108, v14 bitop3:0xa8
  v_cmp_ne_u32 vcc, 0, v27
  s_nop 1
  s_cbranch_vccz L_ok_118
  buffer_load_dwordx4 v[80:83], v1, s[4:7], s43 offen offset:0 sc1
  buffer_load_dwordx4 v[84:87], v1, s[4:7], s43 offen offset:1024 sc1
  buffer_load_dwordx4 v[88:91], v1, s[4:7], s44 offen offset:2048 sc1
  buffer_load_dwordx4 v[92:95], v1, s[4:7], s44 offen offset:3072 sc1
  buffer_load_dword a253, v26, s[4:7], s76 offen
  buffer_load_dwordx4 v[96:99], v1, s[4:7], s46 offen offset:0 sc1
  buffer_load_dwordx4 v[100:103], v1, s[4:7], s46 offen offset:1024 sc1
  buffer_load_dwordx4 v[104:107], v1, s[4:7], s47 offen offset:2048 sc1
  buffer_load_dwordx4 v[108:111], v1, s[4:7], s47 offen offset:3072 sc1
  buffer_load_dword a253, v26, s[4:7], s76 offen
  buffer_load_dword a253, v26, s[4:7], s76 offen
  buffer_load_dword a253, v26, s[4:7], s76 offen
  buffer_load_dword a253, v26, s[4:7], s76 offen
  s_branch L_ok_118
L_retry_117_to:
  s_mov_b32 s69, 0
  s_waitcnt vmcnt(0)
  s_branch L_ok_118
L_retry_119:
  s_sub_u32 s69, s69, 1
  s_cbranch_scc1 L_retry_119_to
  buffer_load_dwordx4 v[80:83], v1, s[4:7], s43 offen offset:0 sc1
  buffer_load_dwordx4 v[84:87], v1, s[4:7], s43 offen offset:1024 sc1
  buffer_load_dwordx4 v[88:91], v1, s[4:7], s44 offen offset:2048 sc1
  buffer_load_dwordx4 v[92:95], v1, s[4:7], s44 offen offset:3072 sc1
  s_waitcnt vmcnt(0)
  v_bitop3_b32 v27, v80, v84, v88 bitop3:0xfe
  v_bitop3_b32 v27, v27, v92, v14 bitop3:0xa8
  v_cmp_ne_u32 vcc, 0, v27
  s_nop 1
  s_cbranch_vccnz L_retry_119
  v_bitop3_b32 v27, v96, v100, v104 bitop3:0xfe
  v_bitop3_b32 v27, v27, v108, v14 bitop3:0xa8
  v_cmp_ne_u32 vcc, 0, v27
  s_nop 1
  s_cbranch_vccz L_ok_120
  buffer_load_dwordx4 v[96:99], v1, s[4:7], s46 offen offset:0 sc1
  buffer_load_dwordx4 v[100:103], v1, s[4:7], s46 offen offset:1024 sc1
  buffer_load_dwordx4 v[104:107], v1, s[4:7], s47 offen offset:2048 sc1
  buffer_load_dwordx4 v[108:111], v1, s[4:7], s47 offen offset:3072 sc1
  buffer_load_dword a253, v26, s[4:7], s76 offen
  buffer_load_dword a253, v26, s[4:7], s76 offen
  buffer_load_dword a253, v26, s[4:7], s76 offen
  buffer_load_dword a253, v26, s[4:7], s76 offen
  buffer_load_dword a253, v26, s[4:7], s76 offen
  buffer_load_dword a253, v26, s[4:7], s76 offen
  buffer_load_dword a253, v26, s[4:7], s76 offen
  buffer_load_dword a253, v26, s[4:7], s76 offen
  s_branch L_ok_120
L_retry_119_to:
  s_mov_b32 s69, 0
  s_waitcnt vmcnt(0)
  s_branch L_ok_120
L_retry_121:
  s_sub_u32 s69, s69, 1
  s_cbranch_scc1 L_retry_121_to
  buffer_load_dwordx4 v[96:99], v1, s[4:7], s46 offen offset:0 sc1
  buffer_load_dwordx4 v[100:103], v1, s[4:7], s46 offen offset:1024 sc1
  buffer_load_dwordx4 v[104:107], v1, s[4:7], s47 offen offset:2048 sc1
  buffer_load_dwordx4 v[108:111], v1, s[4:7], s47 offen offset:3072 sc1
  s_waitcnt vmcnt(0)
  v_bitop3_b32 v27, v96, v100, v104 bitop3:0xfe
  v_bitop3_b32 v27, v27, v108, v14 bitop3:0xa8
  v_cmp_ne_u32 vcc, 0, v27
  s_nop 1
  s_cbranch_vccnz L_retry_121
  s_branch L_ok_122
L_retry_121_to:
  s_mov_b32 s69, 0
  s_waitcnt vmcnt(0)
  s_branch L_ok_122
L_retry_141:
  s_sub_u32 s69, s69, 1
  s_cbranch_scc1 L_retry_141_to
  buffer_load_dwordx4 v[72:75], v1, s[4:7], s22 offen offset:0 sc1
  buffer_load_dwordx4 v[84:87], v1, s[4:7], s22 offen offset:3072 sc1
  buffer_load_dwordx4 v[76:79], v1, s[4:7], s22 offen offset:1024 sc1
  buffer_load_dwordx4 v[88:91], v1, s[4:7], s30 offen offset:0 sc1
  buffer_load_dwordx4 v[80:83], v1, s[4:7], s22 offen offset:2048 sc1
  s_waitcnt vmcnt(0)
  v_bitop3_b32 v27, v72, v84, v76 bitop3:0x80
  v_bitop3_b32 v27, v27, v88, v80 bitop3:0x80
  v_bitop3_b32 v27, v27, v27, v14 bitop3:0x2a
  v_cmp_ne_u32 vcc, 0, v27
  s_nop 1
  s_cbranch_vccnz L_retry_141
  v_bitop3_b32 v27, v112, v114, v92 bitop3:0x80
  v_bitop3_b32 v27, v27, v104, v96 bitop3:0x80
  v_bitop3_b32 v27, v27, v108, v100 bitop3:0x80
  v_bitop3_b32 v27, v27, v27, v14 bitop3:0x2a
  v_cmp_ne_u32 vcc, 0, v27
  s_nop 1
  s_cbranch_vccz L_ok_142
  buffer_load_dwordx2 v[112:113], v15, s[4:7], s54 offen offset:0 sc1
  buffer_load_dwordx2 v[114:115], v15, s[4:7], s54 offen offset:512 sc1
  buffer_load_dwordx4 v[92:95], v1, s[4:7], s23 offen offset:0 sc1
  buffer_load_dwordx4 v[104:107], v1, s[4:7], s23 offen offset:3072 sc1
  buffer_load_dwordx4 v[96:99], v1, s[4:7], s23 offen offset:1024 sc1
  buffer_load_dwordx4 v[108:111], v1, s[4:7], s31 offen offset:0 sc1
  buffer_load_dwordx4 v[100:103], v1, s[4:7], s23 offen offset:2048 sc1
  buffer_load_dword a253, v26, s[4:7], s76 offen
  buffer_load_dword a253, v26, s[4:7], s76 offen
  buffer_load_dword a253, v26, s[4:7], s76 offen
  buffer_load_dword a253, v26, s[4:7], s76 offen
  buffer_load_dword a253, v26, s[4:7], s76 offen
  s_branch L_ok_142
L_retry_141_to:
  s_mov_b32 s69, 0
  s_waitcnt vmcnt(0)
  s_branch L_ok_142
L_retry_145:
  s_sub_u32 s69, s69, 1
  s_cbranch_scc1 L_retry_145_to
  buffer_load_dwordx4 v[92:95], v1, s[4:7], s23 offen offset:0 sc1
  buffer_load_dwordx4 v[104:107], v1, s[4:7], s23 offen offset:3072 sc1
  buffer_load_dwordx4 v[96:99], v1, s[4:7], s23 offen offset:1024 sc1
  buffer_load_dwordx4 v[108:111], v1, s[4:7], s31 offen offset:0 sc1
  buffer_load_dwordx4 v[100:103], v1, s[4:7], s23 offen offset:2048 sc1
  s_waitcnt vmcnt(0)
  v_bitop3_b32 v27, v92, v104, v96 bitop3:0x80
  v_bitop3_b32 v27, v27, v108, v100 bitop3:0x80
  v_bitop3_b32 v27, v27, v27, v14 bitop3:0x2a
  v_cmp_ne_u32 vcc, 0, v27
  s_nop 1
  s_cbranch_vccnz L_retry_145
  s_branch L_ok_146
L_retry_145_to:
  s_mov_b32 s69, 0
  s_waitcnt vmcnt(0)
  s_branch L_ok_146
L_retry_167:
  s_sub_u32 s69, s69, 1
  s_cbranch_scc1 L_retry_167_to
  buffer_load_dwordx4 v[72:75], v1, s[4:7], s18 offen offset:0 sc1
  buffer_load_dwordx4 v[84:87], v1, s[4:7], s18 offen offset:3072 sc1
  buffer_load_dwordx4 v[76:79], v1, s[4:7], s18 offen offset:1024 sc1
  buffer_load_dwordx4 v[88:91], v1, s[4:7], s26 offen offset:0 sc1
  buffer_load_dwordx4 v[80:83], v1, s[4:7], s18 offen offset:2048 sc1
  s_waitcnt vmcnt(0)
  v_bitop3_b32 v27, v72, v84, v76 bitop3:0x80
  v_bitop3_b32 v27, v27, v88, v80 bitop3:0x80
  v_bitop3_b32 v27, v27, v27, v14 bitop3:0x2a
  v_cmp_ne_u32 vcc, 0, v27
  s_nop 1
  s_cbranch_vccnz L_retry_167
  v_bitop3_b32 v27, v92, v104, v96 bitop3:0x80
  v_bitop3_b32 v27, v27, v108, v100 bitop3:0x80
  v_bitop3_b32 v27, v27, v27, v14 bitop3:0x2a
  v_cmp_ne_u32 vcc, 0, v27
  s_nop 1
  s_cbranch_vccz L_ok_168
  buffer_load_dwordx4 v[92:95], v1, s[4:7], s19 offen offset:0 sc1
  buffer_load_dwordx4 v[104:107], v1, s[4:7], s19 offen offset:3072 sc1
  buffer_load_dwordx4 v[96:99], v1, s[4:7], s19 offen offset:1024 sc1
  buffer_load_dwordx4 v[108:111], v1, s[4:7], s27 offen offset:0 sc1
  buffer_load_dwordx4 v[100:103], v1, s[4:7], s19 offen offset:2048 sc1
  s_branch L_ok_168
L_retry_167_to:
  s_mov_b32 s69, 0
  s_waitcnt vmcnt(0)
  s_branch L_ok_168
L_retry_169:
  s_sub_u32 s69, s69, 1
  s_cbranch_scc1 L_retry_169_to
  buffer_load_dwordx4 v[92:95], v1, s[4:7], s19 offen offset:0 sc1
  buffer_load_dwordx4 v[104:107], v1, s[4:7], s19 offen offset:3072 sc1
  buffer_load_dwordx4 v[96:99], v1, s[4:7], s19 offen offset:1024 sc1
  buffer_load_dwordx4 v[108:111], v1, s[4:7], s27 offen offset:0 sc1
  buffer_load_dwordx4 v[100:103], v1, s[4:7], s19 offen offset:2048 sc1
  s_waitcnt vmcnt(0)
  v_bitop3_b32 v27, v92, v104, v96 bitop3:0x80
  v_bitop3_b32 v27, v27, v108, v100 bitop3:0x80
  v_bitop3_b32 v27, v27, v27, v14 bitop3:0x2a
  v_cmp_ne_u32 vcc, 0, v27
  s_nop 1
  s_cbranch_vccnz L_retry_169
  s_branch L_ok_170
L_retry_169_to:
  s_mov_b32 s69, 0
  s_waitcnt vmcnt(0)
  s_branch L_ok_170
L_retry_189:
  s_sub_u32 s69, s69, 1
  s_cbranch_scc1 L_retry_189_to
  buffer_load_dwordx4 v[72:75], v1, s[4:7], s22 offen offset:0 sc1
  buffer_load_dwordx4 v[84:87], v1, s[4:7], s22 offen offset:3072 sc1
  buffer_load_dwordx4 v[76:79], v1, s[4:7], s22 offen offset:1024 sc1
  buffer_load_dwordx4 v[88:91], v1, s[4:7], s30 offen offset:0 sc1
  buffer_load_dwordx4 v[80:83], v1, s[4:7], s22 offen offset:2048 sc1
  s_waitcnt vmcnt(0)
  v_bitop3_b32 v27, v72, v84, v76 bitop3:0xfe
  v_bitop3_b32 v27, v27, v88, v80 bitop3:0xfe
  v_bitop3_b32 v27, v27, v27, v14 bitop3:0xa8
  v_cmp_ne_u32 vcc, 0, v27
  s_nop 1
  s_cbranch_vccnz L_retry_189
  v_bitop3_b32 v27, v112, v114, v92 bitop3:0xfe
  v_bitop3_b32 v27, v27, v104, v96 bitop3:0xfe
  v_bitop3_b32 v27, v27, v27, v14 bitop3:0xa8
  v_cmp_ne_u32 vcc, 0, v27
  s_nop 1
  s_cbranch_vccz L_ok_190
  buffer_load_dwordx2 v[112:113], v15, s[4:7], s55 offen offset:0 sc1
  buffer_load_dwordx2 v[114:115], v15, s[4:7], s55 offen offset:512 sc1
  buffer_load_dwordx4 v[92:95], v1, s[4:7], s23 offen offset:0 sc1
  buffer_load_dwordx4 v[104:107], v1, s[4:7], s23 offen offset:3072 sc1
  buffer_load_dwordx4 v[96:99], v1, s[4:7], s23 offen offset:1024 sc1
  s_branch L_ok_190
L_retry_189_to:
  s_mov_b32 s69, 0
  s_waitcnt vmcnt(0)
  s_branch L_ok_190
L_retry_193:
  s_sub_u32 s69, s69, 1
  s_cbranch_scc1 L_retry_193_to
  buffer_load_dwordx4 v[92:95], v1, s[4:7], s23 offen offset:0 sc1
  buffer_load_dwordx4 v[104:107], v1, s[4:7], s23 offen offset:3072 sc1
  buffer_load_dwordx4 v[96:99], v1, s[4:7], s23 offen offset:1024 sc1
  buffer_load_dwordx4 v[108:111], v1, s[4:7], s31 offen offset:0 sc1
  buffer_load_dwordx4 v[100:103], v1, s[4:7], s23 offen offset:2048 sc1
  s_waitcnt vmcnt(0)
  v_bitop3_b32 v27, v92, v104, v96 bitop3:0xfe
  v_bitop3_b32 v27, v27, v108, v100 bitop3:0xfe
  v_bitop3_b32 v27, v27, v27, v14 bitop3:0xa8
  v_cmp_ne_u32 vcc, 0, v27
  s_nop 1
  s_cbranch_vccnz L_retry_193
  s_branch L_ok_194
L_retry_193_to:
  s_mov_b32 s69, 0
  s_waitcnt vmcnt(0)
  s_branch L_ok_194
L_retry_236:
  s_sub_u32 s69, s69, 1
  s_cbranch_scc1 L_retry_236_to
  buffer_load_dwordx4 v[72:75], v1, s[4:7], s22 offen offset:0 sc1
  buffer_load_dwordx4 v[84:87], v1, s[4:7], s22 offen offset:3072 sc1
  buffer_load_dwordx4 v[76:79], v1, s[4:7], s22 offen offset:1024 sc1
  buffer_load_dwordx4 v[88:91], v1, s[4:7], s30 offen offset:0 sc1
  buffer_load_dwordx4 v[80:83], v1, s[4:7], s22 offen offset:2048 sc1
  s_waitcnt vmcnt(0)
  v_bitop3_b32 v27, v72, v84, v76 bitop3:0x80
  v_bitop3_b32 v27, v27, v88, v80 bitop3:0x80
  v_bitop3_b32 v27, v27, v27, v14 bitop3:0x2a
  v_cmp_ne_u32 vcc, 0, v27
  s_nop 1
  s_cbranch_vccnz L_retry_236
  v_bitop3_b32 v27, v112, v114, v92 bitop3:0x80
  v_bitop3_b32 v27, v27, v104, v96 bitop3:0x80
  v_bitop3_b32 v27, v27, v108, v14 bitop3:0x2a
  v_cmp_ne_u32 vcc, 0, v27
  s_nop 1
  s_cbranch_vccz L_ok_237
  buffer_load_dwordx2 v[112:113], v15, s[4:7], s56 offen offset:0 sc1
  buffer_load_dwordx2 v[114:115], v15, s[4:7], s56 offen offset:512 sc1
  buffer_load_dwordx4 v[92:95], v1, s[4:7], s23 offen offset:0 sc1
  buffer_load_dwordx4 v[104:107], v1, s[4:7], s23 offen offset:3072 sc1
  buffer_load_dwordx4 v[96:99], v1, s[4:7], s23 offen offset:1024 sc1
  buffer_load_dwordx4 v[108:111], v1, s[4:7], s31 offen offset:0 sc1
  s_branch L_ok_237
L_retry_236_to:
  s_mov_b32 s69, 0
  s_waitcnt vmcnt(0)
  s_branch L_ok_237
L_retry_240:
  s_sub_u32 s69, s69, 1
  s_cbranch_scc1 L_retry_240_to
  buffer_load_dwordx4 v[92:95], v1, s[4:7], s23 offen offset:0 sc1
  buffer_load_dwordx4 v[104:107], v1, s[4:7], s23 offen offset:3072 sc1
  buffer_load_dwordx4 v[96:99], v1, s[4:7], s23 offen offset:1024 sc1
  buffer_load_dwordx4 v[108:111], v1, s[4:7], s31 offen offset:0 sc1
  buffer_load_dwordx4 v[100:103], v1, s[4:7], s23 offen offset:2048 sc1
  s_waitcnt vmcnt(0)
  v_bitop3_b32 v27, v92, v104, v96 bitop3:0x80
  v_bitop3_b32 v27, v27, v108, v100 bitop3:0x80
  v_bitop3_b32 v27, v27, v27, v14 bitop3:0x2a
  v_cmp_ne_u32 vcc, 0, v27
  s_nop 1
  s_cbranch_vccnz L_retry_240
  s_branch L_ok_241
L_retry_240_to:
  s_mov_b32 s69, 0
  s_waitcnt vmcnt(0)
  s_branch L_ok_241
L_retry_242:
  s_sub_u32 s69, s69, 1
  s_cbranch_scc1 L_retry_242_to
  buffer_load_dwordx4 v[112:115], v1, s[4:7], s36 offen offset:0 sc1
  buffer_load_dwordx4 v[116:119], v1, s[4:7], s36 offen offset:1024 sc1
  buffer_load_dwordx4 v[120:123], v1, s[4:7], s37 offen offset:2048 sc1
  buffer_load_dwordx4 v[124:127], v1, s[4:7], s37 offen offset:3072 sc1
  s_waitcnt vmcnt(0)
  v_bitop3_b32 v27, v112, v116, v120 bitop3:0x80
  v_bitop3_b32 v27, v27, v124, v14 bitop3:0x2a
  v_cmp_ne_u32 vcc, 0, v27
  s_nop 1
  s_cbranch_vccnz L_retry_242
  v_bitop3_b32 v27, v32, v36, v14 bitop3:0x2a
  v_cmp_ne_u32 vcc, 0, v27
  s_nop 1
  s_cbranch_vccz L_ok_243
  buffer_load_dwordx4 v[32:35], v1, s[4:7], s39 offen offset:0 sc1
  buffer_load_dwordx4 v[36:39], v1, s[4:7], s39 offen offset:1024 sc1
  s_branch L_ok_243
L_retry_242_to:
  s_mov_b32 s69, 0
  s_waitcnt vmcnt(0)
  s_branch L_ok_243
L_retry_244:
  s_sub_u32 s69, s69, 1
  s_cbranch_scc1 L_retry_244_to
  buffer_load_dwordx4 v[32:35], v1, s[4:7], s39 offen offset:0 sc1
  buffer_load_dwordx4 v[36:39], v1, s[4:7], s39 offen offset:1024 sc1
  buffer_load_dwordx4 v[40:43], v1, s[4:7], s40 offen offset:2048 sc1
  buffer_load_dwordx4 v[44:47], v1, s[4:7], s40 offen offset:3072 sc1
  s_waitcnt vmcnt(0)
  v_bitop3_b32 v27, v32, v36, v40 bitop3:0x80
  v_bitop3_b32 v27, v27, v44, v14 bitop3:0x2a
  v_cmp_ne_u32 vcc, 0, v27
  s_nop 1
  s_cbranch_vccnz L_retry_244
  v_bitop3_b32 v27, v48, v52, v56 bitop3:0x80
  v_bitop3_b32 v27, v27, v60, v64 bitop3:0x80
  v_bitop3_b32 v27, v27, v68, v72 bitop3:0x80
  v_bitop3_b32 v27, v27, v76, v80 bitop3:0x80
  v_bitop3_b32 v27, v27, v84, v88 bitop3:0x80
  v_bitop3_b32 v27, v27, v27, v14 bitop3:0x2a
  v_cmp_ne_u32 vcc, 0, v27
  s_nop 1
  s_cbranch_vccz L_ok_245
  buffer_load_dwordx4 v[48:51], v1, s[4:7], s42 offen offset:0 sc1
  buffer_load_dwordx4 v[52:55], v1, s[4:7], s42 offen offset:1024 sc1
  buffer_load_dwordx4 v[56:59], v1, s[4:7], s43 offen offset:2048 sc1
  buffer_load_dwordx4 v[60:63], v1, s[4:7], s43 offen offset:3072 sc1
  buffer_load_dwordx4 v[64:67], v1, s[4:7], s45 offen offset:0 sc1
  buffer_load_dwordx4 v[68:71], v1, s[4:7], s45 offen offset:1024 sc1
  buffer_load_dwordx4 v[72:75], v1, s[4:7], s46 offen offset:2048 sc1
  buffer_load_dwordx4 v[76:79], v1, s[4:7], s46 offen offset:3072 sc1
  buffer_load_dwordx4 v[80:83], v1, s[4:7], s36 offen offset:2048 sc1
  buffer_load_dwordx4 v[84:87], v1, s[4:7], s36 offen offset:3072 sc1
  buffer_load_dwordx4 v[88:91], v1, s[4:7], s38 offen offset:0 sc1
  s_branch L_ok_245
L_retry_244_to:
  s_mov_b32 s69, 0
  s_waitcnt vmcnt(0)
  s_branch L_ok_245
L_retry_246:
  s_sub_u32 s69, s69, 1
  s_cbranch_scc1 L_retry_246_to
  buffer_load_dwordx4 v[48:51], v1, s[4:7], s42 offen offset:0 sc1
  buffer_load_dwordx4 v[52:55], v1, s[4:7], s42 offen offset:1024 sc1
  buffer_load_dwordx4 v[56:59], v1, s[4:7], s43 offen offset:2048 sc1
  buffer_load_dwordx4 v[60:63], v1, s[4:7], s43 offen offset:3072 sc1
  s_waitcnt vmcnt(0)
  v_bitop3_b32 v27, v48, v52, v56 bitop3:0x80
  v_bitop3_b32 v27, v27, v60, v14 bitop3:0x2a
  v_cmp_ne_u32 vcc, 0, v27
  s_nop 1
  s_cbranch_vccnz L_retry_246
  s_branch L_ok_247
L_retry_246_to:
  s_mov_b32 s69, 0
  s_waitcnt vmcnt(0)
  s_branch L_ok_247
L_retry_248:
  s_sub_u32 s69, s69, 1
  s_cbranch_scc1 L_retry_248_to
  buffer_load_dwordx4 v[64:67], v1, s[4:7], s45 offen offset:0 sc1
  buffer_load_dwordx4 v[68:71], v1, s[4:7], s45 offen offset:1024 sc1
  buffer_load_dwordx4 v[72:75], v1, s[4:7], s46 offen offset:2048 sc1
  buffer_load_dwordx4 v[76:79], v1, s[4:7], s46 offen offset:3072 sc1
  s_waitcnt vmcnt(0)
  v_bitop3_b32 v27, v64, v68, v72 bitop3:0x80
  v_bitop3_b32 v27, v27, v76, v14 bitop3:0x2a
  v_cmp_ne_u32 vcc, 0, v27
  s_nop 1
  s_cbranch_vccnz L_retry_248
  v_bitop3_b32 v27, v80, v84, v88 bitop3:0x80
  v_bitop3_b32 v27, v27, v92, v96 bitop3:0x80
  v_bitop3_b32 v27, v27, v100, v104 bitop3:0x80
  v_bitop3_b32 v27, v27, v108, v112 bitop3:0x80
  v_bitop3_b32 v27, v27, v116, v120 bitop3:0x80
  v_bitop3_b32 v27, v27, v124, v32 bitop3:0x80
  v_bitop3_b32 v27, v27, v36, v14 bitop3:0x2a
  v_cmp_ne_u32 vcc, 0, v27
  s_nop 1
  s_cbranch_vccz L_ok_249
  buffer_load_dwordx4 v[80:83], v1, s[4:7], s36 offen offset:2048 sc1
  buffer_load_dwordx4 v[84:87], v1, s[4:7], s36 offen offset:3072 sc1
  buffer_load_dwordx4 v[88:91], v1, s[4:7], s38 offen offset:0 sc1
  buffer_load_dwordx4 v[92:95], v1, s[4:7], s38 offen offset:1024 sc1
  buffer_load_dwordx4 v[96:99], v1, s[4:7], s39 offen offset:2048 sc1
  buffer_load_dwordx4 v[100:103], v1, s[4:7], s39 offen offset:3072 sc1
  buffer_load_dword a253, v26, s[4:7], s76 offen
  buffer_load_dwordx4 v[104:107], v1, s[4:7], s41 offen offset:0 sc1
  buffer_load_dwordx4 v[108:111], v1, s[4:7], s41 offen offset:1024 sc1
  buffer_load_dwordx4 v[112:115], v1, s[4:7], s42 offen offset:2048 sc1
  buffer_load_dwordx4 v[116:119], v1, s[4:7], s42 offen offset:3072 sc1
  buffer_load_dwordx4 v[120:123], v1, s[4:7], s44 offen offset:0 sc1
  buffer_load_dwordx4 v[124:127], v1, s[4:7], s44 offen offset:1024 sc1
  buffer_load_dword a253, v26, s[4:7], s76 offen
  buffer_load_dwordx4 v[32:35], v1, s[4:7], s45 offen offset:2048 sc1
  buffer_load_dwordx4 v[36:39], v1, s[4:7], s45 offen offset:3072 sc1
  s_branch L_ok_249
L_retry_248_to:
  s_mov_b32 s69, 0
  s_waitcnt vmcnt(0)
  s_branch L_ok_249
L_retry_250:
  s_sub_u32 s69, s69, 1
  s_cbranch_scc1 L_retry_250_to
  buffer_load_dwordx4 v[80:83], v1, s[4:7], s36 offen offset:2048 sc1
  buffer_load_dwordx4 v[84:87], v1, s[4:7], s36 offen offset:3072 sc1
  buffer_load_dwordx4 v[88:91], v1, s[4:7], s38 offen offset:0 sc1
  buffer_load_dwordx4 v[92:95], v1, s[4:7], s38 offen offset:1024 sc1
  s_waitcnt vmcnt(0)
  v_bitop3_b32 v27, v80, v84, v88 bitop3:0x80
  v_bitop3_b32 v27, v27, v92, v14 bitop3:0x2a
  v_cmp_ne_u32 vcc, 0, v27
  s_nop 1
  s_cbranch_vccnz L_retry_250
  v_bitop3_b32 v27, v96, v100, v104 bitop3:0x80
  v_bitop3_b32 v27, v27, v108, v112 bitop3:0x80
  v_bitop3_b32 v27, v27, v116, v120 bitop3:0x80
  v_bitop3_b32 v27, v27, v124, v32 bitop3:0x80
  v_bitop3_b32 v27, v27, v36, v40 bitop3:0x80
  v_bitop3_b32 v27, v27, v27, v14 bitop3:0x2a
  v_cmp_ne_u32 vcc, 0, v27
  s_nop 1
  s_cbranch_vccz L_ok_251
  buffer_load_dwordx4 v[96:99], v1, s[4:7], s39 offen offset:2048 sc1
  buffer_load_dwordx4 v[100:103], v1, s[4:7], s39 offen offset:3072 sc1
  buffer_load_dword a253, v26, s[4:7], s76 offen
  buffer_load_dwordx4 v[104:107], v1, s[4:7], s41 offen offset:0 sc1
  buffer_load_dwordx4 v[108:111], v1, s[4:7], s41 offen offset:1024 sc1
  buffer_load_dwordx4 v[112:115], v1, s[4:7], s42 offen offset:2048 sc1
  buffer_load_dwordx4 v[116:119], v1, s[4:7], s42 offen offset:3072 sc1
  buffer_load_dwordx4 v[120:123], v1, s[4:7], s44 offen offset:0 sc1
  buffer_load_dwordx4 v[124:127], v1, s[4:7], s44 offen offset:1024 sc1
  buffer_load_dword a253, v26, s[4:7], s76 offen
  buffer_load_dwordx4 v[32:35], v1, s[4:7], s45 offen offset:2048 sc1
  buffer_load_dwordx4 v[36:39], v1, s[4:7], s45 offen offset:3072 sc1
  buffer_load_dwordx4 v[40:43], v1, s[4:7], s47 offen offset:0 sc1
  s_branch L_ok_251
L_retry_250_to:
  s_mov_b32 s69, 0
  s_waitcnt vmcnt(0)
  s_branch L_ok_251
L_retry_252:
  s_sub_u32 s69, s69, 1
  s_cbranch_scc1 L_retry_252_to
  buffer_load_dwordx4 v[96:99], v1, s[4:7], s39 offen offset:2048 sc1
  buffer_load_dwordx4 v[100:103], v1, s[4:7], s39 offen offset:3072 sc1
  buffer_load_dwordx4 v[104:107], v1, s[4:7], s41 offen offset:0 sc1
  buffer_load_dwordx4 v[108:111], v1, s[4:7], s41 offen offset:1024 sc1
  s_waitcnt vmcnt(0)
  v_bitop3_b32 v27, v96, v100, v104 bitop3:0x80
  v_bitop3_b32 v27, v27, v108, v14 bitop3:0x2a
  v_cmp_ne_u32 vcc, 0, v27
  s_nop 1
  s_cbranch_vccnz L_retry_252
  v_bitop3_b32 v27, v112, v116, v120 bitop3:0x80
  v_bitop3_b32 v27, v27, v124, v32 bitop3:0x80
  v_bitop3_b32 v27, v27, v36, v40 bitop3:0x80
  v_bitop3_b32 v27, v27, v44, v48 bitop3:0x80
  v_bitop3_b32 v27, v27, v27, v14 bitop3:0x2a
  v_cmp_ne_u32 vcc, 0, v27
  s_nop 1
  s_cbranch_vccz L_ok_253
  buffer_load_dwordx4 v[112:115], v1, s[4:7], s42 offen offset:2048 sc1
  buffer_load_dwordx4 v[116:119], v1, s[4:7], s42 offen offset:3072 sc1
  buffer_load_dwordx4 v[120:123], v1, s[4:7], s44 offen offset:0 sc1
  buffer_load_dwordx4 v[124:127], v1, s[4:7], s44 offen offset:1024 sc1
  buffer_load_dword a253, v26, s[4:7], s76 offen
  buffer_load_dwordx4 v[32:35], v1, s[4:7], s45 offen offset:2048 sc1
  buffer_load_dwordx4 v[36:39], v1, s[4:7], s45 offen offset:3072 sc1
  buffer_load_dwordx4 v[40:43], v1, s[4:7], s47 offen offset:0 sc1
  buffer_load_dwordx4 v[44:47], v1, s[4:7], s47 offen offset:1024 sc1
  buffer_load_dword a253, v26, s[4:7], s76 offen
  buffer_load_dword a253, v26, s[4:7], s76 offen
  buffer_load_dwordx4 v[48:51], v1, s[4:7], s37 offen offset:0 sc1
  s_branch L_ok_253
L_retry_252_to:
  s_mov_b32 s69, 0
  s_waitcnt vmcnt(0)
  s_branch L_ok_253
L_retry_254:
  s_sub_u32 s69, s69, 1
  s_cbranch_scc1 L_retry_254_to
  buffer_load_dwordx4 v[112:115], v1, s[4:7], s42 offen offset:2048 sc1
  buffer_load_dwordx4 v[116:119], v1, s[4:7], s42 offen offset:3072 sc1
  buffer_load_dwordx4 v[120:123], v1, s[4:7], s44 offen offset:0 sc1
  buffer_load_dwordx4 v[124:127], v1, s[4:7], s44 offen offset:1024 sc1
  s_waitcnt vmcnt(0)
  v_bitop3_b32 v27, v112, v116, v120 bitop3:0x80
  v_bitop3_b32 v27, v27, v124, v14 bitop3:0x2a
  v_cmp_ne_u32 vcc, 0, v27
  s_nop 1
  s_cbranch_vccnz L_retry_254
  v_bitop3_b32 v27, v32, v36, v40 bitop3:0x80
  v_bitop3_b32 v27, v27, v44, v48 bitop3:0x80
  v_bitop3_b32 v27, v27, v27, v14 bitop3:0x2a
  v_cmp_ne_u32 vcc, 0, v27
  s_nop 1
  s_cbranch_vccz L_ok_255
  buffer_load_dwordx4 v[32:35], v1, s[4:7], s45 offen offset:2048 sc1
  buffer_load_dwordx4 v[36:39], v1, s[4:7], s45 offen offset:3072 sc1
  buffer_load_dwordx4 v[40:43], v1, s[4:7], s47 offen offset:0 sc1
  buffer_load_dwordx4 v[44:47], v1, s[4:7], s47 offen offset:1024 sc1
  buffer_load_dword a253, v26, s[4:7], s76 offen
  buffer_load_dword a253, v26, s[4:7], s76 offen
  buffer_load_dwordx4 v[48:51], v1, s[4:7], s37 offen offset:0 sc1
  buffer_load_dword a253, v26, s[4:7], s76 offen
  buffer_load_dword a253, v26, s[4:7], s76 offen
  buffer_load_dword a253, v26, s[4:7], s76 offen
  buffer_load_dword a253, v26, s[4:7], s76 offen
  s_branch L_ok_255
L_retry_254_to:
  s_mov_b32 s69, 0
  s_waitcnt vmcnt(0)
  s_branch L_ok_255
L_retry_256:
  s_sub_u32 s69, s69, 1
  s_cbranch_scc1 L_retry_256_to
  buffer_load_dwordx4 v[32:35], v1, s[4:7], s45 offen offset:2048 sc1
  buffer_load_dwordx4 v[36:39], v1, s[4:7], s45 offen offset:3072 sc1
  buffer_load_dwordx4 v[40:43], v1, s[4:7], s47 offen offset:0 sc1
  buffer_load_dwordx4 v[44:47], v1, s[4:7], s47 offen offset:1024 sc1
  s_waitcnt vmcnt(0)
  v_bitop3_b32 v27, v32, v36, v40 bitop3:0x80
  v_bitop3_b32 v27, v27, v44, v14 bitop3:0x2a
  v_cmp_ne_u32 vcc, 0, v27
  s_nop 1
  s_cbranch_vccnz L_retry_256
  v_bitop3_b32 v27, v48, v52, v56 bitop3:0x80
  v_bitop3_b32 v27, v27, v60, v14 bitop3:0x2a
  v_cmp_ne_u32 vcc, 0, v27
  s_nop 1
  s_cbranch_vccz L_ok_257
  buffer_load_dwordx4 v[48:51], v1, s[4:7], s37 offen offset:0 sc1
  buffer_load_dword a253, v26, s[4:7], s76 offen
  buffer_load_dword a253, v26, s[4:7], s76 offen
  buffer_load_dword a253, v26, s[4:7], s76 offen
  buffer_load_dword a253, v26, s[4:7], s76 offen
  buffer_load_dword a253, v26, s[4:7], s76 offen
  buffer_load_dword a253, v26, s[4:7], s76 offen
  buffer_load_dwordx4 v[52:55], v1, s[4:7], s37 offen offset:1024 sc1
  buffer_load_dwordx4 v[56:59], v1, s[4:7], s38 offen offset:2048 sc1
  buffer_load_dwordx4 v[60:63], v1, s[4:7], s38 offen offset:3072 sc1
  s_branch L_ok_257
L_retry_256_to:
  s_mov_b32 s69, 0
  s_waitcnt vmcnt(0)
  s_branch L_ok_257
L_retry_258:
  s_sub_u32 s69, s69, 1
  s_cbranch_scc1 L_retry_258_to
  buffer_load_dwordx4 v[48:51], v1, s[4:7], s37 offen offset:0 sc1
  buffer_load_dwordx4 v[52:55], v1, s[4:7], s37 offen offset:1024 sc1
  buffer_load_dwordx4 v[56:59], v1, s[4:7], s38 offen offset:2048 sc1
  buffer_load_dwordx4 v[60:63], v1, s[4:7], s38 offen offset:3072 sc1
  s_waitcnt vmcnt(0)
  v_bitop3_b32 v27, v48, v52, v56 bitop3:0x80
  v_bitop3_b32 v27, v27, v60, v14 bitop3:0x2a
  v_cmp_ne_u32 vcc, 0, v27
  s_nop 1
  s_cbranch_vccnz L_retry_258
  v_bitop3_b32 v27, v64, v68, v72 bitop3:0x80
  v_bitop3_b32 v27, v27, v27, v14 bitop3:0x2a
  v_cmp_ne_u32 vcc, 0, v27
  s_nop 1
  s_cbranch_vccz L_ok_259
  buffer_load_dwordx4 v[64:67], v1, s[4:7], s40 offen offset:0 sc1
  buffer_load_dword a253, v26, s[4:7], s76 offen
  buffer_load_dwordx4 v[68:71], v1, s[4:7], s40 offen offset:1024 sc1
  buffer_load_dwordx4 v[72:75], v1, s[4:7], s41 offen offset:2048 sc1
  buffer_load_dword a253, v26, s[4:7], s76 offen
  s_branch L_ok_259
L_retry_258_to:
  s_mov_b32 s69, 0
  s_waitcnt vmcnt(0)
  s_branch L_ok_259
L_retry_260:
  s_sub_u32 s69, s69, 1
  s_cbranch_scc1 L_retry_260_to
  buffer_load_dwordx4 v[64:67], v1, s[4:7], s40 offen offset:0 sc1
  buffer_load_dwordx4 v[68:71], v1, s[4:7], s40 offen offset:1024 sc1
  buffer_load_dwordx4 v[72:75], v1, s[4:7], s41 offen offset:2048 sc1
  buffer_load_dwordx4 v[76:79], v1, s[4:7], s41 offen offset:3072 sc1
  s_waitcnt vmcnt(0)
  v_bitop3_b32 v27, v64, v68, v72 bitop3:0x80
  v_bitop3_b32 v27, v27, v76, v14 bitop3:0x2a
  v_cmp_ne_u32 vcc, 0, v27
  s_nop 1
  s_cbranch_vccnz L_retry_260
  v_bitop3_b32 v27, v80, v84, v88 bitop3:0x80
  v_bitop3_b32 v27, v27, v92, v96 bitop3:0x80
  v_bitop3_b32 v27, v27, v100, v104 bitop3:0x80
  v_bitop3_b32 v27, v27, v108, v14 bitop3:0x2a
  v_cmp_ne_u32 vcc, 0, v27
  s_nop 1
  s_cbranch_vccz L_ok_261
  buffer_load_dwordx4 v[80:83], v1, s[4:7], s43 offen offset:0 sc1
  buffer_load_dwordx4 v[84:87], v1, s[4:7], s43 offen offset:1024 sc1
  buffer_load_dwordx4 v[88:91], v1, s[4:7], s44 offen offset:2048 sc1
  buffer_load_dwordx4 v[92:95], v1, s[4:7], s44 offen offset:3072 sc1
  buffer_load_dwordx4 v[96:99], v1, s[4:7], s46 offen offset:0 sc1
  buffer_load_dwordx4 v[100:103], v1, s[4:7], s46 offen offset:1024 sc1
  buffer_load_dwordx4 v[104:107], v1, s[4:7], s47 offen offset:2048 sc1
  buffer_load_dwordx4 v[108:111], v1, s[4:7], s47 offen offset:3072 sc1
  s_branch L_ok_261
L_retry_260_to:
  s_mov_b32 s69, 0
  s_waitcnt vmcnt(0)
  s_branch L_ok_261
L_retry_262:
  s_sub_u32 s69, s69, 1
  s_cbranch_scc1 L_retry_262_to
  buffer_load_dwordx4 v[80:83], v1, s[4:7], s43 offen offset:0 sc1
  buffer_load_dwordx4 v[84:87], v1, s[4:7], s43 offen offset:1024 sc1
  buffer_load_dwordx4 v[88:91], v1, s[4:7], s44 offen offset:2048 sc1
  buffer_load_dwordx4 v[92:95], v1, s[4:7], s44 offen offset:3072 sc1
  s_waitcnt vmcnt(0)
  v_bitop3_b32 v27, v80, v84, v88 bitop3:0x80
  v_bitop3_b32 v27, v27, v92, v14 bitop3:0x2a
  v_cmp_ne_u32 vcc, 0, v27
  s_nop 1
  s_cbranch_vccnz L_retry_262
  v_bitop3_b32 v27, v96, v100, v104 bitop3:0x80
  v_bitop3_b32 v27, v27, v108, v14 bitop3:0x2a
  v_cmp_ne_u32 vcc, 0, v27
  s_nop 1
  s_cbranch_vccz L_ok_263
  buffer_load_dwordx4 v[96:99], v1, s[4:7], s46 offen offset:0 sc1
  buffer_load_dwordx4 v[100:103], v1, s[4:7], s46 offen offset:1024 sc1
  buffer_load_dwordx4 v[104:107], v1, s[4:7], s47 offen offset:2048 sc1
  buffer_load_dwordx4 v[108:111], v1, s[4:7], s47 offen offset:3072 sc1
  s_branch L_ok_263
L_retry_262_to:
  s_mov_b32 s69, 0
  s_waitcnt vmcnt(0)
  s_branch L_ok_263
L_retry_264:
  s_sub_u32 s69, s69, 1
  s_cbranch_scc1 L_retry_264_to
  buffer_load_dwordx4 v[96:99], v1, s[4:7], s46 offen offset:0 sc1
  buffer_load_dwordx4 v[100:103], v1, s[4:7], s46 offen offset:1024 sc1
  buffer_load_dwordx4 v[104:107], v1, s[4:7], s47 offen offset:2048 sc1
  buffer_load_dwordx4 v[108:111], v1, s[4:7], s47 offen offset:3072 sc1
  s_waitcnt vmcnt(0)
  v_bitop3_b32 v27, v96, v100, v104 bitop3:0x80
  v_bitop3_b32 v27, v27, v108, v14 bitop3:0x2a
  v_cmp_ne_u32 vcc, 0, v27
  s_nop 1
  s_cbranch_vccnz L_retry_264
  s_branch L_ok_265
L_retry_264_to:
  s_mov_b32 s69, 0
  s_waitcnt vmcnt(0)
  s_branch L_ok_265
L_main_end:

.section .rodata,"a"
.p2align 6
.amdhsa_kernel interleave_layers__linear_kernel_hedgehog__mixer_s_mlp__prompt_kernel
  .amdhsa_next_free_vgpr 512
  .amdhsa_next_free_sgpr 102
  .amdhsa_accum_offset 256
  .amdhsa_group_segment_fixed_size 0
  .amdhsa_kernarg_size 96
  .amdhsa_user_sgpr_count 2
  .amdhsa_user_sgpr_kernarg_segment_ptr 1
  .amdhsa_system_sgpr_workgroup_id_x 1
  .amdhsa_float_denorm_mode_32 3
.end_amdhsa_kernel
```
